```python
import torch

def _softmax(x, axis=-1):
    return torch.softmax(x, dim=axis)
def _gelu(x):
    return torch.nn.functional.gelu(x, approximate="tanh")
def _silu(x):
    return torch.nn.functional.silu(x)
def _sigmoid(x):
    return torch.sigmoid(x)
def _layernorm(x, axis=-1, eps=1e-5):
    m = x.mean(dim=axis, keepdim=True)
    v = x.var(dim=axis, keepdim=True, unbiased=False)
    return (x - m) / torch.sqrt(v + eps)
def _scatter_add(tgt, idx, src, axis=0):
    return tgt.clone().index_add_(axis, idx, src)
def _segment_sum(src, seg, n):
    out = torch.zeros((n,) + src.shape[1:], dtype=src.dtype)
    return out.index_add_(0, seg, src)
def _pad(x, pw):
    flat = tuple(v for pair in reversed(pw) for v in pair)
    return torch.nn.functional.pad(x, flat)

kernel_name = 'sequential_preLN__ssm_conv_h3__dense_activation_relu__prompt'

def setup_inputs():

    _w = (lambda a: (lambda t: t.to(torch.bfloat16) if t.is_floating_point() else t)(torch.as_tensor(a)))
    def _A_setup():
        B, S, D = 1, 2048, 576
        ks = 4
        return {
            "q": _w((lambda *s: torch.randn(*s, dtype=torch.bfloat16) * 0.05)(B, S, D)),
            "k": _w((lambda *s: torch.randn(*s, dtype=torch.bfloat16) * 0.4)(B, S, D)),
            "v": _w((lambda *s: torch.randn(*s, dtype=torch.bfloat16) * 0.4)(B, S, D)),
            "shift_k": _w((lambda *s: torch.randn(*s, dtype=torch.bfloat16) * 0.4)(D, ks) * 0.5),
            "ssm_k": _w((lambda *s: torch.randn(*s, dtype=torch.bfloat16) * 0.4)(D, S) * (1.0 / S ** 0.5)),
            "ssm_D": _w((lambda *s: torch.randn(*s, dtype=torch.bfloat16) * 0.4)(D)),
        }
    _A_in = _A_setup()

    def _B_setup():
        B, S, D, Dff = 1, 2048, 576, 4608
        return {
            "x": _w((lambda *s: torch.randn(*s, dtype=torch.bfloat16) * 0.05)(B, S, D)),
            "w1": _w((lambda *s: torch.randn(*s, dtype=torch.bfloat16) * 0.05)(D, Dff)),
            "w2": _w((lambda *s: torch.randn(*s, dtype=torch.bfloat16) * 0.05)(Dff, D)),
        }
    _B_in = _B_setup()

    return {
        "A_q": _A_in["q"],
        "A_k": _A_in["k"],
        "A_v": _A_in["v"],
        "A_shift_k": _A_in["shift_k"],
        "A_ssm_k": _A_in["ssm_k"],
        "A_ssm_D": _A_in["ssm_D"],
        "B_x": _B_in["x"],
        "B_w1": _B_in["w1"],
        "B_w2": _B_in["w2"],
    }

def reference(A_q, A_k, A_v, A_shift_k, A_ssm_k, A_ssm_D, B_x, B_w1, B_w2):
    def _A_ref(q, k, v, shift_k, ssm_k, ssm_D):
        B, S, D = q.shape
        ks = shift_k.shape[-1]
        k_pad = _pad(k, ((0, 0), (ks - 1, 0), (0, 0)))
        k_shift = torch.zeros_like(k)
        for t in range(ks):
            k_shift = k_shift + k_pad[:, t:t + S, :] * shift_k[:, ks - 1 - t][None, None, :]
        kv = k_shift * v
        L = 2 * S
        kv_pad = _pad(kv, ((0, 0), (0, S), (0, 0)))
        kf_pad = _pad(ssm_k, ((0, 0), (0, S)))
        kv_f = (lambda x, axes=(-2,-1): torch.fft.rfft2(x.float(), dim=axes))(kv_pad[:, None, :, :], axes=(1, 2))
        kf_f = (lambda x, axes=(-2,-1): torch.fft.rfft2(x.float(), dim=axes))(kf_pad[:, None, :], axes=(1, 2))
        kf_f = (lambda x, *d: x.permute(*d))(kf_f, 1, 2, 0)
        y_f = kv_f * kf_f[None, :, :, :]
        y = (lambda x, s, axes=(-2,-1): torch.fft.irfft2(x, s=s, dim=axes).to(torch.bfloat16))(y_f, (1, L), axes=(1, 2))[:, 0, :S, :]
        y = y + kv * ssm_D[None, None, :]
        return q * y

    def _B_ref(x, w1, w2):
        h = torch.einsum("bsd,df->bsf", x, w1)
        zero = torch.zeros_like(h)
        h = torch.maximum(h, zero)
        return torch.einsum("bsf,fd->bsd", h, w2)

    x = A_q
    h = x + _A_ref(_layernorm(x, axis=-1), A_k, A_v, A_shift_k, A_ssm_k, A_ssm_D)
    h2 = h + _B_ref(_layernorm(h, axis=-1), B_w1, B_w2)
    return h2
```

```asm
; @launch grid=(256,1,1) block=(256,1,1) lds=163392
.amdgcn_target "amdgcn-amd-amdhsa--gfx950"
.text
.globl sequential_preLN__ssm_conv_h3__dense_activation_relu__prompt_kernel
.p2align 8
.type sequential_preLN__ssm_conv_h3__dense_activation_relu__prompt_kernel,@function
sequential_preLN__ssm_conv_h3__dense_activation_relu__prompt_kernel:
  s_cmp_ge_u32 s2, 256
  s_cbranch_scc1 L_end
  s_load_dwordx2 s[8:9], s[0:1], 8
  s_load_dwordx2 s[12:13], s[0:1], 16
  s_load_dwordx2 s[24:25], s[0:1], 24
  s_getpc_b64 s[60:61]
L_pc:
  s_lshr_b32 s33, s2, 3
  s_lshl_b32 s62, s33, 5
  v_lshrrev_b32 v18, 3, v0
  v_add_u32 v1, s62, v18
  v_min_u32 v1, 576, v1
  v_lshlrev_b32 v1, 7, v1
  global_load_dword v229, v1, s[60:61]
  v_lshrrev_b32 v1, 6, v0
  v_and_b32 v2, 63, v0
  v_readfirstlane_b32 s39, v1
  s_mov_b32 s10, 2359296
  s_mov_b32 s11, 0x20000
  s_mov_b32 s14, 2359296
  s_mov_b32 s15, 0x20000
  s_and_b32 s38, s2, 7
  s_lshl_b32 s44, s33, 6
  s_mul_i32 s45, s38, 144
  s_lshr_b32 s46, s39, 1
  s_and_b32 s47, s39, 1
  s_mul_i32 s48, s47, 320
  s_sub_u32 s49, s44, 4
  s_mul_i32 s50, s39, 5120
  s_add_u32 s50, s50, 131072
  v_mov_b32 v9, 0x80000000

  v_add_u32 v4, s48, v2
  v_mul_u32_u24 v5, 898, v4
  v_lshrrev_b32 v5, 16, v5
  v_mul_u32_u24 v6, 73, v5
  v_sub_u32 v6, v4, v6
  v_mul_u32_u24 v7, 7282, v6
  v_lshrrev_b32 v7, 16, v7
  v_mul_u32_u24 v8, 9, v7
  v_sub_u32 v8, v6, v8
  v_lshl_add_u32 v5, v5, 3, v7
  v_add_u32 v5, s49, v5
  v_cmp_gt_i32 vcc, 0, v5
  v_mul_u32_u24 v5, 1152, v5
  v_lshl_add_u32 v10, v8, 4, v5
  v_cndmask_b32 v10, v10, v9, vcc
  v_add_u32 v4, s48, v2
  v_add_u32 v4, 64, v4
  v_mul_u32_u24 v5, 898, v4
  v_lshrrev_b32 v5, 16, v5
  v_mul_u32_u24 v6, 73, v5
  v_sub_u32 v6, v4, v6
  v_mul_u32_u24 v7, 7282, v6
  v_lshrrev_b32 v7, 16, v7
  v_mul_u32_u24 v8, 9, v7
  v_sub_u32 v8, v6, v8
  v_lshl_add_u32 v5, v5, 3, v7
  v_add_u32 v5, s49, v5
  v_cmp_gt_i32 vcc, 0, v5
  v_mul_u32_u24 v5, 1152, v5
  v_lshl_add_u32 v11, v8, 4, v5
  v_cndmask_b32 v11, v11, v9, vcc
  v_add_u32 v4, s48, v2
  v_add_u32 v4, 128, v4
  v_mul_u32_u24 v5, 898, v4
  v_lshrrev_b32 v5, 16, v5
  v_mul_u32_u24 v6, 73, v5
  v_sub_u32 v6, v4, v6
  v_mul_u32_u24 v7, 7282, v6
  v_lshrrev_b32 v7, 16, v7
  v_mul_u32_u24 v8, 9, v7
  v_sub_u32 v8, v6, v8
  v_lshl_add_u32 v5, v5, 3, v7
  v_add_u32 v5, s49, v5
  v_cmp_gt_i32 vcc, 0, v5
  v_mul_u32_u24 v5, 1152, v5
  v_lshl_add_u32 v12, v8, 4, v5
  v_cndmask_b32 v12, v12, v9, vcc
  v_add_u32 v4, s48, v2
  v_add_u32 v4, 192, v4
  v_mul_u32_u24 v5, 898, v4
  v_lshrrev_b32 v5, 16, v5
  v_mul_u32_u24 v6, 73, v5
  v_sub_u32 v6, v4, v6
  v_mul_u32_u24 v7, 7282, v6
  v_lshrrev_b32 v7, 16, v7
  v_mul_u32_u24 v8, 9, v7
  v_sub_u32 v8, v6, v8
  v_lshl_add_u32 v5, v5, 3, v7
  v_add_u32 v5, s49, v5
  v_cmp_gt_i32 vcc, 0, v5
  v_mul_u32_u24 v5, 1152, v5
  v_lshl_add_u32 v13, v8, 4, v5
  v_cndmask_b32 v13, v13, v9, vcc
  v_add_u32 v4, s48, v2
  v_add_u32 v4, 256, v4
  v_mul_u32_u24 v5, 898, v4
  v_lshrrev_b32 v5, 16, v5
  v_mul_u32_u24 v6, 73, v5
  v_sub_u32 v6, v4, v6
  v_mul_u32_u24 v7, 7282, v6
  v_lshrrev_b32 v7, 16, v7
  v_mul_u32_u24 v8, 9, v7
  v_sub_u32 v8, v6, v8
  v_lshl_add_u32 v5, v5, 3, v7
  v_add_u32 v5, s49, v5
  v_cmp_gt_i32 vcc, 0, v5
  v_mul_u32_u24 v5, 1152, v5
  v_lshl_add_u32 v14, v8, 4, v5
  v_cndmask_b32 v14, v14, v9, vcc
  s_waitcnt lgkmcnt(0)
  s_cmp_eq_u32 s46, 0
  s_cselect_b32 s16, s8, s12
  s_cselect_b32 s17, s9, s13
  s_mov_b32 s18, 2359296
  s_mov_b32 s19, 0x20000
  s_add_u32 m0, s50, 0
  s_nop 0
  buffer_load_dwordx4 v10, s[16:19], s45 offen lds
  s_add_u32 m0, s50, 1024
  s_nop 0
  buffer_load_dwordx4 v11, s[16:19], s45 offen lds
  s_add_u32 m0, s50, 2048
  s_nop 0
  buffer_load_dwordx4 v12, s[16:19], s45 offen lds
  s_add_u32 m0, s50, 3072
  s_nop 0
  buffer_load_dwordx4 v13, s[16:19], s45 offen lds
  s_add_u32 m0, s50, 4096
  s_nop 0
  buffer_load_dwordx4 v14, s[16:19], s45 offen lds
  s_mov_b32 s26, 4608
  s_mov_b32 s27, 0x20000
  s_mul_i32 s46, s38, 576
  s_mul_i32 s47, s38, 589824
  v_lshlrev_b32 v22, 4, v18
  buffer_load_dwordx4 v[48:51], v22, s[24:27], s46 offen
  s_lshl_b32 s48, s39, 4
  s_add_u32 s48, s48, s46
  v_mov_b32 v22, 512
  buffer_load_dwordx4 v[84:87], v22, s[24:27], s48 offen
  s_load_dwordx16 s[64:79], s[0:1], 0
  s_load_dwordx8 s[80:87], s[0:1], 64
  s_memrealtime s[90:91]
  v_lshlrev_b32 v3, 4, v2
  s_mov_b32 s43, 0xffff0000
  v_and_b32 v17, 7, v0
  v_mul_u32_u24 v19, 1168, v17
  v_lshl_add_u32 v19, v18, 2, v19
  v_add_u32 v19, 131072, v19
  v_lshlrev_b32 v17, 3, v17
  v_add_u32 v17, s44, v17
  v_lshlrev_b32 v22, 14, v18
  v_lshlrev_b32 v23, 1, v17
  v_sub_u32 v23, 4080, v23
  v_add3_u32 v22, v22, v23, s47
  v_add_u32 v23, 8192, v22
  v_lshlrev_b32 v53, 1, v2
  s_lshl_b32 s48, s39, 2
  s_add_u32 s48, s48, 131200

  v_add_u32 v54, 0, v53
  v_lshrrev_b32 v58, 3, v54
  v_mul_u32_u24 v54, 144, v54
  v_lshl_add_u32 v54, v58, 4, v54
  v_add_u32 v55, s48, v54
  v_add_u32 v54, 2, v53
  v_lshrrev_b32 v58, 3, v54
  v_mul_u32_u24 v54, 144, v54
  v_lshl_add_u32 v54, v58, 4, v54
  v_add_u32 v56, s48, v54
  v_add_u32 v54, 4, v53
  v_lshrrev_b32 v58, 3, v54
  v_mul_u32_u24 v54, 144, v54
  v_lshl_add_u32 v54, v58, 4, v54
  v_add_u32 v57, s48, v54
  v_add_u32 v53, s44, v53
  s_add_u32 s48, s39, 32
  s_lshl_b32 s48, s48, 14
  s_add_u32 s48, s48, s47
  v_lshlrev_b32 v59, 1, v53
  v_sub_u32 v59, 4092, v59
  v_add_u32 v58, s48, v59
  v_add_u32 v59, 8192, v58

  s_waitcnt lgkmcnt(0)
  s_mov_b32 s16, s64
  s_mov_b32 s17, s65
  s_mov_b32 s18, 0x240000
  s_mov_b32 s19, 0x20000
  s_mov_b32 s20, s82
  s_mov_b32 s21, s83
  s_mov_b32 s22, 0x240000
  s_mov_b32 s23, 0x20000
  s_mov_b32 s28, s86
  s_mov_b32 s29, s87
  s_mov_b32 s30, 0x10000000
  s_mov_b32 s31, 0x20000
  s_mov_b32 s4, s84
  s_mov_b32 s5, s85
  s_mov_b32 s6, 0x100
  s_mov_b32 s7, 0x20000
  s_mov_b32 s92, s78
  s_mov_b32 s93, s79
  s_mov_b32 s94, s80
  s_mov_b32 s95, s81
  s_mov_b32 s96, s72
  s_mov_b32 s97, s73
  s_mov_b32 s98, s74
  s_mov_b32 s99, s75
  s_or_b32 s62, s2, s39
  s_cmp_lg_u32 s62, 0
  s_cbranch_scc1 L_nonce_skip
  s_and_b32 s62, s90, 0xfffffff0
  s_or_b32 s62, s62, 0x80000000
  v_mov_b32 v4, s62
  v_mov_b32 v5, 0
  s_mov_b64 exec, 1
  buffer_store_dword v4, v5, s[4:7], 0 offen sc1
  s_mov_b64 exec, -1
L_nonce_skip:

  s_and_b32 s32, s2, 3
  s_and_b32 s34, s33, 3
  s_lshr_b32 s35, s33, 2
  s_bfe_u32 s36, s2, 0x10002
  s_lshl_b32 s36, s36, 3
  s_add_u32 s35, s35, s36
  s_lshl_b32 s36, s32, 2
  s_add_u32 s36, s36, s34
  s_lshl_b32 s37, s35, 7
  s_lshl_b32 s40, s36, 3
  s_add_u32 s37, s37, s40
  s_mul_i32 s40, s39, 9216
  s_mul_i32 s41, s36, 331776
  s_add_u32 s41, s41, s40
  s_add_u32 s41, s41, 8388608
  s_add_u32 s42, s41, 6291456
  v_mov_b32 v5, 0
  buffer_load_dword v4, v5, s[4:7], 0 offen sc1

  s_waitcnt vmcnt(1)
  s_barrier
  ds_read_b32 v24, v19 offset:0
  ds_read_b32 v25, v19 offset:144
  ds_read_b32 v26, v19 offset:288
  ds_read_b32 v27, v19 offset:432
  ds_read_b32 v28, v19 offset:576
  ds_read_b32 v29, v19 offset:720
  ds_read_b32 v30, v19 offset:864
  ds_read_b32 v31, v19 offset:1008
  ds_read_b32 v32, v19 offset:1168
  ds_read_b32 v33, v19 offset:1312
  ds_read_b32 v34, v19 offset:1456
  ds_read_b32 v35, v19 offset:1600
  ds_read_b32 v36, v19 offset:10672
  ds_read_b32 v37, v19 offset:10816
  ds_read_b32 v38, v19 offset:10960
  ds_read_b32 v39, v19 offset:11104
  ds_read_b32 v40, v19 offset:11248
  ds_read_b32 v41, v19 offset:11408
  ds_read_b32 v42, v19 offset:11552
  ds_read_b32 v43, v19 offset:11696
  ds_read_b32 v44, v19 offset:11840
  ds_read_b32 v60, v55 offset:0
  ds_read_b32 v61, v55 offset:144
  ds_read_b32 v62, v56 offset:0
  ds_read_b32 v63, v56 offset:144
  ds_read_b32 v64, v57 offset:0
  ds_read_b32 v65, v57 offset:144
  ds_read_b32 v72, v56 offset:10384
  ds_read_b32 v73, v57 offset:10240
  ds_read_b32 v74, v57 offset:10384
  s_waitcnt lgkmcnt(9)
  v_lshlrev_b32 v100, 16, v48
  v_lshlrev_b32 v101, 16, v50
  v_and_b32 v102, s43, v48
  v_and_b32 v103, s43, v50
  v_lshlrev_b32 v104, 16, v49
  v_lshlrev_b32 v105, 16, v51
  v_and_b32 v106, s43, v49
  v_and_b32 v107, s43, v51
  v_lshlrev_b32 v108, 16, v24
  v_and_b32 v109, s43, v24
  v_lshlrev_b32 v110, 16, v25
  v_and_b32 v111, s43, v25
  v_lshlrev_b32 v112, 16, v26
  v_and_b32 v113, s43, v26
  v_lshlrev_b32 v114, 16, v27
  v_and_b32 v115, s43, v27
  v_lshlrev_b32 v116, 16, v28
  v_and_b32 v117, s43, v28
  v_lshlrev_b32 v118, 16, v29
  v_and_b32 v119, s43, v29
  v_lshlrev_b32 v120, 16, v30
  v_and_b32 v121, s43, v30
  v_lshlrev_b32 v122, 16, v31
  v_and_b32 v123, s43, v31
  v_lshlrev_b32 v124, 16, v32
  v_and_b32 v125, s43, v32
  v_lshlrev_b32 v126, 16, v33
  v_and_b32 v127, s43, v33
  v_lshlrev_b32 v128, 16, v34
  v_and_b32 v129, s43, v34
  v_lshlrev_b32 v130, 16, v35
  v_and_b32 v131, s43, v35
  v_lshlrev_b32 v132, 16, v36
  v_and_b32 v133, s43, v36
  v_lshlrev_b32 v134, 16, v37
  v_and_b32 v135, s43, v37
  v_lshlrev_b32 v136, 16, v38
  v_and_b32 v137, s43, v38
  v_lshlrev_b32 v138, 16, v39
  v_and_b32 v139, s43, v39
  v_lshlrev_b32 v140, 16, v40
  v_and_b32 v141, s43, v40
  v_lshlrev_b32 v142, 16, v41
  v_and_b32 v143, s43, v41
  v_lshlrev_b32 v144, 16, v42
  v_and_b32 v145, s43, v42
  v_lshlrev_b32 v146, 16, v43
  v_and_b32 v147, s43, v43
  v_lshlrev_b32 v148, 16, v44
  v_and_b32 v149, s43, v44
  v_pk_mul_f32 v[168:169], v[108:109], v[106:107]
  v_pk_mul_f32 v[180:181], v[110:111], v[106:107]
  v_pk_mul_f32 v[192:193], v[112:113], v[106:107]
  v_pk_mul_f32 v[170:171], v[110:111], v[104:105]
  v_pk_mul_f32 v[182:183], v[112:113], v[104:105]
  v_pk_mul_f32 v[194:195], v[114:115], v[104:105]
  v_pk_mul_f32 v[172:173], v[112:113], v[102:103]
  v_pk_mul_f32 v[184:185], v[114:115], v[102:103]
  v_pk_mul_f32 v[196:197], v[116:117], v[102:103]
  v_pk_mul_f32 v[174:175], v[114:115], v[100:101]
  v_pk_mul_f32 v[186:187], v[116:117], v[100:101]
  v_pk_mul_f32 v[198:199], v[118:119], v[100:101]
  v_cvt_pk_bf16_f32 v176, v168, v169
  v_cvt_pk_bf16_f32 v188, v180, v181
  v_cvt_pk_bf16_f32 v200, v192, v193
  v_cvt_pk_bf16_f32 v177, v170, v171
  v_cvt_pk_bf16_f32 v189, v182, v183
  v_cvt_pk_bf16_f32 v201, v194, v195
  v_cvt_pk_bf16_f32 v178, v172, v173
  v_cvt_pk_bf16_f32 v190, v184, v185
  v_cvt_pk_bf16_f32 v202, v196, v197
  v_cvt_pk_bf16_f32 v179, v174, v175
  v_cvt_pk_bf16_f32 v191, v186, v187
  v_cvt_pk_bf16_f32 v203, v198, v199
  v_lshlrev_b32 v168, 16, v176
  v_lshlrev_b32 v180, 16, v188
  v_lshlrev_b32 v192, 16, v200
  v_and_b32 v169, s43, v176
  v_and_b32 v181, s43, v188
  v_and_b32 v193, s43, v200
  v_lshlrev_b32 v170, 16, v177
  v_lshlrev_b32 v182, 16, v189
  v_lshlrev_b32 v194, 16, v201
  v_and_b32 v171, s43, v177
  v_and_b32 v183, s43, v189
  v_and_b32 v195, s43, v201
  v_lshlrev_b32 v172, 16, v178
  v_lshlrev_b32 v184, 16, v190
  v_lshlrev_b32 v196, 16, v202
  v_and_b32 v173, s43, v178
  v_and_b32 v185, s43, v190
  v_and_b32 v197, s43, v202
  v_lshlrev_b32 v174, 16, v179
  v_lshlrev_b32 v186, 16, v191
  v_lshlrev_b32 v198, 16, v203
  v_and_b32 v175, s43, v179
  v_and_b32 v187, s43, v191
  v_and_b32 v199, s43, v203
  v_pk_add_f32 v[168:169], v[168:169], v[170:171]
  v_pk_add_f32 v[180:181], v[180:181], v[182:183]
  v_pk_add_f32 v[192:193], v[192:193], v[194:195]
  v_cvt_pk_bf16_f32 v176, v168, v169
  v_cvt_pk_bf16_f32 v188, v180, v181
  v_cvt_pk_bf16_f32 v200, v192, v193
  v_lshlrev_b32 v168, 16, v176
  v_lshlrev_b32 v180, 16, v188
  v_lshlrev_b32 v192, 16, v200
  v_and_b32 v169, s43, v176
  v_and_b32 v181, s43, v188
  v_and_b32 v193, s43, v200
  v_pk_add_f32 v[168:169], v[168:169], v[172:173]
  v_pk_add_f32 v[180:181], v[180:181], v[184:185]
  v_pk_add_f32 v[192:193], v[192:193], v[196:197]
  v_cvt_pk_bf16_f32 v176, v168, v169
  v_cvt_pk_bf16_f32 v188, v180, v181
  v_cvt_pk_bf16_f32 v200, v192, v193
  v_lshlrev_b32 v168, 16, v176
  v_lshlrev_b32 v180, 16, v188
  v_lshlrev_b32 v192, 16, v200
  v_and_b32 v169, s43, v176
  v_and_b32 v181, s43, v188
  v_and_b32 v193, s43, v200
  v_pk_add_f32 v[168:169], v[168:169], v[174:175]
  v_pk_add_f32 v[180:181], v[180:181], v[186:187]
  v_pk_add_f32 v[192:193], v[192:193], v[198:199]
  v_cvt_pk_bf16_f32 v176, v168, v169
  v_cvt_pk_bf16_f32 v188, v180, v181
  v_cvt_pk_bf16_f32 v200, v192, v193
  v_lshlrev_b32 v168, 16, v176
  v_lshlrev_b32 v180, 16, v188
  v_lshlrev_b32 v192, 16, v200
  v_and_b32 v169, s43, v176
  v_and_b32 v181, s43, v188
  v_and_b32 v193, s43, v200
  v_pk_mul_f32 v[150:151], v[168:169], v[132:133]
  v_pk_mul_f32 v[152:153], v[180:181], v[134:135]
  v_pk_mul_f32 v[154:155], v[192:193], v[136:137]
  v_pk_mul_f32 v[168:169], v[114:115], v[106:107]
  v_pk_mul_f32 v[180:181], v[116:117], v[106:107]
  v_pk_mul_f32 v[192:193], v[118:119], v[106:107]
  v_pk_mul_f32 v[170:171], v[116:117], v[104:105]
  v_pk_mul_f32 v[182:183], v[118:119], v[104:105]
  v_pk_mul_f32 v[194:195], v[120:121], v[104:105]
  v_pk_mul_f32 v[172:173], v[118:119], v[102:103]
  v_pk_mul_f32 v[184:185], v[120:121], v[102:103]
  v_pk_mul_f32 v[196:197], v[122:123], v[102:103]
  v_pk_mul_f32 v[174:175], v[120:121], v[100:101]
  v_pk_mul_f32 v[186:187], v[122:123], v[100:101]
  v_pk_mul_f32 v[198:199], v[124:125], v[100:101]
  v_cvt_pk_bf16_f32 v176, v168, v169
  v_cvt_pk_bf16_f32 v188, v180, v181
  v_cvt_pk_bf16_f32 v200, v192, v193
  v_cvt_pk_bf16_f32 v177, v170, v171
  v_cvt_pk_bf16_f32 v189, v182, v183
  v_cvt_pk_bf16_f32 v201, v194, v195
  v_cvt_pk_bf16_f32 v178, v172, v173
  v_cvt_pk_bf16_f32 v190, v184, v185
  v_cvt_pk_bf16_f32 v202, v196, v197
  v_cvt_pk_bf16_f32 v179, v174, v175
  v_cvt_pk_bf16_f32 v191, v186, v187
  v_cvt_pk_bf16_f32 v203, v198, v199
  v_lshlrev_b32 v168, 16, v176
  v_lshlrev_b32 v180, 16, v188
  v_lshlrev_b32 v192, 16, v200
  v_and_b32 v169, s43, v176
  v_and_b32 v181, s43, v188
  v_and_b32 v193, s43, v200
  v_lshlrev_b32 v170, 16, v177
  v_lshlrev_b32 v182, 16, v189
  v_lshlrev_b32 v194, 16, v201
  v_and_b32 v171, s43, v177
  v_and_b32 v183, s43, v189
  v_and_b32 v195, s43, v201
  v_lshlrev_b32 v172, 16, v178
  v_lshlrev_b32 v184, 16, v190
  v_lshlrev_b32 v196, 16, v202
  v_and_b32 v173, s43, v178
  v_and_b32 v185, s43, v190
  v_and_b32 v197, s43, v202
  v_lshlrev_b32 v174, 16, v179
  v_lshlrev_b32 v186, 16, v191
  v_lshlrev_b32 v198, 16, v203
  v_and_b32 v175, s43, v179
  v_and_b32 v187, s43, v191
  v_and_b32 v199, s43, v203
  v_pk_add_f32 v[168:169], v[168:169], v[170:171]
  v_pk_add_f32 v[180:181], v[180:181], v[182:183]
  v_pk_add_f32 v[192:193], v[192:193], v[194:195]
  v_cvt_pk_bf16_f32 v176, v168, v169
  v_cvt_pk_bf16_f32 v188, v180, v181
  v_cvt_pk_bf16_f32 v200, v192, v193
  v_lshlrev_b32 v168, 16, v176
  v_lshlrev_b32 v180, 16, v188
  v_lshlrev_b32 v192, 16, v200
  v_and_b32 v169, s43, v176
  v_and_b32 v181, s43, v188
  v_and_b32 v193, s43, v200
  v_pk_add_f32 v[168:169], v[168:169], v[172:173]
  v_pk_add_f32 v[180:181], v[180:181], v[184:185]
  v_pk_add_f32 v[192:193], v[192:193], v[196:197]
  v_cvt_pk_bf16_f32 v176, v168, v169
  v_cvt_pk_bf16_f32 v188, v180, v181
  v_cvt_pk_bf16_f32 v200, v192, v193
  v_lshlrev_b32 v168, 16, v176
  v_lshlrev_b32 v180, 16, v188
  v_lshlrev_b32 v192, 16, v200
  v_and_b32 v169, s43, v176
  v_and_b32 v181, s43, v188
  v_and_b32 v193, s43, v200
  v_pk_add_f32 v[168:169], v[168:169], v[174:175]
  v_pk_add_f32 v[180:181], v[180:181], v[186:187]
  v_pk_add_f32 v[192:193], v[192:193], v[198:199]
  v_cvt_pk_bf16_f32 v176, v168, v169
  v_cvt_pk_bf16_f32 v188, v180, v181
  v_cvt_pk_bf16_f32 v200, v192, v193
  v_lshlrev_b32 v168, 16, v176
  v_lshlrev_b32 v180, 16, v188
  v_lshlrev_b32 v192, 16, v200
  v_and_b32 v169, s43, v176
  v_and_b32 v181, s43, v188
  v_and_b32 v193, s43, v200
  v_pk_mul_f32 v[156:157], v[168:169], v[138:139]
  v_pk_mul_f32 v[158:159], v[180:181], v[140:141]
  v_pk_mul_f32 v[160:161], v[192:193], v[142:143]
  v_pk_mul_f32 v[168:169], v[120:121], v[106:107]
  v_pk_mul_f32 v[180:181], v[122:123], v[106:107]
  v_pk_mul_f32 v[192:193], v[124:125], v[106:107]
  v_pk_mul_f32 v[170:171], v[122:123], v[104:105]
  v_pk_mul_f32 v[182:183], v[124:125], v[104:105]
  v_pk_mul_f32 v[194:195], v[126:127], v[104:105]
  v_pk_mul_f32 v[172:173], v[124:125], v[102:103]
  v_pk_mul_f32 v[184:185], v[126:127], v[102:103]
  v_pk_mul_f32 v[196:197], v[128:129], v[102:103]
  v_pk_mul_f32 v[174:175], v[126:127], v[100:101]
  v_pk_mul_f32 v[186:187], v[128:129], v[100:101]
  v_pk_mul_f32 v[198:199], v[130:131], v[100:101]
  v_cvt_pk_bf16_f32 v176, v168, v169
  v_cvt_pk_bf16_f32 v188, v180, v181
  v_cvt_pk_bf16_f32 v200, v192, v193
  v_cvt_pk_bf16_f32 v177, v170, v171
  v_cvt_pk_bf16_f32 v189, v182, v183
  v_cvt_pk_bf16_f32 v201, v194, v195
  v_cvt_pk_bf16_f32 v178, v172, v173
  v_cvt_pk_bf16_f32 v190, v184, v185
  v_cvt_pk_bf16_f32 v202, v196, v197
  v_cvt_pk_bf16_f32 v179, v174, v175
  v_cvt_pk_bf16_f32 v191, v186, v187
  v_cvt_pk_bf16_f32 v203, v198, v199
  v_lshlrev_b32 v168, 16, v176
  v_lshlrev_b32 v180, 16, v188
  v_lshlrev_b32 v192, 16, v200
  v_and_b32 v169, s43, v176
  v_and_b32 v181, s43, v188
  v_and_b32 v193, s43, v200
  v_lshlrev_b32 v170, 16, v177
  v_lshlrev_b32 v182, 16, v189
  v_lshlrev_b32 v194, 16, v201
  v_and_b32 v171, s43, v177
  v_and_b32 v183, s43, v189
  v_and_b32 v195, s43, v201
  v_lshlrev_b32 v172, 16, v178
  v_lshlrev_b32 v184, 16, v190
  v_lshlrev_b32 v196, 16, v202
  v_and_b32 v173, s43, v178
  v_and_b32 v185, s43, v190
  v_and_b32 v197, s43, v202
  v_lshlrev_b32 v174, 16, v179
  v_lshlrev_b32 v186, 16, v191
  v_lshlrev_b32 v198, 16, v203
  v_and_b32 v175, s43, v179
  v_and_b32 v187, s43, v191
  v_and_b32 v199, s43, v203
  v_pk_add_f32 v[168:169], v[168:169], v[170:171]
  v_pk_add_f32 v[180:181], v[180:181], v[182:183]
  v_pk_add_f32 v[192:193], v[192:193], v[194:195]
  v_cvt_pk_bf16_f32 v176, v168, v169
  v_cvt_pk_bf16_f32 v188, v180, v181
  v_cvt_pk_bf16_f32 v200, v192, v193
  v_lshlrev_b32 v168, 16, v176
  v_lshlrev_b32 v180, 16, v188
  v_lshlrev_b32 v192, 16, v200
  v_and_b32 v169, s43, v176
  v_and_b32 v181, s43, v188
  v_and_b32 v193, s43, v200
  v_pk_add_f32 v[168:169], v[168:169], v[172:173]
  v_pk_add_f32 v[180:181], v[180:181], v[184:185]
  v_pk_add_f32 v[192:193], v[192:193], v[196:197]
  v_cvt_pk_bf16_f32 v176, v168, v169
  v_cvt_pk_bf16_f32 v188, v180, v181
  v_cvt_pk_bf16_f32 v200, v192, v193
  v_lshlrev_b32 v168, 16, v176
  v_lshlrev_b32 v180, 16, v188
  v_lshlrev_b32 v192, 16, v200
  v_and_b32 v169, s43, v176
  v_and_b32 v181, s43, v188
  v_and_b32 v193, s43, v200
  v_pk_add_f32 v[168:169], v[168:169], v[174:175]
  v_pk_add_f32 v[180:181], v[180:181], v[186:187]
  v_pk_add_f32 v[192:193], v[192:193], v[198:199]
  v_cvt_pk_bf16_f32 v176, v168, v169
  v_cvt_pk_bf16_f32 v188, v180, v181
  v_cvt_pk_bf16_f32 v200, v192, v193
  v_lshlrev_b32 v168, 16, v176
  v_lshlrev_b32 v180, 16, v188
  v_lshlrev_b32 v192, 16, v200
  v_and_b32 v169, s43, v176
  v_and_b32 v181, s43, v188
  v_and_b32 v193, s43, v200
  v_pk_mul_f32 v[162:163], v[168:169], v[144:145]
  v_pk_mul_f32 v[164:165], v[180:181], v[146:147]
  v_pk_mul_f32 v[166:167], v[192:193], v[148:149]
  v_cvt_pk_bf16_f32 v24, v164, v162
  v_cvt_pk_bf16_f32 v25, v160, v158
  v_cvt_pk_bf16_f32 v26, v156, v154
  v_cvt_pk_bf16_f32 v27, v152, v150
  v_cvt_pk_bf16_f32 v28, v166, v164
  v_cvt_pk_bf16_f32 v29, v162, v160
  v_cvt_pk_bf16_f32 v30, v158, v156
  v_cvt_pk_bf16_f32 v31, v154, v152
  v_cvt_pk_bf16_f32 v32, v165, v163
  v_cvt_pk_bf16_f32 v33, v161, v159
  v_cvt_pk_bf16_f32 v34, v157, v155
  v_cvt_pk_bf16_f32 v35, v153, v151
  v_cvt_pk_bf16_f32 v36, v167, v165
  v_cvt_pk_bf16_f32 v37, v163, v161
  v_cvt_pk_bf16_f32 v38, v159, v157
  v_cvt_pk_bf16_f32 v39, v155, v153
  s_mov_b32 s48, 0
  buffer_store_dwordx4 v[24:27], v22, s[28:31], s48 offen sc1
  s_mov_b32 s48, 4096
  buffer_store_dwordx4 v[28:31], v22, s[28:31], s48 offen sc1
  s_mov_b32 s48, 0
  buffer_store_dwordx4 v[32:35], v23, s[28:31], s48 offen sc1
  s_mov_b32 s48, 4096
  buffer_store_dwordx4 v[36:39], v23, s[28:31], s48 offen sc1
  s_waitcnt lgkmcnt(0)
  s_mov_b32 exec_hi, 0
  v_lshlrev_b32 v100, 16, v84
  v_lshlrev_b32 v101, 16, v86
  v_and_b32 v102, s43, v84
  v_and_b32 v103, s43, v86
  v_lshlrev_b32 v104, 16, v85
  v_lshlrev_b32 v105, 16, v87
  v_and_b32 v106, s43, v85
  v_and_b32 v107, s43, v87
  v_lshlrev_b32 v108, 16, v60
  v_and_b32 v109, s43, v60
  v_lshlrev_b32 v110, 16, v61
  v_and_b32 v111, s43, v61
  v_lshlrev_b32 v112, 16, v62
  v_and_b32 v113, s43, v62
  v_lshlrev_b32 v114, 16, v63
  v_and_b32 v115, s43, v63
  v_lshlrev_b32 v116, 16, v64
  v_and_b32 v117, s43, v64
  v_lshlrev_b32 v118, 16, v65
  v_and_b32 v119, s43, v65
  v_lshlrev_b32 v132, 16, v72
  v_and_b32 v133, s43, v72
  v_lshlrev_b32 v134, 16, v73
  v_and_b32 v135, s43, v73
  v_lshlrev_b32 v136, 16, v74
  v_and_b32 v137, s43, v74
  v_pk_mul_f32 v[168:169], v[108:109], v[106:107]
  v_pk_mul_f32 v[180:181], v[110:111], v[106:107]
  v_pk_mul_f32 v[192:193], v[112:113], v[106:107]
  v_pk_mul_f32 v[170:171], v[110:111], v[104:105]
  v_pk_mul_f32 v[182:183], v[112:113], v[104:105]
  v_pk_mul_f32 v[194:195], v[114:115], v[104:105]
  v_pk_mul_f32 v[172:173], v[112:113], v[102:103]
  v_pk_mul_f32 v[184:185], v[114:115], v[102:103]
  v_pk_mul_f32 v[196:197], v[116:117], v[102:103]
  v_pk_mul_f32 v[174:175], v[114:115], v[100:101]
  v_pk_mul_f32 v[186:187], v[116:117], v[100:101]
  v_pk_mul_f32 v[198:199], v[118:119], v[100:101]
  v_cvt_pk_bf16_f32 v176, v168, v169
  v_cvt_pk_bf16_f32 v188, v180, v181
  v_cvt_pk_bf16_f32 v200, v192, v193
  v_cvt_pk_bf16_f32 v177, v170, v171
  v_cvt_pk_bf16_f32 v189, v182, v183
  v_cvt_pk_bf16_f32 v201, v194, v195
  v_cvt_pk_bf16_f32 v178, v172, v173
  v_cvt_pk_bf16_f32 v190, v184, v185
  v_cvt_pk_bf16_f32 v202, v196, v197
  v_cvt_pk_bf16_f32 v179, v174, v175
  v_cvt_pk_bf16_f32 v191, v186, v187
  v_cvt_pk_bf16_f32 v203, v198, v199
  v_lshlrev_b32 v168, 16, v176
  v_lshlrev_b32 v180, 16, v188
  v_lshlrev_b32 v192, 16, v200
  v_and_b32 v169, s43, v176
  v_and_b32 v181, s43, v188
  v_and_b32 v193, s43, v200
  v_lshlrev_b32 v170, 16, v177
  v_lshlrev_b32 v182, 16, v189
  v_lshlrev_b32 v194, 16, v201
  v_and_b32 v171, s43, v177
  v_and_b32 v183, s43, v189
  v_and_b32 v195, s43, v201
  v_lshlrev_b32 v172, 16, v178
  v_lshlrev_b32 v184, 16, v190
  v_lshlrev_b32 v196, 16, v202
  v_and_b32 v173, s43, v178
  v_and_b32 v185, s43, v190
  v_and_b32 v197, s43, v202
  v_lshlrev_b32 v174, 16, v179
  v_lshlrev_b32 v186, 16, v191
  v_lshlrev_b32 v198, 16, v203
  v_and_b32 v175, s43, v179
  v_and_b32 v187, s43, v191
  v_and_b32 v199, s43, v203
  v_pk_add_f32 v[168:169], v[168:169], v[170:171]
  v_pk_add_f32 v[180:181], v[180:181], v[182:183]
  v_pk_add_f32 v[192:193], v[192:193], v[194:195]
  v_cvt_pk_bf16_f32 v176, v168, v169
  v_cvt_pk_bf16_f32 v188, v180, v181
  v_cvt_pk_bf16_f32 v200, v192, v193
  v_lshlrev_b32 v168, 16, v176
  v_lshlrev_b32 v180, 16, v188
  v_lshlrev_b32 v192, 16, v200
  v_and_b32 v169, s43, v176
  v_and_b32 v181, s43, v188
  v_and_b32 v193, s43, v200
  v_pk_add_f32 v[168:169], v[168:169], v[172:173]
  v_pk_add_f32 v[180:181], v[180:181], v[184:185]
  v_pk_add_f32 v[192:193], v[192:193], v[196:197]
  v_cvt_pk_bf16_f32 v176, v168, v169
  v_cvt_pk_bf16_f32 v188, v180, v181
  v_cvt_pk_bf16_f32 v200, v192, v193
  v_lshlrev_b32 v168, 16, v176
  v_lshlrev_b32 v180, 16, v188
  v_lshlrev_b32 v192, 16, v200
  v_and_b32 v169, s43, v176
  v_and_b32 v181, s43, v188
  v_and_b32 v193, s43, v200
  v_pk_add_f32 v[168:169], v[168:169], v[174:175]
  v_pk_add_f32 v[180:181], v[180:181], v[186:187]
  v_pk_add_f32 v[192:193], v[192:193], v[198:199]
  v_cvt_pk_bf16_f32 v176, v168, v169
  v_cvt_pk_bf16_f32 v188, v180, v181
  v_cvt_pk_bf16_f32 v200, v192, v193
  v_lshlrev_b32 v168, 16, v176
  v_lshlrev_b32 v180, 16, v188
  v_lshlrev_b32 v192, 16, v200
  v_and_b32 v169, s43, v176
  v_and_b32 v181, s43, v188
  v_and_b32 v193, s43, v200
  v_pk_mul_f32 v[150:151], v[168:169], v[132:133]
  v_pk_mul_f32 v[152:153], v[180:181], v[134:135]
  v_pk_mul_f32 v[154:155], v[192:193], v[136:137]
  v_cvt_pk_bf16_f32 v60, v152, v150
  v_cvt_pk_bf16_f32 v64, v154, v152
  v_cvt_pk_bf16_f32 v68, v153, v151
  v_cvt_pk_bf16_f32 v72, v155, v153
  s_mov_b32 s48, 0
  buffer_store_dword v60, v58, s[28:31], s48 offen sc1
  s_mov_b32 s48, 4096
  buffer_store_dword v64, v58, s[28:31], s48 offen sc1
  s_mov_b32 s48, 0
  buffer_store_dword v68, v59, s[28:31], s48 offen sc1
  s_mov_b32 s48, 4096
  buffer_store_dword v72, v59, s[28:31], s48 offen sc1
  s_mov_b32 exec_hi, -1
L_kvd:
  v_and_b32 v9, 7, v2
  v_lshrrev_b32 v10, 3, v2
  v_mul_u32_u24 v13, 1152, v9
  v_lshl_add_u32 v13, v10, 4, v13
  v_lshlrev_b32 v12, 3, v9
  v_add_u32 v12, 112640, v12
  s_lshl_b32 s47, s39, 6
  v_add_u32 v11, s47, v12
  s_mul_i32 s46, s37, 1152
  s_mul_i32 s47, s39, 384
  s_add_u32 s46, s46, s47

  s_min_u32 s47, s39, 2
  s_mul_i32 s47, s47, 384
  s_mul_i32 s46, s37, 1152
  s_add_u32 s46, s46, s47
  buffer_load_dwordx4 v[232:235], v13, s[16:19], s46 offen offset:0
  buffer_load_dwordx4 v[236:239], v13, s[16:19], s46 offen offset:128
  buffer_load_dwordx4 v[240:243], v13, s[16:19], s46 offen offset:256
  s_cmp_ge_u32 s33, 24
  s_cbranch_scc1 L_sec_pack
  s_cmp_ge_u32 s33, 24
  s_cbranch_scc1 L_nok_1
  s_mov_b32 s24, s96
  s_mov_b32 s25, s97
  s_mov_b32 s26, 0x240000
  s_mov_b32 s27, 0x20000
  s_mul_i32 s48, s38, 72
  s_mul_i32 s49, s33, 3
  s_add_u32 s48, s48, s49
  s_mul_i32 s49, s39, 4160
  s_lshl_b32 s50, s39, 2
  s_add_u32 s51, s48, 0
  s_lshl_b32 s51, s51, 12
  s_add_u32 s51, s51, s50
  s_add_u32 s51, s51, 4
  s_add_u32 m0, s49, 64
  s_nop 0
  buffer_load_dwordx4 v3, s[24:27], s51 offen offset:0 lds
  buffer_load_dwordx4 v3, s[24:27], s51 offen offset:1024 lds
  buffer_load_dwordx4 v3, s[24:27], s51 offen offset:2048 lds
  buffer_load_dwordx4 v3, s[24:27], s51 offen offset:3072 lds
  s_add_u32 s51, s48, 1
  s_lshl_b32 s51, s51, 12
  s_add_u32 s51, s51, s50
  s_add_u32 s51, s51, 4
  s_add_u32 m0, s49, 25856
  s_nop 0
  buffer_load_dwordx4 v3, s[24:27], s51 offen offset:0 lds
  buffer_load_dwordx4 v3, s[24:27], s51 offen offset:1024 lds
  buffer_load_dwordx4 v3, s[24:27], s51 offen offset:2048 lds
  buffer_load_dwordx4 v3, s[24:27], s51 offen offset:3072 lds
  s_add_u32 s51, s48, 2
  s_lshl_b32 s51, s51, 12
  s_add_u32 s51, s51, s50
  s_add_u32 s51, s51, 4
  s_add_u32 m0, s49, 51648
  s_nop 0
  buffer_load_dwordx4 v3, s[24:27], s51 offen offset:0 lds
  buffer_load_dwordx4 v3, s[24:27], s51 offen offset:1024 lds
  buffer_load_dwordx4 v3, s[24:27], s51 offen offset:2048 lds
  buffer_load_dwordx4 v3, s[24:27], s51 offen offset:3072 lds
  s_min_u32 s49, s39, 2
  v_lshrrev_b32 v220, 4, v2
  v_and_b32 v221, 15, v2
  v_add_u32 v222, v220, v221
  v_subrev_u32 v222, 15, v222
  v_lshlrev_b32 v223, 2, v222
  v_cmp_gt_i32 vcc, 0, v222
  v_mov_b32 v224, 0x80000000
  s_nop 1
  v_cndmask_b32 v223, v223, v224, vcc
  s_add_u32 s51, s48, s49
  s_lshl_b32 s51, s51, 12
  buffer_load_dword v225, v223, s[24:27], s51 offen
  s_mul_i32 s49, s49, 25792
  v_mul_u32_u24 v220, 4160, v220
  v_lshl_add_u32 v220, v221, 2, v220
  v_add_u32 v220, s49, v220
  v_mov_b32 v226, 0
  v_mov_b32 v227, 0
  v_lshlrev_b32 v228, 3, v2
  v_add_u32 v228, s49, v228
  v_cmp_gt_u32 vcc, 56, v2
  s_and_saveexec_b64 s[50:51], vcc
  ds_write_b64 v228, v[226:227] offset:20736
  ds_write_b64 v228, v[226:227] offset:25312
  s_mov_b64 exec, s[50:51]

L_nok_1:
  s_waitcnt vmcnt(16)
  s_branch L_sec_done
L_sec_pack:
  s_waitcnt vmcnt(3)
L_sec_done:
  s_mov_b32 s58, 0
L_nonce_chk:
  v_readfirstlane_b32 s88, v4
  s_nop 3
  s_cmp_lg_u32 s88, 0
  s_cbranch_scc1 L_nonce_ok
  s_add_u32 s58, s58, 1
  s_cmp_gt_u32 s58, 20000
  s_cbranch_scc1 L_nonce_ok
  s_sleep 1
  buffer_load_dword v4, v5, s[4:7], 0 offen sc1
  s_waitcnt vmcnt(0)
  s_branch L_nonce_chk
L_nonce_ok:
  s_xor_b32 s89, s88, 0x5bd1e995
  s_lshl_b32 s48, s38, 5
  s_add_u32 s48, s48, s33
  s_lshl_b32 s48, s48, 2
  s_add_u32 s48, s48, s39
  s_lshl_b32 s48, s48, 3
  s_add_u32 s48, s48, 83886080

  s_add_u32 s61, s88, 1
  v_mov_b32 v6, s61
  v_mov_b32 v7, s89
  s_mov_b64 exec, 1
  buffer_store_dwordx2 v[6:7], v5, s[28:31], s48 offen sc1
  s_mov_b64 exec, -1
  s_lshl_b32 s48, s35, 2
  s_add_u32 s48, s48, s32
  s_lshl_b32 s48, s48, 2
  s_add_u32 s48, s48, s39
  s_lshl_b32 s48, s48, 7
  s_add_u32 s48, s48, 83951616
  buffer_load_dword v230, v5, s[28:31], s48 offen sc1
  s_lshl_b32 s48, s35, 2
  s_add_u32 s48, s48, s34
  s_lshl_b32 s48, s48, 2
  s_add_u32 s48, s48, s39
  s_lshl_b32 s48, s48, 7
  s_add_u32 s48, s48, 83984384
  buffer_load_dword v230, v5, s[28:31], s48 offen sc1
  s_lshl_b32 s48, s35, 2
  s_add_u32 s48, s48, s39
  s_lshl_b32 s48, s48, 7
  s_add_u32 s48, s48, 83914752
  buffer_load_dword v230, v5, s[28:31], s48 offen sc1
  s_lshl_b32 s48, s38, 11
  s_and_b32 s49, s33, 15
  s_lshl_b32 s49, s49, 7
  s_add_u32 s48, s48, s49
  s_add_u32 s48, s48, 84017152
  buffer_load_dword v230, v5, s[28:31], s48 offen sc1

  s_cmp_ge_u32 s33, 24
  s_cbranch_scc1 L_pack
  s_mov_b32 s4, s98
  s_mov_b32 s5, s99
  s_mov_b32 s6, 0x480
  s_mov_b32 s7, 0x20000
  s_mul_i32 s48, s38, 72
  s_mul_i32 s49, s33, 3
  s_add_u32 s48, s48, s49
  s_lshl_b32 s49, s48, 1
  buffer_load_ushort v24, v5, s[4:7], s49 offen
  buffer_load_ushort v25, v5, s[4:7], s49 offen offset:2
  buffer_load_ushort v26, v5, s[4:7], s49 offen offset:4
  s_cmp_eq_u32 s39, 3
  s_cbranch_scc1 L_cw3

  s_waitcnt vmcnt(21)
  v_lshlrev_b32 v120, 16, v232
  v_and_b32 v121, s43, v232
  v_lshlrev_b32 v122, 16, v233
  v_and_b32 v123, s43, v233
  v_lshlrev_b32 v124, 16, v234
  v_and_b32 v125, s43, v234
  v_lshlrev_b32 v126, 16, v235
  v_and_b32 v127, s43, v235
  v_lshlrev_b32 v128, 16, v236
  v_and_b32 v129, s43, v236
  v_lshlrev_b32 v130, 16, v237
  v_and_b32 v131, s43, v237
  v_lshlrev_b32 v132, 16, v238
  v_and_b32 v133, s43, v238
  v_lshlrev_b32 v134, 16, v239
  v_and_b32 v135, s43, v239
  v_lshlrev_b32 v136, 16, v240
  v_and_b32 v137, s43, v240
  v_lshlrev_b32 v138, 16, v241
  v_and_b32 v139, s43, v241
  v_lshlrev_b32 v140, 16, v242
  v_and_b32 v141, s43, v242
  v_lshlrev_b32 v142, 16, v243
  v_and_b32 v143, s43, v243
  v_pk_add_f32 v[150:151], v[120:121], v[122:123]
  v_pk_add_f32 v[152:153], v[124:125], v[126:127]
  v_pk_add_f32 v[150:151], v[150:151], v[128:129]
  v_pk_add_f32 v[152:153], v[152:153], v[130:131]
  v_pk_add_f32 v[150:151], v[150:151], v[132:133]
  v_pk_add_f32 v[152:153], v[152:153], v[134:135]
  v_pk_add_f32 v[150:151], v[150:151], v[136:137]
  v_pk_add_f32 v[152:153], v[152:153], v[138:139]
  v_pk_add_f32 v[150:151], v[150:151], v[140:141]
  v_pk_add_f32 v[152:153], v[152:153], v[142:143]
  v_pk_add_f32 v[150:151], v[150:151], v[152:153]
  v_add_f32 v150, v150, v151
  v_mul_f32 v154, 0x3d2aaaab, v150
  v_sub_f32 v150, 0, v154
  v_sub_f32 v151, 0, v154
  v_pk_add_f32 v[160:161], v[120:121], v[150:151]
  v_pk_add_f32 v[162:163], v[122:123], v[150:151]
  v_pk_mul_f32 v[156:157], v[160:161], v[160:161]
  v_pk_mul_f32 v[158:159], v[162:163], v[162:163]
  v_pk_add_f32 v[160:161], v[124:125], v[150:151]
  v_pk_add_f32 v[162:163], v[126:127], v[150:151]
  v_pk_fma_f32 v[156:157], v[160:161], v[160:161], v[156:157]
  v_pk_fma_f32 v[158:159], v[162:163], v[162:163], v[158:159]
  v_pk_add_f32 v[160:161], v[128:129], v[150:151]
  v_pk_add_f32 v[162:163], v[130:131], v[150:151]
  v_pk_fma_f32 v[156:157], v[160:161], v[160:161], v[156:157]
  v_pk_fma_f32 v[158:159], v[162:163], v[162:163], v[158:159]
  v_pk_add_f32 v[160:161], v[132:133], v[150:151]
  v_pk_add_f32 v[162:163], v[134:135], v[150:151]
  v_pk_fma_f32 v[156:157], v[160:161], v[160:161], v[156:157]
  v_pk_fma_f32 v[158:159], v[162:163], v[162:163], v[158:159]
  v_pk_add_f32 v[160:161], v[136:137], v[150:151]
  v_pk_add_f32 v[162:163], v[138:139], v[150:151]
  v_pk_fma_f32 v[156:157], v[160:161], v[160:161], v[156:157]
  v_pk_fma_f32 v[158:159], v[162:163], v[162:163], v[158:159]
  v_pk_add_f32 v[160:161], v[140:141], v[150:151]
  v_pk_add_f32 v[162:163], v[142:143], v[150:151]
  v_pk_fma_f32 v[156:157], v[160:161], v[160:161], v[156:157]
  v_pk_fma_f32 v[158:159], v[162:163], v[162:163], v[158:159]
  v_add_f32 v156, v156, v157
  v_add_f32 v158, v158, v159
  v_add_f32 v155, v156, v158
  s_nop 1
  v_mov_b32_dpp v156, v154 row_ror:8 row_mask:0xf bank_mask:0xf
  v_mov_b32_dpp v157, v155 row_ror:8 row_mask:0xf bank_mask:0xf
  v_sub_f32 v160, v154, v156
  v_add_f32 v154, v154, v156
  v_add_f32 v155, v155, v157
  v_mul_f32 v160, v160, v160
  v_mul_f32 v154, 0.5, v154
  v_fmac_f32 v155, 0x41400000, v160
  v_mov_b32 v156, v154
  v_mov_b32 v157, v154
  v_mov_b32 v158, v155
  v_mov_b32 v159, v155
  s_nop 1
  v_permlane16_swap_b32 v156, v157
  v_permlane16_swap_b32 v158, v159
  s_nop 1
  v_sub_f32 v160, v156, v157
  v_add_f32 v154, v156, v157
  v_add_f32 v155, v158, v159
  v_mul_f32 v160, v160, v160
  v_mul_f32 v154, 0.5, v154
  v_fmac_f32 v155, 0x41c00000, v160
  v_mov_b32 v156, v154
  v_mov_b32 v157, v154
  v_mov_b32 v158, v155
  v_mov_b32 v159, v155
  s_nop 1
  v_permlane32_swap_b32 v156, v157
  v_permlane32_swap_b32 v158, v159
  s_nop 1
  v_sub_f32 v160, v156, v157
  v_add_f32 v154, v156, v157
  v_add_f32 v155, v158, v159
  v_mul_f32 v160, v160, v160
  v_mul_f32 v154, 0.5, v154
  v_fmac_f32 v155, 0x42400000, v160
  ds_write_b64 v11, v[154:155] offset:0
  s_waitcnt lgkmcnt(0)
  s_barrier
  ds_read_b64 v[156:157], v12 offset:0
  ds_read_b64 v[158:159], v12 offset:64
  ds_read_b64 v[160:161], v12 offset:128
  s_waitcnt lgkmcnt(0)
  v_add_f32 v154, v156, v158
  v_add_f32 v155, v157, v159
  v_add_f32 v154, v154, v160
  v_add_f32 v155, v155, v161
  v_mul_f32 v154, 0x3eaaaaab, v154
  v_sub_f32 v156, v156, v154
  v_sub_f32 v158, v158, v154
  v_sub_f32 v160, v160, v154
  v_mul_f32 v156, v156, v156
  v_fmac_f32 v156, v158, v158
  v_fmac_f32 v156, v160, v160
  v_fmac_f32 v155, 0x43400000, v156
  v_mul_f32 v155, 0x3ae38e39, v155
  v_cvt_pk_bf16_f32 v154, v154, v154
  v_lshlrev_b32 v154, 16, v154
  v_cvt_pk_bf16_f32 v155, v155, v155
  v_lshlrev_b32 v155, 16, v155
  v_add_f32 v155, 0x37280000, v155
  v_cvt_pk_bf16_f32 v155, v155, v155
  v_lshlrev_b32 v155, 16, v155
  v_sqrt_f32 v155, v155
  s_nop 0
  v_cvt_pk_bf16_f32 v155, v155, v155
  v_lshlrev_b32 v155, 16, v155
  v_rcp_f32 v152, v155
  v_sub_f32 v150, 0, v154
  v_sub_f32 v151, 0, v154
  s_nop 0
  v_mov_b32 v153, v152
  v_pk_add_f32 v[170:171], v[120:121], v[150:151]
  v_pk_add_f32 v[174:175], v[122:123], v[150:151]
  v_pk_add_f32 v[178:179], v[124:125], v[150:151]
  v_pk_add_f32 v[182:183], v[126:127], v[150:151]
  v_cvt_pk_bf16_f32 v172, v170, v171
  v_cvt_pk_bf16_f32 v176, v174, v175
  v_cvt_pk_bf16_f32 v180, v178, v179
  v_cvt_pk_bf16_f32 v184, v182, v183
  v_lshlrev_b32 v170, 16, v172
  v_lshlrev_b32 v174, 16, v176
  v_lshlrev_b32 v178, 16, v180
  v_lshlrev_b32 v182, 16, v184
  v_and_b32 v171, s43, v172
  v_and_b32 v175, s43, v176
  v_and_b32 v179, s43, v180
  v_and_b32 v183, s43, v184
  v_pk_mul_f32 v[170:171], v[170:171], v[152:153]
  v_pk_mul_f32 v[174:175], v[174:175], v[152:153]
  v_pk_mul_f32 v[178:179], v[178:179], v[152:153]
  v_pk_mul_f32 v[182:183], v[182:183], v[152:153]
  v_cvt_pk_bf16_f32 v244, v170, v171
  v_cvt_pk_bf16_f32 v245, v174, v175
  v_cvt_pk_bf16_f32 v246, v178, v179
  v_cvt_pk_bf16_f32 v247, v182, v183
  v_pk_add_f32 v[170:171], v[128:129], v[150:151]
  v_pk_add_f32 v[174:175], v[130:131], v[150:151]
  v_pk_add_f32 v[178:179], v[132:133], v[150:151]
  v_pk_add_f32 v[182:183], v[134:135], v[150:151]
  v_cvt_pk_bf16_f32 v172, v170, v171
  v_cvt_pk_bf16_f32 v176, v174, v175
  v_cvt_pk_bf16_f32 v180, v178, v179
  v_cvt_pk_bf16_f32 v184, v182, v183
  v_lshlrev_b32 v170, 16, v172
  v_lshlrev_b32 v174, 16, v176
  v_lshlrev_b32 v178, 16, v180
  v_lshlrev_b32 v182, 16, v184
  v_and_b32 v171, s43, v172
  v_and_b32 v175, s43, v176
  v_and_b32 v179, s43, v180
  v_and_b32 v183, s43, v184
  v_pk_mul_f32 v[170:171], v[170:171], v[152:153]
  v_pk_mul_f32 v[174:175], v[174:175], v[152:153]
  v_pk_mul_f32 v[178:179], v[178:179], v[152:153]
  v_pk_mul_f32 v[182:183], v[182:183], v[152:153]
  v_cvt_pk_bf16_f32 v248, v170, v171
  v_cvt_pk_bf16_f32 v249, v174, v175
  v_cvt_pk_bf16_f32 v250, v178, v179
  v_cvt_pk_bf16_f32 v251, v182, v183
  v_pk_add_f32 v[170:171], v[136:137], v[150:151]
  v_pk_add_f32 v[174:175], v[138:139], v[150:151]
  v_pk_add_f32 v[178:179], v[140:141], v[150:151]
  v_pk_add_f32 v[182:183], v[142:143], v[150:151]
  v_cvt_pk_bf16_f32 v172, v170, v171
  v_cvt_pk_bf16_f32 v176, v174, v175
  v_cvt_pk_bf16_f32 v180, v178, v179
  v_cvt_pk_bf16_f32 v184, v182, v183
  v_lshlrev_b32 v170, 16, v172
  v_lshlrev_b32 v174, 16, v176
  v_lshlrev_b32 v178, 16, v180
  v_lshlrev_b32 v182, 16, v184
  v_and_b32 v171, s43, v172
  v_and_b32 v175, s43, v176
  v_and_b32 v179, s43, v180
  v_and_b32 v183, s43, v184
  v_pk_mul_f32 v[170:171], v[170:171], v[152:153]
  v_pk_mul_f32 v[174:175], v[174:175], v[152:153]
  v_pk_mul_f32 v[178:179], v[178:179], v[152:153]
  v_pk_mul_f32 v[182:183], v[182:183], v[152:153]
  v_cvt_pk_bf16_f32 v252, v170, v171
  v_cvt_pk_bf16_f32 v253, v174, v175
  v_cvt_pk_bf16_f32 v254, v178, v179
  v_cvt_pk_bf16_f32 v255, v182, v183
  s_waitcnt vmcnt(0)
  ds_write_b32 v220, v225
  s_branch L_cwd
L_cw3:
  s_barrier
  s_lshl_b32 s49, s38, 10
  s_add_u32 s49, s49, 83886080

  buffer_load_dwordx4 v[224:227], v3, s[28:31], s49 offen offset:0 sc1
  s_waitcnt vmcnt(0)
  s_mov_b32 s58, 0
  s_add_u32 s59, s88, 1
  s_mov_b64 s[60:61], -1
  v_subrev_u32 v20, s59, v224
  v_cmp_gt_u32 vcc, 15, v20
  v_cmp_eq_u32 s[62:63], s89, v225
  s_nop 1
  s_and_b64 vcc, vcc, s[62:63]
  s_and_b64 s[60:61], s[60:61], vcc
  v_subrev_u32 v20, s59, v226
  v_cmp_gt_u32 vcc, 15, v20
  v_cmp_eq_u32 s[62:63], s89, v227
  s_nop 1
  s_and_b64 vcc, vcc, s[62:63]
  s_and_b64 s[60:61], s[60:61], vcc
  s_cmp_eq_u64 s[60:61], -1
  s_cbranch_scc1 L_pfa_ok
  buffer_load_dwordx4 v[224:227], v3, s[28:31], s49 offen offset:0 sc1
  s_sleep 4
  buffer_load_dwordx4 v[16:19], v3, s[28:31], s49 offen offset:0 sc1
L_pfa_chk:
  s_waitcnt vmcnt(1)
  s_mov_b64 s[60:61], -1
  v_subrev_u32 v20, s59, v224
  v_cmp_gt_u32 vcc, 15, v20
  v_cmp_eq_u32 s[62:63], s89, v225
  s_nop 1
  s_and_b64 vcc, vcc, s[62:63]
  s_and_b64 s[60:61], s[60:61], vcc
  v_subrev_u32 v20, s59, v226
  v_cmp_gt_u32 vcc, 15, v20
  v_cmp_eq_u32 s[62:63], s89, v227
  s_nop 1
  s_and_b64 vcc, vcc, s[62:63]
  s_and_b64 s[60:61], s[60:61], vcc
  s_cmp_eq_u64 s[60:61], -1
  s_cbranch_scc1 L_pfa_ok
  buffer_load_dwordx4 v[224:227], v3, s[28:31], s49 offen offset:0 sc1
  s_waitcnt vmcnt(1)
  s_mov_b64 s[60:61], -1
  v_subrev_u32 v20, s59, v16
  v_cmp_gt_u32 vcc, 15, v20
  v_cmp_eq_u32 s[62:63], s89, v17
  s_nop 1
  s_and_b64 vcc, vcc, s[62:63]
  s_and_b64 s[60:61], s[60:61], vcc
  v_subrev_u32 v20, s59, v18
  v_cmp_gt_u32 vcc, 15, v20
  v_cmp_eq_u32 s[62:63], s89, v19
  s_nop 1
  s_and_b64 vcc, vcc, s[62:63]
  s_and_b64 s[60:61], s[60:61], vcc
  s_cmp_eq_u64 s[60:61], -1
  s_cbranch_scc1 L_pfa_ok
  buffer_load_dwordx4 v[16:19], v3, s[28:31], s49 offen offset:0 sc1
  s_add_u32 s58, s58, 1
  s_cmp_gt_u32 s58, 20000
  s_cbranch_scc0 L_pfa_chk
L_pfa_ok:
  s_add_u32 s52, s48, 0
  s_lshl_b32 s52, s52, 13
  s_add_u32 s52, s52, 0
  s_mov_b32 m0, 16640
  s_nop 0
  buffer_load_dwordx4 v3, s[28:31], s52 offen offset:0 sc1 lds
  buffer_load_dwordx4 v3, s[28:31], s52 offen offset:1024 sc1 lds
  buffer_load_dwordx4 v3, s[28:31], s52 offen offset:2048 sc1 lds
  buffer_load_dwordx4 v3, s[28:31], s52 offen offset:3072 sc1 lds
  s_add_u32 s52, s48, 0
  s_lshl_b32 s52, s52, 13
  s_add_u32 s52, s52, 4096
  s_mov_b32 m0, 21216
  s_nop 0
  buffer_load_dwordx4 v3, s[28:31], s52 offen offset:0 sc1 lds
  buffer_load_dwordx4 v3, s[28:31], s52 offen offset:1024 sc1 lds
  buffer_load_dwordx4 v3, s[28:31], s52 offen offset:2048 sc1 lds
  buffer_load_dwordx4 v3, s[28:31], s52 offen offset:3072 sc1 lds
  s_add_u32 s52, s48, 1
  s_lshl_b32 s52, s52, 13
  s_add_u32 s52, s52, 0
  s_mov_b32 m0, 42432
  s_nop 0
  buffer_load_dwordx4 v3, s[28:31], s52 offen offset:0 sc1 lds
  buffer_load_dwordx4 v3, s[28:31], s52 offen offset:1024 sc1 lds
  buffer_load_dwordx4 v3, s[28:31], s52 offen offset:2048 sc1 lds
  buffer_load_dwordx4 v3, s[28:31], s52 offen offset:3072 sc1 lds
  s_add_u32 s52, s48, 1
  s_lshl_b32 s52, s52, 13
  s_add_u32 s52, s52, 4096
  s_mov_b32 m0, 47008
  s_nop 0
  buffer_load_dwordx4 v3, s[28:31], s52 offen offset:0 sc1 lds
  buffer_load_dwordx4 v3, s[28:31], s52 offen offset:1024 sc1 lds
  buffer_load_dwordx4 v3, s[28:31], s52 offen offset:2048 sc1 lds
  buffer_load_dwordx4 v3, s[28:31], s52 offen offset:3072 sc1 lds
  s_add_u32 s52, s48, 2
  s_lshl_b32 s52, s52, 13
  s_add_u32 s52, s52, 0
  s_mov_b32 m0, 68224
  s_nop 0
  buffer_load_dwordx4 v3, s[28:31], s52 offen offset:0 sc1 lds
  buffer_load_dwordx4 v3, s[28:31], s52 offen offset:1024 sc1 lds
  buffer_load_dwordx4 v3, s[28:31], s52 offen offset:2048 sc1 lds
  buffer_load_dwordx4 v3, s[28:31], s52 offen offset:3072 sc1 lds
  s_add_u32 s52, s48, 2
  s_lshl_b32 s52, s52, 13
  s_add_u32 s52, s52, 4096
  s_mov_b32 m0, 72800
  s_nop 0
  buffer_load_dwordx4 v3, s[28:31], s52 offen offset:0 sc1 lds
  buffer_load_dwordx4 v3, s[28:31], s52 offen offset:1024 sc1 lds
  buffer_load_dwordx4 v3, s[28:31], s52 offen offset:2048 sc1 lds
  buffer_load_dwordx4 v3, s[28:31], s52 offen offset:3072 sc1 lds
  s_waitcnt vmcnt(0)
L_cwd:
  v_and_b32 v4, 15, v2
  v_lshrrev_b32 v5, 4, v2
  v_and_b32 v6, 3, v4
  v_lshrrev_b32 v7, 2, v4
  v_sub_u32 v7, v7, v5
  v_lshlrev_b32 v7, 4, v7
  v_add_u32 v7, 48, v7
  v_mul_u32_u24 v6, 4160, v6
  v_add_u32 v20, v6, v7
  v_and_b32 v6, 1, v4
  v_lshrrev_b32 v7, 1, v4
  v_lshlrev_b32 v7, 6, v7
  v_lshl_add_u32 v7, v5, 4, v7
  v_sub_u32 v7, 17136, v7
  v_mul_u32_u24 v6, 4576, v6
  v_add_u32 v21, v6, v7

  s_waitcnt lgkmcnt(0)
  s_barrier
  s_mov_b32 s8, s92
  s_mov_b32 s9, s93
  s_mov_b32 s10, 5308416
  s_mov_b32 s11, 0x20000
  s_mov_b32 s12, s94
  s_mov_b32 s13, s95
  s_mov_b32 s14, 5308416
  s_mov_b32 s15, 0x20000
  s_mul_i32 s57, s39, 12288
  s_mul_i32 s54, s2, 36864
  s_add_u32 s54, s54, s57
L_nostrip:
  s_cmp_lg_u32 s39, 0
  s_cbranch_scc1 L_mm1
  ds_read_b128 v[64:67], v21 offset:3584
  ds_read_b128 v[32:35], v20 offset:0
  ds_read_b128 v[68:71], v21 offset:3072
  ds_read_b128 v[36:39], v20 offset:512
  ds_read_b128 v[72:75], v21 offset:2560
  ds_read_b128 v[40:43], v20 offset:1024
  ds_read_b128 v[76:79], v21 offset:2048
  ds_read_b128 v[44:47], v20 offset:1536
  ds_read_b128 v[80:83], v21 offset:1536
  ds_read_b128 v[48:51], v20 offset:2048
  ds_read_b128 v[84:87], v21 offset:1024
  ds_read_b128 v[52:55], v20 offset:2560
  ds_read_b128 v[88:91], v21 offset:512
  ds_read_b128 v[56:59], v20 offset:3072
  ds_read_b128 v[92:95], v21 offset:0
  ds_read_b128 v[60:63], v20 offset:3584
  s_waitcnt lgkmcnt(14)
  v_mfma_f32_16x16x32_bf16 v[160:163], v[64:67], v[32:35], 0
  s_waitcnt lgkmcnt(12)
  v_mfma_f32_16x16x32_bf16 v[164:167], v[68:71], v[32:35], 0
  v_mfma_f32_16x16x32_bf16 v[164:167], v[64:67], v[36:39], v[164:167]
  s_waitcnt lgkmcnt(10)
  v_mfma_f32_16x16x32_bf16 v[168:171], v[72:75], v[32:35], 0
  v_mfma_f32_16x16x32_bf16 v[168:171], v[68:71], v[36:39], v[168:171]
  v_mfma_f32_16x16x32_bf16 v[168:171], v[64:67], v[40:43], v[168:171]
  s_waitcnt lgkmcnt(8)
  v_mfma_f32_16x16x32_bf16 v[172:175], v[76:79], v[32:35], 0
  v_mfma_f32_16x16x32_bf16 v[172:175], v[72:75], v[36:39], v[172:175]
  v_mfma_f32_16x16x32_bf16 v[172:175], v[68:71], v[40:43], v[172:175]
  v_mfma_f32_16x16x32_bf16 v[172:175], v[64:67], v[44:47], v[172:175]
  s_waitcnt lgkmcnt(6)
  v_mfma_f32_16x16x32_bf16 v[176:179], v[80:83], v[32:35], 0
  v_mfma_f32_16x16x32_bf16 v[176:179], v[76:79], v[36:39], v[176:179]
  ds_read_b128 v[128:131], v21 offset:3648
  v_mfma_f32_16x16x32_bf16 v[176:179], v[72:75], v[40:43], v[176:179]
  v_mfma_f32_16x16x32_bf16 v[176:179], v[68:71], v[44:47], v[176:179]
  ds_read_b128 v[96:99], v20 offset:64
  v_mfma_f32_16x16x32_bf16 v[176:179], v[64:67], v[48:51], v[176:179]
  s_waitcnt lgkmcnt(6)
  v_mfma_f32_16x16x32_bf16 v[180:183], v[84:87], v[32:35], 0
  ds_read_b128 v[132:135], v21 offset:3136
  v_mfma_f32_16x16x32_bf16 v[180:183], v[80:83], v[36:39], v[180:183]
  v_mfma_f32_16x16x32_bf16 v[180:183], v[76:79], v[40:43], v[180:183]
  ds_read_b128 v[100:103], v20 offset:576
  v_mfma_f32_16x16x32_bf16 v[180:183], v[72:75], v[44:47], v[180:183]
  v_mfma_f32_16x16x32_bf16 v[180:183], v[68:71], v[48:51], v[180:183]
  ds_read_b128 v[136:139], v21 offset:2624
  v_mfma_f32_16x16x32_bf16 v[180:183], v[64:67], v[52:55], v[180:183]
  s_waitcnt lgkmcnt(7)
  v_mfma_f32_16x16x32_bf16 v[184:187], v[88:91], v[32:35], 0
  ds_read_b128 v[104:107], v20 offset:1088
  v_mfma_f32_16x16x32_bf16 v[184:187], v[84:87], v[36:39], v[184:187]
  v_mfma_f32_16x16x32_bf16 v[184:187], v[80:83], v[40:43], v[184:187]
  ds_read_b128 v[140:143], v21 offset:2112
  v_mfma_f32_16x16x32_bf16 v[184:187], v[76:79], v[44:47], v[184:187]
  v_mfma_f32_16x16x32_bf16 v[184:187], v[72:75], v[48:51], v[184:187]
  ds_read_b128 v[108:111], v20 offset:1600
  v_mfma_f32_16x16x32_bf16 v[184:187], v[68:71], v[52:55], v[184:187]
  v_mfma_f32_16x16x32_bf16 v[184:187], v[64:67], v[56:59], v[184:187]
  ds_read_b128 v[144:147], v21 offset:1600
  s_waitcnt lgkmcnt(9)
  v_mfma_f32_16x16x32_bf16 v[188:191], v[92:95], v[32:35], 0
  v_mfma_f32_16x16x32_bf16 v[188:191], v[88:91], v[36:39], v[188:191]
  ds_read_b128 v[112:115], v20 offset:2112
  v_mfma_f32_16x16x32_bf16 v[188:191], v[84:87], v[40:43], v[188:191]
  v_mfma_f32_16x16x32_bf16 v[188:191], v[80:83], v[44:47], v[188:191]
  ds_read_b128 v[148:151], v21 offset:1088
  v_mfma_f32_16x16x32_bf16 v[188:191], v[76:79], v[48:51], v[188:191]
  v_mfma_f32_16x16x32_bf16 v[188:191], v[72:75], v[52:55], v[188:191]
  ds_read_b128 v[116:119], v20 offset:2624
  v_mfma_f32_16x16x32_bf16 v[188:191], v[68:71], v[56:59], v[188:191]
  v_mfma_f32_16x16x32_bf16 v[188:191], v[64:67], v[60:63], v[188:191]
  ds_read_b128 v[152:155], v21 offset:576
  ds_read_b128 v[120:123], v20 offset:3136
  ds_read_b128 v[156:159], v21 offset:64
  ds_read_b128 v[124:127], v20 offset:3648
  s_waitcnt lgkmcnt(0)
  v_mfma_f32_16x16x32_bf16 v[160:163], v[128:131], v[96:99], v[160:163]
  v_mfma_f32_16x16x32_bf16 v[164:167], v[132:135], v[96:99], v[164:167]
  ds_read_b128 v[64:67], v21 offset:3712
  v_mfma_f32_16x16x32_bf16 v[164:167], v[128:131], v[100:103], v[164:167]
  s_add_u32 m0, s57, 126528
  s_add_u32 s53, s54, 0
  buffer_load_dwordx4 v3, s[12:15], s53 offen offset:0 nt lds
  v_mfma_f32_16x16x32_bf16 v[168:171], v[136:139], v[96:99], v[168:171]
  ds_read_b128 v[32:35], v20 offset:128
  v_mfma_f32_16x16x32_bf16 v[168:171], v[132:135], v[100:103], v[168:171]
  v_mfma_f32_16x16x32_bf16 v[168:171], v[128:131], v[104:107], v[168:171]
  ds_read_b128 v[68:71], v21 offset:3200
  v_mfma_f32_16x16x32_bf16 v[172:175], v[140:143], v[96:99], v[172:175]
  v_mfma_f32_16x16x32_bf16 v[172:175], v[136:139], v[100:103], v[172:175]
  ds_read_b128 v[36:39], v20 offset:640
  v_mfma_f32_16x16x32_bf16 v[172:175], v[132:135], v[104:107], v[172:175]
  buffer_load_dwordx4 v3, s[12:15], s53 offen offset:1024 nt lds
  v_mfma_f32_16x16x32_bf16 v[172:175], v[128:131], v[108:111], v[172:175]
  ds_read_b128 v[72:75], v21 offset:2688
  v_mfma_f32_16x16x32_bf16 v[176:179], v[144:147], v[96:99], v[176:179]
  v_mfma_f32_16x16x32_bf16 v[176:179], v[140:143], v[100:103], v[176:179]
  ds_read_b128 v[40:43], v20 offset:1152
  v_mfma_f32_16x16x32_bf16 v[176:179], v[136:139], v[104:107], v[176:179]
  v_mfma_f32_16x16x32_bf16 v[176:179], v[132:135], v[108:111], v[176:179]
  ds_read_b128 v[76:79], v21 offset:2176
  v_mfma_f32_16x16x32_bf16 v[176:179], v[128:131], v[112:115], v[176:179]
  buffer_load_dwordx4 v3, s[12:15], s53 offen offset:2048 nt lds
  v_mfma_f32_16x16x32_bf16 v[180:183], v[148:151], v[96:99], v[180:183]
  ds_read_b128 v[44:47], v20 offset:1664
  v_mfma_f32_16x16x32_bf16 v[180:183], v[144:147], v[100:103], v[180:183]
  v_mfma_f32_16x16x32_bf16 v[180:183], v[140:143], v[104:107], v[180:183]
  ds_read_b128 v[80:83], v21 offset:1664
  v_mfma_f32_16x16x32_bf16 v[180:183], v[136:139], v[108:111], v[180:183]
  v_mfma_f32_16x16x32_bf16 v[180:183], v[132:135], v[112:115], v[180:183]
  ds_read_b128 v[48:51], v20 offset:2176
  v_mfma_f32_16x16x32_bf16 v[180:183], v[128:131], v[116:119], v[180:183]
  buffer_load_dwordx4 v3, s[12:15], s53 offen offset:3072 nt lds
  v_mfma_f32_16x16x32_bf16 v[184:187], v[152:155], v[96:99], v[184:187]
  ds_read_b128 v[84:87], v21 offset:1152
  v_mfma_f32_16x16x32_bf16 v[184:187], v[148:151], v[100:103], v[184:187]
  v_mfma_f32_16x16x32_bf16 v[184:187], v[144:147], v[104:107], v[184:187]
  ds_read_b128 v[52:55], v20 offset:2688
  v_mfma_f32_16x16x32_bf16 v[184:187], v[140:143], v[108:111], v[184:187]
  v_mfma_f32_16x16x32_bf16 v[184:187], v[136:139], v[112:115], v[184:187]
  ds_read_b128 v[88:91], v21 offset:640
  v_mfma_f32_16x16x32_bf16 v[184:187], v[132:135], v[116:119], v[184:187]
  s_add_u32 m0, s57, 130624
  s_add_u32 s53, s54, 4096
  buffer_load_dwordx4 v3, s[12:15], s53 offen offset:0 nt lds
  v_mfma_f32_16x16x32_bf16 v[184:187], v[128:131], v[120:123], v[184:187]
  ds_read_b128 v[56:59], v20 offset:3200
  v_mfma_f32_16x16x32_bf16 v[188:191], v[156:159], v[96:99], v[188:191]
  v_mfma_f32_16x16x32_bf16 v[188:191], v[152:155], v[100:103], v[188:191]
  ds_read_b128 v[92:95], v21 offset:128
  v_mfma_f32_16x16x32_bf16 v[188:191], v[148:151], v[104:107], v[188:191]
  v_mfma_f32_16x16x32_bf16 v[188:191], v[144:147], v[108:111], v[188:191]
  ds_read_b128 v[60:63], v20 offset:3712
  v_mfma_f32_16x16x32_bf16 v[188:191], v[140:143], v[112:115], v[188:191]
  buffer_load_dwordx4 v3, s[12:15], s53 offen offset:1024 nt lds
  v_mfma_f32_16x16x32_bf16 v[188:191], v[136:139], v[116:119], v[188:191]
  v_mfma_f32_16x16x32_bf16 v[188:191], v[132:135], v[120:123], v[188:191]
  v_mfma_f32_16x16x32_bf16 v[188:191], v[128:131], v[124:127], v[188:191]
  s_waitcnt lgkmcnt(0)
  v_mfma_f32_16x16x32_bf16 v[160:163], v[64:67], v[32:35], v[160:163]
  v_mfma_f32_16x16x32_bf16 v[164:167], v[68:71], v[32:35], v[164:167]
  ds_read_b128 v[128:131], v21 offset:3776
  v_mfma_f32_16x16x32_bf16 v[164:167], v[64:67], v[36:39], v[164:167]
  buffer_load_dwordx4 v3, s[12:15], s53 offen offset:2048 nt lds
  v_mfma_f32_16x16x32_bf16 v[168:171], v[72:75], v[32:35], v[168:171]
  ds_read_b128 v[96:99], v20 offset:192
  v_mfma_f32_16x16x32_bf16 v[168:171], v[68:71], v[36:39], v[168:171]
  v_mfma_f32_16x16x32_bf16 v[168:171], v[64:67], v[40:43], v[168:171]
  ds_read_b128 v[132:135], v21 offset:3264
  v_mfma_f32_16x16x32_bf16 v[172:175], v[76:79], v[32:35], v[172:175]
  v_mfma_f32_16x16x32_bf16 v[172:175], v[72:75], v[36:39], v[172:175]
  ds_read_b128 v[100:103], v20 offset:704
  v_mfma_f32_16x16x32_bf16 v[172:175], v[68:71], v[40:43], v[172:175]
  buffer_load_dwordx4 v3, s[12:15], s53 offen offset:3072 nt lds
  v_mfma_f32_16x16x32_bf16 v[172:175], v[64:67], v[44:47], v[172:175]
  ds_read_b128 v[136:139], v21 offset:2752
  v_mfma_f32_16x16x32_bf16 v[176:179], v[80:83], v[32:35], v[176:179]
  v_mfma_f32_16x16x32_bf16 v[176:179], v[76:79], v[36:39], v[176:179]
  ds_read_b128 v[104:107], v20 offset:1216
  v_mfma_f32_16x16x32_bf16 v[176:179], v[72:75], v[40:43], v[176:179]
  v_mfma_f32_16x16x32_bf16 v[176:179], v[68:71], v[44:47], v[176:179]
  ds_read_b128 v[140:143], v21 offset:2240
  v_mfma_f32_16x16x32_bf16 v[176:179], v[64:67], v[48:51], v[176:179]
  s_add_u32 m0, s57, 134720
  s_add_u32 s53, s54, 8192
  buffer_load_dwordx4 v3, s[12:15], s53 offen offset:0 nt lds
  v_mfma_f32_16x16x32_bf16 v[180:183], v[84:87], v[32:35], v[180:183]
  ds_read_b128 v[108:111], v20 offset:1728
  v_mfma_f32_16x16x32_bf16 v[180:183], v[80:83], v[36:39], v[180:183]
  v_mfma_f32_16x16x32_bf16 v[180:183], v[76:79], v[40:43], v[180:183]
  ds_read_b128 v[144:147], v21 offset:1728
  v_mfma_f32_16x16x32_bf16 v[180:183], v[72:75], v[44:47], v[180:183]
  v_mfma_f32_16x16x32_bf16 v[180:183], v[68:71], v[48:51], v[180:183]
  ds_read_b128 v[112:115], v20 offset:2240
  v_mfma_f32_16x16x32_bf16 v[180:183], v[64:67], v[52:55], v[180:183]
  buffer_load_dwordx4 v3, s[12:15], s53 offen offset:1024 nt lds
  v_mfma_f32_16x16x32_bf16 v[184:187], v[88:91], v[32:35], v[184:187]
  ds_read_b128 v[148:151], v21 offset:1216
  v_mfma_f32_16x16x32_bf16 v[184:187], v[84:87], v[36:39], v[184:187]
  v_mfma_f32_16x16x32_bf16 v[184:187], v[80:83], v[40:43], v[184:187]
  ds_read_b128 v[116:119], v20 offset:2752
  v_mfma_f32_16x16x32_bf16 v[184:187], v[76:79], v[44:47], v[184:187]
  v_mfma_f32_16x16x32_bf16 v[184:187], v[72:75], v[48:51], v[184:187]
  ds_read_b128 v[152:155], v21 offset:704
  v_mfma_f32_16x16x32_bf16 v[184:187], v[68:71], v[52:55], v[184:187]
  buffer_load_dwordx4 v3, s[12:15], s53 offen offset:2048 nt lds
  v_mfma_f32_16x16x32_bf16 v[184:187], v[64:67], v[56:59], v[184:187]
  ds_read_b128 v[120:123], v20 offset:3264
  v_mfma_f32_16x16x32_bf16 v[188:191], v[92:95], v[32:35], v[188:191]
  v_mfma_f32_16x16x32_bf16 v[188:191], v[88:91], v[36:39], v[188:191]
  ds_read_b128 v[156:159], v21 offset:192
  v_mfma_f32_16x16x32_bf16 v[188:191], v[84:87], v[40:43], v[188:191]
  v_mfma_f32_16x16x32_bf16 v[188:191], v[80:83], v[44:47], v[188:191]
  ds_read_b128 v[124:127], v20 offset:3776
  v_mfma_f32_16x16x32_bf16 v[188:191], v[76:79], v[48:51], v[188:191]
  buffer_load_dwordx4 v3, s[12:15], s53 offen offset:3072 nt lds
  v_mfma_f32_16x16x32_bf16 v[188:191], v[72:75], v[52:55], v[188:191]
  v_mfma_f32_16x16x32_bf16 v[188:191], v[68:71], v[56:59], v[188:191]
  v_mfma_f32_16x16x32_bf16 v[188:191], v[64:67], v[60:63], v[188:191]
  s_waitcnt lgkmcnt(0)
  v_mfma_f32_16x16x32_bf16 v[160:163], v[128:131], v[96:99], v[160:163]
  v_mfma_f32_16x16x32_bf16 v[164:167], v[132:135], v[96:99], v[164:167]
  ds_read_b128 v[64:67], v21 offset:3840
  v_mfma_f32_16x16x32_bf16 v[164:167], v[128:131], v[100:103], v[164:167]
  v_mfma_f32_16x16x32_bf16 v[168:171], v[136:139], v[96:99], v[168:171]
  ds_read_b128 v[32:35], v20 offset:256
  v_mfma_f32_16x16x32_bf16 v[168:171], v[132:135], v[100:103], v[168:171]
  v_mfma_f32_16x16x32_bf16 v[168:171], v[128:131], v[104:107], v[168:171]
  ds_read_b128 v[68:71], v21 offset:3328
  v_mfma_f32_16x16x32_bf16 v[172:175], v[140:143], v[96:99], v[172:175]
  v_mfma_f32_16x16x32_bf16 v[172:175], v[136:139], v[100:103], v[172:175]
  ds_read_b128 v[36:39], v20 offset:768
  v_mfma_f32_16x16x32_bf16 v[172:175], v[132:135], v[104:107], v[172:175]
  v_mfma_f32_16x16x32_bf16 v[172:175], v[128:131], v[108:111], v[172:175]
  ds_read_b128 v[72:75], v21 offset:2816
  v_mfma_f32_16x16x32_bf16 v[176:179], v[144:147], v[96:99], v[176:179]
  v_mfma_f32_16x16x32_bf16 v[176:179], v[140:143], v[100:103], v[176:179]
  ds_read_b128 v[40:43], v20 offset:1280
  v_mfma_f32_16x16x32_bf16 v[176:179], v[136:139], v[104:107], v[176:179]
  v_mfma_f32_16x16x32_bf16 v[176:179], v[132:135], v[108:111], v[176:179]
  ds_read_b128 v[76:79], v21 offset:2304
  v_mfma_f32_16x16x32_bf16 v[176:179], v[128:131], v[112:115], v[176:179]
  v_mfma_f32_16x16x32_bf16 v[180:183], v[148:151], v[96:99], v[180:183]
  ds_read_b128 v[44:47], v20 offset:1792
  v_mfma_f32_16x16x32_bf16 v[180:183], v[144:147], v[100:103], v[180:183]
  v_mfma_f32_16x16x32_bf16 v[180:183], v[140:143], v[104:107], v[180:183]
  ds_read_b128 v[80:83], v21 offset:1792
  v_mfma_f32_16x16x32_bf16 v[180:183], v[136:139], v[108:111], v[180:183]
  v_mfma_f32_16x16x32_bf16 v[180:183], v[132:135], v[112:115], v[180:183]
  ds_read_b128 v[48:51], v20 offset:2304
  v_mfma_f32_16x16x32_bf16 v[180:183], v[128:131], v[116:119], v[180:183]
  v_mfma_f32_16x16x32_bf16 v[184:187], v[152:155], v[96:99], v[184:187]
  ds_read_b128 v[84:87], v21 offset:1280
  v_mfma_f32_16x16x32_bf16 v[184:187], v[148:151], v[100:103], v[184:187]
  v_mfma_f32_16x16x32_bf16 v[184:187], v[144:147], v[104:107], v[184:187]
  ds_read_b128 v[52:55], v20 offset:2816
  v_mfma_f32_16x16x32_bf16 v[184:187], v[140:143], v[108:111], v[184:187]
  v_mfma_f32_16x16x32_bf16 v[184:187], v[136:139], v[112:115], v[184:187]
  ds_read_b128 v[88:91], v21 offset:768
  v_mfma_f32_16x16x32_bf16 v[184:187], v[132:135], v[116:119], v[184:187]
  v_mfma_f32_16x16x32_bf16 v[184:187], v[128:131], v[120:123], v[184:187]
  ds_read_b128 v[56:59], v20 offset:3328
  v_mfma_f32_16x16x32_bf16 v[188:191], v[156:159], v[96:99], v[188:191]
  v_mfma_f32_16x16x32_bf16 v[188:191], v[152:155], v[100:103], v[188:191]
  ds_read_b128 v[92:95], v21 offset:256
  v_mfma_f32_16x16x32_bf16 v[188:191], v[148:151], v[104:107], v[188:191]
  v_mfma_f32_16x16x32_bf16 v[188:191], v[144:147], v[108:111], v[188:191]
  ds_read_b128 v[60:63], v20 offset:3840
  v_mfma_f32_16x16x32_bf16 v[188:191], v[140:143], v[112:115], v[188:191]
  v_mfma_f32_16x16x32_bf16 v[188:191], v[136:139], v[116:119], v[188:191]
  v_mfma_f32_16x16x32_bf16 v[188:191], v[132:135], v[120:123], v[188:191]
  v_mfma_f32_16x16x32_bf16 v[188:191], v[128:131], v[124:127], v[188:191]
  s_waitcnt lgkmcnt(0)
  v_mfma_f32_16x16x32_bf16 v[160:163], v[64:67], v[32:35], v[160:163]
  v_mfma_f32_16x16x32_bf16 v[164:167], v[68:71], v[32:35], v[164:167]
  ds_read_b128 v[128:131], v21 offset:3904
  v_mfma_f32_16x16x32_bf16 v[164:167], v[64:67], v[36:39], v[164:167]
  v_mfma_f32_16x16x32_bf16 v[168:171], v[72:75], v[32:35], v[168:171]
  ds_read_b128 v[96:99], v20 offset:320
  v_mfma_f32_16x16x32_bf16 v[168:171], v[68:71], v[36:39], v[168:171]
  v_mfma_f32_16x16x32_bf16 v[168:171], v[64:67], v[40:43], v[168:171]
  ds_read_b128 v[132:135], v21 offset:3392
  v_mfma_f32_16x16x32_bf16 v[172:175], v[76:79], v[32:35], v[172:175]
  v_mfma_f32_16x16x32_bf16 v[172:175], v[72:75], v[36:39], v[172:175]
  ds_read_b128 v[100:103], v20 offset:832
  v_mfma_f32_16x16x32_bf16 v[172:175], v[68:71], v[40:43], v[172:175]
  v_mfma_f32_16x16x32_bf16 v[172:175], v[64:67], v[44:47], v[172:175]
  ds_read_b128 v[136:139], v21 offset:2880
  v_mfma_f32_16x16x32_bf16 v[176:179], v[80:83], v[32:35], v[176:179]
  v_mfma_f32_16x16x32_bf16 v[176:179], v[76:79], v[36:39], v[176:179]
  ds_read_b128 v[104:107], v20 offset:1344
  v_mfma_f32_16x16x32_bf16 v[176:179], v[72:75], v[40:43], v[176:179]
  v_mfma_f32_16x16x32_bf16 v[176:179], v[68:71], v[44:47], v[176:179]
  ds_read_b128 v[140:143], v21 offset:2368
  v_mfma_f32_16x16x32_bf16 v[176:179], v[64:67], v[48:51], v[176:179]
  v_mfma_f32_16x16x32_bf16 v[180:183], v[84:87], v[32:35], v[180:183]
  ds_read_b128 v[108:111], v20 offset:1856
  v_mfma_f32_16x16x32_bf16 v[180:183], v[80:83], v[36:39], v[180:183]
  v_mfma_f32_16x16x32_bf16 v[180:183], v[76:79], v[40:43], v[180:183]
  ds_read_b128 v[144:147], v21 offset:1856
  v_mfma_f32_16x16x32_bf16 v[180:183], v[72:75], v[44:47], v[180:183]
  v_mfma_f32_16x16x32_bf16 v[180:183], v[68:71], v[48:51], v[180:183]
  ds_read_b128 v[112:115], v20 offset:2368
  v_mfma_f32_16x16x32_bf16 v[180:183], v[64:67], v[52:55], v[180:183]
  v_mfma_f32_16x16x32_bf16 v[184:187], v[88:91], v[32:35], v[184:187]
  ds_read_b128 v[148:151], v21 offset:1344
  v_mfma_f32_16x16x32_bf16 v[184:187], v[84:87], v[36:39], v[184:187]
  v_mfma_f32_16x16x32_bf16 v[184:187], v[80:83], v[40:43], v[184:187]
  ds_read_b128 v[116:119], v20 offset:2880
  v_mfma_f32_16x16x32_bf16 v[184:187], v[76:79], v[44:47], v[184:187]
  v_mfma_f32_16x16x32_bf16 v[184:187], v[72:75], v[48:51], v[184:187]
  ds_read_b128 v[152:155], v21 offset:832
  v_mfma_f32_16x16x32_bf16 v[184:187], v[68:71], v[52:55], v[184:187]
  v_mfma_f32_16x16x32_bf16 v[184:187], v[64:67], v[56:59], v[184:187]
  ds_read_b128 v[120:123], v20 offset:3392
  v_mfma_f32_16x16x32_bf16 v[188:191], v[92:95], v[32:35], v[188:191]
  v_mfma_f32_16x16x32_bf16 v[188:191], v[88:91], v[36:39], v[188:191]
  ds_read_b128 v[156:159], v21 offset:320
  v_mfma_f32_16x16x32_bf16 v[188:191], v[84:87], v[40:43], v[188:191]
  v_mfma_f32_16x16x32_bf16 v[188:191], v[80:83], v[44:47], v[188:191]
  ds_read_b128 v[124:127], v20 offset:3904
  v_mfma_f32_16x16x32_bf16 v[188:191], v[76:79], v[48:51], v[188:191]
  v_mfma_f32_16x16x32_bf16 v[188:191], v[72:75], v[52:55], v[188:191]
  v_mfma_f32_16x16x32_bf16 v[188:191], v[68:71], v[56:59], v[188:191]
  v_mfma_f32_16x16x32_bf16 v[188:191], v[64:67], v[60:63], v[188:191]
  s_waitcnt lgkmcnt(0)
  v_mfma_f32_16x16x32_bf16 v[160:163], v[128:131], v[96:99], v[160:163]
  v_mfma_f32_16x16x32_bf16 v[164:167], v[132:135], v[96:99], v[164:167]
  v_mfma_f32_16x16x32_bf16 v[164:167], v[128:131], v[100:103], v[164:167]
  v_mfma_f32_16x16x32_bf16 v[168:171], v[136:139], v[96:99], v[168:171]
  v_mfma_f32_16x16x32_bf16 v[168:171], v[132:135], v[100:103], v[168:171]
  v_mfma_f32_16x16x32_bf16 v[168:171], v[128:131], v[104:107], v[168:171]
  v_mfma_f32_16x16x32_bf16 v[172:175], v[140:143], v[96:99], v[172:175]
  v_mfma_f32_16x16x32_bf16 v[172:175], v[136:139], v[100:103], v[172:175]
  v_mfma_f32_16x16x32_bf16 v[172:175], v[132:135], v[104:107], v[172:175]
  v_mfma_f32_16x16x32_bf16 v[172:175], v[128:131], v[108:111], v[172:175]
  v_mfma_f32_16x16x32_bf16 v[176:179], v[144:147], v[96:99], v[176:179]
  v_mfma_f32_16x16x32_bf16 v[176:179], v[140:143], v[100:103], v[176:179]
  v_mfma_f32_16x16x32_bf16 v[176:179], v[136:139], v[104:107], v[176:179]
  v_mfma_f32_16x16x32_bf16 v[176:179], v[132:135], v[108:111], v[176:179]
  v_mfma_f32_16x16x32_bf16 v[176:179], v[128:131], v[112:115], v[176:179]
  v_mfma_f32_16x16x32_bf16 v[180:183], v[148:151], v[96:99], v[180:183]
  v_mfma_f32_16x16x32_bf16 v[180:183], v[144:147], v[100:103], v[180:183]
  v_mfma_f32_16x16x32_bf16 v[180:183], v[140:143], v[104:107], v[180:183]
  v_mfma_f32_16x16x32_bf16 v[180:183], v[136:139], v[108:111], v[180:183]
  v_mfma_f32_16x16x32_bf16 v[180:183], v[132:135], v[112:115], v[180:183]
  v_mfma_f32_16x16x32_bf16 v[180:183], v[128:131], v[116:119], v[180:183]
  v_mfma_f32_16x16x32_bf16 v[184:187], v[152:155], v[96:99], v[184:187]
  v_mfma_f32_16x16x32_bf16 v[184:187], v[148:151], v[100:103], v[184:187]
  v_mfma_f32_16x16x32_bf16 v[184:187], v[144:147], v[104:107], v[184:187]
  v_mfma_f32_16x16x32_bf16 v[184:187], v[140:143], v[108:111], v[184:187]
  v_mfma_f32_16x16x32_bf16 v[184:187], v[136:139], v[112:115], v[184:187]
  v_mfma_f32_16x16x32_bf16 v[184:187], v[132:135], v[116:119], v[184:187]
  v_mfma_f32_16x16x32_bf16 v[184:187], v[128:131], v[120:123], v[184:187]
  v_mfma_f32_16x16x32_bf16 v[188:191], v[156:159], v[96:99], v[188:191]
  v_mfma_f32_16x16x32_bf16 v[188:191], v[152:155], v[100:103], v[188:191]
  v_mfma_f32_16x16x32_bf16 v[188:191], v[148:151], v[104:107], v[188:191]
  v_mfma_f32_16x16x32_bf16 v[188:191], v[144:147], v[108:111], v[188:191]
  v_mfma_f32_16x16x32_bf16 v[188:191], v[140:143], v[112:115], v[188:191]
  v_mfma_f32_16x16x32_bf16 v[188:191], v[136:139], v[116:119], v[188:191]
  v_mfma_f32_16x16x32_bf16 v[188:191], v[132:135], v[120:123], v[188:191]
  v_mfma_f32_16x16x32_bf16 v[188:191], v[128:131], v[124:127], v[188:191]
  s_nop 7
  s_nop 7
  v_lshlrev_b32 v6, 8, v5
  v_lshl_add_u32 v6, v4, 3, v6
  v_add_u32 v7, 77376, v6
  ds_write_b64 v7, v[160:161] offset:0
  ds_write_b64 v7, v[162:163] offset:128
  ds_write_b64 v7, v[164:165] offset:1024
  ds_write_b64 v7, v[166:167] offset:1152
  ds_write_b64 v7, v[168:169] offset:2048
  ds_write_b64 v7, v[170:171] offset:2176
  ds_write_b64 v7, v[172:173] offset:3072
  ds_write_b64 v7, v[174:175] offset:3200
  ds_write_b64 v7, v[176:177] offset:4096
  ds_write_b64 v7, v[178:179] offset:4224
  ds_write_b64 v7, v[180:181] offset:5120
  ds_write_b64 v7, v[182:183] offset:5248
  ds_write_b64 v7, v[184:185] offset:6144
  ds_write_b64 v7, v[186:187] offset:6272
  ds_write_b64 v7, v[188:189] offset:7168
  ds_write_b64 v7, v[190:191] offset:7296
  s_branch L_mmd
L_mm1:
  s_cmp_lg_u32 s39, 1
  s_cbranch_scc1 L_mm2
  ds_read_b128 v[64:67], v21 offset:3968
  ds_read_b128 v[32:35], v20 offset:384
  ds_read_b128 v[68:71], v21 offset:3456
  ds_read_b128 v[36:39], v20 offset:896
  ds_read_b128 v[72:75], v21 offset:2944
  ds_read_b128 v[40:43], v20 offset:1408
  ds_read_b128 v[76:79], v21 offset:2432
  ds_read_b128 v[44:47], v20 offset:1920
  ds_read_b128 v[80:83], v21 offset:1920
  ds_read_b128 v[48:51], v20 offset:2432
  ds_read_b128 v[84:87], v21 offset:1408
  ds_read_b128 v[52:55], v20 offset:2944
  ds_read_b128 v[88:91], v21 offset:896
  ds_read_b128 v[56:59], v20 offset:3456
  ds_read_b128 v[92:95], v21 offset:384
  ds_read_b128 v[60:63], v20 offset:3968
  s_waitcnt lgkmcnt(14)
  v_mfma_f32_16x16x32_bf16 v[160:163], v[64:67], v[32:35], 0
  s_waitcnt lgkmcnt(12)
  v_mfma_f32_16x16x32_bf16 v[164:167], v[68:71], v[32:35], 0
  v_mfma_f32_16x16x32_bf16 v[164:167], v[64:67], v[36:39], v[164:167]
  s_waitcnt lgkmcnt(10)
  v_mfma_f32_16x16x32_bf16 v[168:171], v[72:75], v[32:35], 0
  v_mfma_f32_16x16x32_bf16 v[168:171], v[68:71], v[36:39], v[168:171]
  v_mfma_f32_16x16x32_bf16 v[168:171], v[64:67], v[40:43], v[168:171]
  s_waitcnt lgkmcnt(8)
  v_mfma_f32_16x16x32_bf16 v[172:175], v[76:79], v[32:35], 0
  v_mfma_f32_16x16x32_bf16 v[172:175], v[72:75], v[36:39], v[172:175]
  v_mfma_f32_16x16x32_bf16 v[172:175], v[68:71], v[40:43], v[172:175]
  v_mfma_f32_16x16x32_bf16 v[172:175], v[64:67], v[44:47], v[172:175]
  s_waitcnt lgkmcnt(6)
  v_mfma_f32_16x16x32_bf16 v[176:179], v[80:83], v[32:35], 0
  v_mfma_f32_16x16x32_bf16 v[176:179], v[76:79], v[36:39], v[176:179]
  ds_read_b128 v[128:131], v21 offset:4032
  v_mfma_f32_16x16x32_bf16 v[176:179], v[72:75], v[40:43], v[176:179]
  v_mfma_f32_16x16x32_bf16 v[176:179], v[68:71], v[44:47], v[176:179]
  ds_read_b128 v[96:99], v20 offset:448
  v_mfma_f32_16x16x32_bf16 v[176:179], v[64:67], v[48:51], v[176:179]
  s_waitcnt lgkmcnt(6)
  v_mfma_f32_16x16x32_bf16 v[180:183], v[84:87], v[32:35], 0
  ds_read_b128 v[132:135], v21 offset:3520
  v_mfma_f32_16x16x32_bf16 v[180:183], v[80:83], v[36:39], v[180:183]
  v_mfma_f32_16x16x32_bf16 v[180:183], v[76:79], v[40:43], v[180:183]
  ds_read_b128 v[100:103], v20 offset:960
  v_mfma_f32_16x16x32_bf16 v[180:183], v[72:75], v[44:47], v[180:183]
  v_mfma_f32_16x16x32_bf16 v[180:183], v[68:71], v[48:51], v[180:183]
  ds_read_b128 v[136:139], v21 offset:3008
  v_mfma_f32_16x16x32_bf16 v[180:183], v[64:67], v[52:55], v[180:183]
  s_waitcnt lgkmcnt(7)
  v_mfma_f32_16x16x32_bf16 v[184:187], v[88:91], v[32:35], 0
  ds_read_b128 v[104:107], v20 offset:1472
  v_mfma_f32_16x16x32_bf16 v[184:187], v[84:87], v[36:39], v[184:187]
  v_mfma_f32_16x16x32_bf16 v[184:187], v[80:83], v[40:43], v[184:187]
  ds_read_b128 v[140:143], v21 offset:2496
  v_mfma_f32_16x16x32_bf16 v[184:187], v[76:79], v[44:47], v[184:187]
  v_mfma_f32_16x16x32_bf16 v[184:187], v[72:75], v[48:51], v[184:187]
  ds_read_b128 v[108:111], v20 offset:1984
  v_mfma_f32_16x16x32_bf16 v[184:187], v[68:71], v[52:55], v[184:187]
  v_mfma_f32_16x16x32_bf16 v[184:187], v[64:67], v[56:59], v[184:187]
  ds_read_b128 v[144:147], v21 offset:1984
  s_waitcnt lgkmcnt(9)
  v_mfma_f32_16x16x32_bf16 v[188:191], v[92:95], v[32:35], 0
  v_mfma_f32_16x16x32_bf16 v[188:191], v[88:91], v[36:39], v[188:191]
  ds_read_b128 v[112:115], v20 offset:2496
  v_mfma_f32_16x16x32_bf16 v[188:191], v[84:87], v[40:43], v[188:191]
  v_mfma_f32_16x16x32_bf16 v[188:191], v[80:83], v[44:47], v[188:191]
  ds_read_b128 v[148:151], v21 offset:1472
  v_mfma_f32_16x16x32_bf16 v[188:191], v[76:79], v[48:51], v[188:191]
  v_mfma_f32_16x16x32_bf16 v[188:191], v[72:75], v[52:55], v[188:191]
  ds_read_b128 v[116:119], v20 offset:3008
  v_mfma_f32_16x16x32_bf16 v[188:191], v[68:71], v[56:59], v[188:191]
  v_mfma_f32_16x16x32_bf16 v[188:191], v[64:67], v[60:63], v[188:191]
  ds_read_b128 v[152:155], v21 offset:960
  ds_read_b128 v[120:123], v20 offset:3520
  ds_read_b128 v[156:159], v21 offset:448
  ds_read_b128 v[124:127], v20 offset:4032
  s_waitcnt lgkmcnt(0)
  v_mfma_f32_16x16x32_bf16 v[160:163], v[128:131], v[96:99], v[160:163]
  v_mfma_f32_16x16x32_bf16 v[164:167], v[132:135], v[96:99], v[164:167]
  ds_read_b128 v[64:67], v21 offset:29376
  v_mfma_f32_16x16x32_bf16 v[164:167], v[128:131], v[100:103], v[164:167]
  s_add_u32 m0, s57, 126528
  s_add_u32 s53, s54, 0
  buffer_load_dwordx4 v3, s[12:15], s53 offen offset:0 nt lds
  v_mfma_f32_16x16x32_bf16 v[168:171], v[136:139], v[96:99], v[168:171]
  ds_read_b128 v[32:35], v20 offset:25792
  v_mfma_f32_16x16x32_bf16 v[168:171], v[132:135], v[100:103], v[168:171]
  v_mfma_f32_16x16x32_bf16 v[168:171], v[128:131], v[104:107], v[168:171]
  ds_read_b128 v[68:71], v21 offset:28864
  v_mfma_f32_16x16x32_bf16 v[172:175], v[140:143], v[96:99], v[172:175]
  v_mfma_f32_16x16x32_bf16 v[172:175], v[136:139], v[100:103], v[172:175]
  ds_read_b128 v[36:39], v20 offset:26304
  v_mfma_f32_16x16x32_bf16 v[172:175], v[132:135], v[104:107], v[172:175]
  buffer_load_dwordx4 v3, s[12:15], s53 offen offset:1024 nt lds
  v_mfma_f32_16x16x32_bf16 v[172:175], v[128:131], v[108:111], v[172:175]
  ds_read_b128 v[72:75], v21 offset:28352
  v_mfma_f32_16x16x32_bf16 v[176:179], v[144:147], v[96:99], v[176:179]
  v_mfma_f32_16x16x32_bf16 v[176:179], v[140:143], v[100:103], v[176:179]
  ds_read_b128 v[40:43], v20 offset:26816
  v_mfma_f32_16x16x32_bf16 v[176:179], v[136:139], v[104:107], v[176:179]
  v_mfma_f32_16x16x32_bf16 v[176:179], v[132:135], v[108:111], v[176:179]
  ds_read_b128 v[76:79], v21 offset:27840
  v_mfma_f32_16x16x32_bf16 v[176:179], v[128:131], v[112:115], v[176:179]
  buffer_load_dwordx4 v3, s[12:15], s53 offen offset:2048 nt lds
  v_mfma_f32_16x16x32_bf16 v[180:183], v[148:151], v[96:99], v[180:183]
  ds_read_b128 v[44:47], v20 offset:27328
  v_mfma_f32_16x16x32_bf16 v[180:183], v[144:147], v[100:103], v[180:183]
  v_mfma_f32_16x16x32_bf16 v[180:183], v[140:143], v[104:107], v[180:183]
  ds_read_b128 v[80:83], v21 offset:27328
  v_mfma_f32_16x16x32_bf16 v[180:183], v[136:139], v[108:111], v[180:183]
  v_mfma_f32_16x16x32_bf16 v[180:183], v[132:135], v[112:115], v[180:183]
  ds_read_b128 v[48:51], v20 offset:27840
  v_mfma_f32_16x16x32_bf16 v[180:183], v[128:131], v[116:119], v[180:183]
  buffer_load_dwordx4 v3, s[12:15], s53 offen offset:3072 nt lds
  v_mfma_f32_16x16x32_bf16 v[184:187], v[152:155], v[96:99], v[184:187]
  ds_read_b128 v[84:87], v21 offset:26816
  v_mfma_f32_16x16x32_bf16 v[184:187], v[148:151], v[100:103], v[184:187]
  v_mfma_f32_16x16x32_bf16 v[184:187], v[144:147], v[104:107], v[184:187]
  ds_read_b128 v[52:55], v20 offset:28352
  v_mfma_f32_16x16x32_bf16 v[184:187], v[140:143], v[108:111], v[184:187]
  v_mfma_f32_16x16x32_bf16 v[184:187], v[136:139], v[112:115], v[184:187]
  ds_read_b128 v[88:91], v21 offset:26304
  v_mfma_f32_16x16x32_bf16 v[184:187], v[132:135], v[116:119], v[184:187]
  s_add_u32 m0, s57, 130624
  s_add_u32 s53, s54, 4096
  buffer_load_dwordx4 v3, s[12:15], s53 offen offset:0 nt lds
  v_mfma_f32_16x16x32_bf16 v[184:187], v[128:131], v[120:123], v[184:187]
  ds_read_b128 v[56:59], v20 offset:28864
  v_mfma_f32_16x16x32_bf16 v[188:191], v[156:159], v[96:99], v[188:191]
  v_mfma_f32_16x16x32_bf16 v[188:191], v[152:155], v[100:103], v[188:191]
  ds_read_b128 v[92:95], v21 offset:25792
  v_mfma_f32_16x16x32_bf16 v[188:191], v[148:151], v[104:107], v[188:191]
  v_mfma_f32_16x16x32_bf16 v[188:191], v[144:147], v[108:111], v[188:191]
  ds_read_b128 v[60:63], v20 offset:29376
  v_mfma_f32_16x16x32_bf16 v[188:191], v[140:143], v[112:115], v[188:191]
  buffer_load_dwordx4 v3, s[12:15], s53 offen offset:1024 nt lds
  v_mfma_f32_16x16x32_bf16 v[188:191], v[136:139], v[116:119], v[188:191]
  v_mfma_f32_16x16x32_bf16 v[188:191], v[132:135], v[120:123], v[188:191]
  v_mfma_f32_16x16x32_bf16 v[188:191], v[128:131], v[124:127], v[188:191]
  s_waitcnt lgkmcnt(0)
  v_mfma_f32_16x16x32_bf16 v[192:195], v[64:67], v[32:35], 0
  v_mfma_f32_16x16x32_bf16 v[196:199], v[68:71], v[32:35], 0
  ds_read_b128 v[128:131], v21 offset:29440
  v_mfma_f32_16x16x32_bf16 v[196:199], v[64:67], v[36:39], v[196:199]
  buffer_load_dwordx4 v3, s[12:15], s53 offen offset:2048 nt lds
  v_mfma_f32_16x16x32_bf16 v[200:203], v[72:75], v[32:35], 0
  ds_read_b128 v[96:99], v20 offset:25856
  v_mfma_f32_16x16x32_bf16 v[200:203], v[68:71], v[36:39], v[200:203]
  v_mfma_f32_16x16x32_bf16 v[200:203], v[64:67], v[40:43], v[200:203]
  ds_read_b128 v[132:135], v21 offset:28928
  v_mfma_f32_16x16x32_bf16 v[204:207], v[76:79], v[32:35], 0
  v_mfma_f32_16x16x32_bf16 v[204:207], v[72:75], v[36:39], v[204:207]
  ds_read_b128 v[100:103], v20 offset:26368
  v_mfma_f32_16x16x32_bf16 v[204:207], v[68:71], v[40:43], v[204:207]
  buffer_load_dwordx4 v3, s[12:15], s53 offen offset:3072 nt lds
  v_mfma_f32_16x16x32_bf16 v[204:207], v[64:67], v[44:47], v[204:207]
  ds_read_b128 v[136:139], v21 offset:28416
  v_mfma_f32_16x16x32_bf16 v[208:211], v[80:83], v[32:35], 0
  v_mfma_f32_16x16x32_bf16 v[208:211], v[76:79], v[36:39], v[208:211]
  ds_read_b128 v[104:107], v20 offset:26880
  v_mfma_f32_16x16x32_bf16 v[208:211], v[72:75], v[40:43], v[208:211]
  v_mfma_f32_16x16x32_bf16 v[208:211], v[68:71], v[44:47], v[208:211]
  ds_read_b128 v[140:143], v21 offset:27904
  v_mfma_f32_16x16x32_bf16 v[208:211], v[64:67], v[48:51], v[208:211]
  s_add_u32 m0, s57, 134720
  s_add_u32 s53, s54, 8192
  buffer_load_dwordx4 v3, s[12:15], s53 offen offset:0 nt lds
  v_mfma_f32_16x16x32_bf16 v[212:215], v[84:87], v[32:35], 0
  ds_read_b128 v[108:111], v20 offset:27392
  v_mfma_f32_16x16x32_bf16 v[212:215], v[80:83], v[36:39], v[212:215]
  v_mfma_f32_16x16x32_bf16 v[212:215], v[76:79], v[40:43], v[212:215]
  ds_read_b128 v[144:147], v21 offset:27392
  v_mfma_f32_16x16x32_bf16 v[212:215], v[72:75], v[44:47], v[212:215]
  v_mfma_f32_16x16x32_bf16 v[212:215], v[68:71], v[48:51], v[212:215]
  ds_read_b128 v[112:115], v20 offset:27904
  v_mfma_f32_16x16x32_bf16 v[212:215], v[64:67], v[52:55], v[212:215]
  buffer_load_dwordx4 v3, s[12:15], s53 offen offset:1024 nt lds
  v_mfma_f32_16x16x32_bf16 v[216:219], v[88:91], v[32:35], 0
  ds_read_b128 v[148:151], v21 offset:26880
  v_mfma_f32_16x16x32_bf16 v[216:219], v[84:87], v[36:39], v[216:219]
  v_mfma_f32_16x16x32_bf16 v[216:219], v[80:83], v[40:43], v[216:219]
  ds_read_b128 v[116:119], v20 offset:28416
  v_mfma_f32_16x16x32_bf16 v[216:219], v[76:79], v[44:47], v[216:219]
  v_mfma_f32_16x16x32_bf16 v[216:219], v[72:75], v[48:51], v[216:219]
  ds_read_b128 v[152:155], v21 offset:26368
  v_mfma_f32_16x16x32_bf16 v[216:219], v[68:71], v[52:55], v[216:219]
  buffer_load_dwordx4 v3, s[12:15], s53 offen offset:2048 nt lds
  v_mfma_f32_16x16x32_bf16 v[216:219], v[64:67], v[56:59], v[216:219]
  ds_read_b128 v[120:123], v20 offset:28928
  v_mfma_f32_16x16x32_bf16 v[220:223], v[92:95], v[32:35], 0
  v_mfma_f32_16x16x32_bf16 v[220:223], v[88:91], v[36:39], v[220:223]
  ds_read_b128 v[156:159], v21 offset:25856
  v_mfma_f32_16x16x32_bf16 v[220:223], v[84:87], v[40:43], v[220:223]
  v_mfma_f32_16x16x32_bf16 v[220:223], v[80:83], v[44:47], v[220:223]
  ds_read_b128 v[124:127], v20 offset:29440
  v_mfma_f32_16x16x32_bf16 v[220:223], v[76:79], v[48:51], v[220:223]
  buffer_load_dwordx4 v3, s[12:15], s53 offen offset:3072 nt lds
  v_mfma_f32_16x16x32_bf16 v[220:223], v[72:75], v[52:55], v[220:223]
  v_mfma_f32_16x16x32_bf16 v[220:223], v[68:71], v[56:59], v[220:223]
  v_mfma_f32_16x16x32_bf16 v[220:223], v[64:67], v[60:63], v[220:223]
  s_waitcnt lgkmcnt(0)
  v_mfma_f32_16x16x32_bf16 v[192:195], v[128:131], v[96:99], v[192:195]
  v_mfma_f32_16x16x32_bf16 v[196:199], v[132:135], v[96:99], v[196:199]
  ds_read_b128 v[64:67], v21 offset:29504
  v_mfma_f32_16x16x32_bf16 v[196:199], v[128:131], v[100:103], v[196:199]
  v_mfma_f32_16x16x32_bf16 v[200:203], v[136:139], v[96:99], v[200:203]
  ds_read_b128 v[32:35], v20 offset:25920
  v_mfma_f32_16x16x32_bf16 v[200:203], v[132:135], v[100:103], v[200:203]
  v_mfma_f32_16x16x32_bf16 v[200:203], v[128:131], v[104:107], v[200:203]
  ds_read_b128 v[68:71], v21 offset:28992
  v_mfma_f32_16x16x32_bf16 v[204:207], v[140:143], v[96:99], v[204:207]
  v_mfma_f32_16x16x32_bf16 v[204:207], v[136:139], v[100:103], v[204:207]
  ds_read_b128 v[36:39], v20 offset:26432
  v_mfma_f32_16x16x32_bf16 v[204:207], v[132:135], v[104:107], v[204:207]
  v_mfma_f32_16x16x32_bf16 v[204:207], v[128:131], v[108:111], v[204:207]
  ds_read_b128 v[72:75], v21 offset:28480
  v_mfma_f32_16x16x32_bf16 v[208:211], v[144:147], v[96:99], v[208:211]
  v_mfma_f32_16x16x32_bf16 v[208:211], v[140:143], v[100:103], v[208:211]
  ds_read_b128 v[40:43], v20 offset:26944
  v_mfma_f32_16x16x32_bf16 v[208:211], v[136:139], v[104:107], v[208:211]
  v_mfma_f32_16x16x32_bf16 v[208:211], v[132:135], v[108:111], v[208:211]
  ds_read_b128 v[76:79], v21 offset:27968
  v_mfma_f32_16x16x32_bf16 v[208:211], v[128:131], v[112:115], v[208:211]
  v_mfma_f32_16x16x32_bf16 v[212:215], v[148:151], v[96:99], v[212:215]
  ds_read_b128 v[44:47], v20 offset:27456
  v_mfma_f32_16x16x32_bf16 v[212:215], v[144:147], v[100:103], v[212:215]
  v_mfma_f32_16x16x32_bf16 v[212:215], v[140:143], v[104:107], v[212:215]
  ds_read_b128 v[80:83], v21 offset:27456
  v_mfma_f32_16x16x32_bf16 v[212:215], v[136:139], v[108:111], v[212:215]
  v_mfma_f32_16x16x32_bf16 v[212:215], v[132:135], v[112:115], v[212:215]
  ds_read_b128 v[48:51], v20 offset:27968
  v_mfma_f32_16x16x32_bf16 v[212:215], v[128:131], v[116:119], v[212:215]
  v_mfma_f32_16x16x32_bf16 v[216:219], v[152:155], v[96:99], v[216:219]
  ds_read_b128 v[84:87], v21 offset:26944
  v_mfma_f32_16x16x32_bf16 v[216:219], v[148:151], v[100:103], v[216:219]
  v_mfma_f32_16x16x32_bf16 v[216:219], v[144:147], v[104:107], v[216:219]
  ds_read_b128 v[52:55], v20 offset:28480
  v_mfma_f32_16x16x32_bf16 v[216:219], v[140:143], v[108:111], v[216:219]
  v_mfma_f32_16x16x32_bf16 v[216:219], v[136:139], v[112:115], v[216:219]
  ds_read_b128 v[88:91], v21 offset:26432
  v_mfma_f32_16x16x32_bf16 v[216:219], v[132:135], v[116:119], v[216:219]
  v_mfma_f32_16x16x32_bf16 v[216:219], v[128:131], v[120:123], v[216:219]
  ds_read_b128 v[56:59], v20 offset:28992
  v_mfma_f32_16x16x32_bf16 v[220:223], v[156:159], v[96:99], v[220:223]
  v_mfma_f32_16x16x32_bf16 v[220:223], v[152:155], v[100:103], v[220:223]
  ds_read_b128 v[92:95], v21 offset:25920
  v_mfma_f32_16x16x32_bf16 v[220:223], v[148:151], v[104:107], v[220:223]
  v_mfma_f32_16x16x32_bf16 v[220:223], v[144:147], v[108:111], v[220:223]
  ds_read_b128 v[60:63], v20 offset:29504
  v_mfma_f32_16x16x32_bf16 v[220:223], v[140:143], v[112:115], v[220:223]
  v_mfma_f32_16x16x32_bf16 v[220:223], v[136:139], v[116:119], v[220:223]
  v_mfma_f32_16x16x32_bf16 v[220:223], v[132:135], v[120:123], v[220:223]
  v_mfma_f32_16x16x32_bf16 v[220:223], v[128:131], v[124:127], v[220:223]
  s_waitcnt lgkmcnt(0)
  v_mfma_f32_16x16x32_bf16 v[192:195], v[64:67], v[32:35], v[192:195]
  v_mfma_f32_16x16x32_bf16 v[196:199], v[68:71], v[32:35], v[196:199]
  ds_read_b128 v[128:131], v21 offset:29568
  v_mfma_f32_16x16x32_bf16 v[196:199], v[64:67], v[36:39], v[196:199]
  v_mfma_f32_16x16x32_bf16 v[200:203], v[72:75], v[32:35], v[200:203]
  ds_read_b128 v[96:99], v20 offset:25984
  v_mfma_f32_16x16x32_bf16 v[200:203], v[68:71], v[36:39], v[200:203]
  v_mfma_f32_16x16x32_bf16 v[200:203], v[64:67], v[40:43], v[200:203]
  ds_read_b128 v[132:135], v21 offset:29056
  v_mfma_f32_16x16x32_bf16 v[204:207], v[76:79], v[32:35], v[204:207]
  v_mfma_f32_16x16x32_bf16 v[204:207], v[72:75], v[36:39], v[204:207]
  ds_read_b128 v[100:103], v20 offset:26496
  v_mfma_f32_16x16x32_bf16 v[204:207], v[68:71], v[40:43], v[204:207]
  v_mfma_f32_16x16x32_bf16 v[204:207], v[64:67], v[44:47], v[204:207]
  ds_read_b128 v[136:139], v21 offset:28544
  v_mfma_f32_16x16x32_bf16 v[208:211], v[80:83], v[32:35], v[208:211]
  v_mfma_f32_16x16x32_bf16 v[208:211], v[76:79], v[36:39], v[208:211]
  ds_read_b128 v[104:107], v20 offset:27008
  v_mfma_f32_16x16x32_bf16 v[208:211], v[72:75], v[40:43], v[208:211]
  v_mfma_f32_16x16x32_bf16 v[208:211], v[68:71], v[44:47], v[208:211]
  ds_read_b128 v[140:143], v21 offset:28032
  v_mfma_f32_16x16x32_bf16 v[208:211], v[64:67], v[48:51], v[208:211]
  v_mfma_f32_16x16x32_bf16 v[212:215], v[84:87], v[32:35], v[212:215]
  ds_read_b128 v[108:111], v20 offset:27520
  v_mfma_f32_16x16x32_bf16 v[212:215], v[80:83], v[36:39], v[212:215]
  v_mfma_f32_16x16x32_bf16 v[212:215], v[76:79], v[40:43], v[212:215]
  ds_read_b128 v[144:147], v21 offset:27520
  v_mfma_f32_16x16x32_bf16 v[212:215], v[72:75], v[44:47], v[212:215]
  v_mfma_f32_16x16x32_bf16 v[212:215], v[68:71], v[48:51], v[212:215]
  ds_read_b128 v[112:115], v20 offset:28032
  v_mfma_f32_16x16x32_bf16 v[212:215], v[64:67], v[52:55], v[212:215]
  v_mfma_f32_16x16x32_bf16 v[216:219], v[88:91], v[32:35], v[216:219]
  ds_read_b128 v[148:151], v21 offset:27008
  v_mfma_f32_16x16x32_bf16 v[216:219], v[84:87], v[36:39], v[216:219]
  v_mfma_f32_16x16x32_bf16 v[216:219], v[80:83], v[40:43], v[216:219]
  ds_read_b128 v[116:119], v20 offset:28544
  v_mfma_f32_16x16x32_bf16 v[216:219], v[76:79], v[44:47], v[216:219]
  v_mfma_f32_16x16x32_bf16 v[216:219], v[72:75], v[48:51], v[216:219]
  ds_read_b128 v[152:155], v21 offset:26496
  v_mfma_f32_16x16x32_bf16 v[216:219], v[68:71], v[52:55], v[216:219]
  v_mfma_f32_16x16x32_bf16 v[216:219], v[64:67], v[56:59], v[216:219]
  ds_read_b128 v[120:123], v20 offset:29056
  v_mfma_f32_16x16x32_bf16 v[220:223], v[92:95], v[32:35], v[220:223]
  v_mfma_f32_16x16x32_bf16 v[220:223], v[88:91], v[36:39], v[220:223]
  ds_read_b128 v[156:159], v21 offset:25984
  v_mfma_f32_16x16x32_bf16 v[220:223], v[84:87], v[40:43], v[220:223]
  v_mfma_f32_16x16x32_bf16 v[220:223], v[80:83], v[44:47], v[220:223]
  ds_read_b128 v[124:127], v20 offset:29568
  v_mfma_f32_16x16x32_bf16 v[220:223], v[76:79], v[48:51], v[220:223]
  v_mfma_f32_16x16x32_bf16 v[220:223], v[72:75], v[52:55], v[220:223]
  v_mfma_f32_16x16x32_bf16 v[220:223], v[68:71], v[56:59], v[220:223]
  v_mfma_f32_16x16x32_bf16 v[220:223], v[64:67], v[60:63], v[220:223]
  s_waitcnt lgkmcnt(0)
  v_mfma_f32_16x16x32_bf16 v[192:195], v[128:131], v[96:99], v[192:195]
  v_mfma_f32_16x16x32_bf16 v[196:199], v[132:135], v[96:99], v[196:199]
  v_mfma_f32_16x16x32_bf16 v[196:199], v[128:131], v[100:103], v[196:199]
  v_mfma_f32_16x16x32_bf16 v[200:203], v[136:139], v[96:99], v[200:203]
  v_mfma_f32_16x16x32_bf16 v[200:203], v[132:135], v[100:103], v[200:203]
  v_mfma_f32_16x16x32_bf16 v[200:203], v[128:131], v[104:107], v[200:203]
  v_mfma_f32_16x16x32_bf16 v[204:207], v[140:143], v[96:99], v[204:207]
  v_mfma_f32_16x16x32_bf16 v[204:207], v[136:139], v[100:103], v[204:207]
  v_mfma_f32_16x16x32_bf16 v[204:207], v[132:135], v[104:107], v[204:207]
  v_mfma_f32_16x16x32_bf16 v[204:207], v[128:131], v[108:111], v[204:207]
  v_mfma_f32_16x16x32_bf16 v[208:211], v[144:147], v[96:99], v[208:211]
  v_mfma_f32_16x16x32_bf16 v[208:211], v[140:143], v[100:103], v[208:211]
  v_mfma_f32_16x16x32_bf16 v[208:211], v[136:139], v[104:107], v[208:211]
  v_mfma_f32_16x16x32_bf16 v[208:211], v[132:135], v[108:111], v[208:211]
  v_mfma_f32_16x16x32_bf16 v[208:211], v[128:131], v[112:115], v[208:211]
  v_mfma_f32_16x16x32_bf16 v[212:215], v[148:151], v[96:99], v[212:215]
  v_mfma_f32_16x16x32_bf16 v[212:215], v[144:147], v[100:103], v[212:215]
  v_mfma_f32_16x16x32_bf16 v[212:215], v[140:143], v[104:107], v[212:215]
  v_mfma_f32_16x16x32_bf16 v[212:215], v[136:139], v[108:111], v[212:215]
  v_mfma_f32_16x16x32_bf16 v[212:215], v[132:135], v[112:115], v[212:215]
  v_mfma_f32_16x16x32_bf16 v[212:215], v[128:131], v[116:119], v[212:215]
  v_mfma_f32_16x16x32_bf16 v[216:219], v[152:155], v[96:99], v[216:219]
  v_mfma_f32_16x16x32_bf16 v[216:219], v[148:151], v[100:103], v[216:219]
  v_mfma_f32_16x16x32_bf16 v[216:219], v[144:147], v[104:107], v[216:219]
  v_mfma_f32_16x16x32_bf16 v[216:219], v[140:143], v[108:111], v[216:219]
  v_mfma_f32_16x16x32_bf16 v[216:219], v[136:139], v[112:115], v[216:219]
  v_mfma_f32_16x16x32_bf16 v[216:219], v[132:135], v[116:119], v[216:219]
  v_mfma_f32_16x16x32_bf16 v[216:219], v[128:131], v[120:123], v[216:219]
  v_mfma_f32_16x16x32_bf16 v[220:223], v[156:159], v[96:99], v[220:223]
  v_mfma_f32_16x16x32_bf16 v[220:223], v[152:155], v[100:103], v[220:223]
  v_mfma_f32_16x16x32_bf16 v[220:223], v[148:151], v[104:107], v[220:223]
  v_mfma_f32_16x16x32_bf16 v[220:223], v[144:147], v[108:111], v[220:223]
  v_mfma_f32_16x16x32_bf16 v[220:223], v[140:143], v[112:115], v[220:223]
  v_mfma_f32_16x16x32_bf16 v[220:223], v[136:139], v[116:119], v[220:223]
  v_mfma_f32_16x16x32_bf16 v[220:223], v[132:135], v[120:123], v[220:223]
  v_mfma_f32_16x16x32_bf16 v[220:223], v[128:131], v[124:127], v[220:223]
  s_nop 7
  s_nop 7
  v_lshlrev_b32 v6, 8, v5
  v_lshl_add_u32 v6, v4, 3, v6
  v_add_u32 v7, 85568, v6
  ds_write_b64 v7, v[160:161] offset:0
  ds_write_b64 v7, v[162:163] offset:128
  ds_write_b64 v7, v[164:165] offset:1024
  ds_write_b64 v7, v[166:167] offset:1152
  ds_write_b64 v7, v[168:169] offset:2048
  ds_write_b64 v7, v[170:171] offset:2176
  ds_write_b64 v7, v[172:173] offset:3072
  ds_write_b64 v7, v[174:175] offset:3200
  ds_write_b64 v7, v[176:177] offset:4096
  ds_write_b64 v7, v[178:179] offset:4224
  ds_write_b64 v7, v[180:181] offset:5120
  ds_write_b64 v7, v[182:183] offset:5248
  ds_write_b64 v7, v[184:185] offset:6144
  ds_write_b64 v7, v[186:187] offset:6272
  ds_write_b64 v7, v[188:189] offset:7168
  ds_write_b64 v7, v[190:191] offset:7296
  v_add_u32 v7, 93760, v6
  ds_write_b64 v7, v[192:193] offset:0
  ds_write_b64 v7, v[194:195] offset:128
  ds_write_b64 v7, v[196:197] offset:1024
  ds_write_b64 v7, v[198:199] offset:1152
  ds_write_b64 v7, v[200:201] offset:2048
  ds_write_b64 v7, v[202:203] offset:2176
  ds_write_b64 v7, v[204:205] offset:3072
  ds_write_b64 v7, v[206:207] offset:3200
  ds_write_b64 v7, v[208:209] offset:4096
  ds_write_b64 v7, v[210:211] offset:4224
  ds_write_b64 v7, v[212:213] offset:5120
  ds_write_b64 v7, v[214:215] offset:5248
  ds_write_b64 v7, v[216:217] offset:6144
  ds_write_b64 v7, v[218:219] offset:6272
  ds_write_b64 v7, v[220:221] offset:7168
  ds_write_b64 v7, v[222:223] offset:7296
  s_branch L_mmd
L_mm2:
  s_cmp_lg_u32 s39, 2
  s_cbranch_scc1 L_mm3
  ds_read_b128 v[64:67], v21 offset:29632
  ds_read_b128 v[32:35], v20 offset:26048
  ds_read_b128 v[68:71], v21 offset:29120
  ds_read_b128 v[36:39], v20 offset:26560
  ds_read_b128 v[72:75], v21 offset:28608
  ds_read_b128 v[40:43], v20 offset:27072
  ds_read_b128 v[76:79], v21 offset:28096
  ds_read_b128 v[44:47], v20 offset:27584
  ds_read_b128 v[80:83], v21 offset:27584
  ds_read_b128 v[48:51], v20 offset:28096
  ds_read_b128 v[84:87], v21 offset:27072
  ds_read_b128 v[52:55], v20 offset:28608
  ds_read_b128 v[88:91], v21 offset:26560
  ds_read_b128 v[56:59], v20 offset:29120
  ds_read_b128 v[92:95], v21 offset:26048
  ds_read_b128 v[60:63], v20 offset:29632
  s_waitcnt lgkmcnt(14)
  v_mfma_f32_16x16x32_bf16 v[160:163], v[64:67], v[32:35], 0
  s_waitcnt lgkmcnt(12)
  v_mfma_f32_16x16x32_bf16 v[164:167], v[68:71], v[32:35], 0
  v_mfma_f32_16x16x32_bf16 v[164:167], v[64:67], v[36:39], v[164:167]
  s_waitcnt lgkmcnt(10)
  v_mfma_f32_16x16x32_bf16 v[168:171], v[72:75], v[32:35], 0
  v_mfma_f32_16x16x32_bf16 v[168:171], v[68:71], v[36:39], v[168:171]
  v_mfma_f32_16x16x32_bf16 v[168:171], v[64:67], v[40:43], v[168:171]
  s_waitcnt lgkmcnt(8)
  v_mfma_f32_16x16x32_bf16 v[172:175], v[76:79], v[32:35], 0
  v_mfma_f32_16x16x32_bf16 v[172:175], v[72:75], v[36:39], v[172:175]
  v_mfma_f32_16x16x32_bf16 v[172:175], v[68:71], v[40:43], v[172:175]
  v_mfma_f32_16x16x32_bf16 v[172:175], v[64:67], v[44:47], v[172:175]
  s_waitcnt lgkmcnt(6)
  v_mfma_f32_16x16x32_bf16 v[176:179], v[80:83], v[32:35], 0
  v_mfma_f32_16x16x32_bf16 v[176:179], v[76:79], v[36:39], v[176:179]
  ds_read_b128 v[128:131], v21 offset:29696
  v_mfma_f32_16x16x32_bf16 v[176:179], v[72:75], v[40:43], v[176:179]
  v_mfma_f32_16x16x32_bf16 v[176:179], v[68:71], v[44:47], v[176:179]
  ds_read_b128 v[96:99], v20 offset:26112
  v_mfma_f32_16x16x32_bf16 v[176:179], v[64:67], v[48:51], v[176:179]
  s_waitcnt lgkmcnt(6)
  v_mfma_f32_16x16x32_bf16 v[180:183], v[84:87], v[32:35], 0
  ds_read_b128 v[132:135], v21 offset:29184
  v_mfma_f32_16x16x32_bf16 v[180:183], v[80:83], v[36:39], v[180:183]
  v_mfma_f32_16x16x32_bf16 v[180:183], v[76:79], v[40:43], v[180:183]
  ds_read_b128 v[100:103], v20 offset:26624
  v_mfma_f32_16x16x32_bf16 v[180:183], v[72:75], v[44:47], v[180:183]
  v_mfma_f32_16x16x32_bf16 v[180:183], v[68:71], v[48:51], v[180:183]
  ds_read_b128 v[136:139], v21 offset:28672
  v_mfma_f32_16x16x32_bf16 v[180:183], v[64:67], v[52:55], v[180:183]
  s_waitcnt lgkmcnt(7)
  v_mfma_f32_16x16x32_bf16 v[184:187], v[88:91], v[32:35], 0
  ds_read_b128 v[104:107], v20 offset:27136
  v_mfma_f32_16x16x32_bf16 v[184:187], v[84:87], v[36:39], v[184:187]
  v_mfma_f32_16x16x32_bf16 v[184:187], v[80:83], v[40:43], v[184:187]
  ds_read_b128 v[140:143], v21 offset:28160
  v_mfma_f32_16x16x32_bf16 v[184:187], v[76:79], v[44:47], v[184:187]
  v_mfma_f32_16x16x32_bf16 v[184:187], v[72:75], v[48:51], v[184:187]
  ds_read_b128 v[108:111], v20 offset:27648
  v_mfma_f32_16x16x32_bf16 v[184:187], v[68:71], v[52:55], v[184:187]
  v_mfma_f32_16x16x32_bf16 v[184:187], v[64:67], v[56:59], v[184:187]
  ds_read_b128 v[144:147], v21 offset:27648
  s_waitcnt lgkmcnt(9)
  v_mfma_f32_16x16x32_bf16 v[188:191], v[92:95], v[32:35], 0
  v_mfma_f32_16x16x32_bf16 v[188:191], v[88:91], v[36:39], v[188:191]
  ds_read_b128 v[112:115], v20 offset:28160
  v_mfma_f32_16x16x32_bf16 v[188:191], v[84:87], v[40:43], v[188:191]
  v_mfma_f32_16x16x32_bf16 v[188:191], v[80:83], v[44:47], v[188:191]
  ds_read_b128 v[148:151], v21 offset:27136
  v_mfma_f32_16x16x32_bf16 v[188:191], v[76:79], v[48:51], v[188:191]
  v_mfma_f32_16x16x32_bf16 v[188:191], v[72:75], v[52:55], v[188:191]
  ds_read_b128 v[116:119], v20 offset:28672
  v_mfma_f32_16x16x32_bf16 v[188:191], v[68:71], v[56:59], v[188:191]
  v_mfma_f32_16x16x32_bf16 v[188:191], v[64:67], v[60:63], v[188:191]
  ds_read_b128 v[152:155], v21 offset:26624
  ds_read_b128 v[120:123], v20 offset:29184
  ds_read_b128 v[156:159], v21 offset:26112
  ds_read_b128 v[124:127], v20 offset:29696
  s_waitcnt lgkmcnt(0)
  v_mfma_f32_16x16x32_bf16 v[160:163], v[128:131], v[96:99], v[160:163]
  v_mfma_f32_16x16x32_bf16 v[164:167], v[132:135], v[96:99], v[164:167]
  ds_read_b128 v[64:67], v21 offset:29760
  v_mfma_f32_16x16x32_bf16 v[164:167], v[128:131], v[100:103], v[164:167]
  s_add_u32 m0, s57, 126528
  s_add_u32 s53, s54, 0
  buffer_load_dwordx4 v3, s[12:15], s53 offen offset:0 nt lds
  v_mfma_f32_16x16x32_bf16 v[168:171], v[136:139], v[96:99], v[168:171]
  ds_read_b128 v[32:35], v20 offset:26176
  v_mfma_f32_16x16x32_bf16 v[168:171], v[132:135], v[100:103], v[168:171]
  v_mfma_f32_16x16x32_bf16 v[168:171], v[128:131], v[104:107], v[168:171]
  ds_read_b128 v[68:71], v21 offset:29248
  v_mfma_f32_16x16x32_bf16 v[172:175], v[140:143], v[96:99], v[172:175]
  v_mfma_f32_16x16x32_bf16 v[172:175], v[136:139], v[100:103], v[172:175]
  ds_read_b128 v[36:39], v20 offset:26688
  v_mfma_f32_16x16x32_bf16 v[172:175], v[132:135], v[104:107], v[172:175]
  buffer_load_dwordx4 v3, s[12:15], s53 offen offset:1024 nt lds
  v_mfma_f32_16x16x32_bf16 v[172:175], v[128:131], v[108:111], v[172:175]
  ds_read_b128 v[72:75], v21 offset:28736
  v_mfma_f32_16x16x32_bf16 v[176:179], v[144:147], v[96:99], v[176:179]
  v_mfma_f32_16x16x32_bf16 v[176:179], v[140:143], v[100:103], v[176:179]
  ds_read_b128 v[40:43], v20 offset:27200
  v_mfma_f32_16x16x32_bf16 v[176:179], v[136:139], v[104:107], v[176:179]
  v_mfma_f32_16x16x32_bf16 v[176:179], v[132:135], v[108:111], v[176:179]
  ds_read_b128 v[76:79], v21 offset:28224
  v_mfma_f32_16x16x32_bf16 v[176:179], v[128:131], v[112:115], v[176:179]
  buffer_load_dwordx4 v3, s[12:15], s53 offen offset:2048 nt lds
  v_mfma_f32_16x16x32_bf16 v[180:183], v[148:151], v[96:99], v[180:183]
  ds_read_b128 v[44:47], v20 offset:27712
  v_mfma_f32_16x16x32_bf16 v[180:183], v[144:147], v[100:103], v[180:183]
  v_mfma_f32_16x16x32_bf16 v[180:183], v[140:143], v[104:107], v[180:183]
  ds_read_b128 v[80:83], v21 offset:27712
  v_mfma_f32_16x16x32_bf16 v[180:183], v[136:139], v[108:111], v[180:183]
  v_mfma_f32_16x16x32_bf16 v[180:183], v[132:135], v[112:115], v[180:183]
  ds_read_b128 v[48:51], v20 offset:28224
  v_mfma_f32_16x16x32_bf16 v[180:183], v[128:131], v[116:119], v[180:183]
  buffer_load_dwordx4 v3, s[12:15], s53 offen offset:3072 nt lds
  v_mfma_f32_16x16x32_bf16 v[184:187], v[152:155], v[96:99], v[184:187]
  ds_read_b128 v[84:87], v21 offset:27200
  v_mfma_f32_16x16x32_bf16 v[184:187], v[148:151], v[100:103], v[184:187]
  v_mfma_f32_16x16x32_bf16 v[184:187], v[144:147], v[104:107], v[184:187]
  ds_read_b128 v[52:55], v20 offset:28736
  v_mfma_f32_16x16x32_bf16 v[184:187], v[140:143], v[108:111], v[184:187]
  v_mfma_f32_16x16x32_bf16 v[184:187], v[136:139], v[112:115], v[184:187]
  ds_read_b128 v[88:91], v21 offset:26688
  v_mfma_f32_16x16x32_bf16 v[184:187], v[132:135], v[116:119], v[184:187]
  s_add_u32 m0, s57, 130624
  s_add_u32 s53, s54, 4096
  buffer_load_dwordx4 v3, s[12:15], s53 offen offset:0 nt lds
  v_mfma_f32_16x16x32_bf16 v[184:187], v[128:131], v[120:123], v[184:187]
  ds_read_b128 v[56:59], v20 offset:29248
  v_mfma_f32_16x16x32_bf16 v[188:191], v[156:159], v[96:99], v[188:191]
  v_mfma_f32_16x16x32_bf16 v[188:191], v[152:155], v[100:103], v[188:191]
  ds_read_b128 v[92:95], v21 offset:26176
  v_mfma_f32_16x16x32_bf16 v[188:191], v[148:151], v[104:107], v[188:191]
  v_mfma_f32_16x16x32_bf16 v[188:191], v[144:147], v[108:111], v[188:191]
  ds_read_b128 v[60:63], v20 offset:29760
  v_mfma_f32_16x16x32_bf16 v[188:191], v[140:143], v[112:115], v[188:191]
  buffer_load_dwordx4 v3, s[12:15], s53 offen offset:1024 nt lds
  v_mfma_f32_16x16x32_bf16 v[188:191], v[136:139], v[116:119], v[188:191]
  v_mfma_f32_16x16x32_bf16 v[188:191], v[132:135], v[120:123], v[188:191]
  v_mfma_f32_16x16x32_bf16 v[188:191], v[128:131], v[124:127], v[188:191]
  s_waitcnt lgkmcnt(0)
  v_mfma_f32_16x16x32_bf16 v[160:163], v[64:67], v[32:35], v[160:163]
  v_mfma_f32_16x16x32_bf16 v[164:167], v[68:71], v[32:35], v[164:167]
  ds_read_b128 v[128:131], v21 offset:29824
  v_mfma_f32_16x16x32_bf16 v[164:167], v[64:67], v[36:39], v[164:167]
  buffer_load_dwordx4 v3, s[12:15], s53 offen offset:2048 nt lds
  v_mfma_f32_16x16x32_bf16 v[168:171], v[72:75], v[32:35], v[168:171]
  ds_read_b128 v[96:99], v20 offset:26240
  v_mfma_f32_16x16x32_bf16 v[168:171], v[68:71], v[36:39], v[168:171]
  v_mfma_f32_16x16x32_bf16 v[168:171], v[64:67], v[40:43], v[168:171]
  ds_read_b128 v[132:135], v21 offset:29312
  v_mfma_f32_16x16x32_bf16 v[172:175], v[76:79], v[32:35], v[172:175]
  v_mfma_f32_16x16x32_bf16 v[172:175], v[72:75], v[36:39], v[172:175]
  ds_read_b128 v[100:103], v20 offset:26752
  v_mfma_f32_16x16x32_bf16 v[172:175], v[68:71], v[40:43], v[172:175]
  buffer_load_dwordx4 v3, s[12:15], s53 offen offset:3072 nt lds
  v_mfma_f32_16x16x32_bf16 v[172:175], v[64:67], v[44:47], v[172:175]
  ds_read_b128 v[136:139], v21 offset:28800
  v_mfma_f32_16x16x32_bf16 v[176:179], v[80:83], v[32:35], v[176:179]
  v_mfma_f32_16x16x32_bf16 v[176:179], v[76:79], v[36:39], v[176:179]
  ds_read_b128 v[104:107], v20 offset:27264
  v_mfma_f32_16x16x32_bf16 v[176:179], v[72:75], v[40:43], v[176:179]
  v_mfma_f32_16x16x32_bf16 v[176:179], v[68:71], v[44:47], v[176:179]
  ds_read_b128 v[140:143], v21 offset:28288
  v_mfma_f32_16x16x32_bf16 v[176:179], v[64:67], v[48:51], v[176:179]
  s_add_u32 m0, s57, 134720
  s_add_u32 s53, s54, 8192
  buffer_load_dwordx4 v3, s[12:15], s53 offen offset:0 nt lds
  v_mfma_f32_16x16x32_bf16 v[180:183], v[84:87], v[32:35], v[180:183]
  ds_read_b128 v[108:111], v20 offset:27776
  v_mfma_f32_16x16x32_bf16 v[180:183], v[80:83], v[36:39], v[180:183]
  v_mfma_f32_16x16x32_bf16 v[180:183], v[76:79], v[40:43], v[180:183]
  ds_read_b128 v[144:147], v21 offset:27776
  v_mfma_f32_16x16x32_bf16 v[180:183], v[72:75], v[44:47], v[180:183]
  v_mfma_f32_16x16x32_bf16 v[180:183], v[68:71], v[48:51], v[180:183]
  ds_read_b128 v[112:115], v20 offset:28288
  v_mfma_f32_16x16x32_bf16 v[180:183], v[64:67], v[52:55], v[180:183]
  buffer_load_dwordx4 v3, s[12:15], s53 offen offset:1024 nt lds
  v_mfma_f32_16x16x32_bf16 v[184:187], v[88:91], v[32:35], v[184:187]
  ds_read_b128 v[148:151], v21 offset:27264
  v_mfma_f32_16x16x32_bf16 v[184:187], v[84:87], v[36:39], v[184:187]
  v_mfma_f32_16x16x32_bf16 v[184:187], v[80:83], v[40:43], v[184:187]
  ds_read_b128 v[116:119], v20 offset:28800
  v_mfma_f32_16x16x32_bf16 v[184:187], v[76:79], v[44:47], v[184:187]
  v_mfma_f32_16x16x32_bf16 v[184:187], v[72:75], v[48:51], v[184:187]
  ds_read_b128 v[152:155], v21 offset:26752
  v_mfma_f32_16x16x32_bf16 v[184:187], v[68:71], v[52:55], v[184:187]
  buffer_load_dwordx4 v3, s[12:15], s53 offen offset:2048 nt lds
  v_mfma_f32_16x16x32_bf16 v[184:187], v[64:67], v[56:59], v[184:187]
  ds_read_b128 v[120:123], v20 offset:29312
  v_mfma_f32_16x16x32_bf16 v[188:191], v[92:95], v[32:35], v[188:191]
  v_mfma_f32_16x16x32_bf16 v[188:191], v[88:91], v[36:39], v[188:191]
  ds_read_b128 v[156:159], v21 offset:26240
  v_mfma_f32_16x16x32_bf16 v[188:191], v[84:87], v[40:43], v[188:191]
  v_mfma_f32_16x16x32_bf16 v[188:191], v[80:83], v[44:47], v[188:191]
  ds_read_b128 v[124:127], v20 offset:29824
  v_mfma_f32_16x16x32_bf16 v[188:191], v[76:79], v[48:51], v[188:191]
  buffer_load_dwordx4 v3, s[12:15], s53 offen offset:3072 nt lds
  v_mfma_f32_16x16x32_bf16 v[188:191], v[72:75], v[52:55], v[188:191]
  v_mfma_f32_16x16x32_bf16 v[188:191], v[68:71], v[56:59], v[188:191]
  v_mfma_f32_16x16x32_bf16 v[188:191], v[64:67], v[60:63], v[188:191]
  s_waitcnt lgkmcnt(0)
  v_mfma_f32_16x16x32_bf16 v[160:163], v[128:131], v[96:99], v[160:163]
  v_mfma_f32_16x16x32_bf16 v[164:167], v[132:135], v[96:99], v[164:167]
  ds_read_b128 v[64:67], v21 offset:55168
  v_mfma_f32_16x16x32_bf16 v[164:167], v[128:131], v[100:103], v[164:167]
  v_mfma_f32_16x16x32_bf16 v[168:171], v[136:139], v[96:99], v[168:171]
  ds_read_b128 v[32:35], v20 offset:51584
  v_mfma_f32_16x16x32_bf16 v[168:171], v[132:135], v[100:103], v[168:171]
  v_mfma_f32_16x16x32_bf16 v[168:171], v[128:131], v[104:107], v[168:171]
  ds_read_b128 v[68:71], v21 offset:54656
  v_mfma_f32_16x16x32_bf16 v[172:175], v[140:143], v[96:99], v[172:175]
  v_mfma_f32_16x16x32_bf16 v[172:175], v[136:139], v[100:103], v[172:175]
  ds_read_b128 v[36:39], v20 offset:52096
  v_mfma_f32_16x16x32_bf16 v[172:175], v[132:135], v[104:107], v[172:175]
  v_mfma_f32_16x16x32_bf16 v[172:175], v[128:131], v[108:111], v[172:175]
  ds_read_b128 v[72:75], v21 offset:54144
  v_mfma_f32_16x16x32_bf16 v[176:179], v[144:147], v[96:99], v[176:179]
  v_mfma_f32_16x16x32_bf16 v[176:179], v[140:143], v[100:103], v[176:179]
  ds_read_b128 v[40:43], v20 offset:52608
  v_mfma_f32_16x16x32_bf16 v[176:179], v[136:139], v[104:107], v[176:179]
  v_mfma_f32_16x16x32_bf16 v[176:179], v[132:135], v[108:111], v[176:179]
  ds_read_b128 v[76:79], v21 offset:53632
  v_mfma_f32_16x16x32_bf16 v[176:179], v[128:131], v[112:115], v[176:179]
  v_mfma_f32_16x16x32_bf16 v[180:183], v[148:151], v[96:99], v[180:183]
  ds_read_b128 v[44:47], v20 offset:53120
  v_mfma_f32_16x16x32_bf16 v[180:183], v[144:147], v[100:103], v[180:183]
  v_mfma_f32_16x16x32_bf16 v[180:183], v[140:143], v[104:107], v[180:183]
  ds_read_b128 v[80:83], v21 offset:53120
  v_mfma_f32_16x16x32_bf16 v[180:183], v[136:139], v[108:111], v[180:183]
  v_mfma_f32_16x16x32_bf16 v[180:183], v[132:135], v[112:115], v[180:183]
  ds_read_b128 v[48:51], v20 offset:53632
  v_mfma_f32_16x16x32_bf16 v[180:183], v[128:131], v[116:119], v[180:183]
  v_mfma_f32_16x16x32_bf16 v[184:187], v[152:155], v[96:99], v[184:187]
  ds_read_b128 v[84:87], v21 offset:52608
  v_mfma_f32_16x16x32_bf16 v[184:187], v[148:151], v[100:103], v[184:187]
  v_mfma_f32_16x16x32_bf16 v[184:187], v[144:147], v[104:107], v[184:187]
  ds_read_b128 v[52:55], v20 offset:54144
  v_mfma_f32_16x16x32_bf16 v[184:187], v[140:143], v[108:111], v[184:187]
  v_mfma_f32_16x16x32_bf16 v[184:187], v[136:139], v[112:115], v[184:187]
  ds_read_b128 v[88:91], v21 offset:52096
  v_mfma_f32_16x16x32_bf16 v[184:187], v[132:135], v[116:119], v[184:187]
  v_mfma_f32_16x16x32_bf16 v[184:187], v[128:131], v[120:123], v[184:187]
  ds_read_b128 v[56:59], v20 offset:54656
  v_mfma_f32_16x16x32_bf16 v[188:191], v[156:159], v[96:99], v[188:191]
  v_mfma_f32_16x16x32_bf16 v[188:191], v[152:155], v[100:103], v[188:191]
  ds_read_b128 v[92:95], v21 offset:51584
  v_mfma_f32_16x16x32_bf16 v[188:191], v[148:151], v[104:107], v[188:191]
  v_mfma_f32_16x16x32_bf16 v[188:191], v[144:147], v[108:111], v[188:191]
  ds_read_b128 v[60:63], v20 offset:55168
  v_mfma_f32_16x16x32_bf16 v[188:191], v[140:143], v[112:115], v[188:191]
  v_mfma_f32_16x16x32_bf16 v[188:191], v[136:139], v[116:119], v[188:191]
  v_mfma_f32_16x16x32_bf16 v[188:191], v[132:135], v[120:123], v[188:191]
  v_mfma_f32_16x16x32_bf16 v[188:191], v[128:131], v[124:127], v[188:191]
  s_waitcnt lgkmcnt(0)
  v_mfma_f32_16x16x32_bf16 v[192:195], v[64:67], v[32:35], 0
  v_mfma_f32_16x16x32_bf16 v[196:199], v[68:71], v[32:35], 0
  ds_read_b128 v[128:131], v21 offset:55232
  v_mfma_f32_16x16x32_bf16 v[196:199], v[64:67], v[36:39], v[196:199]
  v_mfma_f32_16x16x32_bf16 v[200:203], v[72:75], v[32:35], 0
  ds_read_b128 v[96:99], v20 offset:51648
  v_mfma_f32_16x16x32_bf16 v[200:203], v[68:71], v[36:39], v[200:203]
  v_mfma_f32_16x16x32_bf16 v[200:203], v[64:67], v[40:43], v[200:203]
  ds_read_b128 v[132:135], v21 offset:54720
  v_mfma_f32_16x16x32_bf16 v[204:207], v[76:79], v[32:35], 0
  v_mfma_f32_16x16x32_bf16 v[204:207], v[72:75], v[36:39], v[204:207]
  ds_read_b128 v[100:103], v20 offset:52160
  v_mfma_f32_16x16x32_bf16 v[204:207], v[68:71], v[40:43], v[204:207]
  v_mfma_f32_16x16x32_bf16 v[204:207], v[64:67], v[44:47], v[204:207]
  ds_read_b128 v[136:139], v21 offset:54208
  v_mfma_f32_16x16x32_bf16 v[208:211], v[80:83], v[32:35], 0
  v_mfma_f32_16x16x32_bf16 v[208:211], v[76:79], v[36:39], v[208:211]
  ds_read_b128 v[104:107], v20 offset:52672
  v_mfma_f32_16x16x32_bf16 v[208:211], v[72:75], v[40:43], v[208:211]
  v_mfma_f32_16x16x32_bf16 v[208:211], v[68:71], v[44:47], v[208:211]
  ds_read_b128 v[140:143], v21 offset:53696
  v_mfma_f32_16x16x32_bf16 v[208:211], v[64:67], v[48:51], v[208:211]
  v_mfma_f32_16x16x32_bf16 v[212:215], v[84:87], v[32:35], 0
  ds_read_b128 v[108:111], v20 offset:53184
  v_mfma_f32_16x16x32_bf16 v[212:215], v[80:83], v[36:39], v[212:215]
  v_mfma_f32_16x16x32_bf16 v[212:215], v[76:79], v[40:43], v[212:215]
  ds_read_b128 v[144:147], v21 offset:53184
  v_mfma_f32_16x16x32_bf16 v[212:215], v[72:75], v[44:47], v[212:215]
  v_mfma_f32_16x16x32_bf16 v[212:215], v[68:71], v[48:51], v[212:215]
  ds_read_b128 v[112:115], v20 offset:53696
  v_mfma_f32_16x16x32_bf16 v[212:215], v[64:67], v[52:55], v[212:215]
  v_mfma_f32_16x16x32_bf16 v[216:219], v[88:91], v[32:35], 0
  ds_read_b128 v[148:151], v21 offset:52672
  v_mfma_f32_16x16x32_bf16 v[216:219], v[84:87], v[36:39], v[216:219]
  v_mfma_f32_16x16x32_bf16 v[216:219], v[80:83], v[40:43], v[216:219]
  ds_read_b128 v[116:119], v20 offset:54208
  v_mfma_f32_16x16x32_bf16 v[216:219], v[76:79], v[44:47], v[216:219]
  v_mfma_f32_16x16x32_bf16 v[216:219], v[72:75], v[48:51], v[216:219]
  ds_read_b128 v[152:155], v21 offset:52160
  v_mfma_f32_16x16x32_bf16 v[216:219], v[68:71], v[52:55], v[216:219]
  v_mfma_f32_16x16x32_bf16 v[216:219], v[64:67], v[56:59], v[216:219]
  ds_read_b128 v[120:123], v20 offset:54720
  v_mfma_f32_16x16x32_bf16 v[220:223], v[92:95], v[32:35], 0
  v_mfma_f32_16x16x32_bf16 v[220:223], v[88:91], v[36:39], v[220:223]
  ds_read_b128 v[156:159], v21 offset:51648
  v_mfma_f32_16x16x32_bf16 v[220:223], v[84:87], v[40:43], v[220:223]
  v_mfma_f32_16x16x32_bf16 v[220:223], v[80:83], v[44:47], v[220:223]
  ds_read_b128 v[124:127], v20 offset:55232
  v_mfma_f32_16x16x32_bf16 v[220:223], v[76:79], v[48:51], v[220:223]
  v_mfma_f32_16x16x32_bf16 v[220:223], v[72:75], v[52:55], v[220:223]
  v_mfma_f32_16x16x32_bf16 v[220:223], v[68:71], v[56:59], v[220:223]
  v_mfma_f32_16x16x32_bf16 v[220:223], v[64:67], v[60:63], v[220:223]
  s_waitcnt lgkmcnt(0)
  v_mfma_f32_16x16x32_bf16 v[192:195], v[128:131], v[96:99], v[192:195]
  v_mfma_f32_16x16x32_bf16 v[196:199], v[132:135], v[96:99], v[196:199]
  v_mfma_f32_16x16x32_bf16 v[196:199], v[128:131], v[100:103], v[196:199]
  v_mfma_f32_16x16x32_bf16 v[200:203], v[136:139], v[96:99], v[200:203]
  v_mfma_f32_16x16x32_bf16 v[200:203], v[132:135], v[100:103], v[200:203]
  v_mfma_f32_16x16x32_bf16 v[200:203], v[128:131], v[104:107], v[200:203]
  v_mfma_f32_16x16x32_bf16 v[204:207], v[140:143], v[96:99], v[204:207]
  v_mfma_f32_16x16x32_bf16 v[204:207], v[136:139], v[100:103], v[204:207]
  v_mfma_f32_16x16x32_bf16 v[204:207], v[132:135], v[104:107], v[204:207]
  v_mfma_f32_16x16x32_bf16 v[204:207], v[128:131], v[108:111], v[204:207]
  v_mfma_f32_16x16x32_bf16 v[208:211], v[144:147], v[96:99], v[208:211]
  v_mfma_f32_16x16x32_bf16 v[208:211], v[140:143], v[100:103], v[208:211]
  v_mfma_f32_16x16x32_bf16 v[208:211], v[136:139], v[104:107], v[208:211]
  v_mfma_f32_16x16x32_bf16 v[208:211], v[132:135], v[108:111], v[208:211]
  v_mfma_f32_16x16x32_bf16 v[208:211], v[128:131], v[112:115], v[208:211]
  v_mfma_f32_16x16x32_bf16 v[212:215], v[148:151], v[96:99], v[212:215]
  v_mfma_f32_16x16x32_bf16 v[212:215], v[144:147], v[100:103], v[212:215]
  v_mfma_f32_16x16x32_bf16 v[212:215], v[140:143], v[104:107], v[212:215]
  v_mfma_f32_16x16x32_bf16 v[212:215], v[136:139], v[108:111], v[212:215]
  v_mfma_f32_16x16x32_bf16 v[212:215], v[132:135], v[112:115], v[212:215]
  v_mfma_f32_16x16x32_bf16 v[212:215], v[128:131], v[116:119], v[212:215]
  v_mfma_f32_16x16x32_bf16 v[216:219], v[152:155], v[96:99], v[216:219]
  v_mfma_f32_16x16x32_bf16 v[216:219], v[148:151], v[100:103], v[216:219]
  v_mfma_f32_16x16x32_bf16 v[216:219], v[144:147], v[104:107], v[216:219]
  v_mfma_f32_16x16x32_bf16 v[216:219], v[140:143], v[108:111], v[216:219]
  v_mfma_f32_16x16x32_bf16 v[216:219], v[136:139], v[112:115], v[216:219]
  v_mfma_f32_16x16x32_bf16 v[216:219], v[132:135], v[116:119], v[216:219]
  v_mfma_f32_16x16x32_bf16 v[216:219], v[128:131], v[120:123], v[216:219]
  v_mfma_f32_16x16x32_bf16 v[220:223], v[156:159], v[96:99], v[220:223]
  v_mfma_f32_16x16x32_bf16 v[220:223], v[152:155], v[100:103], v[220:223]
  v_mfma_f32_16x16x32_bf16 v[220:223], v[148:151], v[104:107], v[220:223]
  v_mfma_f32_16x16x32_bf16 v[220:223], v[144:147], v[108:111], v[220:223]
  v_mfma_f32_16x16x32_bf16 v[220:223], v[140:143], v[112:115], v[220:223]
  v_mfma_f32_16x16x32_bf16 v[220:223], v[136:139], v[116:119], v[220:223]
  v_mfma_f32_16x16x32_bf16 v[220:223], v[132:135], v[120:123], v[220:223]
  v_mfma_f32_16x16x32_bf16 v[220:223], v[128:131], v[124:127], v[220:223]
  s_nop 7
  s_nop 7
  v_lshlrev_b32 v6, 8, v5
  v_lshl_add_u32 v6, v4, 3, v6
  v_add_u32 v7, 101952, v6
  ds_write_b64 v7, v[160:161] offset:0
  ds_write_b64 v7, v[162:163] offset:128
  ds_write_b64 v7, v[164:165] offset:1024
  ds_write_b64 v7, v[166:167] offset:1152
  ds_write_b64 v7, v[168:169] offset:2048
  ds_write_b64 v7, v[170:171] offset:2176
  ds_write_b64 v7, v[172:173] offset:3072
  ds_write_b64 v7, v[174:175] offset:3200
  ds_write_b64 v7, v[176:177] offset:4096
  ds_write_b64 v7, v[178:179] offset:4224
  ds_write_b64 v7, v[180:181] offset:5120
  ds_write_b64 v7, v[182:183] offset:5248
  ds_write_b64 v7, v[184:185] offset:6144
  ds_write_b64 v7, v[186:187] offset:6272
  ds_write_b64 v7, v[188:189] offset:7168
  ds_write_b64 v7, v[190:191] offset:7296
  v_add_u32 v7, 110144, v6
  ds_write_b64 v7, v[192:193] offset:0
  ds_write_b64 v7, v[194:195] offset:128
  ds_write_b64 v7, v[196:197] offset:1024
  ds_write_b64 v7, v[198:199] offset:1152
  ds_write_b64 v7, v[200:201] offset:2048
  ds_write_b64 v7, v[202:203] offset:2176
  ds_write_b64 v7, v[204:205] offset:3072
  ds_write_b64 v7, v[206:207] offset:3200
  ds_write_b64 v7, v[208:209] offset:4096
  ds_write_b64 v7, v[210:211] offset:4224
  ds_write_b64 v7, v[212:213] offset:5120
  ds_write_b64 v7, v[214:215] offset:5248
  ds_write_b64 v7, v[216:217] offset:6144
  ds_write_b64 v7, v[218:219] offset:6272
  ds_write_b64 v7, v[220:221] offset:7168
  ds_write_b64 v7, v[222:223] offset:7296
  s_branch L_mmd
L_mm3:
  ds_read_b128 v[64:67], v21 offset:55296
  ds_read_b128 v[32:35], v20 offset:51712
  ds_read_b128 v[68:71], v21 offset:54784
  ds_read_b128 v[36:39], v20 offset:52224
  ds_read_b128 v[72:75], v21 offset:54272
  ds_read_b128 v[40:43], v20 offset:52736
  ds_read_b128 v[76:79], v21 offset:53760
  ds_read_b128 v[44:47], v20 offset:53248
  ds_read_b128 v[80:83], v21 offset:53248
  ds_read_b128 v[48:51], v20 offset:53760
  ds_read_b128 v[84:87], v21 offset:52736
  ds_read_b128 v[52:55], v20 offset:54272
  ds_read_b128 v[88:91], v21 offset:52224
  ds_read_b128 v[56:59], v20 offset:54784
  ds_read_b128 v[92:95], v21 offset:51712
  ds_read_b128 v[60:63], v20 offset:55296
  s_waitcnt lgkmcnt(14)
  v_mfma_f32_16x16x32_bf16 v[160:163], v[64:67], v[32:35], 0
  s_waitcnt lgkmcnt(12)
  v_mfma_f32_16x16x32_bf16 v[164:167], v[68:71], v[32:35], 0
  v_mfma_f32_16x16x32_bf16 v[164:167], v[64:67], v[36:39], v[164:167]
  s_waitcnt lgkmcnt(10)
  v_mfma_f32_16x16x32_bf16 v[168:171], v[72:75], v[32:35], 0
  v_mfma_f32_16x16x32_bf16 v[168:171], v[68:71], v[36:39], v[168:171]
  v_mfma_f32_16x16x32_bf16 v[168:171], v[64:67], v[40:43], v[168:171]
  s_waitcnt lgkmcnt(8)
  v_mfma_f32_16x16x32_bf16 v[172:175], v[76:79], v[32:35], 0
  v_mfma_f32_16x16x32_bf16 v[172:175], v[72:75], v[36:39], v[172:175]
  v_mfma_f32_16x16x32_bf16 v[172:175], v[68:71], v[40:43], v[172:175]
  v_mfma_f32_16x16x32_bf16 v[172:175], v[64:67], v[44:47], v[172:175]
  s_waitcnt lgkmcnt(6)
  v_mfma_f32_16x16x32_bf16 v[176:179], v[80:83], v[32:35], 0
  v_mfma_f32_16x16x32_bf16 v[176:179], v[76:79], v[36:39], v[176:179]
  ds_read_b128 v[128:131], v21 offset:55360
  v_mfma_f32_16x16x32_bf16 v[176:179], v[72:75], v[40:43], v[176:179]
  v_mfma_f32_16x16x32_bf16 v[176:179], v[68:71], v[44:47], v[176:179]
  ds_read_b128 v[96:99], v20 offset:51776
  v_mfma_f32_16x16x32_bf16 v[176:179], v[64:67], v[48:51], v[176:179]
  s_waitcnt lgkmcnt(6)
  v_mfma_f32_16x16x32_bf16 v[180:183], v[84:87], v[32:35], 0
  ds_read_b128 v[132:135], v21 offset:54848
  v_mfma_f32_16x16x32_bf16 v[180:183], v[80:83], v[36:39], v[180:183]
  v_mfma_f32_16x16x32_bf16 v[180:183], v[76:79], v[40:43], v[180:183]
  ds_read_b128 v[100:103], v20 offset:52288
  v_mfma_f32_16x16x32_bf16 v[180:183], v[72:75], v[44:47], v[180:183]
  v_mfma_f32_16x16x32_bf16 v[180:183], v[68:71], v[48:51], v[180:183]
  ds_read_b128 v[136:139], v21 offset:54336
  v_mfma_f32_16x16x32_bf16 v[180:183], v[64:67], v[52:55], v[180:183]
  s_waitcnt lgkmcnt(7)
  v_mfma_f32_16x16x32_bf16 v[184:187], v[88:91], v[32:35], 0
  ds_read_b128 v[104:107], v20 offset:52800
  v_mfma_f32_16x16x32_bf16 v[184:187], v[84:87], v[36:39], v[184:187]
  v_mfma_f32_16x16x32_bf16 v[184:187], v[80:83], v[40:43], v[184:187]
  ds_read_b128 v[140:143], v21 offset:53824
  v_mfma_f32_16x16x32_bf16 v[184:187], v[76:79], v[44:47], v[184:187]
  v_mfma_f32_16x16x32_bf16 v[184:187], v[72:75], v[48:51], v[184:187]
  ds_read_b128 v[108:111], v20 offset:53312
  v_mfma_f32_16x16x32_bf16 v[184:187], v[68:71], v[52:55], v[184:187]
  v_mfma_f32_16x16x32_bf16 v[184:187], v[64:67], v[56:59], v[184:187]
  ds_read_b128 v[144:147], v21 offset:53312
  s_waitcnt lgkmcnt(9)
  v_mfma_f32_16x16x32_bf16 v[188:191], v[92:95], v[32:35], 0
  v_mfma_f32_16x16x32_bf16 v[188:191], v[88:91], v[36:39], v[188:191]
  ds_read_b128 v[112:115], v20 offset:53824
  v_mfma_f32_16x16x32_bf16 v[188:191], v[84:87], v[40:43], v[188:191]
  v_mfma_f32_16x16x32_bf16 v[188:191], v[80:83], v[44:47], v[188:191]
  ds_read_b128 v[148:151], v21 offset:52800
  v_mfma_f32_16x16x32_bf16 v[188:191], v[76:79], v[48:51], v[188:191]
  v_mfma_f32_16x16x32_bf16 v[188:191], v[72:75], v[52:55], v[188:191]
  ds_read_b128 v[116:119], v20 offset:54336
  v_mfma_f32_16x16x32_bf16 v[188:191], v[68:71], v[56:59], v[188:191]
  v_mfma_f32_16x16x32_bf16 v[188:191], v[64:67], v[60:63], v[188:191]
  ds_read_b128 v[152:155], v21 offset:52288
  ds_read_b128 v[120:123], v20 offset:54848
  ds_read_b128 v[156:159], v21 offset:51776
  ds_read_b128 v[124:127], v20 offset:55360
  s_waitcnt lgkmcnt(0)
  v_mfma_f32_16x16x32_bf16 v[160:163], v[128:131], v[96:99], v[160:163]
  v_mfma_f32_16x16x32_bf16 v[164:167], v[132:135], v[96:99], v[164:167]
  ds_read_b128 v[64:67], v21 offset:55424
  v_mfma_f32_16x16x32_bf16 v[164:167], v[128:131], v[100:103], v[164:167]
  v_mfma_f32_16x16x32_bf16 v[168:171], v[136:139], v[96:99], v[168:171]
  ds_read_b128 v[32:35], v20 offset:51840
  v_mfma_f32_16x16x32_bf16 v[168:171], v[132:135], v[100:103], v[168:171]
  v_mfma_f32_16x16x32_bf16 v[168:171], v[128:131], v[104:107], v[168:171]
  ds_read_b128 v[68:71], v21 offset:54912
  v_mfma_f32_16x16x32_bf16 v[172:175], v[140:143], v[96:99], v[172:175]
  v_mfma_f32_16x16x32_bf16 v[172:175], v[136:139], v[100:103], v[172:175]
  ds_read_b128 v[36:39], v20 offset:52352
  v_mfma_f32_16x16x32_bf16 v[172:175], v[132:135], v[104:107], v[172:175]
  v_mfma_f32_16x16x32_bf16 v[172:175], v[128:131], v[108:111], v[172:175]
  ds_read_b128 v[72:75], v21 offset:54400
  v_mfma_f32_16x16x32_bf16 v[176:179], v[144:147], v[96:99], v[176:179]
  v_mfma_f32_16x16x32_bf16 v[176:179], v[140:143], v[100:103], v[176:179]
  ds_read_b128 v[40:43], v20 offset:52864
  v_mfma_f32_16x16x32_bf16 v[176:179], v[136:139], v[104:107], v[176:179]
  v_mfma_f32_16x16x32_bf16 v[176:179], v[132:135], v[108:111], v[176:179]
  ds_read_b128 v[76:79], v21 offset:53888
  v_mfma_f32_16x16x32_bf16 v[176:179], v[128:131], v[112:115], v[176:179]
  v_mfma_f32_16x16x32_bf16 v[180:183], v[148:151], v[96:99], v[180:183]
  ds_read_b128 v[44:47], v20 offset:53376
  v_mfma_f32_16x16x32_bf16 v[180:183], v[144:147], v[100:103], v[180:183]
  v_mfma_f32_16x16x32_bf16 v[180:183], v[140:143], v[104:107], v[180:183]
  ds_read_b128 v[80:83], v21 offset:53376
  v_mfma_f32_16x16x32_bf16 v[180:183], v[136:139], v[108:111], v[180:183]
  v_mfma_f32_16x16x32_bf16 v[180:183], v[132:135], v[112:115], v[180:183]
  ds_read_b128 v[48:51], v20 offset:53888
  v_mfma_f32_16x16x32_bf16 v[180:183], v[128:131], v[116:119], v[180:183]
  v_mfma_f32_16x16x32_bf16 v[184:187], v[152:155], v[96:99], v[184:187]
  ds_read_b128 v[84:87], v21 offset:52864
  v_mfma_f32_16x16x32_bf16 v[184:187], v[148:151], v[100:103], v[184:187]
  v_mfma_f32_16x16x32_bf16 v[184:187], v[144:147], v[104:107], v[184:187]
  ds_read_b128 v[52:55], v20 offset:54400
  v_mfma_f32_16x16x32_bf16 v[184:187], v[140:143], v[108:111], v[184:187]
  v_mfma_f32_16x16x32_bf16 v[184:187], v[136:139], v[112:115], v[184:187]
  ds_read_b128 v[88:91], v21 offset:52352
  v_mfma_f32_16x16x32_bf16 v[184:187], v[132:135], v[116:119], v[184:187]
  v_mfma_f32_16x16x32_bf16 v[184:187], v[128:131], v[120:123], v[184:187]
  ds_read_b128 v[56:59], v20 offset:54912
  v_mfma_f32_16x16x32_bf16 v[188:191], v[156:159], v[96:99], v[188:191]
  v_mfma_f32_16x16x32_bf16 v[188:191], v[152:155], v[100:103], v[188:191]
  ds_read_b128 v[92:95], v21 offset:51840
  v_mfma_f32_16x16x32_bf16 v[188:191], v[148:151], v[104:107], v[188:191]
  v_mfma_f32_16x16x32_bf16 v[188:191], v[144:147], v[108:111], v[188:191]
  ds_read_b128 v[60:63], v20 offset:55424
  v_mfma_f32_16x16x32_bf16 v[188:191], v[140:143], v[112:115], v[188:191]
  v_mfma_f32_16x16x32_bf16 v[188:191], v[136:139], v[116:119], v[188:191]
  v_mfma_f32_16x16x32_bf16 v[188:191], v[132:135], v[120:123], v[188:191]
  v_mfma_f32_16x16x32_bf16 v[188:191], v[128:131], v[124:127], v[188:191]
  s_waitcnt lgkmcnt(0)
  v_mfma_f32_16x16x32_bf16 v[160:163], v[64:67], v[32:35], v[160:163]
  v_mfma_f32_16x16x32_bf16 v[164:167], v[68:71], v[32:35], v[164:167]
  ds_read_b128 v[128:131], v21 offset:55488
  v_mfma_f32_16x16x32_bf16 v[164:167], v[64:67], v[36:39], v[164:167]
  v_mfma_f32_16x16x32_bf16 v[168:171], v[72:75], v[32:35], v[168:171]
  ds_read_b128 v[96:99], v20 offset:51904
  v_mfma_f32_16x16x32_bf16 v[168:171], v[68:71], v[36:39], v[168:171]
  v_mfma_f32_16x16x32_bf16 v[168:171], v[64:67], v[40:43], v[168:171]
  ds_read_b128 v[132:135], v21 offset:54976
  v_mfma_f32_16x16x32_bf16 v[172:175], v[76:79], v[32:35], v[172:175]
  v_mfma_f32_16x16x32_bf16 v[172:175], v[72:75], v[36:39], v[172:175]
  ds_read_b128 v[100:103], v20 offset:52416
  v_mfma_f32_16x16x32_bf16 v[172:175], v[68:71], v[40:43], v[172:175]
  v_mfma_f32_16x16x32_bf16 v[172:175], v[64:67], v[44:47], v[172:175]
  ds_read_b128 v[136:139], v21 offset:54464
  v_mfma_f32_16x16x32_bf16 v[176:179], v[80:83], v[32:35], v[176:179]
  v_mfma_f32_16x16x32_bf16 v[176:179], v[76:79], v[36:39], v[176:179]
  ds_read_b128 v[104:107], v20 offset:52928
  v_mfma_f32_16x16x32_bf16 v[176:179], v[72:75], v[40:43], v[176:179]
  v_mfma_f32_16x16x32_bf16 v[176:179], v[68:71], v[44:47], v[176:179]
  ds_read_b128 v[140:143], v21 offset:53952
  v_mfma_f32_16x16x32_bf16 v[176:179], v[64:67], v[48:51], v[176:179]
  v_mfma_f32_16x16x32_bf16 v[180:183], v[84:87], v[32:35], v[180:183]
  ds_read_b128 v[108:111], v20 offset:53440
  v_mfma_f32_16x16x32_bf16 v[180:183], v[80:83], v[36:39], v[180:183]
  v_mfma_f32_16x16x32_bf16 v[180:183], v[76:79], v[40:43], v[180:183]
  ds_read_b128 v[144:147], v21 offset:53440
  v_mfma_f32_16x16x32_bf16 v[180:183], v[72:75], v[44:47], v[180:183]
  v_mfma_f32_16x16x32_bf16 v[180:183], v[68:71], v[48:51], v[180:183]
  ds_read_b128 v[112:115], v20 offset:53952
  v_mfma_f32_16x16x32_bf16 v[180:183], v[64:67], v[52:55], v[180:183]
  v_mfma_f32_16x16x32_bf16 v[184:187], v[88:91], v[32:35], v[184:187]
  ds_read_b128 v[148:151], v21 offset:52928
  v_mfma_f32_16x16x32_bf16 v[184:187], v[84:87], v[36:39], v[184:187]
  v_mfma_f32_16x16x32_bf16 v[184:187], v[80:83], v[40:43], v[184:187]
  ds_read_b128 v[116:119], v20 offset:54464
  v_mfma_f32_16x16x32_bf16 v[184:187], v[76:79], v[44:47], v[184:187]
  v_mfma_f32_16x16x32_bf16 v[184:187], v[72:75], v[48:51], v[184:187]
  ds_read_b128 v[152:155], v21 offset:52416
  v_mfma_f32_16x16x32_bf16 v[184:187], v[68:71], v[52:55], v[184:187]
  v_mfma_f32_16x16x32_bf16 v[184:187], v[64:67], v[56:59], v[184:187]
  ds_read_b128 v[120:123], v20 offset:54976
  v_mfma_f32_16x16x32_bf16 v[188:191], v[92:95], v[32:35], v[188:191]
  v_mfma_f32_16x16x32_bf16 v[188:191], v[88:91], v[36:39], v[188:191]
  ds_read_b128 v[156:159], v21 offset:51904
  v_mfma_f32_16x16x32_bf16 v[188:191], v[84:87], v[40:43], v[188:191]
  v_mfma_f32_16x16x32_bf16 v[188:191], v[80:83], v[44:47], v[188:191]
  ds_read_b128 v[124:127], v20 offset:55488
  v_mfma_f32_16x16x32_bf16 v[188:191], v[76:79], v[48:51], v[188:191]
  v_mfma_f32_16x16x32_bf16 v[188:191], v[72:75], v[52:55], v[188:191]
  v_mfma_f32_16x16x32_bf16 v[188:191], v[68:71], v[56:59], v[188:191]
  v_mfma_f32_16x16x32_bf16 v[188:191], v[64:67], v[60:63], v[188:191]
  s_waitcnt lgkmcnt(0)
  v_mfma_f32_16x16x32_bf16 v[160:163], v[128:131], v[96:99], v[160:163]
  v_mfma_f32_16x16x32_bf16 v[164:167], v[132:135], v[96:99], v[164:167]
  ds_read_b128 v[64:67], v21 offset:55552
  v_mfma_f32_16x16x32_bf16 v[164:167], v[128:131], v[100:103], v[164:167]
  v_mfma_f32_16x16x32_bf16 v[168:171], v[136:139], v[96:99], v[168:171]
  ds_read_b128 v[32:35], v20 offset:51968
  v_mfma_f32_16x16x32_bf16 v[168:171], v[132:135], v[100:103], v[168:171]
  v_mfma_f32_16x16x32_bf16 v[168:171], v[128:131], v[104:107], v[168:171]
  ds_read_b128 v[68:71], v21 offset:55040
  v_mfma_f32_16x16x32_bf16 v[172:175], v[140:143], v[96:99], v[172:175]
  v_mfma_f32_16x16x32_bf16 v[172:175], v[136:139], v[100:103], v[172:175]
  ds_read_b128 v[36:39], v20 offset:52480
  v_mfma_f32_16x16x32_bf16 v[172:175], v[132:135], v[104:107], v[172:175]
  v_mfma_f32_16x16x32_bf16 v[172:175], v[128:131], v[108:111], v[172:175]
  ds_read_b128 v[72:75], v21 offset:54528
  v_mfma_f32_16x16x32_bf16 v[176:179], v[144:147], v[96:99], v[176:179]
  v_mfma_f32_16x16x32_bf16 v[176:179], v[140:143], v[100:103], v[176:179]
  ds_read_b128 v[40:43], v20 offset:52992
  v_mfma_f32_16x16x32_bf16 v[176:179], v[136:139], v[104:107], v[176:179]
  v_mfma_f32_16x16x32_bf16 v[176:179], v[132:135], v[108:111], v[176:179]
  ds_read_b128 v[76:79], v21 offset:54016
  v_mfma_f32_16x16x32_bf16 v[176:179], v[128:131], v[112:115], v[176:179]
  v_mfma_f32_16x16x32_bf16 v[180:183], v[148:151], v[96:99], v[180:183]
  ds_read_b128 v[44:47], v20 offset:53504
  v_mfma_f32_16x16x32_bf16 v[180:183], v[144:147], v[100:103], v[180:183]
  v_mfma_f32_16x16x32_bf16 v[180:183], v[140:143], v[104:107], v[180:183]
  ds_read_b128 v[80:83], v21 offset:53504
  v_mfma_f32_16x16x32_bf16 v[180:183], v[136:139], v[108:111], v[180:183]
  v_mfma_f32_16x16x32_bf16 v[180:183], v[132:135], v[112:115], v[180:183]
  ds_read_b128 v[48:51], v20 offset:54016
  v_mfma_f32_16x16x32_bf16 v[180:183], v[128:131], v[116:119], v[180:183]
  v_mfma_f32_16x16x32_bf16 v[184:187], v[152:155], v[96:99], v[184:187]
  ds_read_b128 v[84:87], v21 offset:52992
  v_mfma_f32_16x16x32_bf16 v[184:187], v[148:151], v[100:103], v[184:187]
  v_mfma_f32_16x16x32_bf16 v[184:187], v[144:147], v[104:107], v[184:187]
  ds_read_b128 v[52:55], v20 offset:54528
  v_mfma_f32_16x16x32_bf16 v[184:187], v[140:143], v[108:111], v[184:187]
  v_mfma_f32_16x16x32_bf16 v[184:187], v[136:139], v[112:115], v[184:187]
  ds_read_b128 v[88:91], v21 offset:52480
  v_mfma_f32_16x16x32_bf16 v[184:187], v[132:135], v[116:119], v[184:187]
  v_mfma_f32_16x16x32_bf16 v[184:187], v[128:131], v[120:123], v[184:187]
  ds_read_b128 v[56:59], v20 offset:55040
  v_mfma_f32_16x16x32_bf16 v[188:191], v[156:159], v[96:99], v[188:191]
  v_mfma_f32_16x16x32_bf16 v[188:191], v[152:155], v[100:103], v[188:191]
  ds_read_b128 v[92:95], v21 offset:51968
  v_mfma_f32_16x16x32_bf16 v[188:191], v[148:151], v[104:107], v[188:191]
  v_mfma_f32_16x16x32_bf16 v[188:191], v[144:147], v[108:111], v[188:191]
  ds_read_b128 v[60:63], v20 offset:55552
  v_mfma_f32_16x16x32_bf16 v[188:191], v[140:143], v[112:115], v[188:191]
  v_mfma_f32_16x16x32_bf16 v[188:191], v[136:139], v[116:119], v[188:191]
  v_mfma_f32_16x16x32_bf16 v[188:191], v[132:135], v[120:123], v[188:191]
  v_mfma_f32_16x16x32_bf16 v[188:191], v[128:131], v[124:127], v[188:191]
  s_waitcnt lgkmcnt(0)
  v_mfma_f32_16x16x32_bf16 v[160:163], v[64:67], v[32:35], v[160:163]
  v_mfma_f32_16x16x32_bf16 v[164:167], v[68:71], v[32:35], v[164:167]
  ds_read_b128 v[128:131], v21 offset:55616
  v_mfma_f32_16x16x32_bf16 v[164:167], v[64:67], v[36:39], v[164:167]
  v_mfma_f32_16x16x32_bf16 v[168:171], v[72:75], v[32:35], v[168:171]
  ds_read_b128 v[96:99], v20 offset:52032
  v_mfma_f32_16x16x32_bf16 v[168:171], v[68:71], v[36:39], v[168:171]
  v_mfma_f32_16x16x32_bf16 v[168:171], v[64:67], v[40:43], v[168:171]
  ds_read_b128 v[132:135], v21 offset:55104
  v_mfma_f32_16x16x32_bf16 v[172:175], v[76:79], v[32:35], v[172:175]
  v_mfma_f32_16x16x32_bf16 v[172:175], v[72:75], v[36:39], v[172:175]
  ds_read_b128 v[100:103], v20 offset:52544
  v_mfma_f32_16x16x32_bf16 v[172:175], v[68:71], v[40:43], v[172:175]
  v_mfma_f32_16x16x32_bf16 v[172:175], v[64:67], v[44:47], v[172:175]
  ds_read_b128 v[136:139], v21 offset:54592
  v_mfma_f32_16x16x32_bf16 v[176:179], v[80:83], v[32:35], v[176:179]
  v_mfma_f32_16x16x32_bf16 v[176:179], v[76:79], v[36:39], v[176:179]
  ds_read_b128 v[104:107], v20 offset:53056
  v_mfma_f32_16x16x32_bf16 v[176:179], v[72:75], v[40:43], v[176:179]
  v_mfma_f32_16x16x32_bf16 v[176:179], v[68:71], v[44:47], v[176:179]
  ds_read_b128 v[140:143], v21 offset:54080
  v_mfma_f32_16x16x32_bf16 v[176:179], v[64:67], v[48:51], v[176:179]
  v_mfma_f32_16x16x32_bf16 v[180:183], v[84:87], v[32:35], v[180:183]
  ds_read_b128 v[108:111], v20 offset:53568
  v_mfma_f32_16x16x32_bf16 v[180:183], v[80:83], v[36:39], v[180:183]
  v_mfma_f32_16x16x32_bf16 v[180:183], v[76:79], v[40:43], v[180:183]
  ds_read_b128 v[144:147], v21 offset:53568
  v_mfma_f32_16x16x32_bf16 v[180:183], v[72:75], v[44:47], v[180:183]
  v_mfma_f32_16x16x32_bf16 v[180:183], v[68:71], v[48:51], v[180:183]
  ds_read_b128 v[112:115], v20 offset:54080
  v_mfma_f32_16x16x32_bf16 v[180:183], v[64:67], v[52:55], v[180:183]
  v_mfma_f32_16x16x32_bf16 v[184:187], v[88:91], v[32:35], v[184:187]
  ds_read_b128 v[148:151], v21 offset:53056
  v_mfma_f32_16x16x32_bf16 v[184:187], v[84:87], v[36:39], v[184:187]
  v_mfma_f32_16x16x32_bf16 v[184:187], v[80:83], v[40:43], v[184:187]
  ds_read_b128 v[116:119], v20 offset:54592
  v_mfma_f32_16x16x32_bf16 v[184:187], v[76:79], v[44:47], v[184:187]
  v_mfma_f32_16x16x32_bf16 v[184:187], v[72:75], v[48:51], v[184:187]
  ds_read_b128 v[152:155], v21 offset:52544
  v_mfma_f32_16x16x32_bf16 v[184:187], v[68:71], v[52:55], v[184:187]
  v_mfma_f32_16x16x32_bf16 v[184:187], v[64:67], v[56:59], v[184:187]
  ds_read_b128 v[120:123], v20 offset:55104
  v_mfma_f32_16x16x32_bf16 v[188:191], v[92:95], v[32:35], v[188:191]
  v_mfma_f32_16x16x32_bf16 v[188:191], v[88:91], v[36:39], v[188:191]
  ds_read_b128 v[156:159], v21 offset:52032
  v_mfma_f32_16x16x32_bf16 v[188:191], v[84:87], v[40:43], v[188:191]
  v_mfma_f32_16x16x32_bf16 v[188:191], v[80:83], v[44:47], v[188:191]
  ds_read_b128 v[124:127], v20 offset:55616
  v_mfma_f32_16x16x32_bf16 v[188:191], v[76:79], v[48:51], v[188:191]
  v_mfma_f32_16x16x32_bf16 v[188:191], v[72:75], v[52:55], v[188:191]
  v_mfma_f32_16x16x32_bf16 v[188:191], v[68:71], v[56:59], v[188:191]
  v_mfma_f32_16x16x32_bf16 v[188:191], v[64:67], v[60:63], v[188:191]
  s_waitcnt lgkmcnt(0)
  v_mfma_f32_16x16x32_bf16 v[160:163], v[128:131], v[96:99], v[160:163]
  v_mfma_f32_16x16x32_bf16 v[164:167], v[132:135], v[96:99], v[164:167]
  v_mfma_f32_16x16x32_bf16 v[164:167], v[128:131], v[100:103], v[164:167]
  v_mfma_f32_16x16x32_bf16 v[168:171], v[136:139], v[96:99], v[168:171]
  v_mfma_f32_16x16x32_bf16 v[168:171], v[132:135], v[100:103], v[168:171]
  v_mfma_f32_16x16x32_bf16 v[168:171], v[128:131], v[104:107], v[168:171]
  v_mfma_f32_16x16x32_bf16 v[172:175], v[140:143], v[96:99], v[172:175]
  v_mfma_f32_16x16x32_bf16 v[172:175], v[136:139], v[100:103], v[172:175]
  v_mfma_f32_16x16x32_bf16 v[172:175], v[132:135], v[104:107], v[172:175]
  v_mfma_f32_16x16x32_bf16 v[172:175], v[128:131], v[108:111], v[172:175]
  v_mfma_f32_16x16x32_bf16 v[176:179], v[144:147], v[96:99], v[176:179]
  v_mfma_f32_16x16x32_bf16 v[176:179], v[140:143], v[100:103], v[176:179]
  v_mfma_f32_16x16x32_bf16 v[176:179], v[136:139], v[104:107], v[176:179]
  v_mfma_f32_16x16x32_bf16 v[176:179], v[132:135], v[108:111], v[176:179]
  v_mfma_f32_16x16x32_bf16 v[176:179], v[128:131], v[112:115], v[176:179]
  v_mfma_f32_16x16x32_bf16 v[180:183], v[148:151], v[96:99], v[180:183]
  v_mfma_f32_16x16x32_bf16 v[180:183], v[144:147], v[100:103], v[180:183]
  v_mfma_f32_16x16x32_bf16 v[180:183], v[140:143], v[104:107], v[180:183]
  v_mfma_f32_16x16x32_bf16 v[180:183], v[136:139], v[108:111], v[180:183]
  v_mfma_f32_16x16x32_bf16 v[180:183], v[132:135], v[112:115], v[180:183]
  v_mfma_f32_16x16x32_bf16 v[180:183], v[128:131], v[116:119], v[180:183]
  v_mfma_f32_16x16x32_bf16 v[184:187], v[152:155], v[96:99], v[184:187]
  v_mfma_f32_16x16x32_bf16 v[184:187], v[148:151], v[100:103], v[184:187]
  v_mfma_f32_16x16x32_bf16 v[184:187], v[144:147], v[104:107], v[184:187]
  v_mfma_f32_16x16x32_bf16 v[184:187], v[140:143], v[108:111], v[184:187]
  v_mfma_f32_16x16x32_bf16 v[184:187], v[136:139], v[112:115], v[184:187]
  v_mfma_f32_16x16x32_bf16 v[184:187], v[132:135], v[116:119], v[184:187]
  v_mfma_f32_16x16x32_bf16 v[184:187], v[128:131], v[120:123], v[184:187]
  v_mfma_f32_16x16x32_bf16 v[188:191], v[156:159], v[96:99], v[188:191]
  v_mfma_f32_16x16x32_bf16 v[188:191], v[152:155], v[100:103], v[188:191]
  v_mfma_f32_16x16x32_bf16 v[188:191], v[148:151], v[104:107], v[188:191]
  v_mfma_f32_16x16x32_bf16 v[188:191], v[144:147], v[108:111], v[188:191]
  v_mfma_f32_16x16x32_bf16 v[188:191], v[140:143], v[112:115], v[188:191]
  v_mfma_f32_16x16x32_bf16 v[188:191], v[136:139], v[116:119], v[188:191]
  v_mfma_f32_16x16x32_bf16 v[188:191], v[132:135], v[120:123], v[188:191]
  v_mfma_f32_16x16x32_bf16 v[188:191], v[128:131], v[124:127], v[188:191]
  s_nop 7
  s_nop 7
  v_lshlrev_b32 v6, 8, v5
  v_lshl_add_u32 v6, v4, 3, v6
  v_add_u32 v7, 118336, v6
  ds_write_b64 v7, v[160:161] offset:0
  ds_write_b64 v7, v[162:163] offset:128
  ds_write_b64 v7, v[164:165] offset:1024
  ds_write_b64 v7, v[166:167] offset:1152
  ds_write_b64 v7, v[168:169] offset:2048
  ds_write_b64 v7, v[170:171] offset:2176
  ds_write_b64 v7, v[172:173] offset:3072
  ds_write_b64 v7, v[174:175] offset:3200
  ds_write_b64 v7, v[176:177] offset:4096
  ds_write_b64 v7, v[178:179] offset:4224
  ds_write_b64 v7, v[180:181] offset:5120
  ds_write_b64 v7, v[182:183] offset:5248
  ds_write_b64 v7, v[184:185] offset:6144
  ds_write_b64 v7, v[186:187] offset:6272
  ds_write_b64 v7, v[188:189] offset:7168
  ds_write_b64 v7, v[190:191] offset:7296
L_mmd:
  v_lshlrev_b32 v9, 5, v0
  v_lshlrev_b32 v10, 4, v0
  v_sub_u32 v11, 20720, v10
  s_waitcnt lgkmcnt(0)
  s_barrier

  v_add_u32 v12, 77376, v9
  ds_read_b128 v[32:35], v12
  ds_read_b128 v[36:39], v12 offset:16
  ds_read_b128 v[40:43], v12 offset:8192
  ds_read_b128 v[44:47], v12 offset:8208
  ds_read_b128 v[48:51], v11 offset:4576
  v_add_u32 v12, 93760, v9
  ds_read_b128 v[56:59], v12
  ds_read_b128 v[60:63], v12 offset:16
  ds_read_b128 v[64:67], v12 offset:8192
  ds_read_b128 v[68:71], v12 offset:8208
  ds_read_b128 v[72:75], v11 offset:30368
  v_add_u32 v12, 110144, v9
  ds_read_b128 v[80:83], v12
  ds_read_b128 v[84:87], v12 offset:16
  ds_read_b128 v[88:91], v12 offset:8192
  ds_read_b128 v[92:95], v12 offset:8208
  ds_read_b128 v[96:99], v11 offset:56160
  v_lshlrev_b32 v24, 16, v24
  v_lshlrev_b32 v25, 16, v25
  v_lshlrev_b32 v26, 16, v26
  s_waitcnt lgkmcnt(10)
  v_pk_add_f32 v[32:33], v[32:33], v[40:41]
  v_pk_add_f32 v[34:35], v[34:35], v[42:43]
  v_pk_add_f32 v[36:37], v[36:37], v[44:45]
  v_pk_add_f32 v[38:39], v[38:39], v[46:47]
  v_lshlrev_b32 v41, 16, v51
  v_lshlrev_b32 v43, 16, v50
  v_lshlrev_b32 v45, 16, v49
  v_lshlrev_b32 v47, 16, v48
  v_and_b32 v40, s43, v51
  v_and_b32 v42, s43, v50
  v_and_b32 v44, s43, v49
  v_and_b32 v46, s43, v48
  v_cvt_pk_bf16_f32 v110, v32, v33
  v_cvt_pk_bf16_f32 v114, v34, v35
  v_cvt_pk_bf16_f32 v118, v36, v37
  v_cvt_pk_bf16_f32 v122, v38, v39
  v_lshlrev_b32 v32, 16, v110
  v_lshlrev_b32 v34, 16, v114
  v_lshlrev_b32 v36, 16, v118
  v_lshlrev_b32 v38, 16, v122
  v_and_b32 v33, s43, v110
  v_and_b32 v35, s43, v114
  v_and_b32 v37, s43, v118
  v_and_b32 v39, s43, v122
  v_mul_f32 v40, v40, v24
  v_mul_f32 v42, v42, v24
  v_mul_f32 v44, v44, v24
  v_mul_f32 v46, v46, v24
  v_mul_f32 v41, v41, v24
  v_mul_f32 v43, v43, v24
  v_mul_f32 v45, v45, v24
  v_mul_f32 v47, v47, v24
  v_cvt_pk_bf16_f32 v111, v40, v41
  v_cvt_pk_bf16_f32 v115, v42, v43
  v_cvt_pk_bf16_f32 v119, v44, v45
  v_cvt_pk_bf16_f32 v123, v46, v47
  v_lshlrev_b32 v40, 16, v111
  v_lshlrev_b32 v42, 16, v115
  v_lshlrev_b32 v44, 16, v119
  v_lshlrev_b32 v46, 16, v123
  v_and_b32 v41, s43, v111
  v_and_b32 v43, s43, v115
  v_and_b32 v45, s43, v119
  v_and_b32 v47, s43, v123
  v_pk_add_f32 v[32:33], v[32:33], v[40:41]
  v_pk_add_f32 v[34:35], v[34:35], v[42:43]
  v_pk_add_f32 v[36:37], v[36:37], v[44:45]
  v_pk_add_f32 v[38:39], v[38:39], v[46:47]
  v_cvt_pk_bf16_f32 v130, v32, v33
  v_cvt_pk_bf16_f32 v131, v34, v35
  v_cvt_pk_bf16_f32 v132, v36, v37
  v_cvt_pk_bf16_f32 v133, v38, v39
  ds_write_b128 v10, v[130:133] offset:0
  s_waitcnt lgkmcnt(5)
  v_pk_add_f32 v[56:57], v[56:57], v[64:65]
  v_pk_add_f32 v[58:59], v[58:59], v[66:67]
  v_pk_add_f32 v[60:61], v[60:61], v[68:69]
  v_pk_add_f32 v[62:63], v[62:63], v[70:71]
  v_lshlrev_b32 v65, 16, v75
  v_lshlrev_b32 v67, 16, v74
  v_lshlrev_b32 v69, 16, v73
  v_lshlrev_b32 v71, 16, v72
  v_and_b32 v64, s43, v75
  v_and_b32 v66, s43, v74
  v_and_b32 v68, s43, v73
  v_and_b32 v70, s43, v72
  v_cvt_pk_bf16_f32 v110, v56, v57
  v_cvt_pk_bf16_f32 v114, v58, v59
  v_cvt_pk_bf16_f32 v118, v60, v61
  v_cvt_pk_bf16_f32 v122, v62, v63
  v_lshlrev_b32 v56, 16, v110
  v_lshlrev_b32 v58, 16, v114
  v_lshlrev_b32 v60, 16, v118
  v_lshlrev_b32 v62, 16, v122
  v_and_b32 v57, s43, v110
  v_and_b32 v59, s43, v114
  v_and_b32 v61, s43, v118
  v_and_b32 v63, s43, v122
  v_mul_f32 v64, v64, v25
  v_mul_f32 v66, v66, v25
  v_mul_f32 v68, v68, v25
  v_mul_f32 v70, v70, v25
  v_mul_f32 v65, v65, v25
  v_mul_f32 v67, v67, v25
  v_mul_f32 v69, v69, v25
  v_mul_f32 v71, v71, v25
  v_cvt_pk_bf16_f32 v111, v64, v65
  v_cvt_pk_bf16_f32 v115, v66, v67
  v_cvt_pk_bf16_f32 v119, v68, v69
  v_cvt_pk_bf16_f32 v123, v70, v71
  v_lshlrev_b32 v64, 16, v111
  v_lshlrev_b32 v66, 16, v115
  v_lshlrev_b32 v68, 16, v119
  v_lshlrev_b32 v70, 16, v123
  v_and_b32 v65, s43, v111
  v_and_b32 v67, s43, v115
  v_and_b32 v69, s43, v119
  v_and_b32 v71, s43, v123
  v_pk_add_f32 v[56:57], v[56:57], v[64:65]
  v_pk_add_f32 v[58:59], v[58:59], v[66:67]
  v_pk_add_f32 v[60:61], v[60:61], v[68:69]
  v_pk_add_f32 v[62:63], v[62:63], v[70:71]
  v_cvt_pk_bf16_f32 v134, v56, v57
  v_cvt_pk_bf16_f32 v135, v58, v59
  v_cvt_pk_bf16_f32 v136, v60, v61
  v_cvt_pk_bf16_f32 v137, v62, v63
  ds_write_b128 v10, v[134:137] offset:25792
  s_waitcnt lgkmcnt(0)
  v_pk_add_f32 v[80:81], v[80:81], v[88:89]
  v_pk_add_f32 v[82:83], v[82:83], v[90:91]
  v_pk_add_f32 v[84:85], v[84:85], v[92:93]
  v_pk_add_f32 v[86:87], v[86:87], v[94:95]
  v_lshlrev_b32 v89, 16, v99
  v_lshlrev_b32 v91, 16, v98
  v_lshlrev_b32 v93, 16, v97
  v_lshlrev_b32 v95, 16, v96
  v_and_b32 v88, s43, v99
  v_and_b32 v90, s43, v98
  v_and_b32 v92, s43, v97
  v_and_b32 v94, s43, v96
  v_cvt_pk_bf16_f32 v110, v80, v81
  v_cvt_pk_bf16_f32 v114, v82, v83
  v_cvt_pk_bf16_f32 v118, v84, v85
  v_cvt_pk_bf16_f32 v122, v86, v87
  v_lshlrev_b32 v80, 16, v110
  v_lshlrev_b32 v82, 16, v114
  v_lshlrev_b32 v84, 16, v118
  v_lshlrev_b32 v86, 16, v122
  v_and_b32 v81, s43, v110
  v_and_b32 v83, s43, v114
  v_and_b32 v85, s43, v118
  v_and_b32 v87, s43, v122
  v_mul_f32 v88, v88, v26
  v_mul_f32 v90, v90, v26
  v_mul_f32 v92, v92, v26
  v_mul_f32 v94, v94, v26
  v_mul_f32 v89, v89, v26
  v_mul_f32 v91, v91, v26
  v_mul_f32 v93, v93, v26
  v_mul_f32 v95, v95, v26
  v_cvt_pk_bf16_f32 v111, v88, v89
  v_cvt_pk_bf16_f32 v115, v90, v91
  v_cvt_pk_bf16_f32 v119, v92, v93
  v_cvt_pk_bf16_f32 v123, v94, v95
  v_lshlrev_b32 v88, 16, v111
  v_lshlrev_b32 v90, 16, v115
  v_lshlrev_b32 v92, 16, v119
  v_lshlrev_b32 v94, 16, v123
  v_and_b32 v89, s43, v111
  v_and_b32 v91, s43, v115
  v_and_b32 v93, s43, v119
  v_and_b32 v95, s43, v123
  v_pk_add_f32 v[80:81], v[80:81], v[88:89]
  v_pk_add_f32 v[82:83], v[82:83], v[90:91]
  v_pk_add_f32 v[84:85], v[84:85], v[92:93]
  v_pk_add_f32 v[86:87], v[86:87], v[94:95]
  v_cvt_pk_bf16_f32 v138, v80, v81
  v_cvt_pk_bf16_f32 v139, v82, v83
  v_cvt_pk_bf16_f32 v140, v84, v85
  v_cvt_pk_bf16_f32 v141, v86, v87
  ds_write_b128 v10, v[138:141] offset:51584
  s_waitcnt lgkmcnt(0)
  s_barrier
  s_cmp_lg_u32 s39, 3
  s_cbranch_scc1 L_fzs

  ds_read_b128 v[32:35], v3 offset:0
  ds_read_b128 v[36:39], v3 offset:1024
  ds_read_b128 v[40:43], v3 offset:2048
  ds_read_b128 v[44:47], v3 offset:3072
  ds_read_b128 v[48:51], v3 offset:25792
  ds_read_b128 v[52:55], v3 offset:26816
  ds_read_b128 v[56:59], v3 offset:27840
  ds_read_b128 v[60:63], v3 offset:28864
  ds_read_b128 v[64:67], v3 offset:51584
  ds_read_b128 v[68:71], v3 offset:52608
  ds_read_b128 v[72:75], v3 offset:53632
  ds_read_b128 v[76:79], v3 offset:54656
  s_add_u32 s49, s48, 0
  s_mul_i32 s49, s49, 8192
  s_add_u32 s49, s49, 0
  s_waitcnt lgkmcnt(11)
  buffer_store_dwordx4 v[32:35], v3, s[28:31], s49 offen offset:0 sc1
  s_waitcnt lgkmcnt(10)
  buffer_store_dwordx4 v[36:39], v3, s[28:31], s49 offen offset:1024 sc1
  s_waitcnt lgkmcnt(9)
  buffer_store_dwordx4 v[40:43], v3, s[28:31], s49 offen offset:2048 sc1
  s_waitcnt lgkmcnt(8)
  buffer_store_dwordx4 v[44:47], v3, s[28:31], s49 offen offset:3072 sc1
  s_add_u32 s49, s48, 1
  s_mul_i32 s49, s49, 8192
  s_add_u32 s49, s49, 0
  s_waitcnt lgkmcnt(7)
  buffer_store_dwordx4 v[48:51], v3, s[28:31], s49 offen offset:0 sc1
  s_waitcnt lgkmcnt(6)
  buffer_store_dwordx4 v[52:55], v3, s[28:31], s49 offen offset:1024 sc1
  s_waitcnt lgkmcnt(5)
  buffer_store_dwordx4 v[56:59], v3, s[28:31], s49 offen offset:2048 sc1
  s_waitcnt lgkmcnt(4)
  buffer_store_dwordx4 v[60:63], v3, s[28:31], s49 offen offset:3072 sc1
  s_add_u32 s49, s48, 2
  s_mul_i32 s49, s49, 8192
  s_add_u32 s49, s49, 0
  s_waitcnt lgkmcnt(3)
  buffer_store_dwordx4 v[64:67], v3, s[28:31], s49 offen offset:0 sc1
  s_waitcnt lgkmcnt(2)
  buffer_store_dwordx4 v[68:71], v3, s[28:31], s49 offen offset:1024 sc1
  s_waitcnt lgkmcnt(1)
  buffer_store_dwordx4 v[72:75], v3, s[28:31], s49 offen offset:2048 sc1
  s_waitcnt lgkmcnt(0)
  buffer_store_dwordx4 v[76:79], v3, s[28:31], s49 offen offset:3072 sc1
  s_mul_i32 s49, s38, 24
  s_add_u32 s49, s49, s33
  s_lshl_b32 s49, s49, 3
  s_add_u32 s49, s49, 84017152
  v_lshlrev_b32 v5, 11, v2
  s_add_u32 s61, s88, 1
  v_mov_b32 v6, s61
  v_mov_b32 v7, s89
  s_waitcnt vmcnt(0)
  s_mov_b64 exec, 0xff
  buffer_store_dwordx2 v[6:7], v5, s[28:31], s49 offen sc1
  s_mov_b64 exec, -1

L_fzs:
  s_waitcnt vmcnt(0)
  s_barrier
  s_branch L_join
L_pack:
  s_movk_i32 s44, 1821
  s_movk_i32 s45, 9216
  s_mul_i32 s49, s39, 576
  s_mul_i32 s57, s39, 9216

  v_add_u32 v196, s49, v2
  v_mul_lo_u32 v197, v196, s44
  v_lshrrev_b32 v197, 16, v197
  v_mul_u32_u24 v198, 36, v197
  v_sub_u32 v198, v196, v198
  v_mul_lo_u32 v197, v197, s45
  v_lshl_add_u32 v176, v198, 4, v197
  v_add_u32 v196, s49, v2
  v_add_u32 v196, 64, v196
  v_mul_lo_u32 v197, v196, s44
  v_lshrrev_b32 v197, 16, v197
  v_mul_u32_u24 v198, 36, v197
  v_sub_u32 v198, v196, v198
  v_mul_lo_u32 v197, v197, s45
  v_lshl_add_u32 v177, v198, 4, v197
  v_add_u32 v196, s49, v2
  v_add_u32 v196, 128, v196
  v_mul_lo_u32 v197, v196, s44
  v_lshrrev_b32 v197, 16, v197
  v_mul_u32_u24 v198, 36, v197
  v_sub_u32 v198, v196, v198
  v_mul_lo_u32 v197, v197, s45
  v_lshl_add_u32 v178, v198, 4, v197
  v_add_u32 v196, s49, v2
  v_add_u32 v196, 192, v196
  v_mul_lo_u32 v197, v196, s44
  v_lshrrev_b32 v197, 16, v197
  v_mul_u32_u24 v198, 36, v197
  v_sub_u32 v198, v196, v198
  v_mul_lo_u32 v197, v197, s45
  v_lshl_add_u32 v179, v198, 4, v197
  v_add_u32 v196, s49, v2
  v_add_u32 v196, 256, v196
  v_mul_lo_u32 v197, v196, s44
  v_lshrrev_b32 v197, 16, v197
  v_mul_u32_u24 v198, 36, v197
  v_sub_u32 v198, v196, v198
  v_mul_lo_u32 v197, v197, s45
  v_lshl_add_u32 v180, v198, 4, v197
  v_add_u32 v196, s49, v2
  v_add_u32 v196, 320, v196
  v_mul_lo_u32 v197, v196, s44
  v_lshrrev_b32 v197, 16, v197
  v_mul_u32_u24 v198, 36, v197
  v_sub_u32 v198, v196, v198
  v_mul_lo_u32 v197, v197, s45
  v_lshl_add_u32 v181, v198, 4, v197
  v_add_u32 v196, s49, v2
  v_add_u32 v196, 384, v196
  v_mul_lo_u32 v197, v196, s44
  v_lshrrev_b32 v197, 16, v197
  v_mul_u32_u24 v198, 36, v197
  v_sub_u32 v198, v196, v198
  v_mul_lo_u32 v197, v197, s45
  v_lshl_add_u32 v182, v198, 4, v197
  v_add_u32 v196, s49, v2
  v_add_u32 v196, 448, v196
  v_mul_lo_u32 v197, v196, s44
  v_lshrrev_b32 v197, 16, v197
  v_mul_u32_u24 v198, 36, v197
  v_sub_u32 v198, v196, v198
  v_mul_lo_u32 v197, v197, s45
  v_lshl_add_u32 v183, v198, 4, v197
  v_add_u32 v196, s49, v2
  v_add_u32 v196, 512, v196
  v_mul_lo_u32 v197, v196, s44
  v_lshrrev_b32 v197, 16, v197
  v_mul_u32_u24 v198, 36, v197
  v_sub_u32 v198, v196, v198
  v_mul_lo_u32 v197, v197, s45
  v_lshl_add_u32 v184, v198, 4, v197
  s_mov_b32 s8, s92
  s_mov_b32 s9, s93
  s_mov_b32 s10, 0x510000
  s_mov_b32 s11, 0x20000
  s_mov_b32 s12, s94
  s_mov_b32 s13, s95
  s_mov_b32 s14, 0x510000
  s_mov_b32 s15, 0x20000
  v_lshrrev_b32 v192, 4, v2
  v_bfe_u32 v193, v2, 2, 2
  v_lshl_add_u32 v194, v192, 3, v193
  v_mul_u32_u24 v194, 576, v194
  v_and_b32 v195, 3, v2
  v_lshl_add_u32 v194, v195, 3, v194
  s_lshr_b32 s46, s39, 1
  s_and_b32 s47, s39, 1
  s_mul_i32 s50, s46, 18432
  s_mul_i32 s51, s47, 288
  s_add_u32 s50, s50, s51
  v_add_u32 v189, s50, v194
  v_lshl_add_u32 v194, v192, 2, v193
  v_mul_u32_u24 v194, 1152, v194
  v_lshl_add_u32 v194, v195, 3, v194
  v_mov_b32 v190, v194

  s_sub_u32 s48, s2, 192
  v_mov_b32 v5, 0
  s_mov_b32 s52, s48
  s_mul_i32 s53, s52, 7282
  s_lshr_b32 s53, s53, 16
  s_mul_i32 s54, s53, 9
  s_sub_u32 s54, s52, s54
  s_mul_i32 s54, s54, 589824
  s_mul_i32 s53, s53, 576
  s_add_u32 s54, s54, s53
  s_add_u32 m0, s57, 0
  s_nop 0
  buffer_load_dwordx4 v176, s[8:11], s54 offen nt lds
  s_add_u32 m0, s57, 1024
  s_nop 0
  buffer_load_dwordx4 v177, s[8:11], s54 offen nt lds
  s_add_u32 m0, s57, 2048
  s_nop 0
  buffer_load_dwordx4 v178, s[8:11], s54 offen nt lds
  s_add_u32 m0, s57, 3072
  s_nop 0
  buffer_load_dwordx4 v179, s[8:11], s54 offen nt lds
  s_add_u32 m0, s57, 4096
  s_nop 0
  buffer_load_dwordx4 v180, s[8:11], s54 offen nt lds
  s_add_u32 m0, s57, 5120
  s_nop 0
  buffer_load_dwordx4 v181, s[8:11], s54 offen nt lds
  s_add_u32 m0, s57, 6144
  s_nop 0
  buffer_load_dwordx4 v182, s[8:11], s54 offen nt lds
  s_add_u32 m0, s57, 7168
  s_nop 0
  buffer_load_dwordx4 v183, s[8:11], s54 offen nt lds
  s_add_u32 m0, s57, 8192
  s_nop 0
  buffer_load_dwordx4 v184, s[8:11], s54 offen nt lds
  s_add_u32 s52, s48, 64
  s_mul_i32 s53, s52, 7282
  s_lshr_b32 s53, s53, 16
  s_mul_i32 s54, s53, 9
  s_sub_u32 s54, s52, s54
  s_mul_i32 s54, s54, 589824
  s_mul_i32 s53, s53, 576
  s_add_u32 s54, s54, s53
  s_add_u32 m0, s57, 36864
  s_nop 0
  buffer_load_dwordx4 v176, s[8:11], s54 offen nt lds
  s_add_u32 m0, s57, 37888
  s_nop 0
  buffer_load_dwordx4 v177, s[8:11], s54 offen nt lds
  s_add_u32 m0, s57, 38912
  s_nop 0
  buffer_load_dwordx4 v178, s[8:11], s54 offen nt lds
  s_add_u32 m0, s57, 39936
  s_nop 0
  buffer_load_dwordx4 v179, s[8:11], s54 offen nt lds
  s_add_u32 m0, s57, 40960
  s_nop 0
  buffer_load_dwordx4 v180, s[8:11], s54 offen nt lds
  s_add_u32 m0, s57, 41984
  s_nop 0
  buffer_load_dwordx4 v181, s[8:11], s54 offen nt lds
  s_add_u32 m0, s57, 43008
  s_nop 0
  buffer_load_dwordx4 v182, s[8:11], s54 offen nt lds
  s_add_u32 m0, s57, 44032
  s_nop 0
  buffer_load_dwordx4 v183, s[8:11], s54 offen nt lds
  s_add_u32 m0, s57, 45056
  s_nop 0
  buffer_load_dwordx4 v184, s[8:11], s54 offen nt lds
  s_cmp_ge_u32 s48, 16
  s_cbranch_scc1 L_pack2
  s_add_u32 s52, s48, 128
  s_mul_i32 s53, s52, 7282
  s_lshr_b32 s53, s53, 16
  s_mul_i32 s54, s53, 9
  s_sub_u32 s54, s52, s54
  s_mul_i32 s54, s54, 589824
  s_mul_i32 s53, s53, 576
  s_add_u32 s54, s54, s53
  s_add_u32 m0, s57, 73728
  s_nop 0
  buffer_load_dwordx4 v176, s[8:11], s54 offen nt lds
  s_add_u32 m0, s57, 74752
  s_nop 0
  buffer_load_dwordx4 v177, s[8:11], s54 offen nt lds
  s_add_u32 m0, s57, 75776
  s_nop 0
  buffer_load_dwordx4 v178, s[8:11], s54 offen nt lds
  s_add_u32 m0, s57, 76800
  s_nop 0
  buffer_load_dwordx4 v179, s[8:11], s54 offen nt lds
  s_add_u32 m0, s57, 77824
  s_nop 0
  buffer_load_dwordx4 v180, s[8:11], s54 offen nt lds
  s_add_u32 m0, s57, 78848
  s_nop 0
  buffer_load_dwordx4 v181, s[8:11], s54 offen nt lds
  s_add_u32 m0, s57, 79872
  s_nop 0
  buffer_load_dwordx4 v182, s[8:11], s54 offen nt lds
  s_add_u32 m0, s57, 80896
  s_nop 0
  buffer_load_dwordx4 v183, s[8:11], s54 offen nt lds
  s_add_u32 m0, s57, 81920
  s_nop 0
  buffer_load_dwordx4 v184, s[8:11], s54 offen nt lds
  s_cmp_eq_u32 s39, 3
  s_cbranch_scc1 L_q3_4
  s_waitcnt vmcnt(32)
  v_lshlrev_b32 v120, 16, v232
  v_and_b32 v121, s43, v232
  v_lshlrev_b32 v122, 16, v233
  v_and_b32 v123, s43, v233
  v_lshlrev_b32 v124, 16, v234
  v_and_b32 v125, s43, v234
  v_lshlrev_b32 v126, 16, v235
  v_and_b32 v127, s43, v235
  v_lshlrev_b32 v128, 16, v236
  v_and_b32 v129, s43, v236
  v_lshlrev_b32 v130, 16, v237
  v_and_b32 v131, s43, v237
  v_lshlrev_b32 v132, 16, v238
  v_and_b32 v133, s43, v238
  v_lshlrev_b32 v134, 16, v239
  v_and_b32 v135, s43, v239
  v_lshlrev_b32 v136, 16, v240
  v_and_b32 v137, s43, v240
  v_lshlrev_b32 v138, 16, v241
  v_and_b32 v139, s43, v241
  v_lshlrev_b32 v140, 16, v242
  v_and_b32 v141, s43, v242
  v_lshlrev_b32 v142, 16, v243
  v_and_b32 v143, s43, v243
  v_pk_add_f32 v[150:151], v[120:121], v[122:123]
  v_pk_add_f32 v[152:153], v[124:125], v[126:127]
  v_pk_add_f32 v[150:151], v[150:151], v[128:129]
  v_pk_add_f32 v[152:153], v[152:153], v[130:131]
  v_pk_add_f32 v[150:151], v[150:151], v[132:133]
  v_pk_add_f32 v[152:153], v[152:153], v[134:135]
  v_pk_add_f32 v[150:151], v[150:151], v[136:137]
  v_pk_add_f32 v[152:153], v[152:153], v[138:139]
  v_pk_add_f32 v[150:151], v[150:151], v[140:141]
  v_pk_add_f32 v[152:153], v[152:153], v[142:143]
  v_pk_add_f32 v[150:151], v[150:151], v[152:153]
  v_add_f32 v150, v150, v151
  v_mul_f32 v154, 0x3d2aaaab, v150
  v_sub_f32 v150, 0, v154
  v_sub_f32 v151, 0, v154
  v_pk_add_f32 v[160:161], v[120:121], v[150:151]
  v_pk_add_f32 v[162:163], v[122:123], v[150:151]
  v_pk_mul_f32 v[156:157], v[160:161], v[160:161]
  v_pk_mul_f32 v[158:159], v[162:163], v[162:163]
  v_pk_add_f32 v[160:161], v[124:125], v[150:151]
  v_pk_add_f32 v[162:163], v[126:127], v[150:151]
  v_pk_fma_f32 v[156:157], v[160:161], v[160:161], v[156:157]
  v_pk_fma_f32 v[158:159], v[162:163], v[162:163], v[158:159]
  v_pk_add_f32 v[160:161], v[128:129], v[150:151]
  v_pk_add_f32 v[162:163], v[130:131], v[150:151]
  v_pk_fma_f32 v[156:157], v[160:161], v[160:161], v[156:157]
  v_pk_fma_f32 v[158:159], v[162:163], v[162:163], v[158:159]
  v_pk_add_f32 v[160:161], v[132:133], v[150:151]
  v_pk_add_f32 v[162:163], v[134:135], v[150:151]
  v_pk_fma_f32 v[156:157], v[160:161], v[160:161], v[156:157]
  v_pk_fma_f32 v[158:159], v[162:163], v[162:163], v[158:159]
  v_pk_add_f32 v[160:161], v[136:137], v[150:151]
  v_pk_add_f32 v[162:163], v[138:139], v[150:151]
  v_pk_fma_f32 v[156:157], v[160:161], v[160:161], v[156:157]
  v_pk_fma_f32 v[158:159], v[162:163], v[162:163], v[158:159]
  v_pk_add_f32 v[160:161], v[140:141], v[150:151]
  v_pk_add_f32 v[162:163], v[142:143], v[150:151]
  v_pk_fma_f32 v[156:157], v[160:161], v[160:161], v[156:157]
  v_pk_fma_f32 v[158:159], v[162:163], v[162:163], v[158:159]
  v_add_f32 v156, v156, v157
  v_add_f32 v158, v158, v159
  v_add_f32 v155, v156, v158
  s_nop 1
  v_mov_b32_dpp v156, v154 row_ror:8 row_mask:0xf bank_mask:0xf
  v_mov_b32_dpp v157, v155 row_ror:8 row_mask:0xf bank_mask:0xf
  v_sub_f32 v160, v154, v156
  v_add_f32 v154, v154, v156
  v_add_f32 v155, v155, v157
  v_mul_f32 v160, v160, v160
  v_mul_f32 v154, 0.5, v154
  v_fmac_f32 v155, 0x41400000, v160
  v_mov_b32 v156, v154
  v_mov_b32 v157, v154
  v_mov_b32 v158, v155
  v_mov_b32 v159, v155
  s_nop 1
  v_permlane16_swap_b32 v156, v157
  v_permlane16_swap_b32 v158, v159
  s_nop 1
  v_sub_f32 v160, v156, v157
  v_add_f32 v154, v156, v157
  v_add_f32 v155, v158, v159
  v_mul_f32 v160, v160, v160
  v_mul_f32 v154, 0.5, v154
  v_fmac_f32 v155, 0x41c00000, v160
  v_mov_b32 v156, v154
  v_mov_b32 v157, v154
  v_mov_b32 v158, v155
  v_mov_b32 v159, v155
  s_nop 1
  v_permlane32_swap_b32 v156, v157
  v_permlane32_swap_b32 v158, v159
  s_nop 1
  v_sub_f32 v160, v156, v157
  v_add_f32 v154, v156, v157
  v_add_f32 v155, v158, v159
  v_mul_f32 v160, v160, v160
  v_mul_f32 v154, 0.5, v154
  v_fmac_f32 v155, 0x42400000, v160
  ds_write_b64 v11, v[154:155] offset:0
  s_waitcnt lgkmcnt(0)
  s_barrier
  ds_read_b64 v[156:157], v12 offset:0
  ds_read_b64 v[158:159], v12 offset:64
  ds_read_b64 v[160:161], v12 offset:128
  s_waitcnt lgkmcnt(0)
  v_add_f32 v154, v156, v158
  v_add_f32 v155, v157, v159
  v_add_f32 v154, v154, v160
  v_add_f32 v155, v155, v161
  v_mul_f32 v154, 0x3eaaaaab, v154
  v_sub_f32 v156, v156, v154
  v_sub_f32 v158, v158, v154
  v_sub_f32 v160, v160, v154
  v_mul_f32 v156, v156, v156
  v_fmac_f32 v156, v158, v158
  v_fmac_f32 v156, v160, v160
  v_fmac_f32 v155, 0x43400000, v156
  v_mul_f32 v155, 0x3ae38e39, v155
  v_cvt_pk_bf16_f32 v154, v154, v154
  v_lshlrev_b32 v154, 16, v154
  v_cvt_pk_bf16_f32 v155, v155, v155
  v_lshlrev_b32 v155, 16, v155
  v_add_f32 v155, 0x37280000, v155
  v_cvt_pk_bf16_f32 v155, v155, v155
  v_lshlrev_b32 v155, 16, v155
  v_sqrt_f32 v155, v155
  s_nop 0
  v_cvt_pk_bf16_f32 v155, v155, v155
  v_lshlrev_b32 v155, 16, v155
  v_rcp_f32 v152, v155
  v_sub_f32 v150, 0, v154
  v_sub_f32 v151, 0, v154
  s_nop 0
  v_mov_b32 v153, v152
  v_pk_add_f32 v[170:171], v[120:121], v[150:151]
  v_pk_add_f32 v[174:175], v[122:123], v[150:151]
  v_pk_add_f32 v[178:179], v[124:125], v[150:151]
  v_pk_add_f32 v[182:183], v[126:127], v[150:151]
  v_cvt_pk_bf16_f32 v172, v170, v171
  v_cvt_pk_bf16_f32 v176, v174, v175
  v_cvt_pk_bf16_f32 v180, v178, v179
  v_cvt_pk_bf16_f32 v184, v182, v183
  v_lshlrev_b32 v170, 16, v172
  v_lshlrev_b32 v174, 16, v176
  v_lshlrev_b32 v178, 16, v180
  v_lshlrev_b32 v182, 16, v184
  v_and_b32 v171, s43, v172
  v_and_b32 v175, s43, v176
  v_and_b32 v179, s43, v180
  v_and_b32 v183, s43, v184
  v_pk_mul_f32 v[170:171], v[170:171], v[152:153]
  v_pk_mul_f32 v[174:175], v[174:175], v[152:153]
  v_pk_mul_f32 v[178:179], v[178:179], v[152:153]
  v_pk_mul_f32 v[182:183], v[182:183], v[152:153]
  v_cvt_pk_bf16_f32 v244, v170, v171
  v_cvt_pk_bf16_f32 v245, v174, v175
  v_cvt_pk_bf16_f32 v246, v178, v179
  v_cvt_pk_bf16_f32 v247, v182, v183
  v_pk_add_f32 v[170:171], v[128:129], v[150:151]
  v_pk_add_f32 v[174:175], v[130:131], v[150:151]
  v_pk_add_f32 v[178:179], v[132:133], v[150:151]
  v_pk_add_f32 v[182:183], v[134:135], v[150:151]
  v_cvt_pk_bf16_f32 v172, v170, v171
  v_cvt_pk_bf16_f32 v176, v174, v175
  v_cvt_pk_bf16_f32 v180, v178, v179
  v_cvt_pk_bf16_f32 v184, v182, v183
  v_lshlrev_b32 v170, 16, v172
  v_lshlrev_b32 v174, 16, v176
  v_lshlrev_b32 v178, 16, v180
  v_lshlrev_b32 v182, 16, v184
  v_and_b32 v171, s43, v172
  v_and_b32 v175, s43, v176
  v_and_b32 v179, s43, v180
  v_and_b32 v183, s43, v184
  v_pk_mul_f32 v[170:171], v[170:171], v[152:153]
  v_pk_mul_f32 v[174:175], v[174:175], v[152:153]
  v_pk_mul_f32 v[178:179], v[178:179], v[152:153]
  v_pk_mul_f32 v[182:183], v[182:183], v[152:153]
  v_cvt_pk_bf16_f32 v248, v170, v171
  v_cvt_pk_bf16_f32 v249, v174, v175
  v_cvt_pk_bf16_f32 v250, v178, v179
  v_cvt_pk_bf16_f32 v251, v182, v183
  v_pk_add_f32 v[170:171], v[136:137], v[150:151]
  v_pk_add_f32 v[174:175], v[138:139], v[150:151]
  v_pk_add_f32 v[178:179], v[140:141], v[150:151]
  v_pk_add_f32 v[182:183], v[142:143], v[150:151]
  v_cvt_pk_bf16_f32 v172, v170, v171
  v_cvt_pk_bf16_f32 v176, v174, v175
  v_cvt_pk_bf16_f32 v180, v178, v179
  v_cvt_pk_bf16_f32 v184, v182, v183
  v_lshlrev_b32 v170, 16, v172
  v_lshlrev_b32 v174, 16, v176
  v_lshlrev_b32 v178, 16, v180
  v_lshlrev_b32 v182, 16, v184
  v_and_b32 v171, s43, v172
  v_and_b32 v175, s43, v176
  v_and_b32 v179, s43, v180
  v_and_b32 v183, s43, v184
  v_pk_mul_f32 v[170:171], v[170:171], v[152:153]
  v_pk_mul_f32 v[174:175], v[174:175], v[152:153]
  v_pk_mul_f32 v[178:179], v[178:179], v[152:153]
  v_pk_mul_f32 v[182:183], v[182:183], v[152:153]
  v_cvt_pk_bf16_f32 v252, v170, v171
  v_cvt_pk_bf16_f32 v253, v174, v175
  v_cvt_pk_bf16_f32 v254, v178, v179
  v_cvt_pk_bf16_f32 v255, v182, v183
  s_branch L_qd_5
L_q3_4:
  s_barrier
L_qd_5:
  s_waitcnt vmcnt(18)
  s_barrier
  s_mov_b32 s52, s48
  v_add_u32 v191, 0, v189
  ds_read_b64_tr_b16 v[32:33], v191 offset:0
  ds_read_b64_tr_b16 v[34:35], v191 offset:2304
  ds_read_b64_tr_b16 v[36:37], v191 offset:32
  ds_read_b64_tr_b16 v[38:39], v191 offset:2336
  ds_read_b64_tr_b16 v[40:41], v191 offset:64
  ds_read_b64_tr_b16 v[42:43], v191 offset:2368
  ds_read_b64_tr_b16 v[44:45], v191 offset:96
  ds_read_b64_tr_b16 v[46:47], v191 offset:2400
  ds_read_b64_tr_b16 v[48:49], v191 offset:128
  ds_read_b64_tr_b16 v[50:51], v191 offset:2432
  ds_read_b64_tr_b16 v[52:53], v191 offset:160
  ds_read_b64_tr_b16 v[54:55], v191 offset:2464
  ds_read_b64_tr_b16 v[56:57], v191 offset:192
  ds_read_b64_tr_b16 v[58:59], v191 offset:2496
  ds_read_b64_tr_b16 v[60:61], v191 offset:224
  ds_read_b64_tr_b16 v[62:63], v191 offset:2528
  ds_read_b64_tr_b16 v[64:65], v191 offset:256
  ds_read_b64_tr_b16 v[66:67], v191 offset:2560
  s_mul_i32 s53, s52, 7282
  s_lshr_b32 s53, s53, 16
  s_mul_i32 s54, s53, 9
  s_sub_u32 s54, s52, s54
  s_mul_i32 s50, s53, 331776
  s_add_u32 s50, s50, 8388608
  s_lshl_b32 s51, s54, 1
  s_add_u32 s51, s51, s46
  s_lshl_b32 s53, s53, 9
  s_lshl_b32 s54, s54, 5
  s_add_u32 s49, s53, s54
  s_lshl_b32 s54, s39, 3
  s_add_u32 s49, s49, s54
  s_add_u32 s49, s49, 83898368
  s_mul_i32 s53, s47, 9
  s_add_u32 s53, s53, 0
  s_mul_i32 s54, s51, 6
  s_add_u32 s54, s54, s53
  s_lshl_b32 s54, s54, 10
  s_lshr_b32 s55, s53, 1
  s_mul_i32 s55, s55, 36
  s_lshl_b32 s56, s51, 1
  s_add_u32 s55, s55, s56
  s_and_b32 s56, s53, 1
  s_add_u32 s55, s55, s56
  s_lshl_b32 s55, s55, 10
  s_cmp_lt_u32 s53, 6
  s_cselect_b32 s55, s54, s55
  s_add_u32 s55, s55, s50
  s_waitcnt lgkmcnt(14)
  buffer_store_dwordx4 v[32:35], v3, s[28:31], s55 offen sc1
  s_mul_i32 s53, s47, 9
  s_add_u32 s53, s53, 1
  s_mul_i32 s54, s51, 6
  s_add_u32 s54, s54, s53
  s_lshl_b32 s54, s54, 10
  s_lshr_b32 s55, s53, 1
  s_mul_i32 s55, s55, 36
  s_lshl_b32 s56, s51, 1
  s_add_u32 s55, s55, s56
  s_and_b32 s56, s53, 1
  s_add_u32 s55, s55, s56
  s_lshl_b32 s55, s55, 10
  s_cmp_lt_u32 s53, 6
  s_cselect_b32 s55, s54, s55
  s_add_u32 s55, s55, s50
  s_waitcnt lgkmcnt(14)
  buffer_store_dwordx4 v[36:39], v3, s[28:31], s55 offen sc1
  s_mul_i32 s53, s47, 9
  s_add_u32 s53, s53, 2
  s_mul_i32 s54, s51, 6
  s_add_u32 s54, s54, s53
  s_lshl_b32 s54, s54, 10
  s_lshr_b32 s55, s53, 1
  s_mul_i32 s55, s55, 36
  s_lshl_b32 s56, s51, 1
  s_add_u32 s55, s55, s56
  s_and_b32 s56, s53, 1
  s_add_u32 s55, s55, s56
  s_lshl_b32 s55, s55, 10
  s_cmp_lt_u32 s53, 6
  s_cselect_b32 s55, s54, s55
  s_add_u32 s55, s55, s50
  s_waitcnt lgkmcnt(12)
  buffer_store_dwordx4 v[40:43], v3, s[28:31], s55 offen sc1
  s_mul_i32 s53, s47, 9
  s_add_u32 s53, s53, 3
  s_mul_i32 s54, s51, 6
  s_add_u32 s54, s54, s53
  s_lshl_b32 s54, s54, 10
  s_lshr_b32 s55, s53, 1
  s_mul_i32 s55, s55, 36
  s_lshl_b32 s56, s51, 1
  s_add_u32 s55, s55, s56
  s_and_b32 s56, s53, 1
  s_add_u32 s55, s55, s56
  s_lshl_b32 s55, s55, 10
  s_cmp_lt_u32 s53, 6
  s_cselect_b32 s55, s54, s55
  s_add_u32 s55, s55, s50
  s_waitcnt lgkmcnt(10)
  buffer_store_dwordx4 v[44:47], v3, s[28:31], s55 offen sc1
  s_mul_i32 s53, s47, 9
  s_add_u32 s53, s53, 4
  s_mul_i32 s54, s51, 6
  s_add_u32 s54, s54, s53
  s_lshl_b32 s54, s54, 10
  s_lshr_b32 s55, s53, 1
  s_mul_i32 s55, s55, 36
  s_lshl_b32 s56, s51, 1
  s_add_u32 s55, s55, s56
  s_and_b32 s56, s53, 1
  s_add_u32 s55, s55, s56
  s_lshl_b32 s55, s55, 10
  s_cmp_lt_u32 s53, 6
  s_cselect_b32 s55, s54, s55
  s_add_u32 s55, s55, s50
  s_waitcnt lgkmcnt(8)
  buffer_store_dwordx4 v[48:51], v3, s[28:31], s55 offen sc1
  s_mul_i32 s53, s47, 9
  s_add_u32 s53, s53, 5
  s_mul_i32 s54, s51, 6
  s_add_u32 s54, s54, s53
  s_lshl_b32 s54, s54, 10
  s_lshr_b32 s55, s53, 1
  s_mul_i32 s55, s55, 36
  s_lshl_b32 s56, s51, 1
  s_add_u32 s55, s55, s56
  s_and_b32 s56, s53, 1
  s_add_u32 s55, s55, s56
  s_lshl_b32 s55, s55, 10
  s_cmp_lt_u32 s53, 6
  s_cselect_b32 s55, s54, s55
  s_add_u32 s55, s55, s50
  s_waitcnt lgkmcnt(6)
  buffer_store_dwordx4 v[52:55], v3, s[28:31], s55 offen sc1
  s_mul_i32 s53, s47, 9
  s_add_u32 s53, s53, 6
  s_mul_i32 s54, s51, 6
  s_add_u32 s54, s54, s53
  s_lshl_b32 s54, s54, 10
  s_lshr_b32 s55, s53, 1
  s_mul_i32 s55, s55, 36
  s_lshl_b32 s56, s51, 1
  s_add_u32 s55, s55, s56
  s_and_b32 s56, s53, 1
  s_add_u32 s55, s55, s56
  s_lshl_b32 s55, s55, 10
  s_cmp_lt_u32 s53, 6
  s_cselect_b32 s55, s54, s55
  s_add_u32 s55, s55, s50
  s_waitcnt lgkmcnt(4)
  buffer_store_dwordx4 v[56:59], v3, s[28:31], s55 offen sc1
  s_mul_i32 s53, s47, 9
  s_add_u32 s53, s53, 7
  s_mul_i32 s54, s51, 6
  s_add_u32 s54, s54, s53
  s_lshl_b32 s54, s54, 10
  s_lshr_b32 s55, s53, 1
  s_mul_i32 s55, s55, 36
  s_lshl_b32 s56, s51, 1
  s_add_u32 s55, s55, s56
  s_and_b32 s56, s53, 1
  s_add_u32 s55, s55, s56
  s_lshl_b32 s55, s55, 10
  s_cmp_lt_u32 s53, 6
  s_cselect_b32 s55, s54, s55
  s_add_u32 s55, s55, s50
  s_waitcnt lgkmcnt(2)
  buffer_store_dwordx4 v[60:63], v3, s[28:31], s55 offen sc1
  s_mul_i32 s53, s47, 9
  s_add_u32 s53, s53, 8
  s_mul_i32 s54, s51, 6
  s_add_u32 s54, s54, s53
  s_lshl_b32 s54, s54, 10
  s_lshr_b32 s55, s53, 1
  s_mul_i32 s55, s55, 36
  s_lshl_b32 s56, s51, 1
  s_add_u32 s55, s55, s56
  s_and_b32 s56, s53, 1
  s_add_u32 s55, s55, s56
  s_lshl_b32 s55, s55, 10
  s_cmp_lt_u32 s53, 6
  s_cselect_b32 s55, s54, s55
  s_add_u32 s55, s55, s50
  s_waitcnt lgkmcnt(0)
  buffer_store_dwordx4 v[64:67], v3, s[28:31], s55 offen sc1
  s_mov_b32 s100, s49
  s_waitcnt vmcnt(18)
  s_barrier
  s_add_u32 s52, s48, 64
  v_add_u32 v191, 36864, v189
  ds_read_b64_tr_b16 v[68:69], v191 offset:0
  ds_read_b64_tr_b16 v[70:71], v191 offset:2304
  ds_read_b64_tr_b16 v[72:73], v191 offset:32
  ds_read_b64_tr_b16 v[74:75], v191 offset:2336
  ds_read_b64_tr_b16 v[76:77], v191 offset:64
  ds_read_b64_tr_b16 v[78:79], v191 offset:2368
  ds_read_b64_tr_b16 v[80:81], v191 offset:96
  ds_read_b64_tr_b16 v[82:83], v191 offset:2400
  ds_read_b64_tr_b16 v[84:85], v191 offset:128
  ds_read_b64_tr_b16 v[86:87], v191 offset:2432
  ds_read_b64_tr_b16 v[88:89], v191 offset:160
  ds_read_b64_tr_b16 v[90:91], v191 offset:2464
  ds_read_b64_tr_b16 v[92:93], v191 offset:192
  ds_read_b64_tr_b16 v[94:95], v191 offset:2496
  ds_read_b64_tr_b16 v[96:97], v191 offset:224
  ds_read_b64_tr_b16 v[98:99], v191 offset:2528
  ds_read_b64_tr_b16 v[100:101], v191 offset:256
  ds_read_b64_tr_b16 v[102:103], v191 offset:2560
  s_mul_i32 s53, s52, 7282
  s_lshr_b32 s53, s53, 16
  s_mul_i32 s54, s53, 9
  s_sub_u32 s54, s52, s54
  s_mul_i32 s50, s53, 331776
  s_add_u32 s50, s50, 8388608
  s_lshl_b32 s51, s54, 1
  s_add_u32 s51, s51, s46
  s_lshl_b32 s53, s53, 9
  s_lshl_b32 s54, s54, 5
  s_add_u32 s49, s53, s54
  s_lshl_b32 s54, s39, 3
  s_add_u32 s49, s49, s54
  s_add_u32 s49, s49, 83898368
  s_mul_i32 s53, s47, 9
  s_add_u32 s53, s53, 0
  s_mul_i32 s54, s51, 6
  s_add_u32 s54, s54, s53
  s_lshl_b32 s54, s54, 10
  s_lshr_b32 s55, s53, 1
  s_mul_i32 s55, s55, 36
  s_lshl_b32 s56, s51, 1
  s_add_u32 s55, s55, s56
  s_and_b32 s56, s53, 1
  s_add_u32 s55, s55, s56
  s_lshl_b32 s55, s55, 10
  s_cmp_lt_u32 s53, 6
  s_cselect_b32 s55, s54, s55
  s_add_u32 s55, s55, s50
  s_waitcnt lgkmcnt(14)
  buffer_store_dwordx4 v[68:71], v3, s[28:31], s55 offen sc1
  s_mul_i32 s53, s47, 9
  s_add_u32 s53, s53, 1
  s_mul_i32 s54, s51, 6
  s_add_u32 s54, s54, s53
  s_lshl_b32 s54, s54, 10
  s_lshr_b32 s55, s53, 1
  s_mul_i32 s55, s55, 36
  s_lshl_b32 s56, s51, 1
  s_add_u32 s55, s55, s56
  s_and_b32 s56, s53, 1
  s_add_u32 s55, s55, s56
  s_lshl_b32 s55, s55, 10
  s_cmp_lt_u32 s53, 6
  s_cselect_b32 s55, s54, s55
  s_add_u32 s55, s55, s50
  s_waitcnt lgkmcnt(14)
  buffer_store_dwordx4 v[72:75], v3, s[28:31], s55 offen sc1
  s_mul_i32 s53, s47, 9
  s_add_u32 s53, s53, 2
  s_mul_i32 s54, s51, 6
  s_add_u32 s54, s54, s53
  s_lshl_b32 s54, s54, 10
  s_lshr_b32 s55, s53, 1
  s_mul_i32 s55, s55, 36
  s_lshl_b32 s56, s51, 1
  s_add_u32 s55, s55, s56
  s_and_b32 s56, s53, 1
  s_add_u32 s55, s55, s56
  s_lshl_b32 s55, s55, 10
  s_cmp_lt_u32 s53, 6
  s_cselect_b32 s55, s54, s55
  s_add_u32 s55, s55, s50
  s_waitcnt lgkmcnt(12)
  buffer_store_dwordx4 v[76:79], v3, s[28:31], s55 offen sc1
  s_mul_i32 s53, s47, 9
  s_add_u32 s53, s53, 3
  s_mul_i32 s54, s51, 6
  s_add_u32 s54, s54, s53
  s_lshl_b32 s54, s54, 10
  s_lshr_b32 s55, s53, 1
  s_mul_i32 s55, s55, 36
  s_lshl_b32 s56, s51, 1
  s_add_u32 s55, s55, s56
  s_and_b32 s56, s53, 1
  s_add_u32 s55, s55, s56
  s_lshl_b32 s55, s55, 10
  s_cmp_lt_u32 s53, 6
  s_cselect_b32 s55, s54, s55
  s_add_u32 s55, s55, s50
  s_waitcnt lgkmcnt(10)
  buffer_store_dwordx4 v[80:83], v3, s[28:31], s55 offen sc1
  s_mul_i32 s53, s47, 9
  s_add_u32 s53, s53, 4
  s_mul_i32 s54, s51, 6
  s_add_u32 s54, s54, s53
  s_lshl_b32 s54, s54, 10
  s_lshr_b32 s55, s53, 1
  s_mul_i32 s55, s55, 36
  s_lshl_b32 s56, s51, 1
  s_add_u32 s55, s55, s56
  s_and_b32 s56, s53, 1
  s_add_u32 s55, s55, s56
  s_lshl_b32 s55, s55, 10
  s_cmp_lt_u32 s53, 6
  s_cselect_b32 s55, s54, s55
  s_add_u32 s55, s55, s50
  s_waitcnt lgkmcnt(8)
  buffer_store_dwordx4 v[84:87], v3, s[28:31], s55 offen sc1
  s_mul_i32 s53, s47, 9
  s_add_u32 s53, s53, 5
  s_mul_i32 s54, s51, 6
  s_add_u32 s54, s54, s53
  s_lshl_b32 s54, s54, 10
  s_lshr_b32 s55, s53, 1
  s_mul_i32 s55, s55, 36
  s_lshl_b32 s56, s51, 1
  s_add_u32 s55, s55, s56
  s_and_b32 s56, s53, 1
  s_add_u32 s55, s55, s56
  s_lshl_b32 s55, s55, 10
  s_cmp_lt_u32 s53, 6
  s_cselect_b32 s55, s54, s55
  s_add_u32 s55, s55, s50
  s_waitcnt lgkmcnt(6)
  buffer_store_dwordx4 v[88:91], v3, s[28:31], s55 offen sc1
  s_mul_i32 s53, s47, 9
  s_add_u32 s53, s53, 6
  s_mul_i32 s54, s51, 6
  s_add_u32 s54, s54, s53
  s_lshl_b32 s54, s54, 10
  s_lshr_b32 s55, s53, 1
  s_mul_i32 s55, s55, 36
  s_lshl_b32 s56, s51, 1
  s_add_u32 s55, s55, s56
  s_and_b32 s56, s53, 1
  s_add_u32 s55, s55, s56
  s_lshl_b32 s55, s55, 10
  s_cmp_lt_u32 s53, 6
  s_cselect_b32 s55, s54, s55
  s_add_u32 s55, s55, s50
  s_waitcnt lgkmcnt(4)
  buffer_store_dwordx4 v[92:95], v3, s[28:31], s55 offen sc1
  s_mul_i32 s53, s47, 9
  s_add_u32 s53, s53, 7
  s_mul_i32 s54, s51, 6
  s_add_u32 s54, s54, s53
  s_lshl_b32 s54, s54, 10
  s_lshr_b32 s55, s53, 1
  s_mul_i32 s55, s55, 36
  s_lshl_b32 s56, s51, 1
  s_add_u32 s55, s55, s56
  s_and_b32 s56, s53, 1
  s_add_u32 s55, s55, s56
  s_lshl_b32 s55, s55, 10
  s_cmp_lt_u32 s53, 6
  s_cselect_b32 s55, s54, s55
  s_add_u32 s55, s55, s50
  s_waitcnt lgkmcnt(2)
  buffer_store_dwordx4 v[96:99], v3, s[28:31], s55 offen sc1
  s_mul_i32 s53, s47, 9
  s_add_u32 s53, s53, 8
  s_mul_i32 s54, s51, 6
  s_add_u32 s54, s54, s53
  s_lshl_b32 s54, s54, 10
  s_lshr_b32 s55, s53, 1
  s_mul_i32 s55, s55, 36
  s_lshl_b32 s56, s51, 1
  s_add_u32 s55, s55, s56
  s_and_b32 s56, s53, 1
  s_add_u32 s55, s55, s56
  s_lshl_b32 s55, s55, 10
  s_cmp_lt_u32 s53, 6
  s_cselect_b32 s55, s54, s55
  s_add_u32 s55, s55, s50
  s_waitcnt lgkmcnt(0)
  buffer_store_dwordx4 v[100:103], v3, s[28:31], s55 offen sc1
  s_mov_b32 s101, s49
  s_waitcnt vmcnt(18)
  s_barrier
  s_add_u32 s52, s48, 128
  v_add_u32 v191, 73728, v189
  ds_read_b64_tr_b16 v[104:105], v191 offset:0
  ds_read_b64_tr_b16 v[106:107], v191 offset:2304
  ds_read_b64_tr_b16 v[108:109], v191 offset:32
  ds_read_b64_tr_b16 v[110:111], v191 offset:2336
  ds_read_b64_tr_b16 v[112:113], v191 offset:64
  ds_read_b64_tr_b16 v[114:115], v191 offset:2368
  ds_read_b64_tr_b16 v[116:117], v191 offset:96
  ds_read_b64_tr_b16 v[118:119], v191 offset:2400
  ds_read_b64_tr_b16 v[120:121], v191 offset:128
  ds_read_b64_tr_b16 v[122:123], v191 offset:2432
  ds_read_b64_tr_b16 v[124:125], v191 offset:160
  ds_read_b64_tr_b16 v[126:127], v191 offset:2464
  ds_read_b64_tr_b16 v[128:129], v191 offset:192
  ds_read_b64_tr_b16 v[130:131], v191 offset:2496
  ds_read_b64_tr_b16 v[132:133], v191 offset:224
  ds_read_b64_tr_b16 v[134:135], v191 offset:2528
  ds_read_b64_tr_b16 v[136:137], v191 offset:256
  ds_read_b64_tr_b16 v[138:139], v191 offset:2560
  s_mul_i32 s53, s52, 7282
  s_lshr_b32 s53, s53, 16
  s_mul_i32 s54, s53, 9
  s_sub_u32 s54, s52, s54
  s_mul_i32 s50, s53, 331776
  s_add_u32 s50, s50, 8388608
  s_lshl_b32 s51, s54, 1
  s_add_u32 s51, s51, s46
  s_lshl_b32 s53, s53, 9
  s_lshl_b32 s54, s54, 5
  s_add_u32 s49, s53, s54
  s_lshl_b32 s54, s39, 3
  s_add_u32 s49, s49, s54
  s_add_u32 s49, s49, 83898368
  s_mul_i32 s53, s47, 9
  s_add_u32 s53, s53, 0
  s_mul_i32 s54, s51, 6
  s_add_u32 s54, s54, s53
  s_lshl_b32 s54, s54, 10
  s_lshr_b32 s55, s53, 1
  s_mul_i32 s55, s55, 36
  s_lshl_b32 s56, s51, 1
  s_add_u32 s55, s55, s56
  s_and_b32 s56, s53, 1
  s_add_u32 s55, s55, s56
  s_lshl_b32 s55, s55, 10
  s_cmp_lt_u32 s53, 6
  s_cselect_b32 s55, s54, s55
  s_add_u32 s55, s55, s50
  s_waitcnt lgkmcnt(14)
  buffer_store_dwordx4 v[104:107], v3, s[28:31], s55 offen sc1
  s_mul_i32 s53, s47, 9
  s_add_u32 s53, s53, 1
  s_mul_i32 s54, s51, 6
  s_add_u32 s54, s54, s53
  s_lshl_b32 s54, s54, 10
  s_lshr_b32 s55, s53, 1
  s_mul_i32 s55, s55, 36
  s_lshl_b32 s56, s51, 1
  s_add_u32 s55, s55, s56
  s_and_b32 s56, s53, 1
  s_add_u32 s55, s55, s56
  s_lshl_b32 s55, s55, 10
  s_cmp_lt_u32 s53, 6
  s_cselect_b32 s55, s54, s55
  s_add_u32 s55, s55, s50
  s_waitcnt lgkmcnt(14)
  buffer_store_dwordx4 v[108:111], v3, s[28:31], s55 offen sc1
  s_mul_i32 s53, s47, 9
  s_add_u32 s53, s53, 2
  s_mul_i32 s54, s51, 6
  s_add_u32 s54, s54, s53
  s_lshl_b32 s54, s54, 10
  s_lshr_b32 s55, s53, 1
  s_mul_i32 s55, s55, 36
  s_lshl_b32 s56, s51, 1
  s_add_u32 s55, s55, s56
  s_and_b32 s56, s53, 1
  s_add_u32 s55, s55, s56
  s_lshl_b32 s55, s55, 10
  s_cmp_lt_u32 s53, 6
  s_cselect_b32 s55, s54, s55
  s_add_u32 s55, s55, s50
  s_waitcnt lgkmcnt(12)
  buffer_store_dwordx4 v[112:115], v3, s[28:31], s55 offen sc1
  s_mul_i32 s53, s47, 9
  s_add_u32 s53, s53, 3
  s_mul_i32 s54, s51, 6
  s_add_u32 s54, s54, s53
  s_lshl_b32 s54, s54, 10
  s_lshr_b32 s55, s53, 1
  s_mul_i32 s55, s55, 36
  s_lshl_b32 s56, s51, 1
  s_add_u32 s55, s55, s56
  s_and_b32 s56, s53, 1
  s_add_u32 s55, s55, s56
  s_lshl_b32 s55, s55, 10
  s_cmp_lt_u32 s53, 6
  s_cselect_b32 s55, s54, s55
  s_add_u32 s55, s55, s50
  s_waitcnt lgkmcnt(10)
  buffer_store_dwordx4 v[116:119], v3, s[28:31], s55 offen sc1
  s_mul_i32 s53, s47, 9
  s_add_u32 s53, s53, 4
  s_mul_i32 s54, s51, 6
  s_add_u32 s54, s54, s53
  s_lshl_b32 s54, s54, 10
  s_lshr_b32 s55, s53, 1
  s_mul_i32 s55, s55, 36
  s_lshl_b32 s56, s51, 1
  s_add_u32 s55, s55, s56
  s_and_b32 s56, s53, 1
  s_add_u32 s55, s55, s56
  s_lshl_b32 s55, s55, 10
  s_cmp_lt_u32 s53, 6
  s_cselect_b32 s55, s54, s55
  s_add_u32 s55, s55, s50
  s_waitcnt lgkmcnt(8)
  buffer_store_dwordx4 v[120:123], v3, s[28:31], s55 offen sc1
  s_mul_i32 s53, s47, 9
  s_add_u32 s53, s53, 5
  s_mul_i32 s54, s51, 6
  s_add_u32 s54, s54, s53
  s_lshl_b32 s54, s54, 10
  s_lshr_b32 s55, s53, 1
  s_mul_i32 s55, s55, 36
  s_lshl_b32 s56, s51, 1
  s_add_u32 s55, s55, s56
  s_and_b32 s56, s53, 1
  s_add_u32 s55, s55, s56
  s_lshl_b32 s55, s55, 10
  s_cmp_lt_u32 s53, 6
  s_cselect_b32 s55, s54, s55
  s_add_u32 s55, s55, s50
  s_waitcnt lgkmcnt(6)
  buffer_store_dwordx4 v[124:127], v3, s[28:31], s55 offen sc1
  s_mul_i32 s53, s47, 9
  s_add_u32 s53, s53, 6
  s_mul_i32 s54, s51, 6
  s_add_u32 s54, s54, s53
  s_lshl_b32 s54, s54, 10
  s_lshr_b32 s55, s53, 1
  s_mul_i32 s55, s55, 36
  s_lshl_b32 s56, s51, 1
  s_add_u32 s55, s55, s56
  s_and_b32 s56, s53, 1
  s_add_u32 s55, s55, s56
  s_lshl_b32 s55, s55, 10
  s_cmp_lt_u32 s53, 6
  s_cselect_b32 s55, s54, s55
  s_add_u32 s55, s55, s50
  s_waitcnt lgkmcnt(4)
  buffer_store_dwordx4 v[128:131], v3, s[28:31], s55 offen sc1
  s_mul_i32 s53, s47, 9
  s_add_u32 s53, s53, 7
  s_mul_i32 s54, s51, 6
  s_add_u32 s54, s54, s53
  s_lshl_b32 s54, s54, 10
  s_lshr_b32 s55, s53, 1
  s_mul_i32 s55, s55, 36
  s_lshl_b32 s56, s51, 1
  s_add_u32 s55, s55, s56
  s_and_b32 s56, s53, 1
  s_add_u32 s55, s55, s56
  s_lshl_b32 s55, s55, 10
  s_cmp_lt_u32 s53, 6
  s_cselect_b32 s55, s54, s55
  s_add_u32 s55, s55, s50
  s_waitcnt lgkmcnt(2)
  buffer_store_dwordx4 v[132:135], v3, s[28:31], s55 offen sc1
  s_mul_i32 s53, s47, 9
  s_add_u32 s53, s53, 8
  s_mul_i32 s54, s51, 6
  s_add_u32 s54, s54, s53
  s_lshl_b32 s54, s54, 10
  s_lshr_b32 s55, s53, 1
  s_mul_i32 s55, s55, 36
  s_lshl_b32 s56, s51, 1
  s_add_u32 s55, s55, s56
  s_and_b32 s56, s53, 1
  s_add_u32 s55, s55, s56
  s_lshl_b32 s55, s55, 10
  s_cmp_lt_u32 s53, 6
  s_cselect_b32 s55, s54, s55
  s_add_u32 s55, s55, s50
  s_waitcnt lgkmcnt(0)
  buffer_store_dwordx4 v[136:139], v3, s[28:31], s55 offen sc1
  s_waitcnt vmcnt(0)
  s_add_u32 s61, s88, 1
  v_mov_b32 v6, s61
  v_mov_b32 v7, s89
  s_mov_b64 exec, 1
  buffer_store_dwordx2 v[6:7], v5, s[28:31], s49 offen sc1
  s_mov_b64 exec, -1
  s_branch L_pack_fin
L_pack2:
  s_cmp_eq_u32 s39, 3
  s_cbranch_scc1 L_q3_6
  s_waitcnt vmcnt(23)
  v_lshlrev_b32 v120, 16, v232
  v_and_b32 v121, s43, v232
  v_lshlrev_b32 v122, 16, v233
  v_and_b32 v123, s43, v233
  v_lshlrev_b32 v124, 16, v234
  v_and_b32 v125, s43, v234
  v_lshlrev_b32 v126, 16, v235
  v_and_b32 v127, s43, v235
  v_lshlrev_b32 v128, 16, v236
  v_and_b32 v129, s43, v236
  v_lshlrev_b32 v130, 16, v237
  v_and_b32 v131, s43, v237
  v_lshlrev_b32 v132, 16, v238
  v_and_b32 v133, s43, v238
  v_lshlrev_b32 v134, 16, v239
  v_and_b32 v135, s43, v239
  v_lshlrev_b32 v136, 16, v240
  v_and_b32 v137, s43, v240
  v_lshlrev_b32 v138, 16, v241
  v_and_b32 v139, s43, v241
  v_lshlrev_b32 v140, 16, v242
  v_and_b32 v141, s43, v242
  v_lshlrev_b32 v142, 16, v243
  v_and_b32 v143, s43, v243
  v_pk_add_f32 v[150:151], v[120:121], v[122:123]
  v_pk_add_f32 v[152:153], v[124:125], v[126:127]
  v_pk_add_f32 v[150:151], v[150:151], v[128:129]
  v_pk_add_f32 v[152:153], v[152:153], v[130:131]
  v_pk_add_f32 v[150:151], v[150:151], v[132:133]
  v_pk_add_f32 v[152:153], v[152:153], v[134:135]
  v_pk_add_f32 v[150:151], v[150:151], v[136:137]
  v_pk_add_f32 v[152:153], v[152:153], v[138:139]
  v_pk_add_f32 v[150:151], v[150:151], v[140:141]
  v_pk_add_f32 v[152:153], v[152:153], v[142:143]
  v_pk_add_f32 v[150:151], v[150:151], v[152:153]
  v_add_f32 v150, v150, v151
  v_mul_f32 v154, 0x3d2aaaab, v150
  v_sub_f32 v150, 0, v154
  v_sub_f32 v151, 0, v154
  v_pk_add_f32 v[160:161], v[120:121], v[150:151]
  v_pk_add_f32 v[162:163], v[122:123], v[150:151]
  v_pk_mul_f32 v[156:157], v[160:161], v[160:161]
  v_pk_mul_f32 v[158:159], v[162:163], v[162:163]
  v_pk_add_f32 v[160:161], v[124:125], v[150:151]
  v_pk_add_f32 v[162:163], v[126:127], v[150:151]
  v_pk_fma_f32 v[156:157], v[160:161], v[160:161], v[156:157]
  v_pk_fma_f32 v[158:159], v[162:163], v[162:163], v[158:159]
  v_pk_add_f32 v[160:161], v[128:129], v[150:151]
  v_pk_add_f32 v[162:163], v[130:131], v[150:151]
  v_pk_fma_f32 v[156:157], v[160:161], v[160:161], v[156:157]
  v_pk_fma_f32 v[158:159], v[162:163], v[162:163], v[158:159]
  v_pk_add_f32 v[160:161], v[132:133], v[150:151]
  v_pk_add_f32 v[162:163], v[134:135], v[150:151]
  v_pk_fma_f32 v[156:157], v[160:161], v[160:161], v[156:157]
  v_pk_fma_f32 v[158:159], v[162:163], v[162:163], v[158:159]
  v_pk_add_f32 v[160:161], v[136:137], v[150:151]
  v_pk_add_f32 v[162:163], v[138:139], v[150:151]
  v_pk_fma_f32 v[156:157], v[160:161], v[160:161], v[156:157]
  v_pk_fma_f32 v[158:159], v[162:163], v[162:163], v[158:159]
  v_pk_add_f32 v[160:161], v[140:141], v[150:151]
  v_pk_add_f32 v[162:163], v[142:143], v[150:151]
  v_pk_fma_f32 v[156:157], v[160:161], v[160:161], v[156:157]
  v_pk_fma_f32 v[158:159], v[162:163], v[162:163], v[158:159]
  v_add_f32 v156, v156, v157
  v_add_f32 v158, v158, v159
  v_add_f32 v155, v156, v158
  s_nop 1
  v_mov_b32_dpp v156, v154 row_ror:8 row_mask:0xf bank_mask:0xf
  v_mov_b32_dpp v157, v155 row_ror:8 row_mask:0xf bank_mask:0xf
  v_sub_f32 v160, v154, v156
  v_add_f32 v154, v154, v156
  v_add_f32 v155, v155, v157
  v_mul_f32 v160, v160, v160
  v_mul_f32 v154, 0.5, v154
  v_fmac_f32 v155, 0x41400000, v160
  v_mov_b32 v156, v154
  v_mov_b32 v157, v154
  v_mov_b32 v158, v155
  v_mov_b32 v159, v155
  s_nop 1
  v_permlane16_swap_b32 v156, v157
  v_permlane16_swap_b32 v158, v159
  s_nop 1
  v_sub_f32 v160, v156, v157
  v_add_f32 v154, v156, v157
  v_add_f32 v155, v158, v159
  v_mul_f32 v160, v160, v160
  v_mul_f32 v154, 0.5, v154
  v_fmac_f32 v155, 0x41c00000, v160
  v_mov_b32 v156, v154
  v_mov_b32 v157, v154
  v_mov_b32 v158, v155
  v_mov_b32 v159, v155
  s_nop 1
  v_permlane32_swap_b32 v156, v157
  v_permlane32_swap_b32 v158, v159
  s_nop 1
  v_sub_f32 v160, v156, v157
  v_add_f32 v154, v156, v157
  v_add_f32 v155, v158, v159
  v_mul_f32 v160, v160, v160
  v_mul_f32 v154, 0.5, v154
  v_fmac_f32 v155, 0x42400000, v160
  ds_write_b64 v11, v[154:155] offset:0
  s_waitcnt lgkmcnt(0)
  s_barrier
  ds_read_b64 v[156:157], v12 offset:0
  ds_read_b64 v[158:159], v12 offset:64
  ds_read_b64 v[160:161], v12 offset:128
  s_waitcnt lgkmcnt(0)
  v_add_f32 v154, v156, v158
  v_add_f32 v155, v157, v159
  v_add_f32 v154, v154, v160
  v_add_f32 v155, v155, v161
  v_mul_f32 v154, 0x3eaaaaab, v154
  v_sub_f32 v156, v156, v154
  v_sub_f32 v158, v158, v154
  v_sub_f32 v160, v160, v154
  v_mul_f32 v156, v156, v156
  v_fmac_f32 v156, v158, v158
  v_fmac_f32 v156, v160, v160
  v_fmac_f32 v155, 0x43400000, v156
  v_mul_f32 v155, 0x3ae38e39, v155
  v_cvt_pk_bf16_f32 v154, v154, v154
  v_lshlrev_b32 v154, 16, v154
  v_cvt_pk_bf16_f32 v155, v155, v155
  v_lshlrev_b32 v155, 16, v155
  v_add_f32 v155, 0x37280000, v155
  v_cvt_pk_bf16_f32 v155, v155, v155
  v_lshlrev_b32 v155, 16, v155
  v_sqrt_f32 v155, v155
  s_nop 0
  v_cvt_pk_bf16_f32 v155, v155, v155
  v_lshlrev_b32 v155, 16, v155
  v_rcp_f32 v152, v155
  v_sub_f32 v150, 0, v154
  v_sub_f32 v151, 0, v154
  s_nop 0
  v_mov_b32 v153, v152
  v_pk_add_f32 v[170:171], v[120:121], v[150:151]
  v_pk_add_f32 v[174:175], v[122:123], v[150:151]
  v_pk_add_f32 v[178:179], v[124:125], v[150:151]
  v_pk_add_f32 v[182:183], v[126:127], v[150:151]
  v_cvt_pk_bf16_f32 v172, v170, v171
  v_cvt_pk_bf16_f32 v176, v174, v175
  v_cvt_pk_bf16_f32 v180, v178, v179
  v_cvt_pk_bf16_f32 v184, v182, v183
  v_lshlrev_b32 v170, 16, v172
  v_lshlrev_b32 v174, 16, v176
  v_lshlrev_b32 v178, 16, v180
  v_lshlrev_b32 v182, 16, v184
  v_and_b32 v171, s43, v172
  v_and_b32 v175, s43, v176
  v_and_b32 v179, s43, v180
  v_and_b32 v183, s43, v184
  v_pk_mul_f32 v[170:171], v[170:171], v[152:153]
  v_pk_mul_f32 v[174:175], v[174:175], v[152:153]
  v_pk_mul_f32 v[178:179], v[178:179], v[152:153]
  v_pk_mul_f32 v[182:183], v[182:183], v[152:153]
  v_cvt_pk_bf16_f32 v244, v170, v171
  v_cvt_pk_bf16_f32 v245, v174, v175
  v_cvt_pk_bf16_f32 v246, v178, v179
  v_cvt_pk_bf16_f32 v247, v182, v183
  v_pk_add_f32 v[170:171], v[128:129], v[150:151]
  v_pk_add_f32 v[174:175], v[130:131], v[150:151]
  v_pk_add_f32 v[178:179], v[132:133], v[150:151]
  v_pk_add_f32 v[182:183], v[134:135], v[150:151]
  v_cvt_pk_bf16_f32 v172, v170, v171
  v_cvt_pk_bf16_f32 v176, v174, v175
  v_cvt_pk_bf16_f32 v180, v178, v179
  v_cvt_pk_bf16_f32 v184, v182, v183
  v_lshlrev_b32 v170, 16, v172
  v_lshlrev_b32 v174, 16, v176
  v_lshlrev_b32 v178, 16, v180
  v_lshlrev_b32 v182, 16, v184
  v_and_b32 v171, s43, v172
  v_and_b32 v175, s43, v176
  v_and_b32 v179, s43, v180
  v_and_b32 v183, s43, v184
  v_pk_mul_f32 v[170:171], v[170:171], v[152:153]
  v_pk_mul_f32 v[174:175], v[174:175], v[152:153]
  v_pk_mul_f32 v[178:179], v[178:179], v[152:153]
  v_pk_mul_f32 v[182:183], v[182:183], v[152:153]
  v_cvt_pk_bf16_f32 v248, v170, v171
  v_cvt_pk_bf16_f32 v249, v174, v175
  v_cvt_pk_bf16_f32 v250, v178, v179
  v_cvt_pk_bf16_f32 v251, v182, v183
  v_pk_add_f32 v[170:171], v[136:137], v[150:151]
  v_pk_add_f32 v[174:175], v[138:139], v[150:151]
  v_pk_add_f32 v[178:179], v[140:141], v[150:151]
  v_pk_add_f32 v[182:183], v[142:143], v[150:151]
  v_cvt_pk_bf16_f32 v172, v170, v171
  v_cvt_pk_bf16_f32 v176, v174, v175
  v_cvt_pk_bf16_f32 v180, v178, v179
  v_cvt_pk_bf16_f32 v184, v182, v183
  v_lshlrev_b32 v170, 16, v172
  v_lshlrev_b32 v174, 16, v176
  v_lshlrev_b32 v178, 16, v180
  v_lshlrev_b32 v182, 16, v184
  v_and_b32 v171, s43, v172
  v_and_b32 v175, s43, v176
  v_and_b32 v179, s43, v180
  v_and_b32 v183, s43, v184
  v_pk_mul_f32 v[170:171], v[170:171], v[152:153]
  v_pk_mul_f32 v[174:175], v[174:175], v[152:153]
  v_pk_mul_f32 v[178:179], v[178:179], v[152:153]
  v_pk_mul_f32 v[182:183], v[182:183], v[152:153]
  v_cvt_pk_bf16_f32 v252, v170, v171
  v_cvt_pk_bf16_f32 v253, v174, v175
  v_cvt_pk_bf16_f32 v254, v178, v179
  v_cvt_pk_bf16_f32 v255, v182, v183
  s_branch L_qd_7
L_q3_6:
  s_barrier
L_qd_7:
  s_waitcnt vmcnt(9)
  s_barrier
  s_mov_b32 s52, s48
  v_add_u32 v191, 0, v189
  ds_read_b64_tr_b16 v[32:33], v191 offset:0
  ds_read_b64_tr_b16 v[34:35], v191 offset:2304
  ds_read_b64_tr_b16 v[36:37], v191 offset:32
  ds_read_b64_tr_b16 v[38:39], v191 offset:2336
  ds_read_b64_tr_b16 v[40:41], v191 offset:64
  ds_read_b64_tr_b16 v[42:43], v191 offset:2368
  ds_read_b64_tr_b16 v[44:45], v191 offset:96
  ds_read_b64_tr_b16 v[46:47], v191 offset:2400
  ds_read_b64_tr_b16 v[48:49], v191 offset:128
  ds_read_b64_tr_b16 v[50:51], v191 offset:2432
  ds_read_b64_tr_b16 v[52:53], v191 offset:160
  ds_read_b64_tr_b16 v[54:55], v191 offset:2464
  ds_read_b64_tr_b16 v[56:57], v191 offset:192
  ds_read_b64_tr_b16 v[58:59], v191 offset:2496
  ds_read_b64_tr_b16 v[60:61], v191 offset:224
  ds_read_b64_tr_b16 v[62:63], v191 offset:2528
  ds_read_b64_tr_b16 v[64:65], v191 offset:256
  ds_read_b64_tr_b16 v[66:67], v191 offset:2560
  s_mul_i32 s53, s52, 7282
  s_lshr_b32 s53, s53, 16
  s_mul_i32 s54, s53, 9
  s_sub_u32 s54, s52, s54
  s_mul_i32 s50, s53, 331776
  s_add_u32 s50, s50, 8388608
  s_lshl_b32 s51, s54, 1
  s_add_u32 s51, s51, s46
  s_lshl_b32 s53, s53, 9
  s_lshl_b32 s54, s54, 5
  s_add_u32 s49, s53, s54
  s_lshl_b32 s54, s39, 3
  s_add_u32 s49, s49, s54
  s_add_u32 s49, s49, 83898368
  s_mul_i32 s53, s47, 9
  s_add_u32 s53, s53, 0
  s_mul_i32 s54, s51, 6
  s_add_u32 s54, s54, s53
  s_lshl_b32 s54, s54, 10
  s_lshr_b32 s55, s53, 1
  s_mul_i32 s55, s55, 36
  s_lshl_b32 s56, s51, 1
  s_add_u32 s55, s55, s56
  s_and_b32 s56, s53, 1
  s_add_u32 s55, s55, s56
  s_lshl_b32 s55, s55, 10
  s_cmp_lt_u32 s53, 6
  s_cselect_b32 s55, s54, s55
  s_add_u32 s55, s55, s50
  s_waitcnt lgkmcnt(14)
  buffer_store_dwordx4 v[32:35], v3, s[28:31], s55 offen sc1
  s_mul_i32 s53, s47, 9
  s_add_u32 s53, s53, 1
  s_mul_i32 s54, s51, 6
  s_add_u32 s54, s54, s53
  s_lshl_b32 s54, s54, 10
  s_lshr_b32 s55, s53, 1
  s_mul_i32 s55, s55, 36
  s_lshl_b32 s56, s51, 1
  s_add_u32 s55, s55, s56
  s_and_b32 s56, s53, 1
  s_add_u32 s55, s55, s56
  s_lshl_b32 s55, s55, 10
  s_cmp_lt_u32 s53, 6
  s_cselect_b32 s55, s54, s55
  s_add_u32 s55, s55, s50
  s_waitcnt lgkmcnt(14)
  buffer_store_dwordx4 v[36:39], v3, s[28:31], s55 offen sc1
  s_mul_i32 s53, s47, 9
  s_add_u32 s53, s53, 2
  s_mul_i32 s54, s51, 6
  s_add_u32 s54, s54, s53
  s_lshl_b32 s54, s54, 10
  s_lshr_b32 s55, s53, 1
  s_mul_i32 s55, s55, 36
  s_lshl_b32 s56, s51, 1
  s_add_u32 s55, s55, s56
  s_and_b32 s56, s53, 1
  s_add_u32 s55, s55, s56
  s_lshl_b32 s55, s55, 10
  s_cmp_lt_u32 s53, 6
  s_cselect_b32 s55, s54, s55
  s_add_u32 s55, s55, s50
  s_waitcnt lgkmcnt(12)
  buffer_store_dwordx4 v[40:43], v3, s[28:31], s55 offen sc1
  s_mul_i32 s53, s47, 9
  s_add_u32 s53, s53, 3
  s_mul_i32 s54, s51, 6
  s_add_u32 s54, s54, s53
  s_lshl_b32 s54, s54, 10
  s_lshr_b32 s55, s53, 1
  s_mul_i32 s55, s55, 36
  s_lshl_b32 s56, s51, 1
  s_add_u32 s55, s55, s56
  s_and_b32 s56, s53, 1
  s_add_u32 s55, s55, s56
  s_lshl_b32 s55, s55, 10
  s_cmp_lt_u32 s53, 6
  s_cselect_b32 s55, s54, s55
  s_add_u32 s55, s55, s50
  s_waitcnt lgkmcnt(10)
  buffer_store_dwordx4 v[44:47], v3, s[28:31], s55 offen sc1
  s_mul_i32 s53, s47, 9
  s_add_u32 s53, s53, 4
  s_mul_i32 s54, s51, 6
  s_add_u32 s54, s54, s53
  s_lshl_b32 s54, s54, 10
  s_lshr_b32 s55, s53, 1
  s_mul_i32 s55, s55, 36
  s_lshl_b32 s56, s51, 1
  s_add_u32 s55, s55, s56
  s_and_b32 s56, s53, 1
  s_add_u32 s55, s55, s56
  s_lshl_b32 s55, s55, 10
  s_cmp_lt_u32 s53, 6
  s_cselect_b32 s55, s54, s55
  s_add_u32 s55, s55, s50
  s_waitcnt lgkmcnt(8)
  buffer_store_dwordx4 v[48:51], v3, s[28:31], s55 offen sc1
  s_mul_i32 s53, s47, 9
  s_add_u32 s53, s53, 5
  s_mul_i32 s54, s51, 6
  s_add_u32 s54, s54, s53
  s_lshl_b32 s54, s54, 10
  s_lshr_b32 s55, s53, 1
  s_mul_i32 s55, s55, 36
  s_lshl_b32 s56, s51, 1
  s_add_u32 s55, s55, s56
  s_and_b32 s56, s53, 1
  s_add_u32 s55, s55, s56
  s_lshl_b32 s55, s55, 10
  s_cmp_lt_u32 s53, 6
  s_cselect_b32 s55, s54, s55
  s_add_u32 s55, s55, s50
  s_waitcnt lgkmcnt(6)
  buffer_store_dwordx4 v[52:55], v3, s[28:31], s55 offen sc1
  s_mul_i32 s53, s47, 9
  s_add_u32 s53, s53, 6
  s_mul_i32 s54, s51, 6
  s_add_u32 s54, s54, s53
  s_lshl_b32 s54, s54, 10
  s_lshr_b32 s55, s53, 1
  s_mul_i32 s55, s55, 36
  s_lshl_b32 s56, s51, 1
  s_add_u32 s55, s55, s56
  s_and_b32 s56, s53, 1
  s_add_u32 s55, s55, s56
  s_lshl_b32 s55, s55, 10
  s_cmp_lt_u32 s53, 6
  s_cselect_b32 s55, s54, s55
  s_add_u32 s55, s55, s50
  s_waitcnt lgkmcnt(4)
  buffer_store_dwordx4 v[56:59], v3, s[28:31], s55 offen sc1
  s_mul_i32 s53, s47, 9
  s_add_u32 s53, s53, 7
  s_mul_i32 s54, s51, 6
  s_add_u32 s54, s54, s53
  s_lshl_b32 s54, s54, 10
  s_lshr_b32 s55, s53, 1
  s_mul_i32 s55, s55, 36
  s_lshl_b32 s56, s51, 1
  s_add_u32 s55, s55, s56
  s_and_b32 s56, s53, 1
  s_add_u32 s55, s55, s56
  s_lshl_b32 s55, s55, 10
  s_cmp_lt_u32 s53, 6
  s_cselect_b32 s55, s54, s55
  s_add_u32 s55, s55, s50
  s_waitcnt lgkmcnt(2)
  buffer_store_dwordx4 v[60:63], v3, s[28:31], s55 offen sc1
  s_mul_i32 s53, s47, 9
  s_add_u32 s53, s53, 8
  s_mul_i32 s54, s51, 6
  s_add_u32 s54, s54, s53
  s_lshl_b32 s54, s54, 10
  s_lshr_b32 s55, s53, 1
  s_mul_i32 s55, s55, 36
  s_lshl_b32 s56, s51, 1
  s_add_u32 s55, s55, s56
  s_and_b32 s56, s53, 1
  s_add_u32 s55, s55, s56
  s_lshl_b32 s55, s55, 10
  s_cmp_lt_u32 s53, 6
  s_cselect_b32 s55, s54, s55
  s_add_u32 s55, s55, s50
  s_waitcnt lgkmcnt(0)
  buffer_store_dwordx4 v[64:67], v3, s[28:31], s55 offen sc1
  s_mov_b32 s100, s49
  s_waitcnt vmcnt(9)
  s_barrier
  s_add_u32 s52, s48, 64
  v_add_u32 v191, 36864, v189
  ds_read_b64_tr_b16 v[68:69], v191 offset:0
  ds_read_b64_tr_b16 v[70:71], v191 offset:2304
  ds_read_b64_tr_b16 v[72:73], v191 offset:32
  ds_read_b64_tr_b16 v[74:75], v191 offset:2336
  ds_read_b64_tr_b16 v[76:77], v191 offset:64
  ds_read_b64_tr_b16 v[78:79], v191 offset:2368
  ds_read_b64_tr_b16 v[80:81], v191 offset:96
  ds_read_b64_tr_b16 v[82:83], v191 offset:2400
  ds_read_b64_tr_b16 v[84:85], v191 offset:128
  ds_read_b64_tr_b16 v[86:87], v191 offset:2432
  ds_read_b64_tr_b16 v[88:89], v191 offset:160
  ds_read_b64_tr_b16 v[90:91], v191 offset:2464
  ds_read_b64_tr_b16 v[92:93], v191 offset:192
  ds_read_b64_tr_b16 v[94:95], v191 offset:2496
  ds_read_b64_tr_b16 v[96:97], v191 offset:224
  ds_read_b64_tr_b16 v[98:99], v191 offset:2528
  ds_read_b64_tr_b16 v[100:101], v191 offset:256
  ds_read_b64_tr_b16 v[102:103], v191 offset:2560
  s_mul_i32 s53, s52, 7282
  s_lshr_b32 s53, s53, 16
  s_mul_i32 s54, s53, 9
  s_sub_u32 s54, s52, s54
  s_mul_i32 s50, s53, 331776
  s_add_u32 s50, s50, 8388608
  s_lshl_b32 s51, s54, 1
  s_add_u32 s51, s51, s46
  s_lshl_b32 s53, s53, 9
  s_lshl_b32 s54, s54, 5
  s_add_u32 s49, s53, s54
  s_lshl_b32 s54, s39, 3
  s_add_u32 s49, s49, s54
  s_add_u32 s49, s49, 83898368
  s_mul_i32 s53, s47, 9
  s_add_u32 s53, s53, 0
  s_mul_i32 s54, s51, 6
  s_add_u32 s54, s54, s53
  s_lshl_b32 s54, s54, 10
  s_lshr_b32 s55, s53, 1
  s_mul_i32 s55, s55, 36
  s_lshl_b32 s56, s51, 1
  s_add_u32 s55, s55, s56
  s_and_b32 s56, s53, 1
  s_add_u32 s55, s55, s56
  s_lshl_b32 s55, s55, 10
  s_cmp_lt_u32 s53, 6
  s_cselect_b32 s55, s54, s55
  s_add_u32 s55, s55, s50
  s_waitcnt lgkmcnt(14)
  buffer_store_dwordx4 v[68:71], v3, s[28:31], s55 offen sc1
  s_mul_i32 s53, s47, 9
  s_add_u32 s53, s53, 1
  s_mul_i32 s54, s51, 6
  s_add_u32 s54, s54, s53
  s_lshl_b32 s54, s54, 10
  s_lshr_b32 s55, s53, 1
  s_mul_i32 s55, s55, 36
  s_lshl_b32 s56, s51, 1
  s_add_u32 s55, s55, s56
  s_and_b32 s56, s53, 1
  s_add_u32 s55, s55, s56
  s_lshl_b32 s55, s55, 10
  s_cmp_lt_u32 s53, 6
  s_cselect_b32 s55, s54, s55
  s_add_u32 s55, s55, s50
  s_waitcnt lgkmcnt(14)
  buffer_store_dwordx4 v[72:75], v3, s[28:31], s55 offen sc1
  s_mul_i32 s53, s47, 9
  s_add_u32 s53, s53, 2
  s_mul_i32 s54, s51, 6
  s_add_u32 s54, s54, s53
  s_lshl_b32 s54, s54, 10
  s_lshr_b32 s55, s53, 1
  s_mul_i32 s55, s55, 36
  s_lshl_b32 s56, s51, 1
  s_add_u32 s55, s55, s56
  s_and_b32 s56, s53, 1
  s_add_u32 s55, s55, s56
  s_lshl_b32 s55, s55, 10
  s_cmp_lt_u32 s53, 6
  s_cselect_b32 s55, s54, s55
  s_add_u32 s55, s55, s50
  s_waitcnt lgkmcnt(12)
  buffer_store_dwordx4 v[76:79], v3, s[28:31], s55 offen sc1
  s_mul_i32 s53, s47, 9
  s_add_u32 s53, s53, 3
  s_mul_i32 s54, s51, 6
  s_add_u32 s54, s54, s53
  s_lshl_b32 s54, s54, 10
  s_lshr_b32 s55, s53, 1
  s_mul_i32 s55, s55, 36
  s_lshl_b32 s56, s51, 1
  s_add_u32 s55, s55, s56
  s_and_b32 s56, s53, 1
  s_add_u32 s55, s55, s56
  s_lshl_b32 s55, s55, 10
  s_cmp_lt_u32 s53, 6
  s_cselect_b32 s55, s54, s55
  s_add_u32 s55, s55, s50
  s_waitcnt lgkmcnt(10)
  buffer_store_dwordx4 v[80:83], v3, s[28:31], s55 offen sc1
  s_mul_i32 s53, s47, 9
  s_add_u32 s53, s53, 4
  s_mul_i32 s54, s51, 6
  s_add_u32 s54, s54, s53
  s_lshl_b32 s54, s54, 10
  s_lshr_b32 s55, s53, 1
  s_mul_i32 s55, s55, 36
  s_lshl_b32 s56, s51, 1
  s_add_u32 s55, s55, s56
  s_and_b32 s56, s53, 1
  s_add_u32 s55, s55, s56
  s_lshl_b32 s55, s55, 10
  s_cmp_lt_u32 s53, 6
  s_cselect_b32 s55, s54, s55
  s_add_u32 s55, s55, s50
  s_waitcnt lgkmcnt(8)
  buffer_store_dwordx4 v[84:87], v3, s[28:31], s55 offen sc1
  s_mul_i32 s53, s47, 9
  s_add_u32 s53, s53, 5
  s_mul_i32 s54, s51, 6
  s_add_u32 s54, s54, s53
  s_lshl_b32 s54, s54, 10
  s_lshr_b32 s55, s53, 1
  s_mul_i32 s55, s55, 36
  s_lshl_b32 s56, s51, 1
  s_add_u32 s55, s55, s56
  s_and_b32 s56, s53, 1
  s_add_u32 s55, s55, s56
  s_lshl_b32 s55, s55, 10
  s_cmp_lt_u32 s53, 6
  s_cselect_b32 s55, s54, s55
  s_add_u32 s55, s55, s50
  s_waitcnt lgkmcnt(6)
  buffer_store_dwordx4 v[88:91], v3, s[28:31], s55 offen sc1
  s_mul_i32 s53, s47, 9
  s_add_u32 s53, s53, 6
  s_mul_i32 s54, s51, 6
  s_add_u32 s54, s54, s53
  s_lshl_b32 s54, s54, 10
  s_lshr_b32 s55, s53, 1
  s_mul_i32 s55, s55, 36
  s_lshl_b32 s56, s51, 1
  s_add_u32 s55, s55, s56
  s_and_b32 s56, s53, 1
  s_add_u32 s55, s55, s56
  s_lshl_b32 s55, s55, 10
  s_cmp_lt_u32 s53, 6
  s_cselect_b32 s55, s54, s55
  s_add_u32 s55, s55, s50
  s_waitcnt lgkmcnt(4)
  buffer_store_dwordx4 v[92:95], v3, s[28:31], s55 offen sc1
  s_mul_i32 s53, s47, 9
  s_add_u32 s53, s53, 7
  s_mul_i32 s54, s51, 6
  s_add_u32 s54, s54, s53
  s_lshl_b32 s54, s54, 10
  s_lshr_b32 s55, s53, 1
  s_mul_i32 s55, s55, 36
  s_lshl_b32 s56, s51, 1
  s_add_u32 s55, s55, s56
  s_and_b32 s56, s53, 1
  s_add_u32 s55, s55, s56
  s_lshl_b32 s55, s55, 10
  s_cmp_lt_u32 s53, 6
  s_cselect_b32 s55, s54, s55
  s_add_u32 s55, s55, s50
  s_waitcnt lgkmcnt(2)
  buffer_store_dwordx4 v[96:99], v3, s[28:31], s55 offen sc1
  s_mul_i32 s53, s47, 9
  s_add_u32 s53, s53, 8
  s_mul_i32 s54, s51, 6
  s_add_u32 s54, s54, s53
  s_lshl_b32 s54, s54, 10
  s_lshr_b32 s55, s53, 1
  s_mul_i32 s55, s55, 36
  s_lshl_b32 s56, s51, 1
  s_add_u32 s55, s55, s56
  s_and_b32 s56, s53, 1
  s_add_u32 s55, s55, s56
  s_lshl_b32 s55, s55, 10
  s_cmp_lt_u32 s53, 6
  s_cselect_b32 s55, s54, s55
  s_add_u32 s55, s55, s50
  s_waitcnt lgkmcnt(0)
  buffer_store_dwordx4 v[100:103], v3, s[28:31], s55 offen sc1
  s_mov_b32 s101, s49
L_pack_fin:
  s_waitcnt vmcnt(0)
  s_add_u32 s61, s88, 1
  v_mov_b32 v6, s61
  v_mov_b32 v7, s89
  s_mov_b64 exec, 1
  buffer_store_dwordx2 v[6:7], v5, s[28:31], s100 offen sc1
  s_mov_b64 exec, -1
  s_add_u32 s61, s88, 1
  v_mov_b32 v6, s61
  v_mov_b32 v7, s89
  s_mov_b64 exec, 1
  buffer_store_dwordx2 v[6:7], v5, s[28:31], s101 offen sc1
  s_mov_b64 exec, -1
  s_barrier
L_join:
  v_add_u32 v4, 0, v3
  v_add_u32 v5, 36864, v3
  v_add_u32 v6, 73728, v3
  v_add_u32 v7, 110592, v3
  s_lshl_b32 s45, s38, 11
  s_add_u32 s45, s45, 84017152
  v_and_b32 v9, 7, v2
  v_lshrrev_b32 v10, 3, v2
  v_mul_u32_u24 v13, 1152, v9
  v_lshl_add_u32 v13, v10, 4, v13
  v_lshlrev_b32 v12, 3, v9
  v_add_u32 v12, 119808, v12
  s_lshl_b32 s47, s39, 6
  v_add_u32 v11, s47, v12
  s_mul_i32 s46, s37, 1152
  s_mul_i32 s47, s39, 384
  s_add_u32 s46, s46, s47

  v_lshlrev_b32 v8, 13, v2
  s_min_u32 s50, s39, 2
  s_mul_i32 s48, s50, 1572864
  s_lshl_b32 s49, s37, 1
  s_add_u32 s48, s48, s49
  s_add_u32 s48, s48, 0
  s_mul_i32 s49, s50, 3072
  v_lshrrev_b32 v14, 4, v2
  v_lshlrev_b32 v14, 8, v14
  v_bfe_u32 v15, v2, 1, 1
  v_lshl_add_u32 v14, v15, 7, v14
  v_bfe_u32 v15, v2, 2, 2
  v_lshl_add_u32 v14, v15, 4, v14
  v_and_b32 v15, 1, v2
  v_lshl_add_u32 v14, v15, 3, v14
  v_add_u32 v14, s49, v14
  v_add_u32 v14, 110592, v14
  s_cmp_eq_u32 s39, 3
  s_cbranch_scc1 L_w3

  v_mov_b32 v150, 120448
  s_cmp_lg_u32 s39, 0
  s_cbranch_scc1 L_fz_lds
  buffer_load_dwordx4 v[208:211], v3, s[28:31], s45 offen offset:0 sc1
  buffer_load_dwordx4 v[212:215], v3, s[28:31], s45 offen offset:1024 sc1
  s_waitcnt vmcnt(0)
  s_mov_b32 s58, 0
  s_add_u32 s59, s88, 1
  s_mov_b64 s[60:61], -1
  v_subrev_u32 v18, s59, v208
  v_cmp_gt_u32 vcc, 15, v18
  v_cmp_eq_u32 s[62:63], s89, v209
  s_nop 1
  s_and_b64 vcc, vcc, s[62:63]
  s_and_b64 s[60:61], s[60:61], vcc
  v_subrev_u32 v18, s59, v210
  v_cmp_gt_u32 vcc, 15, v18
  v_cmp_eq_u32 s[62:63], s89, v211
  s_nop 1
  s_and_b64 vcc, vcc, s[62:63]
  s_and_b64 s[60:61], s[60:61], vcc
  v_subrev_u32 v18, s59, v212
  v_cmp_gt_u32 vcc, 15, v18
  v_cmp_eq_u32 s[62:63], s89, v213
  s_nop 1
  s_and_b64 vcc, vcc, s[62:63]
  s_mov_b32 s62, 0x0
  s_mov_b32 s63, 0xffffffff
  s_or_b64 vcc, vcc, s[62:63]
  s_and_b64 s[60:61], s[60:61], vcc
  v_subrev_u32 v18, s59, v214
  v_cmp_gt_u32 vcc, 15, v18
  v_cmp_eq_u32 s[62:63], s89, v215
  s_nop 1
  s_and_b64 vcc, vcc, s[62:63]
  s_mov_b32 s62, 0x0
  s_mov_b32 s63, 0xffffffff
  s_or_b64 vcc, vcc, s[62:63]
  s_and_b64 s[60:61], s[60:61], vcc
  s_cmp_eq_u64 s[60:61], -1
  s_cbranch_scc1 L_pfz_ok
  buffer_load_dwordx4 v[208:211], v3, s[28:31], s45 offen offset:0 sc1
  buffer_load_dwordx4 v[212:215], v3, s[28:31], s45 offen offset:1024 sc1
  s_sleep 4
  buffer_load_dwordx4 v[216:219], v3, s[28:31], s45 offen offset:0 sc1
  buffer_load_dwordx4 v[220:223], v3, s[28:31], s45 offen offset:1024 sc1
L_pfz_chk:
  s_waitcnt vmcnt(2)
  s_mov_b64 s[60:61], -1
  v_subrev_u32 v18, s59, v208
  v_cmp_gt_u32 vcc, 15, v18
  v_cmp_eq_u32 s[62:63], s89, v209
  s_nop 1
  s_and_b64 vcc, vcc, s[62:63]
  s_and_b64 s[60:61], s[60:61], vcc
  v_subrev_u32 v18, s59, v210
  v_cmp_gt_u32 vcc, 15, v18
  v_cmp_eq_u32 s[62:63], s89, v211
  s_nop 1
  s_and_b64 vcc, vcc, s[62:63]
  s_and_b64 s[60:61], s[60:61], vcc
  v_subrev_u32 v18, s59, v212
  v_cmp_gt_u32 vcc, 15, v18
  v_cmp_eq_u32 s[62:63], s89, v213
  s_nop 1
  s_and_b64 vcc, vcc, s[62:63]
  s_mov_b32 s62, 0x0
  s_mov_b32 s63, 0xffffffff
  s_or_b64 vcc, vcc, s[62:63]
  s_and_b64 s[60:61], s[60:61], vcc
  v_subrev_u32 v18, s59, v214
  v_cmp_gt_u32 vcc, 15, v18
  v_cmp_eq_u32 s[62:63], s89, v215
  s_nop 1
  s_and_b64 vcc, vcc, s[62:63]
  s_mov_b32 s62, 0x0
  s_mov_b32 s63, 0xffffffff
  s_or_b64 vcc, vcc, s[62:63]
  s_and_b64 s[60:61], s[60:61], vcc
  s_cmp_eq_u64 s[60:61], -1
  s_cbranch_scc1 L_pfz_ok
  buffer_load_dwordx4 v[208:211], v3, s[28:31], s45 offen offset:0 sc1
  buffer_load_dwordx4 v[212:215], v3, s[28:31], s45 offen offset:1024 sc1
  s_waitcnt vmcnt(2)
  s_mov_b64 s[60:61], -1
  v_subrev_u32 v18, s59, v216
  v_cmp_gt_u32 vcc, 15, v18
  v_cmp_eq_u32 s[62:63], s89, v217
  s_nop 1
  s_and_b64 vcc, vcc, s[62:63]
  s_and_b64 s[60:61], s[60:61], vcc
  v_subrev_u32 v18, s59, v218
  v_cmp_gt_u32 vcc, 15, v18
  v_cmp_eq_u32 s[62:63], s89, v219
  s_nop 1
  s_and_b64 vcc, vcc, s[62:63]
  s_and_b64 s[60:61], s[60:61], vcc
  v_subrev_u32 v18, s59, v220
  v_cmp_gt_u32 vcc, 15, v18
  v_cmp_eq_u32 s[62:63], s89, v221
  s_nop 1
  s_and_b64 vcc, vcc, s[62:63]
  s_mov_b32 s62, 0x0
  s_mov_b32 s63, 0xffffffff
  s_or_b64 vcc, vcc, s[62:63]
  s_and_b64 s[60:61], s[60:61], vcc
  v_subrev_u32 v18, s59, v222
  v_cmp_gt_u32 vcc, 15, v18
  v_cmp_eq_u32 s[62:63], s89, v223
  s_nop 1
  s_and_b64 vcc, vcc, s[62:63]
  s_mov_b32 s62, 0x0
  s_mov_b32 s63, 0xffffffff
  s_or_b64 vcc, vcc, s[62:63]
  s_and_b64 s[60:61], s[60:61], vcc
  s_cmp_eq_u64 s[60:61], -1
  s_cbranch_scc1 L_pfz_ok
  buffer_load_dwordx4 v[216:219], v3, s[28:31], s45 offen offset:0 sc1
  buffer_load_dwordx4 v[220:223], v3, s[28:31], s45 offen offset:1024 sc1
  s_add_u32 s58, s58, 1
  s_cmp_gt_u32 s58, 20000
  s_cbranch_scc0 L_pfz_chk
L_pfz_ok:
  v_mov_b32 v151, s88
  ds_write_b32 v150, v151
  s_branch L_fz_go
L_fz_lds:
  s_mov_b32 s58, 0
L_fz_spin:
  ds_read_b32 v151, v150
  s_waitcnt lgkmcnt(0)
  v_readfirstlane_b32 s59, v151
  s_add_u32 s58, s58, 1
  s_cmp_eq_u32 s59, s88
  s_cbranch_scc1 L_fz_go
  s_cmp_gt_u32 s58, 4000000
  s_cbranch_scc1 L_fz_go
  s_sleep 1
  s_branch L_fz_spin

L_fz_go:
  s_add_u32 m0, s49, 110592
  s_add_u32 s47, s48, 0
  buffer_load_dwordx4 v8, s[28:31], s47 offen sc1 lds
  s_add_u32 m0, s49, 111616
  s_add_u32 s47, s48, 524288
  buffer_load_dwordx4 v8, s[28:31], s47 offen sc1 lds
  s_add_u32 m0, s49, 112640
  s_add_u32 s47, s48, 1048576
  buffer_load_dwordx4 v8, s[28:31], s47 offen sc1 lds
  v_lshlrev_b32 v40, 16, v232
  v_and_b32 v41, s43, v232
  v_lshlrev_b32 v64, 16, v244
  v_and_b32 v65, s43, v244
  v_lshlrev_b32 v42, 16, v233
  v_and_b32 v43, s43, v233
  v_lshlrev_b32 v66, 16, v245
  v_and_b32 v67, s43, v245
  v_lshlrev_b32 v44, 16, v234
  v_and_b32 v45, s43, v234
  v_lshlrev_b32 v68, 16, v246
  v_and_b32 v69, s43, v246
  v_lshlrev_b32 v46, 16, v235
  v_and_b32 v47, s43, v235
  v_lshlrev_b32 v70, 16, v247
  v_and_b32 v71, s43, v247
  v_lshlrev_b32 v48, 16, v236
  v_and_b32 v49, s43, v236
  v_lshlrev_b32 v72, 16, v248
  v_and_b32 v73, s43, v248
  v_lshlrev_b32 v50, 16, v237
  v_and_b32 v51, s43, v237
  v_lshlrev_b32 v74, 16, v249
  v_and_b32 v75, s43, v249
  v_lshlrev_b32 v52, 16, v238
  v_and_b32 v53, s43, v238
  v_lshlrev_b32 v76, 16, v250
  v_and_b32 v77, s43, v250
  v_lshlrev_b32 v54, 16, v239
  v_and_b32 v55, s43, v239
  v_lshlrev_b32 v78, 16, v251
  v_and_b32 v79, s43, v251
  v_lshlrev_b32 v56, 16, v240
  v_and_b32 v57, s43, v240
  v_lshlrev_b32 v80, 16, v252
  v_and_b32 v81, s43, v252
  v_lshlrev_b32 v58, 16, v241
  v_and_b32 v59, s43, v241
  v_lshlrev_b32 v82, 16, v253
  v_and_b32 v83, s43, v253
  v_lshlrev_b32 v60, 16, v242
  v_and_b32 v61, s43, v242
  v_lshlrev_b32 v84, 16, v254
  v_and_b32 v85, s43, v254
  v_lshlrev_b32 v62, 16, v243
  v_and_b32 v63, s43, v243
  v_lshlrev_b32 v86, 16, v255
  v_and_b32 v87, s43, v255
  s_waitcnt vmcnt(0)
  ds_read_b64_tr_b16 v[28:29], v14 offset:0
  ds_read_b64_tr_b16 v[30:31], v14 offset:64
  ds_read_b64_tr_b16 v[32:33], v14 offset:1024
  ds_read_b64_tr_b16 v[34:35], v14 offset:1088
  ds_read_b64_tr_b16 v[36:37], v14 offset:2048
  ds_read_b64_tr_b16 v[38:39], v14 offset:2112
  s_waitcnt lgkmcnt(0)
  v_lshlrev_b32 v142, 16, v28
  v_lshlrev_b32 v148, 16, v29
  v_lshlrev_b32 v154, 16, v30
  v_lshlrev_b32 v160, 16, v31
  v_and_b32 v143, s43, v28
  v_and_b32 v149, s43, v29
  v_and_b32 v155, s43, v30
  v_and_b32 v161, s43, v31
  v_pk_mul_f32 v[140:141], v[64:65], v[142:143]
  v_pk_mul_f32 v[146:147], v[66:67], v[148:149]
  v_pk_mul_f32 v[152:153], v[68:69], v[154:155]
  v_pk_mul_f32 v[158:159], v[70:71], v[160:161]
  v_cvt_pk_bf16_f32 v144, v140, v141
  v_cvt_pk_bf16_f32 v150, v146, v147
  v_cvt_pk_bf16_f32 v156, v152, v153
  v_cvt_pk_bf16_f32 v162, v158, v159
  v_lshlrev_b32 v140, 16, v144
  v_lshlrev_b32 v146, 16, v150
  v_lshlrev_b32 v152, 16, v156
  v_lshlrev_b32 v158, 16, v162
  v_and_b32 v141, s43, v144
  v_and_b32 v147, s43, v150
  v_and_b32 v153, s43, v156
  v_and_b32 v159, s43, v162
  v_pk_add_f32 v[88:89], v[40:41], v[140:141]
  v_pk_add_f32 v[90:91], v[42:43], v[146:147]
  v_pk_add_f32 v[92:93], v[44:45], v[152:153]
  v_pk_add_f32 v[94:95], v[46:47], v[158:159]
  v_cvt_pk_bf16_f32 v232, v88, v89
  v_cvt_pk_bf16_f32 v233, v90, v91
  v_cvt_pk_bf16_f32 v234, v92, v93
  v_cvt_pk_bf16_f32 v235, v94, v95
  v_lshlrev_b32 v88, 16, v232
  v_lshlrev_b32 v90, 16, v233
  v_lshlrev_b32 v92, 16, v234
  v_lshlrev_b32 v94, 16, v235
  v_and_b32 v89, s43, v232
  v_and_b32 v91, s43, v233
  v_and_b32 v93, s43, v234
  v_and_b32 v95, s43, v235
  v_lshlrev_b32 v142, 16, v32
  v_lshlrev_b32 v148, 16, v33
  v_lshlrev_b32 v154, 16, v34
  v_lshlrev_b32 v160, 16, v35
  v_and_b32 v143, s43, v32
  v_and_b32 v149, s43, v33
  v_and_b32 v155, s43, v34
  v_and_b32 v161, s43, v35
  v_pk_mul_f32 v[140:141], v[72:73], v[142:143]
  v_pk_mul_f32 v[146:147], v[74:75], v[148:149]
  v_pk_mul_f32 v[152:153], v[76:77], v[154:155]
  v_pk_mul_f32 v[158:159], v[78:79], v[160:161]
  v_cvt_pk_bf16_f32 v144, v140, v141
  v_cvt_pk_bf16_f32 v150, v146, v147
  v_cvt_pk_bf16_f32 v156, v152, v153
  v_cvt_pk_bf16_f32 v162, v158, v159
  v_lshlrev_b32 v140, 16, v144
  v_lshlrev_b32 v146, 16, v150
  v_lshlrev_b32 v152, 16, v156
  v_lshlrev_b32 v158, 16, v162
  v_and_b32 v141, s43, v144
  v_and_b32 v147, s43, v150
  v_and_b32 v153, s43, v156
  v_and_b32 v159, s43, v162
  v_pk_add_f32 v[96:97], v[48:49], v[140:141]
  v_pk_add_f32 v[98:99], v[50:51], v[146:147]
  v_pk_add_f32 v[100:101], v[52:53], v[152:153]
  v_pk_add_f32 v[102:103], v[54:55], v[158:159]
  v_cvt_pk_bf16_f32 v236, v96, v97
  v_cvt_pk_bf16_f32 v237, v98, v99
  v_cvt_pk_bf16_f32 v238, v100, v101
  v_cvt_pk_bf16_f32 v239, v102, v103
  v_lshlrev_b32 v96, 16, v236
  v_lshlrev_b32 v98, 16, v237
  v_lshlrev_b32 v100, 16, v238
  v_lshlrev_b32 v102, 16, v239
  v_and_b32 v97, s43, v236
  v_and_b32 v99, s43, v237
  v_and_b32 v101, s43, v238
  v_and_b32 v103, s43, v239
  v_lshlrev_b32 v142, 16, v36
  v_lshlrev_b32 v148, 16, v37
  v_lshlrev_b32 v154, 16, v38
  v_lshlrev_b32 v160, 16, v39
  v_and_b32 v143, s43, v36
  v_and_b32 v149, s43, v37
  v_and_b32 v155, s43, v38
  v_and_b32 v161, s43, v39
  v_pk_mul_f32 v[140:141], v[80:81], v[142:143]
  v_pk_mul_f32 v[146:147], v[82:83], v[148:149]
  v_pk_mul_f32 v[152:153], v[84:85], v[154:155]
  v_pk_mul_f32 v[158:159], v[86:87], v[160:161]
  v_cvt_pk_bf16_f32 v144, v140, v141
  v_cvt_pk_bf16_f32 v150, v146, v147
  v_cvt_pk_bf16_f32 v156, v152, v153
  v_cvt_pk_bf16_f32 v162, v158, v159
  v_lshlrev_b32 v140, 16, v144
  v_lshlrev_b32 v146, 16, v150
  v_lshlrev_b32 v152, 16, v156
  v_lshlrev_b32 v158, 16, v162
  v_and_b32 v141, s43, v144
  v_and_b32 v147, s43, v150
  v_and_b32 v153, s43, v156
  v_and_b32 v159, s43, v162
  v_pk_add_f32 v[104:105], v[56:57], v[140:141]
  v_pk_add_f32 v[106:107], v[58:59], v[146:147]
  v_pk_add_f32 v[108:109], v[60:61], v[152:153]
  v_pk_add_f32 v[110:111], v[62:63], v[158:159]
  v_cvt_pk_bf16_f32 v240, v104, v105
  v_cvt_pk_bf16_f32 v241, v106, v107
  v_cvt_pk_bf16_f32 v242, v108, v109
  v_cvt_pk_bf16_f32 v243, v110, v111
  v_lshlrev_b32 v104, 16, v240
  v_lshlrev_b32 v106, 16, v241
  v_lshlrev_b32 v108, 16, v242
  v_lshlrev_b32 v110, 16, v243
  v_and_b32 v105, s43, v240
  v_and_b32 v107, s43, v241
  v_and_b32 v109, s43, v242
  v_and_b32 v111, s43, v243
  s_add_u32 s101, s46, 24117248
  v_mov_b32 v249, v13
  v_pk_add_f32 v[120:121], v[88:89], v[90:91]
  v_pk_add_f32 v[122:123], v[92:93], v[94:95]
  v_pk_add_f32 v[120:121], v[120:121], v[96:97]
  v_pk_add_f32 v[122:123], v[122:123], v[98:99]
  v_pk_add_f32 v[120:121], v[120:121], v[100:101]
  v_pk_add_f32 v[122:123], v[122:123], v[102:103]
  v_pk_add_f32 v[120:121], v[120:121], v[104:105]
  v_pk_add_f32 v[122:123], v[122:123], v[106:107]
  v_pk_add_f32 v[120:121], v[120:121], v[108:109]
  v_pk_add_f32 v[122:123], v[122:123], v[110:111]
  v_pk_add_f32 v[120:121], v[120:121], v[122:123]
  v_add_f32 v120, v120, v121
  v_mul_f32 v124, 0x3d2aaaab, v120
  v_sub_f32 v120, 0, v124
  v_sub_f32 v121, 0, v124
  v_pk_add_f32 v[130:131], v[88:89], v[120:121]
  v_pk_add_f32 v[132:133], v[90:91], v[120:121]
  v_pk_mul_f32 v[126:127], v[130:131], v[130:131]
  v_pk_mul_f32 v[128:129], v[132:133], v[132:133]
  v_pk_add_f32 v[130:131], v[92:93], v[120:121]
  v_pk_add_f32 v[132:133], v[94:95], v[120:121]
  v_pk_fma_f32 v[126:127], v[130:131], v[130:131], v[126:127]
  v_pk_fma_f32 v[128:129], v[132:133], v[132:133], v[128:129]
  v_pk_add_f32 v[130:131], v[96:97], v[120:121]
  v_pk_add_f32 v[132:133], v[98:99], v[120:121]
  v_pk_fma_f32 v[126:127], v[130:131], v[130:131], v[126:127]
  v_pk_fma_f32 v[128:129], v[132:133], v[132:133], v[128:129]
  v_pk_add_f32 v[130:131], v[100:101], v[120:121]
  v_pk_add_f32 v[132:133], v[102:103], v[120:121]
  v_pk_fma_f32 v[126:127], v[130:131], v[130:131], v[126:127]
  v_pk_fma_f32 v[128:129], v[132:133], v[132:133], v[128:129]
  v_pk_add_f32 v[130:131], v[104:105], v[120:121]
  v_pk_add_f32 v[132:133], v[106:107], v[120:121]
  v_pk_fma_f32 v[126:127], v[130:131], v[130:131], v[126:127]
  v_pk_fma_f32 v[128:129], v[132:133], v[132:133], v[128:129]
  v_pk_add_f32 v[130:131], v[108:109], v[120:121]
  v_pk_add_f32 v[132:133], v[110:111], v[120:121]
  v_pk_fma_f32 v[126:127], v[130:131], v[130:131], v[126:127]
  v_pk_fma_f32 v[128:129], v[132:133], v[132:133], v[128:129]
  v_add_f32 v126, v126, v127
  v_add_f32 v128, v128, v129
  v_add_f32 v125, v126, v128
  s_nop 1
  v_mov_b32_dpp v126, v124 row_ror:8 row_mask:0xf bank_mask:0xf
  v_mov_b32_dpp v127, v125 row_ror:8 row_mask:0xf bank_mask:0xf
  v_sub_f32 v130, v124, v126
  v_add_f32 v124, v124, v126
  v_add_f32 v125, v125, v127
  v_mul_f32 v130, v130, v130
  v_mul_f32 v124, 0.5, v124
  v_fmac_f32 v125, 0x41400000, v130
  v_mov_b32 v126, v124
  v_mov_b32 v127, v124
  v_mov_b32 v128, v125
  v_mov_b32 v129, v125
  s_nop 1
  v_permlane16_swap_b32 v126, v127
  v_permlane16_swap_b32 v128, v129
  s_nop 1
  v_sub_f32 v130, v126, v127
  v_add_f32 v124, v126, v127
  v_add_f32 v125, v128, v129
  v_mul_f32 v130, v130, v130
  v_mul_f32 v124, 0.5, v124
  v_fmac_f32 v125, 0x41c00000, v130
  v_mov_b32 v126, v124
  v_mov_b32 v127, v124
  v_mov_b32 v128, v125
  v_mov_b32 v129, v125
  s_nop 1
  v_permlane32_swap_b32 v126, v127
  v_permlane32_swap_b32 v128, v129
  s_nop 1
  v_sub_f32 v130, v126, v127
  v_add_f32 v124, v126, v127
  v_add_f32 v125, v128, v129
  v_mul_f32 v130, v130, v130
  v_mul_f32 v124, 0.5, v124
  v_fmac_f32 v125, 0x42400000, v130
  v_mov_b32 v132, s88
  ds_write_b64 v11, v[124:125] offset:192
  ds_write_b32 v11, v132 offset:384
  s_mov_b32 s58, 0
L_lns_8:
  ds_read_b32 v133, v12 offset:384
  ds_read_b32 v134, v12 offset:448
  ds_read_b32 v135, v12 offset:512
  s_waitcnt lgkmcnt(0)
  v_cmp_eq_u32 vcc, v132, v133
  v_cmp_eq_u32 s[60:61], v132, v134
  v_cmp_eq_u32 s[62:63], v132, v135
  s_add_u32 s58, s58, 1
  s_and_b64 vcc, vcc, s[60:61]
  s_and_b64 vcc, vcc, s[62:63]
  s_cmp_gt_u32 s58, 4000000
  s_cbranch_scc1 L_lns_8_ok
  s_cmp_eq_u64 vcc, -1
  s_cbranch_scc0 L_lns_8
L_lns_8_ok:
  ds_read_b64 v[126:127], v12 offset:192
  ds_read_b64 v[128:129], v12 offset:256
  ds_read_b64 v[130:131], v12 offset:320
  s_waitcnt lgkmcnt(0)
  v_add_f32 v124, v126, v128
  v_add_f32 v125, v127, v129
  v_add_f32 v124, v124, v130
  v_add_f32 v125, v125, v131
  v_mul_f32 v124, 0x3eaaaaab, v124
  v_sub_f32 v126, v126, v124
  v_sub_f32 v128, v128, v124
  v_sub_f32 v130, v130, v124
  v_mul_f32 v126, v126, v126
  v_fmac_f32 v126, v128, v128
  v_fmac_f32 v126, v130, v130
  v_fmac_f32 v125, 0x43400000, v126
  v_mul_f32 v125, 0x3ae38e39, v125
  v_cvt_pk_bf16_f32 v124, v124, v124
  v_lshlrev_b32 v124, 16, v124
  v_cvt_pk_bf16_f32 v125, v125, v125
  v_lshlrev_b32 v125, 16, v125
  v_add_f32 v125, 0x37280000, v125
  v_cvt_pk_bf16_f32 v125, v125, v125
  v_lshlrev_b32 v125, 16, v125
  v_sqrt_f32 v125, v125
  s_nop 0
  v_cvt_pk_bf16_f32 v125, v125, v125
  v_lshlrev_b32 v125, 16, v125
  v_rcp_f32 v122, v125
  v_sub_f32 v120, 0, v124
  v_sub_f32 v121, 0, v124
  s_nop 0
  v_mov_b32 v123, v122
  v_pk_add_f32 v[140:141], v[88:89], v[120:121]
  v_pk_add_f32 v[144:145], v[90:91], v[120:121]
  v_pk_add_f32 v[148:149], v[92:93], v[120:121]
  v_pk_add_f32 v[152:153], v[94:95], v[120:121]
  v_cvt_pk_bf16_f32 v142, v140, v141
  v_cvt_pk_bf16_f32 v146, v144, v145
  v_cvt_pk_bf16_f32 v150, v148, v149
  v_cvt_pk_bf16_f32 v154, v152, v153
  v_lshlrev_b32 v140, 16, v142
  v_lshlrev_b32 v144, 16, v146
  v_lshlrev_b32 v148, 16, v150
  v_lshlrev_b32 v152, 16, v154
  v_and_b32 v141, s43, v142
  v_and_b32 v145, s43, v146
  v_and_b32 v149, s43, v150
  v_and_b32 v153, s43, v154
  v_pk_mul_f32 v[140:141], v[140:141], v[122:123]
  v_pk_mul_f32 v[144:145], v[144:145], v[122:123]
  v_pk_mul_f32 v[148:149], v[148:149], v[122:123]
  v_pk_mul_f32 v[152:153], v[152:153], v[122:123]
  v_cvt_pk_bf16_f32 v28, v140, v141
  v_cvt_pk_bf16_f32 v29, v144, v145
  v_cvt_pk_bf16_f32 v30, v148, v149
  v_cvt_pk_bf16_f32 v31, v152, v153
  v_pk_add_f32 v[140:141], v[96:97], v[120:121]
  v_pk_add_f32 v[144:145], v[98:99], v[120:121]
  v_pk_add_f32 v[148:149], v[100:101], v[120:121]
  v_pk_add_f32 v[152:153], v[102:103], v[120:121]
  v_cvt_pk_bf16_f32 v142, v140, v141
  v_cvt_pk_bf16_f32 v146, v144, v145
  v_cvt_pk_bf16_f32 v150, v148, v149
  v_cvt_pk_bf16_f32 v154, v152, v153
  v_lshlrev_b32 v140, 16, v142
  v_lshlrev_b32 v144, 16, v146
  v_lshlrev_b32 v148, 16, v150
  v_lshlrev_b32 v152, 16, v154
  v_and_b32 v141, s43, v142
  v_and_b32 v145, s43, v146
  v_and_b32 v149, s43, v150
  v_and_b32 v153, s43, v154
  v_pk_mul_f32 v[140:141], v[140:141], v[122:123]
  v_pk_mul_f32 v[144:145], v[144:145], v[122:123]
  v_pk_mul_f32 v[148:149], v[148:149], v[122:123]
  v_pk_mul_f32 v[152:153], v[152:153], v[122:123]
  v_cvt_pk_bf16_f32 v32, v140, v141
  v_cvt_pk_bf16_f32 v33, v144, v145
  v_cvt_pk_bf16_f32 v34, v148, v149
  v_cvt_pk_bf16_f32 v35, v152, v153
  v_pk_add_f32 v[140:141], v[104:105], v[120:121]
  v_pk_add_f32 v[144:145], v[106:107], v[120:121]
  v_pk_add_f32 v[148:149], v[108:109], v[120:121]
  v_pk_add_f32 v[152:153], v[110:111], v[120:121]
  v_cvt_pk_bf16_f32 v142, v140, v141
  v_cvt_pk_bf16_f32 v146, v144, v145
  v_cvt_pk_bf16_f32 v150, v148, v149
  v_cvt_pk_bf16_f32 v154, v152, v153
  v_lshlrev_b32 v140, 16, v142
  v_lshlrev_b32 v144, 16, v146
  v_lshlrev_b32 v148, 16, v150
  v_lshlrev_b32 v152, 16, v154
  v_and_b32 v141, s43, v142
  v_and_b32 v145, s43, v146
  v_and_b32 v149, s43, v150
  v_and_b32 v153, s43, v154
  v_pk_mul_f32 v[140:141], v[140:141], v[122:123]
  v_pk_mul_f32 v[144:145], v[144:145], v[122:123]
  v_pk_mul_f32 v[148:149], v[148:149], v[122:123]
  v_pk_mul_f32 v[152:153], v[152:153], v[122:123]
  v_cvt_pk_bf16_f32 v36, v140, v141
  v_cvt_pk_bf16_f32 v37, v144, v145
  v_cvt_pk_bf16_f32 v38, v148, v149
  v_cvt_pk_bf16_f32 v39, v152, v153
  v_lshrrev_b32 v8, 5, v2
  v_lshlrev_b32 v8, 10, v8
  v_bfe_u32 v15, v2, 3, 2
  v_lshl_add_u32 v8, v15, 8, v8
  v_lshl_add_u32 v8, v9, 4, v8
  s_lshr_b32 s47, s37, 4
  s_mul_i32 s47, s47, 18
  s_mul_i32 s48, s39, 6
  s_add_u32 s47, s47, s48
  s_and_b32 s48, s36, 1
  s_lshl_b32 s48, s48, 7
  s_add_u32 s48, s48, 4096

  s_add_u32 s49, s47, 0
  s_lshr_b32 s50, s49, 2
  s_lshl_b32 s50, s50, 13
  s_and_b32 s49, s49, 3
  s_lshl_b32 s49, s49, 10
  s_add_u32 s50, s50, s49
  s_add_u32 s50, s50, s48
  buffer_store_dwordx4 v[28:31], v8, s[28:31], s50 offen sc1
  s_add_u32 s49, s47, 2
  s_lshr_b32 s50, s49, 2
  s_lshl_b32 s50, s50, 13
  s_and_b32 s49, s49, 3
  s_lshl_b32 s49, s49, 10
  s_add_u32 s50, s50, s49
  s_add_u32 s50, s50, s48
  buffer_store_dwordx4 v[32:35], v8, s[28:31], s50 offen sc1
  s_add_u32 s49, s47, 4
  s_lshr_b32 s50, s49, 2
  s_lshl_b32 s50, s50, 13
  s_and_b32 s49, s49, 3
  s_lshl_b32 s49, s49, 10
  s_add_u32 s50, s50, s49
  s_add_u32 s50, s50, s48
  buffer_store_dwordx4 v[36:39], v8, s[28:31], s50 offen sc1
  s_lshl_b32 s47, s35, 2
  s_add_u32 s47, s47, s32
  s_lshl_b32 s47, s47, 7
  s_lshl_b32 s48, s34, 5
  s_add_u32 s47, s47, s48
  s_lshl_b32 s48, s39, 3
  s_add_u32 s47, s47, s48
  s_add_u32 s47, s47, 83914752
  v_mov_b32 v8, 0

  s_waitcnt vmcnt(0)
  s_add_u32 s61, s88, 1
  v_mov_b32 v16, s61
  v_mov_b32 v17, s89
  s_mov_b64 exec, 1
  buffer_store_dwordx2 v[16:17], v8, s[28:31], s47 offen sc1
  s_mov_b64 exec, -1
  s_branch L_lnd
L_w3:
  v_mov_b32 v249, 0x80000000
  v_lshlrev_b32 v8, 3, v2
  s_lshl_b32 s101, s36, 9
  s_add_u32 s101, s101, 83898368
  v_mov_b32 v10, 0

  buffer_load_dwordx2 v[16:17], v8, s[28:31], s101 offen offset:0 sc1
  s_cmp_ge_u32 s2, 144
  s_cbranch_scc1 L_w3_nostrip
  v_lshrrev_b32 v192, 4, v2
  v_bfe_u32 v193, v2, 2, 2
  v_lshl_add_u32 v194, v192, 3, v193
  v_mul_u32_u24 v194, 576, v194
  v_and_b32 v195, 3, v2
  v_lshl_add_u32 v194, v195, 3, v194
  s_lshr_b32 s46, s39, 1
  s_and_b32 s47, s39, 1
  s_mul_i32 s50, s46, 18432
  s_mul_i32 s51, s47, 288
  s_add_u32 s50, s50, s51
  v_add_u32 v189, s50, v194
  v_lshl_add_u32 v194, v192, 2, v193
  v_mul_u32_u24 v194, 1152, v194
  v_lshl_add_u32 v194, v195, 3, v194
  v_mov_b32 v190, v194

  s_mov_b32 s52, s2
  v_add_u32 v191, 126528, v190
  ds_read_b64_tr_b16 v[32:33], v191 offset:0
  ds_read_b64_tr_b16 v[34:35], v191 offset:18432
  ds_read_b64_tr_b16 v[36:37], v191 offset:32
  ds_read_b64_tr_b16 v[38:39], v191 offset:18464
  ds_read_b64_tr_b16 v[40:41], v191 offset:64
  ds_read_b64_tr_b16 v[42:43], v191 offset:18496
  ds_read_b64_tr_b16 v[44:45], v191 offset:96
  ds_read_b64_tr_b16 v[46:47], v191 offset:18528
  ds_read_b64_tr_b16 v[48:49], v191 offset:128
  ds_read_b64_tr_b16 v[50:51], v191 offset:18560
  ds_read_b64_tr_b16 v[52:53], v191 offset:160
  ds_read_b64_tr_b16 v[54:55], v191 offset:18592
  ds_read_b64_tr_b16 v[56:57], v191 offset:192
  ds_read_b64_tr_b16 v[58:59], v191 offset:18624
  ds_read_b64_tr_b16 v[60:61], v191 offset:224
  ds_read_b64_tr_b16 v[62:63], v191 offset:18656
  ds_read_b64_tr_b16 v[64:65], v191 offset:256
  ds_read_b64_tr_b16 v[66:67], v191 offset:18688
  s_mul_i32 s53, s52, 1821
  s_lshr_b32 s53, s53, 16
  s_mul_i32 s54, s53, 36
  s_sub_u32 s54, s52, s54
  s_lshl_b32 s60, s53, 2
  s_add_u32 s60, s60, 0
  s_lshl_b32 s49, s60, 9
  s_lshl_b32 s55, s54, 3
  s_add_u32 s49, s49, s55
  s_add_u32 s49, s49, 83906560
  s_mul_i32 s55, s54, 7282
  s_lshr_b32 s55, s55, 16
  s_mul_i32 s56, s55, 9
  s_sub_u32 s56, s54, s56
  s_sub_u32 s50, s55, 0
  s_sub_u32 s50, s50, 1
  s_and_b32 s50, s50, 3
  s_mul_i32 s51, s56, 3
  s_add_u32 s51, s51, s50
  s_add_u32 s53, s51, 27
  s_add_u32 s54, s51, 45
  s_add_u32 s57, s51, 45
  s_add_u32 s61, s51, 54
  s_cmp_ge_u32 s56, 6
  s_cselect_b32 s53, s57, s53
  s_cselect_b32 s54, s61, s54
  s_add_u32 s55, s51, 81
  s_add_u32 s57, s56, 9
  s_add_u32 s61, s56, 18
  s_cmp_eq_u32 s50, 3
  s_cselect_b32 s53, s56, s53
  s_cselect_b32 s54, s57, s54
  s_cselect_b32 s55, s61, s55
  s_mul_i32 s60, s60, 331776
  s_add_u32 s60, s60, 14680064
  s_mul_i32 s53, s53, 3072
  s_mul_i32 s54, s54, 3072
  s_mul_i32 s55, s55, 3072
  s_add_u32 s53, s53, s60
  s_add_u32 s54, s54, s60
  s_add_u32 s55, s55, s60

  s_waitcnt lgkmcnt(14)
  buffer_store_dwordx4 v[32:35], v3, s[28:31], s53 offen offset:0 sc1
  s_waitcnt lgkmcnt(14)
  buffer_store_dwordx4 v[36:39], v3, s[28:31], s53 offen offset:1024 sc1
  s_waitcnt lgkmcnt(12)
  buffer_store_dwordx4 v[40:43], v3, s[28:31], s53 offen offset:2048 sc1
  s_waitcnt lgkmcnt(10)
  buffer_store_dwordx4 v[44:47], v3, s[28:31], s54 offen offset:0 sc1
  s_waitcnt lgkmcnt(8)
  buffer_store_dwordx4 v[48:51], v3, s[28:31], s54 offen offset:1024 sc1
  s_waitcnt lgkmcnt(6)
  buffer_store_dwordx4 v[52:55], v3, s[28:31], s54 offen offset:2048 sc1
  s_waitcnt lgkmcnt(4)
  buffer_store_dwordx4 v[56:59], v3, s[28:31], s55 offen offset:0 sc1
  s_waitcnt lgkmcnt(2)
  buffer_store_dwordx4 v[60:63], v3, s[28:31], s55 offen offset:1024 sc1
  s_waitcnt lgkmcnt(0)
  buffer_store_dwordx4 v[64:67], v3, s[28:31], s55 offen offset:2048 sc1
  v_add_u32 v191, 126816, v190
  ds_read_b64_tr_b16 v[68:69], v191 offset:0
  ds_read_b64_tr_b16 v[70:71], v191 offset:18432
  ds_read_b64_tr_b16 v[72:73], v191 offset:32
  ds_read_b64_tr_b16 v[74:75], v191 offset:18464
  ds_read_b64_tr_b16 v[76:77], v191 offset:64
  ds_read_b64_tr_b16 v[78:79], v191 offset:18496
  ds_read_b64_tr_b16 v[80:81], v191 offset:96
  ds_read_b64_tr_b16 v[82:83], v191 offset:18528
  ds_read_b64_tr_b16 v[84:85], v191 offset:128
  ds_read_b64_tr_b16 v[86:87], v191 offset:18560
  ds_read_b64_tr_b16 v[88:89], v191 offset:160
  ds_read_b64_tr_b16 v[90:91], v191 offset:18592
  ds_read_b64_tr_b16 v[92:93], v191 offset:192
  ds_read_b64_tr_b16 v[94:95], v191 offset:18624
  ds_read_b64_tr_b16 v[96:97], v191 offset:224
  ds_read_b64_tr_b16 v[98:99], v191 offset:18656
  ds_read_b64_tr_b16 v[100:101], v191 offset:256
  ds_read_b64_tr_b16 v[102:103], v191 offset:18688
  s_mul_i32 s53, s52, 1821
  s_lshr_b32 s53, s53, 16
  s_mul_i32 s54, s53, 36
  s_sub_u32 s54, s52, s54
  s_lshl_b32 s60, s53, 2
  s_add_u32 s60, s60, 1
  s_lshl_b32 s49, s60, 9
  s_lshl_b32 s55, s54, 3
  s_add_u32 s49, s49, s55
  s_add_u32 s49, s49, 83906560
  s_mul_i32 s55, s54, 7282
  s_lshr_b32 s55, s55, 16
  s_mul_i32 s56, s55, 9
  s_sub_u32 s56, s54, s56
  s_sub_u32 s50, s55, 1
  s_sub_u32 s50, s50, 1
  s_and_b32 s50, s50, 3
  s_mul_i32 s51, s56, 3
  s_add_u32 s51, s51, s50
  s_add_u32 s53, s51, 27
  s_add_u32 s54, s51, 45
  s_add_u32 s57, s51, 45
  s_add_u32 s61, s51, 54
  s_cmp_ge_u32 s56, 6
  s_cselect_b32 s53, s57, s53
  s_cselect_b32 s54, s61, s54
  s_add_u32 s55, s51, 81
  s_add_u32 s57, s56, 9
  s_add_u32 s61, s56, 18
  s_cmp_eq_u32 s50, 3
  s_cselect_b32 s53, s56, s53
  s_cselect_b32 s54, s57, s54
  s_cselect_b32 s55, s61, s55
  s_mul_i32 s60, s60, 331776
  s_add_u32 s60, s60, 14680064
  s_mul_i32 s53, s53, 3072
  s_mul_i32 s54, s54, 3072
  s_mul_i32 s55, s55, 3072
  s_add_u32 s53, s53, s60
  s_add_u32 s54, s54, s60
  s_add_u32 s55, s55, s60

  s_waitcnt lgkmcnt(14)
  buffer_store_dwordx4 v[68:71], v3, s[28:31], s53 offen offset:0 sc1
  s_waitcnt lgkmcnt(14)
  buffer_store_dwordx4 v[72:75], v3, s[28:31], s53 offen offset:1024 sc1
  s_waitcnt lgkmcnt(12)
  buffer_store_dwordx4 v[76:79], v3, s[28:31], s53 offen offset:2048 sc1
  s_waitcnt lgkmcnt(10)
  buffer_store_dwordx4 v[80:83], v3, s[28:31], s54 offen offset:0 sc1
  s_waitcnt lgkmcnt(8)
  buffer_store_dwordx4 v[84:87], v3, s[28:31], s54 offen offset:1024 sc1
  s_waitcnt lgkmcnt(6)
  buffer_store_dwordx4 v[88:91], v3, s[28:31], s54 offen offset:2048 sc1
  s_waitcnt lgkmcnt(4)
  buffer_store_dwordx4 v[92:95], v3, s[28:31], s55 offen offset:0 sc1
  s_waitcnt lgkmcnt(2)
  buffer_store_dwordx4 v[96:99], v3, s[28:31], s55 offen offset:1024 sc1
  s_waitcnt lgkmcnt(0)
  buffer_store_dwordx4 v[100:103], v3, s[28:31], s55 offen offset:2048 sc1
  v_add_u32 v191, 127104, v190
  ds_read_b64_tr_b16 v[104:105], v191 offset:0
  ds_read_b64_tr_b16 v[106:107], v191 offset:18432
  ds_read_b64_tr_b16 v[108:109], v191 offset:32
  ds_read_b64_tr_b16 v[110:111], v191 offset:18464
  ds_read_b64_tr_b16 v[112:113], v191 offset:64
  ds_read_b64_tr_b16 v[114:115], v191 offset:18496
  ds_read_b64_tr_b16 v[116:117], v191 offset:96
  ds_read_b64_tr_b16 v[118:119], v191 offset:18528
  ds_read_b64_tr_b16 v[120:121], v191 offset:128
  ds_read_b64_tr_b16 v[122:123], v191 offset:18560
  ds_read_b64_tr_b16 v[124:125], v191 offset:160
  ds_read_b64_tr_b16 v[126:127], v191 offset:18592
  ds_read_b64_tr_b16 v[128:129], v191 offset:192
  ds_read_b64_tr_b16 v[130:131], v191 offset:18624
  ds_read_b64_tr_b16 v[132:133], v191 offset:224
  ds_read_b64_tr_b16 v[134:135], v191 offset:18656
  ds_read_b64_tr_b16 v[136:137], v191 offset:256
  ds_read_b64_tr_b16 v[138:139], v191 offset:18688
  s_mul_i32 s53, s52, 1821
  s_lshr_b32 s53, s53, 16
  s_mul_i32 s54, s53, 36
  s_sub_u32 s54, s52, s54
  s_lshl_b32 s60, s53, 2
  s_add_u32 s60, s60, 2
  s_lshl_b32 s49, s60, 9
  s_lshl_b32 s55, s54, 3
  s_add_u32 s49, s49, s55
  s_add_u32 s49, s49, 83906560
  s_mul_i32 s55, s54, 7282
  s_lshr_b32 s55, s55, 16
  s_mul_i32 s56, s55, 9
  s_sub_u32 s56, s54, s56
  s_sub_u32 s50, s55, 2
  s_sub_u32 s50, s50, 1
  s_and_b32 s50, s50, 3
  s_mul_i32 s51, s56, 3
  s_add_u32 s51, s51, s50
  s_add_u32 s53, s51, 27
  s_add_u32 s54, s51, 45
  s_add_u32 s57, s51, 45
  s_add_u32 s61, s51, 54
  s_cmp_ge_u32 s56, 6
  s_cselect_b32 s53, s57, s53
  s_cselect_b32 s54, s61, s54
  s_add_u32 s55, s51, 81
  s_add_u32 s57, s56, 9
  s_add_u32 s61, s56, 18
  s_cmp_eq_u32 s50, 3
  s_cselect_b32 s53, s56, s53
  s_cselect_b32 s54, s57, s54
  s_cselect_b32 s55, s61, s55
  s_mul_i32 s60, s60, 331776
  s_add_u32 s60, s60, 14680064
  s_mul_i32 s53, s53, 3072
  s_mul_i32 s54, s54, 3072
  s_mul_i32 s55, s55, 3072
  s_add_u32 s53, s53, s60
  s_add_u32 s54, s54, s60
  s_add_u32 s55, s55, s60

  s_waitcnt lgkmcnt(14)
  buffer_store_dwordx4 v[104:107], v3, s[28:31], s53 offen offset:0 sc1
  s_waitcnt lgkmcnt(14)
  buffer_store_dwordx4 v[108:111], v3, s[28:31], s53 offen offset:1024 sc1
  s_waitcnt lgkmcnt(12)
  buffer_store_dwordx4 v[112:115], v3, s[28:31], s53 offen offset:2048 sc1
  s_waitcnt lgkmcnt(10)
  buffer_store_dwordx4 v[116:119], v3, s[28:31], s54 offen offset:0 sc1
  s_waitcnt lgkmcnt(8)
  buffer_store_dwordx4 v[120:123], v3, s[28:31], s54 offen offset:1024 sc1
  s_waitcnt lgkmcnt(6)
  buffer_store_dwordx4 v[124:127], v3, s[28:31], s54 offen offset:2048 sc1
  s_waitcnt lgkmcnt(4)
  buffer_store_dwordx4 v[128:131], v3, s[28:31], s55 offen offset:0 sc1
  s_waitcnt lgkmcnt(2)
  buffer_store_dwordx4 v[132:135], v3, s[28:31], s55 offen offset:1024 sc1
  s_waitcnt lgkmcnt(0)
  buffer_store_dwordx4 v[136:139], v3, s[28:31], s55 offen offset:2048 sc1
  v_add_u32 v191, 127392, v190
  ds_read_b64_tr_b16 v[140:141], v191 offset:0
  ds_read_b64_tr_b16 v[142:143], v191 offset:18432
  ds_read_b64_tr_b16 v[144:145], v191 offset:32
  ds_read_b64_tr_b16 v[146:147], v191 offset:18464
  ds_read_b64_tr_b16 v[148:149], v191 offset:64
  ds_read_b64_tr_b16 v[150:151], v191 offset:18496
  ds_read_b64_tr_b16 v[152:153], v191 offset:96
  ds_read_b64_tr_b16 v[154:155], v191 offset:18528
  ds_read_b64_tr_b16 v[156:157], v191 offset:128
  ds_read_b64_tr_b16 v[158:159], v191 offset:18560
  ds_read_b64_tr_b16 v[160:161], v191 offset:160
  ds_read_b64_tr_b16 v[162:163], v191 offset:18592
  ds_read_b64_tr_b16 v[164:165], v191 offset:192
  ds_read_b64_tr_b16 v[166:167], v191 offset:18624
  ds_read_b64_tr_b16 v[168:169], v191 offset:224
  ds_read_b64_tr_b16 v[170:171], v191 offset:18656
  ds_read_b64_tr_b16 v[172:173], v191 offset:256
  ds_read_b64_tr_b16 v[174:175], v191 offset:18688
  s_mul_i32 s53, s52, 1821
  s_lshr_b32 s53, s53, 16
  s_mul_i32 s54, s53, 36
  s_sub_u32 s54, s52, s54
  s_lshl_b32 s60, s53, 2
  s_add_u32 s60, s60, 3
  s_lshl_b32 s49, s60, 9
  s_lshl_b32 s55, s54, 3
  s_add_u32 s49, s49, s55
  s_add_u32 s49, s49, 83906560
  s_mul_i32 s55, s54, 7282
  s_lshr_b32 s55, s55, 16
  s_mul_i32 s56, s55, 9
  s_sub_u32 s56, s54, s56
  s_sub_u32 s50, s55, 3
  s_sub_u32 s50, s50, 1
  s_and_b32 s50, s50, 3
  s_mul_i32 s51, s56, 3
  s_add_u32 s51, s51, s50
  s_add_u32 s53, s51, 27
  s_add_u32 s54, s51, 45
  s_add_u32 s57, s51, 45
  s_add_u32 s61, s51, 54
  s_cmp_ge_u32 s56, 6
  s_cselect_b32 s53, s57, s53
  s_cselect_b32 s54, s61, s54
  s_add_u32 s55, s51, 81
  s_add_u32 s57, s56, 9
  s_add_u32 s61, s56, 18
  s_cmp_eq_u32 s50, 3
  s_cselect_b32 s53, s56, s53
  s_cselect_b32 s54, s57, s54
  s_cselect_b32 s55, s61, s55
  s_mul_i32 s60, s60, 331776
  s_add_u32 s60, s60, 14680064
  s_mul_i32 s53, s53, 3072
  s_mul_i32 s54, s54, 3072
  s_mul_i32 s55, s55, 3072
  s_add_u32 s53, s53, s60
  s_add_u32 s54, s54, s60
  s_add_u32 s55, s55, s60

  s_waitcnt lgkmcnt(14)
  buffer_store_dwordx4 v[140:143], v3, s[28:31], s53 offen offset:0 sc1
  s_waitcnt lgkmcnt(14)
  buffer_store_dwordx4 v[144:147], v3, s[28:31], s53 offen offset:1024 sc1
  s_waitcnt lgkmcnt(12)
  buffer_store_dwordx4 v[148:151], v3, s[28:31], s53 offen offset:2048 sc1
  s_waitcnt lgkmcnt(10)
  buffer_store_dwordx4 v[152:155], v3, s[28:31], s54 offen offset:0 sc1
  s_waitcnt lgkmcnt(8)
  buffer_store_dwordx4 v[156:159], v3, s[28:31], s54 offen offset:1024 sc1
  s_waitcnt lgkmcnt(6)
  buffer_store_dwordx4 v[160:163], v3, s[28:31], s54 offen offset:2048 sc1
  s_waitcnt lgkmcnt(4)
  buffer_store_dwordx4 v[164:167], v3, s[28:31], s55 offen offset:0 sc1
  s_waitcnt lgkmcnt(2)
  buffer_store_dwordx4 v[168:171], v3, s[28:31], s55 offen offset:1024 sc1
  s_waitcnt lgkmcnt(0)
  buffer_store_dwordx4 v[172:175], v3, s[28:31], s55 offen offset:2048 sc1
  s_mov_b32 s100, s49
  s_branch L_w3_chk
L_w3_nostrip:
  s_waitcnt vmcnt(0)
L_w3_chk:
  s_waitcnt vmcnt(36)
  s_mov_b32 s58, 0
  s_add_u32 s59, s88, 1
L_pp1_chk:
  s_mov_b64 s[60:61], -1
  v_subrev_u32 v18, s59, v16
  v_cmp_gt_u32 vcc, 15, v18
  v_cmp_eq_u32 s[62:63], s89, v17
  s_nop 1
  s_and_b64 vcc, vcc, s[62:63]
  s_mov_b32 s62, 0x0
  s_mov_b32 s63, 0xfffffff0
  s_or_b64 vcc, vcc, s[62:63]
  s_and_b64 s[60:61], s[60:61], vcc
  s_cmp_eq_u64 s[60:61], -1
  s_cbranch_scc1 L_pp1_ok
  s_add_u32 s58, s58, 1
  s_cmp_gt_u32 s58, 20000
  s_cbranch_scc1 L_pp1_ok
  buffer_load_dwordx2 v[16:17], v8, s[28:31], s101 offen offset:0 sc1
  s_waitcnt vmcnt(0)
  s_branch L_pp1_chk
L_pp1_ok:
  s_sub_u32 s46, s41, s40
  s_mov_b32 m0, 0
  s_add_u32 s44, s46, 0
  buffer_load_dwordx4 v3, s[28:31], s44 offen offset:0 sc1 lds
  buffer_load_dwordx4 v3, s[28:31], s44 offen offset:1024 sc1 lds
  buffer_load_dwordx4 v3, s[28:31], s44 offen offset:2048 sc1 lds
  buffer_load_dwordx4 v3, s[28:31], s44 offen offset:3072 sc1 lds
  s_mov_b32 m0, 4096
  s_add_u32 s44, s46, 4096
  buffer_load_dwordx4 v3, s[28:31], s44 offen offset:0 sc1 lds
  buffer_load_dwordx4 v3, s[28:31], s44 offen offset:1024 sc1 lds
  buffer_load_dwordx4 v3, s[28:31], s44 offen offset:2048 sc1 lds
  buffer_load_dwordx4 v3, s[28:31], s44 offen offset:3072 sc1 lds
  s_mov_b32 m0, 8192
  s_add_u32 s44, s46, 8192
  buffer_load_dwordx4 v3, s[28:31], s44 offen offset:0 sc1 lds
  buffer_load_dwordx4 v3, s[28:31], s44 offen offset:1024 sc1 lds
  buffer_load_dwordx4 v3, s[28:31], s44 offen offset:2048 sc1 lds
  buffer_load_dwordx4 v3, s[28:31], s44 offen offset:3072 sc1 lds
  s_mov_b32 m0, 12288
  s_add_u32 s44, s46, 12288
  buffer_load_dwordx4 v3, s[28:31], s44 offen offset:0 sc1 lds
  buffer_load_dwordx4 v3, s[28:31], s44 offen offset:1024 sc1 lds
  buffer_load_dwordx4 v3, s[28:31], s44 offen offset:2048 sc1 lds
  buffer_load_dwordx4 v3, s[28:31], s44 offen offset:3072 sc1 lds
  s_mov_b32 m0, 16384
  s_add_u32 s44, s46, 16384
  buffer_load_dwordx4 v3, s[28:31], s44 offen offset:0 sc1 lds
  buffer_load_dwordx4 v3, s[28:31], s44 offen offset:1024 sc1 lds
  buffer_load_dwordx4 v3, s[28:31], s44 offen offset:2048 sc1 lds
  buffer_load_dwordx4 v3, s[28:31], s44 offen offset:3072 sc1 lds
  s_mov_b32 m0, 20480
  s_add_u32 s44, s46, 20480
  buffer_load_dwordx4 v3, s[28:31], s44 offen offset:0 sc1 lds
  buffer_load_dwordx4 v3, s[28:31], s44 offen offset:1024 sc1 lds
  buffer_load_dwordx4 v3, s[28:31], s44 offen offset:2048 sc1 lds
  buffer_load_dwordx4 v3, s[28:31], s44 offen offset:3072 sc1 lds
  s_mov_b32 m0, 24576
  s_add_u32 s44, s46, 24576
  buffer_load_dwordx4 v3, s[28:31], s44 offen offset:0 sc1 lds
  buffer_load_dwordx4 v3, s[28:31], s44 offen offset:1024 sc1 lds
  buffer_load_dwordx4 v3, s[28:31], s44 offen offset:2048 sc1 lds
  buffer_load_dwordx4 v3, s[28:31], s44 offen offset:3072 sc1 lds
  s_mov_b32 m0, 28672
  s_add_u32 s44, s46, 28672
  buffer_load_dwordx4 v3, s[28:31], s44 offen offset:0 sc1 lds
  buffer_load_dwordx4 v3, s[28:31], s44 offen offset:1024 sc1 lds
  buffer_load_dwordx4 v3, s[28:31], s44 offen offset:2048 sc1 lds
  buffer_load_dwordx4 v3, s[28:31], s44 offen offset:3072 sc1 lds
  s_mov_b32 m0, 32768
  s_add_u32 s44, s46, 32768
  buffer_load_dwordx4 v3, s[28:31], s44 offen offset:0 sc1 lds
  buffer_load_dwordx4 v3, s[28:31], s44 offen offset:1024 sc1 lds
  buffer_load_dwordx4 v3, s[28:31], s44 offen offset:2048 sc1 lds
  buffer_load_dwordx4 v3, s[28:31], s44 offen offset:3072 sc1 lds
  s_mov_b32 m0, 36864
  s_add_u32 s44, s46, 36864
  buffer_load_dwordx4 v3, s[28:31], s44 offen offset:0 sc1 lds
  buffer_load_dwordx4 v3, s[28:31], s44 offen offset:1024 sc1 lds
  buffer_load_dwordx4 v3, s[28:31], s44 offen offset:2048 sc1 lds
  buffer_load_dwordx4 v3, s[28:31], s44 offen offset:3072 sc1 lds
  s_mov_b32 m0, 40960
  s_add_u32 s44, s46, 40960
  buffer_load_dwordx4 v3, s[28:31], s44 offen offset:0 sc1 lds
  buffer_load_dwordx4 v3, s[28:31], s44 offen offset:1024 sc1 lds
  buffer_load_dwordx4 v3, s[28:31], s44 offen offset:2048 sc1 lds
  buffer_load_dwordx4 v3, s[28:31], s44 offen offset:3072 sc1 lds
  s_mov_b32 m0, 45056
  s_add_u32 s44, s46, 45056
  buffer_load_dwordx4 v3, s[28:31], s44 offen offset:0 sc1 lds
  buffer_load_dwordx4 v3, s[28:31], s44 offen offset:1024 sc1 lds
  buffer_load_dwordx4 v3, s[28:31], s44 offen offset:2048 sc1 lds
  buffer_load_dwordx4 v3, s[28:31], s44 offen offset:3072 sc1 lds
  s_mov_b32 m0, 49152
  s_add_u32 s44, s46, 49152
  buffer_load_dwordx4 v3, s[28:31], s44 offen offset:0 sc1 lds
  buffer_load_dwordx4 v3, s[28:31], s44 offen offset:1024 sc1 lds
  buffer_load_dwordx4 v3, s[28:31], s44 offen offset:2048 sc1 lds
  buffer_load_dwordx4 v3, s[28:31], s44 offen offset:3072 sc1 lds
  s_mov_b32 m0, 53248
  s_add_u32 s44, s46, 53248
  buffer_load_dwordx4 v3, s[28:31], s44 offen offset:0 sc1 lds
  buffer_load_dwordx4 v3, s[28:31], s44 offen offset:1024 sc1 lds
  buffer_load_dwordx4 v3, s[28:31], s44 offen offset:2048 sc1 lds
  buffer_load_dwordx4 v3, s[28:31], s44 offen offset:3072 sc1 lds
  s_mov_b32 m0, 57344
  s_add_u32 s44, s46, 57344
  buffer_load_dwordx4 v3, s[28:31], s44 offen offset:0 sc1 lds
  buffer_load_dwordx4 v3, s[28:31], s44 offen offset:1024 sc1 lds
  buffer_load_dwordx4 v3, s[28:31], s44 offen offset:2048 sc1 lds
  buffer_load_dwordx4 v3, s[28:31], s44 offen offset:3072 sc1 lds
  s_mov_b32 m0, 61440
  s_add_u32 s44, s46, 61440
  buffer_load_dwordx4 v3, s[28:31], s44 offen offset:0 sc1 lds
  buffer_load_dwordx4 v3, s[28:31], s44 offen offset:1024 sc1 lds
  buffer_load_dwordx4 v3, s[28:31], s44 offen offset:2048 sc1 lds
  buffer_load_dwordx4 v3, s[28:31], s44 offen offset:3072 sc1 lds
  s_mov_b32 m0, 65536
  s_add_u32 s44, s46, 65536
  buffer_load_dwordx4 v3, s[28:31], s44 offen offset:0 sc1 lds
  buffer_load_dwordx4 v3, s[28:31], s44 offen offset:1024 sc1 lds
  buffer_load_dwordx4 v3, s[28:31], s44 offen offset:2048 sc1 lds
  buffer_load_dwordx4 v3, s[28:31], s44 offen offset:3072 sc1 lds
  s_mov_b32 m0, 69632
  s_add_u32 s44, s46, 69632
  buffer_load_dwordx4 v3, s[28:31], s44 offen offset:0 sc1 lds
  buffer_load_dwordx4 v3, s[28:31], s44 offen offset:1024 sc1 lds
  buffer_load_dwordx4 v3, s[28:31], s44 offen offset:2048 sc1 lds
  buffer_load_dwordx4 v3, s[28:31], s44 offen offset:3072 sc1 lds
  s_mov_b32 m0, 73728
  s_add_u32 s44, s46, 73728
  buffer_load_dwordx4 v3, s[28:31], s44 offen offset:0 sc1 lds
  buffer_load_dwordx4 v3, s[28:31], s44 offen offset:1024 sc1 lds
  buffer_load_dwordx4 v3, s[28:31], s44 offen offset:2048 sc1 lds
  buffer_load_dwordx4 v3, s[28:31], s44 offen offset:3072 sc1 lds
  s_mov_b32 m0, 77824
  s_add_u32 s44, s46, 77824
  buffer_load_dwordx4 v3, s[28:31], s44 offen offset:0 sc1 lds
  buffer_load_dwordx4 v3, s[28:31], s44 offen offset:1024 sc1 lds
  buffer_load_dwordx4 v3, s[28:31], s44 offen offset:2048 sc1 lds
  buffer_load_dwordx4 v3, s[28:31], s44 offen offset:3072 sc1 lds
  s_mov_b32 m0, 81920
  s_add_u32 s44, s46, 81920
  buffer_load_dwordx4 v3, s[28:31], s44 offen offset:0 sc1 lds
  buffer_load_dwordx4 v3, s[28:31], s44 offen offset:1024 sc1 lds
  buffer_load_dwordx4 v3, s[28:31], s44 offen offset:2048 sc1 lds
  buffer_load_dwordx4 v3, s[28:31], s44 offen offset:3072 sc1 lds
  s_mov_b32 m0, 86016
  s_add_u32 s44, s46, 86016
  buffer_load_dwordx4 v3, s[28:31], s44 offen offset:0 sc1 lds
  buffer_load_dwordx4 v3, s[28:31], s44 offen offset:1024 sc1 lds
  buffer_load_dwordx4 v3, s[28:31], s44 offen offset:2048 sc1 lds
  buffer_load_dwordx4 v3, s[28:31], s44 offen offset:3072 sc1 lds
  s_mov_b32 m0, 90112
  s_add_u32 s44, s46, 90112
  buffer_load_dwordx4 v3, s[28:31], s44 offen offset:0 sc1 lds
  buffer_load_dwordx4 v3, s[28:31], s44 offen offset:1024 sc1 lds
  buffer_load_dwordx4 v3, s[28:31], s44 offen offset:2048 sc1 lds
  buffer_load_dwordx4 v3, s[28:31], s44 offen offset:3072 sc1 lds
  s_mov_b32 m0, 94208
  s_add_u32 s44, s46, 94208
  buffer_load_dwordx4 v3, s[28:31], s44 offen offset:0 sc1 lds
  buffer_load_dwordx4 v3, s[28:31], s44 offen offset:1024 sc1 lds
  buffer_load_dwordx4 v3, s[28:31], s44 offen offset:2048 sc1 lds
  buffer_load_dwordx4 v3, s[28:31], s44 offen offset:3072 sc1 lds
  s_mov_b32 m0, 98304
  s_add_u32 s44, s46, 98304
  buffer_load_dwordx4 v3, s[28:31], s44 offen offset:0 sc1 lds
  buffer_load_dwordx4 v3, s[28:31], s44 offen offset:1024 sc1 lds
  buffer_load_dwordx4 v3, s[28:31], s44 offen offset:2048 sc1 lds
  buffer_load_dwordx4 v3, s[28:31], s44 offen offset:3072 sc1 lds
  s_mov_b32 m0, 102400
  s_add_u32 s44, s46, 102400
  buffer_load_dwordx4 v3, s[28:31], s44 offen offset:0 sc1 lds
  buffer_load_dwordx4 v3, s[28:31], s44 offen offset:1024 sc1 lds
  buffer_load_dwordx4 v3, s[28:31], s44 offen offset:2048 sc1 lds
  buffer_load_dwordx4 v3, s[28:31], s44 offen offset:3072 sc1 lds
  s_mov_b32 m0, 106496
  s_add_u32 s44, s46, 106496
  buffer_load_dwordx4 v3, s[28:31], s44 offen offset:0 sc1 lds
  buffer_load_dwordx4 v3, s[28:31], s44 offen offset:1024 sc1 lds
  buffer_load_dwordx4 v3, s[28:31], s44 offen offset:2048 sc1 lds
  buffer_load_dwordx4 v3, s[28:31], s44 offen offset:3072 sc1 lds
  s_cmp_ge_u32 s2, 144
  s_cbranch_scc1 L_lnd
  s_waitcnt vmcnt(63)
  s_sub_u32 s49, s100, 1536
  s_add_u32 s61, s88, 1
  v_mov_b32 v16, s61
  v_mov_b32 v17, s89
  s_mov_b64 exec, 1
  buffer_store_dwordx2 v[16:17], v10, s[28:31], s49 offen sc1
  s_mov_b64 exec, -1
  s_sub_u32 s49, s100, 1024
  s_add_u32 s61, s88, 1
  v_mov_b32 v16, s61
  v_mov_b32 v17, s89
  s_mov_b64 exec, 1
  buffer_store_dwordx2 v[16:17], v10, s[28:31], s49 offen sc1
  s_mov_b64 exec, -1
  s_sub_u32 s49, s100, 512
  s_add_u32 s61, s88, 1
  v_mov_b32 v16, s61
  v_mov_b32 v17, s89
  s_mov_b64 exec, 1
  buffer_store_dwordx2 v[16:17], v10, s[28:31], s49 offen sc1
  s_mov_b64 exec, -1
  s_sub_u32 s49, s100, 0
  s_add_u32 s61, s88, 1
  v_mov_b32 v16, s61
  v_mov_b32 v17, s89
  s_mov_b64 exec, 1
  buffer_store_dwordx2 v[16:17], v10, s[28:31], s49 offen sc1
  s_mov_b64 exec, -1
L_lnd:
  s_lshl_b32 s45, s35, 2
  s_add_u32 s45, s45, s39
  s_mul_i32 s46, s45, 297472
  s_add_u32 s46, s46, 27262976
  s_mul_i32 s47, s36, 9216
  s_add_u32 s47, s47, s46
  s_lshl_b32 s48, s35, 2
  s_add_u32 s48, s48, s32
  s_lshl_b32 s48, s48, 2
  s_add_u32 s48, s48, s39
  s_lshl_b32 s48, s48, 7
  s_add_u32 s48, s48, 83951616
  s_lshl_b32 s49, s35, 2
  s_add_u32 s49, s49, s34
  s_lshl_b32 s49, s49, 2
  s_add_u32 s49, s49, s39
  s_mul_i32 s50, s49, 73728
  s_add_u32 s50, s50, 50331648
  s_lshl_b32 s49, s49, 7
  s_add_u32 s49, s49, 83984384
  v_and_b32 v8, 3, v2
  v_lshlrev_b32 v8, 3, v8
  v_mov_b32 v10, 0
  s_lshl_b32 s51, s34, 3
  s_add_u32 s51, s51, s48
  s_lshl_b32 s52, s32, 3
  s_add_u32 s52, s52, s49
  v_lshlrev_b32 v9, 3, v2
  s_lshl_b32 s100, s36, 9
  s_add_u32 s100, s100, 83906560

  s_add_u32 s53, s34, 1
  s_and_b32 s53, s53, 3
  s_lshl_b32 s56, s32, 2
  s_add_u32 s53, s53, s56
  s_mul_i32 s53, s53, 9216
  s_add_u32 s53, s53, s46
  s_add_u32 s54, s34, 2
  s_and_b32 s54, s54, 3
  s_lshl_b32 s56, s32, 2
  s_add_u32 s54, s54, s56
  s_mul_i32 s54, s54, 9216
  s_add_u32 s54, s54, s46
  s_add_u32 s55, s34, 3
  s_and_b32 s55, s55, 3
  s_lshl_b32 s56, s32, 2
  s_add_u32 s55, s55, s56
  s_mul_i32 s55, s55, 9216
  s_add_u32 s55, s55, s46
  v_and_b32 v11, 15, v2
  v_mul_u32_u24 v11, 1152, v11
  v_lshrrev_b32 v12, 4, v2
  v_lshl_add_u32 v11, v12, 3, v11
  s_lshl_b32 s56, s35, 7
  s_lshl_b32 s57, s39, 5
  s_add_u32 s56, s56, s57
  s_mul_i32 s56, s56, 1152
  s_mul_i32 s57, s34, 288
  s_add_u32 s56, s56, s57
  s_add_u32 s57, s56, 24117248
  s_lshl_b32 s93, s32, 12
  s_add_u32 s93, s93, s50
  s_add_u32 s94, s93, 65536
  s_add_u32 s93, s93, 49152
  s_cmp_lt_u32 s32, 2
  s_cselect_b32 s94, s94, s93
  s_mov_b32 s95, 0
  v_mov_b32 v252, -1
  v_mov_b32 v253, -1
  v_mov_b32 v254, -1
  v_mov_b32 v255, -1

  s_lshl_b32 s92, s35, 2
  s_add_u32 s92, s92, s39
  s_lshl_b32 s92, s92, 7
  s_add_u32 s92, s92, 83914752
  v_and_b32 v12, 15, v2
  v_lshlrev_b32 v12, 3, v12

  buffer_load_dwordx2 v[224:225], v12, s[28:31], s92 offen offset:0 sc1
  s_waitcnt vmcnt(0)
  s_mov_b32 s58, 0
  s_add_u32 s59, s88, 1
  s_mov_b64 s[60:61], -1
  v_subrev_u32 v18, s59, v224
  v_cmp_gt_u32 vcc, 15, v18
  v_cmp_eq_u32 s[62:63], s89, v225
  s_nop 1
  s_and_b64 vcc, vcc, s[62:63]
  s_mov_b32 s62, 0xffff8888
  s_mov_b32 s63, 0xffffffff
  s_or_b64 vcc, vcc, s[62:63]
  s_and_b64 s[60:61], s[60:61], vcc
  s_cmp_eq_u64 s[60:61], -1
  s_cbranch_scc1 L_pf1_ok
  buffer_load_dwordx2 v[224:225], v12, s[28:31], s92 offen offset:0 sc1
  s_sleep 4
  buffer_load_dwordx2 v[226:227], v12, s[28:31], s92 offen offset:0 sc1
L_pf1_chk:
  s_waitcnt vmcnt(1)
  s_mov_b64 s[60:61], -1
  v_subrev_u32 v18, s59, v224
  v_cmp_gt_u32 vcc, 15, v18
  v_cmp_eq_u32 s[62:63], s89, v225
  s_nop 1
  s_and_b64 vcc, vcc, s[62:63]
  s_mov_b32 s62, 0xffff8888
  s_mov_b32 s63, 0xffffffff
  s_or_b64 vcc, vcc, s[62:63]
  s_and_b64 s[60:61], s[60:61], vcc
  s_cmp_eq_u64 s[60:61], -1
  s_cbranch_scc1 L_pf1_ok
  buffer_load_dwordx2 v[224:225], v12, s[28:31], s92 offen offset:0 sc1
  s_waitcnt vmcnt(1)
  s_mov_b64 s[60:61], -1
  v_subrev_u32 v18, s59, v226
  v_cmp_gt_u32 vcc, 15, v18
  v_cmp_eq_u32 s[62:63], s89, v227
  s_nop 1
  s_and_b64 vcc, vcc, s[62:63]
  s_mov_b32 s62, 0xffff8888
  s_mov_b32 s63, 0xffffffff
  s_or_b64 vcc, vcc, s[62:63]
  s_and_b64 s[60:61], s[60:61], vcc
  s_cmp_eq_u64 s[60:61], -1
  s_cbranch_scc1 L_pf1_ok
  buffer_load_dwordx2 v[226:227], v12, s[28:31], s92 offen offset:0 sc1
  s_add_u32 s58, s58, 1
  s_cmp_gt_u32 s58, 20000
  s_cbranch_scc0 L_pf1_chk
L_pf1_ok:
  s_lshl_b32 s92, s35, 3
  s_lshl_b32 s45, s39, 1
  s_add_u32 s92, s92, s45
  s_mul_i32 s92, s92, 36864
  s_add_u32 s92, s92, 4096

  s_add_u32 s45, s92, 0
  buffer_load_dwordx4 a[0:3], v3, s[28:31], s45 offen offset:0 sc1
  s_add_u32 s45, s92, 32768
  buffer_load_dwordx4 a[4:7], v3, s[28:31], s45 offen offset:2048 sc1
  s_add_u32 s45, s92, 0
  buffer_load_dwordx4 a[8:11], v3, s[28:31], s45 offen offset:1024 sc1
  s_add_u32 s45, s92, 32768
  buffer_load_dwordx4 a[12:15], v3, s[28:31], s45 offen offset:3072 sc1
  s_add_u32 s45, s92, 0
  buffer_load_dwordx4 a[16:19], v3, s[28:31], s45 offen offset:2048 sc1
  s_add_u32 s45, s92, 40960
  buffer_load_dwordx4 a[20:23], v3, s[28:31], s45 offen offset:0 sc1
  s_add_u32 s45, s92, 0
  buffer_load_dwordx4 a[24:27], v3, s[28:31], s45 offen offset:3072 sc1
  s_add_u32 s45, s92, 40960
  buffer_load_dwordx4 a[28:31], v3, s[28:31], s45 offen offset:1024 sc1
  s_add_u32 s45, s92, 8192
  buffer_load_dwordx4 a[32:35], v3, s[28:31], s45 offen offset:0 sc1
  s_add_u32 s45, s92, 40960
  buffer_load_dwordx4 a[36:39], v3, s[28:31], s45 offen offset:2048 sc1
  s_waitcnt vmcnt(10)
  s_barrier
  ds_read_b128 v[16:19], v4 offset:0
  ds_read_b128 v[20:23], v4 offset:1024
  ds_read_b128 v[24:27], v4 offset:2048
  ds_read_b128 v[28:31], v4 offset:3072
  ds_read_b128 v[32:35], v4 offset:4096
  ds_read_b128 v[36:39], v4 offset:5120
  ds_read_b128 v[40:43], v4 offset:6144
  ds_read_b128 v[44:47], v4 offset:7168
  ds_read_b128 v[48:51], v4 offset:8192
  ds_read_b128 v[52:55], v4 offset:9216
  ds_read_b128 v[56:59], v4 offset:10240
  ds_read_b128 v[60:63], v4 offset:11264
  ds_read_b128 v[64:67], v4 offset:12288
  s_waitcnt lgkmcnt(11)
  s_waitcnt vmcnt(8)
  v_mfma_f32_16x16x32_bf16 v[152:155], v[16:19], a[0:3], 0
  v_mfma_f32_16x16x32_bf16 v[156:159], v[16:19], a[4:7], 0
  s_add_u32 s45, s92, 8192
  buffer_load_dwordx4 a[40:43], v3, s[28:31], s45 offen offset:1024 sc1
  v_mfma_f32_16x16x32_bf16 v[160:163], v[20:23], a[0:3], 0
  ds_read_b128 v[68:71], v4 offset:13312
  v_mfma_f32_16x16x32_bf16 v[164:167], v[20:23], a[4:7], 0
  s_waitcnt lgkmcnt(10)
  v_mfma_f32_16x16x32_bf16 v[168:171], v[24:27], a[0:3], 0
  ds_read_b128 v[72:75], v4 offset:14336
  v_mfma_f32_16x16x32_bf16 v[172:175], v[24:27], a[4:7], 0
  s_add_u32 s45, s92, 40960
  buffer_load_dwordx4 a[44:47], v3, s[28:31], s45 offen offset:3072 sc1
  v_mfma_f32_16x16x32_bf16 v[176:179], v[28:31], a[0:3], 0
  ds_read_b128 v[76:79], v4 offset:15360
  v_mfma_f32_16x16x32_bf16 v[180:183], v[28:31], a[4:7], 0
  s_waitcnt lgkmcnt(10)
  v_mfma_f32_16x16x32_bf16 v[184:187], v[32:35], a[0:3], 0
  ds_read_b128 v[16:19], v4 offset:16384
  v_mfma_f32_16x16x32_bf16 v[188:191], v[32:35], a[4:7], 0
  s_add_u32 s45, s92, 8192
  buffer_load_dwordx4 a[48:51], v3, s[28:31], s45 offen offset:2048 sc1
  v_mfma_f32_16x16x32_bf16 v[192:195], v[36:39], a[0:3], 0
  ds_read_b128 v[20:23], v4 offset:17408
  v_mfma_f32_16x16x32_bf16 v[196:199], v[36:39], a[4:7], 0
  s_waitcnt lgkmcnt(10)
  s_waitcnt vmcnt(9)
  v_mfma_f32_16x16x32_bf16 v[152:155], v[40:43], a[8:11], v[152:155]
  ds_read_b128 v[24:27], v4 offset:18432
  v_mfma_f32_16x16x32_bf16 v[156:159], v[40:43], a[12:15], v[156:159]
  s_add_u32 s45, s92, 49152
  buffer_load_dwordx4 a[52:55], v3, s[28:31], s45 offen offset:0 sc1
  v_mfma_f32_16x16x32_bf16 v[160:163], v[44:47], a[8:11], v[160:163]
  ds_read_b128 v[28:31], v4 offset:19456
  v_mfma_f32_16x16x32_bf16 v[164:167], v[44:47], a[12:15], v[164:167]
  s_waitcnt lgkmcnt(10)
  v_mfma_f32_16x16x32_bf16 v[168:171], v[48:51], a[8:11], v[168:171]
  ds_read_b128 v[32:35], v4 offset:20480
  v_mfma_f32_16x16x32_bf16 v[172:175], v[48:51], a[12:15], v[172:175]
  s_add_u32 s45, s92, 8192
  buffer_load_dwordx4 a[56:59], v3, s[28:31], s45 offen offset:3072 sc1
  v_mfma_f32_16x16x32_bf16 v[176:179], v[52:55], a[8:11], v[176:179]
  ds_read_b128 v[36:39], v4 offset:21504
  v_mfma_f32_16x16x32_bf16 v[180:183], v[52:55], a[12:15], v[180:183]
  s_add_u32 s45, s92, 49152
  buffer_load_dwordx4 a[60:63], v3, s[28:31], s45 offen offset:1024 sc1
  s_waitcnt lgkmcnt(10)
  v_mfma_f32_16x16x32_bf16 v[184:187], v[56:59], a[8:11], v[184:187]
  ds_read_b128 v[40:43], v4 offset:22528
  v_mfma_f32_16x16x32_bf16 v[188:191], v[56:59], a[12:15], v[188:191]
  v_mfma_f32_16x16x32_bf16 v[192:195], v[60:63], a[8:11], v[192:195]
  ds_read_b128 v[44:47], v4 offset:23552
  v_mfma_f32_16x16x32_bf16 v[196:199], v[60:63], a[12:15], v[196:199]
  s_add_u32 s45, s92, 16384
  buffer_load_dwordx4 a[64:67], v3, s[28:31], s45 offen offset:0 sc1
  s_waitcnt lgkmcnt(10)
  s_waitcnt vmcnt(11)
  v_mfma_f32_16x16x32_bf16 v[152:155], v[64:67], a[16:19], v[152:155]
  ds_read_b128 v[48:51], v4 offset:24576
  v_mfma_f32_16x16x32_bf16 v[156:159], v[64:67], a[20:23], v[156:159]
  v_mfma_f32_16x16x32_bf16 v[160:163], v[68:71], a[16:19], v[160:163]
  ds_read_b128 v[52:55], v4 offset:25600
  v_mfma_f32_16x16x32_bf16 v[164:167], v[68:71], a[20:23], v[164:167]
  s_add_u32 s45, s92, 49152
  buffer_load_dwordx4 a[68:71], v3, s[28:31], s45 offen offset:2048 sc1
  s_waitcnt lgkmcnt(10)
  v_mfma_f32_16x16x32_bf16 v[168:171], v[72:75], a[16:19], v[168:171]
  ds_read_b128 v[56:59], v4 offset:26624
  v_mfma_f32_16x16x32_bf16 v[172:175], v[72:75], a[20:23], v[172:175]
  v_mfma_f32_16x16x32_bf16 v[176:179], v[76:79], a[16:19], v[176:179]
  ds_read_b128 v[60:63], v4 offset:27648
  v_mfma_f32_16x16x32_bf16 v[180:183], v[76:79], a[20:23], v[180:183]
  s_add_u32 s45, s92, 16384
  buffer_load_dwordx4 a[72:75], v3, s[28:31], s45 offen offset:1024 sc1
  s_waitcnt lgkmcnt(10)
  v_mfma_f32_16x16x32_bf16 v[184:187], v[16:19], a[16:19], v[184:187]
  ds_read_b128 v[64:67], v4 offset:28672
  v_mfma_f32_16x16x32_bf16 v[188:191], v[16:19], a[20:23], v[188:191]
  v_mfma_f32_16x16x32_bf16 v[192:195], v[20:23], a[16:19], v[192:195]
  ds_read_b128 v[68:71], v4 offset:29696
  v_mfma_f32_16x16x32_bf16 v[196:199], v[20:23], a[20:23], v[196:199]
  s_add_u32 s45, s92, 49152
  buffer_load_dwordx4 a[76:79], v3, s[28:31], s45 offen offset:3072 sc1
  s_waitcnt lgkmcnt(10)
  s_waitcnt vmcnt(12)
  v_mfma_f32_16x16x32_bf16 v[152:155], v[24:27], a[24:27], v[152:155]
  ds_read_b128 v[72:75], v4 offset:30720
  v_mfma_f32_16x16x32_bf16 v[156:159], v[24:27], a[28:31], v[156:159]
  s_add_u32 s45, s92, 16384
  buffer_load_dwordx4 a[80:83], v3, s[28:31], s45 offen offset:2048 sc1
  v_mfma_f32_16x16x32_bf16 v[160:163], v[28:31], a[24:27], v[160:163]
  ds_read_b128 v[76:79], v4 offset:31744
  v_mfma_f32_16x16x32_bf16 v[164:167], v[28:31], a[28:31], v[164:167]
  s_waitcnt lgkmcnt(10)
  v_mfma_f32_16x16x32_bf16 v[168:171], v[32:35], a[24:27], v[168:171]
  ds_read_b128 v[16:19], v4 offset:32768
  v_mfma_f32_16x16x32_bf16 v[172:175], v[32:35], a[28:31], v[172:175]
  s_add_u32 s45, s92, 57344
  buffer_load_dwordx4 a[84:87], v3, s[28:31], s45 offen offset:0 sc1
  v_mfma_f32_16x16x32_bf16 v[176:179], v[36:39], a[24:27], v[176:179]
  ds_read_b128 v[20:23], v4 offset:33792
  v_mfma_f32_16x16x32_bf16 v[180:183], v[36:39], a[28:31], v[180:183]
  s_waitcnt lgkmcnt(10)
  v_mfma_f32_16x16x32_bf16 v[184:187], v[40:43], a[24:27], v[184:187]
  ds_read_b128 v[24:27], v4 offset:34816
  v_mfma_f32_16x16x32_bf16 v[188:191], v[40:43], a[28:31], v[188:191]
  s_add_u32 s45, s92, 16384
  buffer_load_dwordx4 a[88:91], v3, s[28:31], s45 offen offset:3072 sc1
  v_mfma_f32_16x16x32_bf16 v[192:195], v[44:47], a[24:27], v[192:195]
  ds_read_b128 v[28:31], v4 offset:35840
  v_mfma_f32_16x16x32_bf16 v[196:199], v[44:47], a[28:31], v[196:199]
  s_waitcnt lgkmcnt(10)
  s_waitcnt vmcnt(13)
  v_mfma_f32_16x16x32_bf16 v[152:155], v[48:51], a[32:35], v[152:155]
  v_mfma_f32_16x16x32_bf16 v[156:159], v[48:51], a[36:39], v[156:159]
  s_add_u32 s45, s92, 57344
  buffer_load_dwordx4 a[92:95], v3, s[28:31], s45 offen offset:1024 sc1
  v_mfma_f32_16x16x32_bf16 v[160:163], v[52:55], a[32:35], v[160:163]
  v_mfma_f32_16x16x32_bf16 v[164:167], v[52:55], a[36:39], v[164:167]
  s_waitcnt lgkmcnt(8)
  v_mfma_f32_16x16x32_bf16 v[168:171], v[56:59], a[32:35], v[168:171]
  v_mfma_f32_16x16x32_bf16 v[172:175], v[56:59], a[36:39], v[172:175]
  s_add_u32 s45, s92, 24576
  buffer_load_dwordx4 a[96:99], v3, s[28:31], s45 offen offset:0 sc1
  v_mfma_f32_16x16x32_bf16 v[176:179], v[60:63], a[32:35], v[176:179]
  v_mfma_f32_16x16x32_bf16 v[180:183], v[60:63], a[36:39], v[180:183]
  s_add_u32 s45, s92, 57344
  buffer_load_dwordx4 a[100:103], v3, s[28:31], s45 offen offset:2048 sc1
  s_waitcnt lgkmcnt(6)
  v_mfma_f32_16x16x32_bf16 v[184:187], v[64:67], a[32:35], v[184:187]
  v_mfma_f32_16x16x32_bf16 v[188:191], v[64:67], a[36:39], v[188:191]
  v_mfma_f32_16x16x32_bf16 v[192:195], v[68:71], a[32:35], v[192:195]
  v_mfma_f32_16x16x32_bf16 v[196:199], v[68:71], a[36:39], v[196:199]
  s_add_u32 s45, s92, 24576
  buffer_load_dwordx4 a[104:107], v3, s[28:31], s45 offen offset:1024 sc1
  s_waitcnt lgkmcnt(0)
  s_waitcnt vmcnt(27)
  s_barrier
  s_waitcnt vmcnt(15)
  v_mfma_f32_16x16x32_bf16 v[152:155], v[72:75], a[40:43], v[152:155]
  ds_read_b128 v[32:35], v5 offset:0
  v_mfma_f32_16x16x32_bf16 v[156:159], v[72:75], a[44:47], v[156:159]
  ds_read_b128 v[36:39], v5 offset:1024
  v_mfma_f32_16x16x32_bf16 v[160:163], v[76:79], a[40:43], v[160:163]
  ds_read_b128 v[40:43], v5 offset:2048
  v_mfma_f32_16x16x32_bf16 v[164:167], v[76:79], a[44:47], v[164:167]
  s_add_u32 s45, s92, 57344
  buffer_load_dwordx4 a[108:111], v3, s[28:31], s45 offen offset:3072 sc1
  v_mfma_f32_16x16x32_bf16 v[168:171], v[16:19], a[40:43], v[168:171]
  ds_read_b128 v[44:47], v5 offset:3072
  v_mfma_f32_16x16x32_bf16 v[172:175], v[16:19], a[44:47], v[172:175]
  ds_read_b128 v[48:51], v5 offset:4096
  v_mfma_f32_16x16x32_bf16 v[176:179], v[20:23], a[40:43], v[176:179]
  ds_read_b128 v[52:55], v5 offset:5120
  v_mfma_f32_16x16x32_bf16 v[180:183], v[20:23], a[44:47], v[180:183]
  s_add_u32 s45, s92, 24576
  buffer_load_dwordx4 a[112:115], v3, s[28:31], s45 offen offset:2048 sc1
  v_mfma_f32_16x16x32_bf16 v[184:187], v[24:27], a[40:43], v[184:187]
  ds_read_b128 v[56:59], v5 offset:6144
  v_mfma_f32_16x16x32_bf16 v[188:191], v[24:27], a[44:47], v[188:191]
  ds_read_b128 v[60:63], v5 offset:7168
  v_mfma_f32_16x16x32_bf16 v[192:195], v[28:31], a[40:43], v[192:195]
  ds_read_b128 v[64:67], v5 offset:8192
  v_mfma_f32_16x16x32_bf16 v[196:199], v[28:31], a[44:47], v[196:199]
  s_add_u32 s45, s92, 65536
  buffer_load_dwordx4 a[116:119], v3, s[28:31], s45 offen offset:0 sc1
  s_waitcnt lgkmcnt(7)
  s_waitcnt vmcnt(16)
  v_mfma_f32_16x16x32_bf16 v[152:155], v[32:35], a[48:51], v[152:155]
  ds_read_b128 v[68:71], v5 offset:9216
  v_mfma_f32_16x16x32_bf16 v[156:159], v[32:35], a[52:55], v[156:159]
  s_add_u32 s45, s92, 24576
  buffer_load_dwordx4 a[120:123], v3, s[28:31], s45 offen offset:3072 sc1
  v_mfma_f32_16x16x32_bf16 v[160:163], v[36:39], a[48:51], v[160:163]
  ds_read_b128 v[72:75], v5 offset:10240
  v_mfma_f32_16x16x32_bf16 v[164:167], v[36:39], a[52:55], v[164:167]
  ds_read_b128 v[76:79], v5 offset:11264
  s_waitcnt lgkmcnt(8)
  v_mfma_f32_16x16x32_bf16 v[168:171], v[40:43], a[48:51], v[168:171]
  ds_read_b128 v[16:19], v5 offset:12288
  v_mfma_f32_16x16x32_bf16 v[172:175], v[40:43], a[52:55], v[172:175]
  s_add_u32 s45, s92, 65536
  buffer_load_dwordx4 a[124:127], v3, s[28:31], s45 offen offset:1024 sc1
  v_mfma_f32_16x16x32_bf16 v[176:179], v[44:47], a[48:51], v[176:179]
  ds_read_b128 v[20:23], v5 offset:13312
  v_mfma_f32_16x16x32_bf16 v[180:183], v[44:47], a[52:55], v[180:183]
  ds_read_b128 v[24:27], v5 offset:14336
  s_waitcnt lgkmcnt(9)
  v_mfma_f32_16x16x32_bf16 v[184:187], v[48:51], a[48:51], v[184:187]
  ds_read_b128 v[28:31], v5 offset:15360
  v_mfma_f32_16x16x32_bf16 v[188:191], v[48:51], a[52:55], v[188:191]
  s_add_u32 m0, s40, 110592
  s_add_u32 s44, s41, 110592
  buffer_load_dwordx4 v3, s[28:31], s44 offen offset:0 sc1 lds
  v_mfma_f32_16x16x32_bf16 v[192:195], v[52:55], a[48:51], v[192:195]
  ds_read_b128 v[32:35], v5 offset:16384
  v_mfma_f32_16x16x32_bf16 v[196:199], v[52:55], a[52:55], v[196:199]
  ds_read_b128 v[36:39], v5 offset:17408
  s_waitcnt lgkmcnt(10)
  s_waitcnt vmcnt(17)
  v_mfma_f32_16x16x32_bf16 v[152:155], v[56:59], a[56:59], v[152:155]
  ds_read_b128 v[40:43], v5 offset:18432
  v_mfma_f32_16x16x32_bf16 v[156:159], v[56:59], a[60:63], v[156:159]
  buffer_load_dwordx4 v3, s[28:31], s44 offen offset:1024 sc1 lds
  v_mfma_f32_16x16x32_bf16 v[160:163], v[60:63], a[56:59], v[160:163]
  ds_read_b128 v[44:47], v5 offset:19456
  v_mfma_f32_16x16x32_bf16 v[164:167], v[60:63], a[60:63], v[164:167]
  s_waitcnt lgkmcnt(10)
  v_mfma_f32_16x16x32_bf16 v[168:171], v[64:67], a[56:59], v[168:171]
  ds_read_b128 v[48:51], v5 offset:20480
  v_mfma_f32_16x16x32_bf16 v[172:175], v[64:67], a[60:63], v[172:175]
  v_mfma_f32_16x16x32_bf16 v[176:179], v[68:71], a[56:59], v[176:179]
  ds_read_b128 v[52:55], v5 offset:21504
  v_mfma_f32_16x16x32_bf16 v[180:183], v[68:71], a[60:63], v[180:183]
  buffer_load_dwordx4 v3, s[28:31], s44 offen offset:2048 sc1 lds
  s_waitcnt lgkmcnt(10)
  v_mfma_f32_16x16x32_bf16 v[184:187], v[72:75], a[56:59], v[184:187]
  ds_read_b128 v[56:59], v5 offset:22528
  v_mfma_f32_16x16x32_bf16 v[188:191], v[72:75], a[60:63], v[188:191]
  v_mfma_f32_16x16x32_bf16 v[192:195], v[76:79], a[56:59], v[192:195]
  ds_read_b128 v[60:63], v5 offset:23552
  v_mfma_f32_16x16x32_bf16 v[196:199], v[76:79], a[60:63], v[196:199]
  buffer_load_dwordx4 v3, s[28:31], s44 offen offset:3072 sc1 lds
  s_waitcnt lgkmcnt(10)
  s_waitcnt vmcnt(18)
  v_mfma_f32_16x16x32_bf16 v[152:155], v[16:19], a[64:67], v[152:155]
  ds_read_b128 v[64:67], v5 offset:24576
  v_mfma_f32_16x16x32_bf16 v[156:159], v[16:19], a[68:71], v[156:159]
  v_mfma_f32_16x16x32_bf16 v[160:163], v[20:23], a[64:67], v[160:163]
  ds_read_b128 v[68:71], v5 offset:25600
  v_mfma_f32_16x16x32_bf16 v[164:167], v[20:23], a[68:71], v[164:167]
  s_add_u32 m0, s40, 114688
  s_add_u32 s44, s41, 114688
  buffer_load_dwordx4 v3, s[28:31], s44 offen offset:0 sc1 lds
  s_waitcnt lgkmcnt(10)
  v_mfma_f32_16x16x32_bf16 v[168:171], v[24:27], a[64:67], v[168:171]
  ds_read_b128 v[72:75], v5 offset:26624
  v_mfma_f32_16x16x32_bf16 v[172:175], v[24:27], a[68:71], v[172:175]
  v_mfma_f32_16x16x32_bf16 v[176:179], v[28:31], a[64:67], v[176:179]
  ds_read_b128 v[76:79], v5 offset:27648
  v_mfma_f32_16x16x32_bf16 v[180:183], v[28:31], a[68:71], v[180:183]
  buffer_load_dwordx4 v3, s[28:31], s44 offen offset:1024 sc1 lds
  s_waitcnt lgkmcnt(10)
  v_mfma_f32_16x16x32_bf16 v[184:187], v[32:35], a[64:67], v[184:187]
  ds_read_b128 v[16:19], v5 offset:28672
  v_mfma_f32_16x16x32_bf16 v[188:191], v[32:35], a[68:71], v[188:191]
  v_mfma_f32_16x16x32_bf16 v[192:195], v[36:39], a[64:67], v[192:195]
  ds_read_b128 v[20:23], v5 offset:29696
  v_mfma_f32_16x16x32_bf16 v[196:199], v[36:39], a[68:71], v[196:199]
  s_waitcnt lgkmcnt(10)
  s_waitcnt vmcnt(18)
  v_mfma_f32_16x16x32_bf16 v[152:155], v[40:43], a[72:75], v[152:155]
  ds_read_b128 v[24:27], v5 offset:30720
  v_mfma_f32_16x16x32_bf16 v[156:159], v[40:43], a[76:79], v[156:159]
  buffer_load_dwordx4 v3, s[28:31], s44 offen offset:2048 sc1 lds
  v_mfma_f32_16x16x32_bf16 v[160:163], v[44:47], a[72:75], v[160:163]
  ds_read_b128 v[28:31], v5 offset:31744
  v_mfma_f32_16x16x32_bf16 v[164:167], v[44:47], a[76:79], v[164:167]
  s_waitcnt lgkmcnt(10)
  v_mfma_f32_16x16x32_bf16 v[168:171], v[48:51], a[72:75], v[168:171]
  ds_read_b128 v[32:35], v5 offset:32768
  v_mfma_f32_16x16x32_bf16 v[172:175], v[48:51], a[76:79], v[172:175]
  buffer_load_dwordx4 v3, s[28:31], s44 offen offset:3072 sc1 lds
  v_mfma_f32_16x16x32_bf16 v[176:179], v[52:55], a[72:75], v[176:179]
  ds_read_b128 v[36:39], v5 offset:33792
  v_mfma_f32_16x16x32_bf16 v[180:183], v[52:55], a[76:79], v[180:183]
  s_waitcnt lgkmcnt(10)
  v_mfma_f32_16x16x32_bf16 v[184:187], v[56:59], a[72:75], v[184:187]
  ds_read_b128 v[40:43], v5 offset:34816
  v_mfma_f32_16x16x32_bf16 v[188:191], v[56:59], a[76:79], v[188:191]
  s_add_u32 m0, s40, 118784
  s_add_u32 s44, s41, 118784
  buffer_load_dwordx4 v3, s[28:31], s44 offen offset:0 sc1 lds
  v_mfma_f32_16x16x32_bf16 v[192:195], v[60:63], a[72:75], v[192:195]
  ds_read_b128 v[44:47], v5 offset:35840
  v_mfma_f32_16x16x32_bf16 v[196:199], v[60:63], a[76:79], v[196:199]
  s_waitcnt lgkmcnt(10)
  s_waitcnt vmcnt(19)
  v_mfma_f32_16x16x32_bf16 v[152:155], v[64:67], a[80:83], v[152:155]
  v_mfma_f32_16x16x32_bf16 v[156:159], v[64:67], a[84:87], v[156:159]
  s_add_u32 s45, s92, 32768
  buffer_load_dwordx4 a[128:131], v3, s[28:31], s45 offen offset:0 sc1
  v_mfma_f32_16x16x32_bf16 v[160:163], v[68:71], a[80:83], v[160:163]
  v_mfma_f32_16x16x32_bf16 v[164:167], v[68:71], a[84:87], v[164:167]
  s_waitcnt lgkmcnt(8)
  v_mfma_f32_16x16x32_bf16 v[168:171], v[72:75], a[80:83], v[168:171]
  v_mfma_f32_16x16x32_bf16 v[172:175], v[72:75], a[84:87], v[172:175]
  v_mfma_f32_16x16x32_bf16 v[176:179], v[76:79], a[80:83], v[176:179]
  v_mfma_f32_16x16x32_bf16 v[180:183], v[76:79], a[84:87], v[180:183]
  s_add_u32 s45, s92, 65536
  buffer_load_dwordx4 a[132:135], v3, s[28:31], s45 offen offset:2048 sc1
  s_waitcnt lgkmcnt(6)
  v_mfma_f32_16x16x32_bf16 v[184:187], v[16:19], a[80:83], v[184:187]
  v_mfma_f32_16x16x32_bf16 v[188:191], v[16:19], a[84:87], v[188:191]
  v_mfma_f32_16x16x32_bf16 v[192:195], v[20:23], a[80:83], v[192:195]
  v_mfma_f32_16x16x32_bf16 v[196:199], v[20:23], a[84:87], v[196:199]
  s_add_u32 s45, s92, 32768
  buffer_load_dwordx4 a[136:139], v3, s[28:31], s45 offen offset:1024 sc1
  s_waitcnt lgkmcnt(0)
  s_waitcnt vmcnt(44)
  s_barrier
  s_waitcnt vmcnt(20)
  v_mfma_f32_16x16x32_bf16 v[152:155], v[24:27], a[88:91], v[152:155]
  ds_read_b128 v[48:51], v6 offset:0
  v_mfma_f32_16x16x32_bf16 v[156:159], v[24:27], a[92:95], v[156:159]
  ds_read_b128 v[52:55], v6 offset:1024
  v_mfma_f32_16x16x32_bf16 v[160:163], v[28:31], a[88:91], v[160:163]
  ds_read_b128 v[56:59], v6 offset:2048
  v_mfma_f32_16x16x32_bf16 v[164:167], v[28:31], a[92:95], v[164:167]
  s_add_u32 s45, s92, 65536
  buffer_load_dwordx4 a[140:143], v3, s[28:31], s45 offen offset:3072 sc1
  v_mfma_f32_16x16x32_bf16 v[168:171], v[32:35], a[88:91], v[168:171]
  ds_read_b128 v[60:63], v6 offset:3072
  v_mfma_f32_16x16x32_bf16 v[172:175], v[32:35], a[92:95], v[172:175]
  ds_read_b128 v[64:67], v6 offset:4096
  v_mfma_f32_16x16x32_bf16 v[176:179], v[36:39], a[88:91], v[176:179]
  ds_read_b128 v[68:71], v6 offset:5120
  v_mfma_f32_16x16x32_bf16 v[180:183], v[36:39], a[92:95], v[180:183]
  s_add_u32 m0, s40, 0
  s_add_u32 s44, s41, 147456
  buffer_load_dwordx4 v3, s[28:31], s44 offen offset:0 sc1 lds
  v_mfma_f32_16x16x32_bf16 v[184:187], v[40:43], a[88:91], v[184:187]
  ds_read_b128 v[72:75], v6 offset:6144
  v_mfma_f32_16x16x32_bf16 v[188:191], v[40:43], a[92:95], v[188:191]
  ds_read_b128 v[76:79], v6 offset:7168
  v_mfma_f32_16x16x32_bf16 v[192:195], v[44:47], a[88:91], v[192:195]
  ds_read_b128 v[16:19], v6 offset:8192
  v_mfma_f32_16x16x32_bf16 v[196:199], v[44:47], a[92:95], v[196:199]
  ds_read_b128 v[20:23], v6 offset:9216
  s_waitcnt lgkmcnt(8)
  s_waitcnt vmcnt(20)
  v_mfma_f32_16x16x32_bf16 v[152:155], v[48:51], a[96:99], v[152:155]
  ds_read_b128 v[24:27], v6 offset:10240
  v_mfma_f32_16x16x32_bf16 v[156:159], v[48:51], a[100:103], v[156:159]
  buffer_store_dwordx4 v[232:235], v249, s[28:31], s101 offen offset:0 sc1
  v_mfma_f32_16x16x32_bf16 v[160:163], v[52:55], a[96:99], v[160:163]
  ds_read_b128 v[28:31], v6 offset:11264
  v_mfma_f32_16x16x32_bf16 v[164:167], v[52:55], a[100:103], v[164:167]
  ds_read_b128 v[32:35], v6 offset:12288
  s_waitcnt lgkmcnt(9)
  v_mfma_f32_16x16x32_bf16 v[168:171], v[56:59], a[96:99], v[168:171]
  ds_read_b128 v[36:39], v6 offset:13312
  v_mfma_f32_16x16x32_bf16 v[172:175], v[56:59], a[100:103], v[172:175]
  buffer_load_dwordx4 v3, s[28:31], s44 offen offset:1024 sc1 lds
  v_mfma_f32_16x16x32_bf16 v[176:179], v[60:63], a[96:99], v[176:179]
  ds_read_b128 v[40:43], v6 offset:14336
  v_mfma_f32_16x16x32_bf16 v[180:183], v[60:63], a[100:103], v[180:183]
  ds_read_b128 v[44:47], v6 offset:15360
  s_waitcnt lgkmcnt(10)
  v_mfma_f32_16x16x32_bf16 v[184:187], v[64:67], a[96:99], v[184:187]
  ds_read_b128 v[48:51], v6 offset:16384
  v_mfma_f32_16x16x32_bf16 v[188:191], v[64:67], a[100:103], v[188:191]
  buffer_load_dwordx4 v3, s[28:31], s44 offen offset:2048 sc1 lds
  v_mfma_f32_16x16x32_bf16 v[192:195], v[68:71], a[96:99], v[192:195]
  ds_read_b128 v[52:55], v6 offset:17408
  v_mfma_f32_16x16x32_bf16 v[196:199], v[68:71], a[100:103], v[196:199]
  s_waitcnt lgkmcnt(10)
  s_waitcnt vmcnt(21)
  v_mfma_f32_16x16x32_bf16 v[152:155], v[72:75], a[104:107], v[152:155]
  ds_read_b128 v[56:59], v6 offset:18432
  v_mfma_f32_16x16x32_bf16 v[156:159], v[72:75], a[108:111], v[156:159]
  buffer_store_dwordx4 v[236:239], v249, s[28:31], s101 offen offset:128 sc1
  v_mfma_f32_16x16x32_bf16 v[160:163], v[76:79], a[104:107], v[160:163]
  ds_read_b128 v[60:63], v6 offset:19456
  v_mfma_f32_16x16x32_bf16 v[164:167], v[76:79], a[108:111], v[164:167]
  s_waitcnt lgkmcnt(10)
  v_mfma_f32_16x16x32_bf16 v[168:171], v[16:19], a[104:107], v[168:171]
  ds_read_b128 v[64:67], v6 offset:20480
  v_mfma_f32_16x16x32_bf16 v[172:175], v[16:19], a[108:111], v[172:175]
  v_mfma_f32_16x16x32_bf16 v[176:179], v[20:23], a[104:107], v[176:179]
  ds_read_b128 v[68:71], v6 offset:21504
  v_mfma_f32_16x16x32_bf16 v[180:183], v[20:23], a[108:111], v[180:183]
  buffer_load_dwordx4 v3, s[28:31], s44 offen offset:3072 sc1 lds
  s_waitcnt lgkmcnt(10)
  v_mfma_f32_16x16x32_bf16 v[184:187], v[24:27], a[104:107], v[184:187]
  ds_read_b128 v[72:75], v6 offset:22528
  v_mfma_f32_16x16x32_bf16 v[188:191], v[24:27], a[108:111], v[188:191]
  v_mfma_f32_16x16x32_bf16 v[192:195], v[28:31], a[104:107], v[192:195]
  ds_read_b128 v[76:79], v6 offset:23552
  v_mfma_f32_16x16x32_bf16 v[196:199], v[28:31], a[108:111], v[196:199]
  s_add_u32 m0, s40, 4096
  s_add_u32 s44, s41, 151552
  buffer_load_dwordx4 v3, s[28:31], s44 offen offset:0 sc1 lds
  s_waitcnt lgkmcnt(10)
  s_waitcnt vmcnt(22)
  v_mfma_f32_16x16x32_bf16 v[152:155], v[32:35], a[112:115], v[152:155]
  ds_read_b128 v[16:19], v6 offset:24576
  v_mfma_f32_16x16x32_bf16 v[156:159], v[32:35], a[116:119], v[156:159]
  v_mfma_f32_16x16x32_bf16 v[160:163], v[36:39], a[112:115], v[160:163]
  ds_read_b128 v[20:23], v6 offset:25600
  v_mfma_f32_16x16x32_bf16 v[164:167], v[36:39], a[116:119], v[164:167]
  buffer_load_dwordx4 v3, s[28:31], s44 offen offset:1024 sc1 lds
  s_waitcnt lgkmcnt(10)
  v_mfma_f32_16x16x32_bf16 v[168:171], v[40:43], a[112:115], v[168:171]
  ds_read_b128 v[24:27], v6 offset:26624
  v_mfma_f32_16x16x32_bf16 v[172:175], v[40:43], a[116:119], v[172:175]
  v_mfma_f32_16x16x32_bf16 v[176:179], v[44:47], a[112:115], v[176:179]
  ds_read_b128 v[28:31], v6 offset:27648
  v_mfma_f32_16x16x32_bf16 v[180:183], v[44:47], a[116:119], v[180:183]
  buffer_store_dwordx4 v[240:243], v249, s[28:31], s101 offen offset:256 sc1
  s_waitcnt lgkmcnt(10)
  v_mfma_f32_16x16x32_bf16 v[184:187], v[48:51], a[112:115], v[184:187]
  ds_read_b128 v[32:35], v6 offset:28672
  v_mfma_f32_16x16x32_bf16 v[188:191], v[48:51], a[116:119], v[188:191]
  v_mfma_f32_16x16x32_bf16 v[192:195], v[52:55], a[112:115], v[192:195]
  ds_read_b128 v[36:39], v6 offset:29696
  v_mfma_f32_16x16x32_bf16 v[196:199], v[52:55], a[116:119], v[196:199]
  s_waitcnt lgkmcnt(10)
  s_waitcnt vmcnt(22)
  v_mfma_f32_16x16x32_bf16 v[152:155], v[56:59], a[120:123], v[152:155]
  ds_read_b128 v[40:43], v6 offset:30720
  v_mfma_f32_16x16x32_bf16 v[156:159], v[56:59], a[124:127], v[156:159]
  buffer_load_dwordx4 v3, s[28:31], s44 offen offset:2048 sc1 lds
  v_mfma_f32_16x16x32_bf16 v[160:163], v[60:63], a[120:123], v[160:163]
  ds_read_b128 v[44:47], v6 offset:31744
  v_mfma_f32_16x16x32_bf16 v[164:167], v[60:63], a[124:127], v[164:167]
  s_waitcnt lgkmcnt(10)
  v_mfma_f32_16x16x32_bf16 v[168:171], v[64:67], a[120:123], v[168:171]
  ds_read_b128 v[48:51], v6 offset:32768
  v_mfma_f32_16x16x32_bf16 v[172:175], v[64:67], a[124:127], v[172:175]
  buffer_load_dwordx4 v3, s[28:31], s44 offen offset:3072 sc1 lds
  v_mfma_f32_16x16x32_bf16 v[176:179], v[68:71], a[120:123], v[176:179]
  ds_read_b128 v[52:55], v6 offset:33792
  v_mfma_f32_16x16x32_bf16 v[180:183], v[68:71], a[124:127], v[180:183]
  s_waitcnt lgkmcnt(10)
  v_mfma_f32_16x16x32_bf16 v[184:187], v[72:75], a[120:123], v[184:187]
  ds_read_b128 v[56:59], v6 offset:34816
  v_mfma_f32_16x16x32_bf16 v[188:191], v[72:75], a[124:127], v[188:191]
  s_add_u32 m0, s40, 8192
  s_add_u32 s44, s41, 155648
  buffer_load_dwordx4 v3, s[28:31], s44 offen offset:0 sc1 lds
  v_mfma_f32_16x16x32_bf16 v[192:195], v[76:79], a[120:123], v[192:195]
  ds_read_b128 v[60:63], v6 offset:35840
  v_mfma_f32_16x16x32_bf16 v[196:199], v[76:79], a[124:127], v[196:199]
  s_waitcnt lgkmcnt(10)
  s_waitcnt vmcnt(14)
  v_mfma_f32_16x16x32_bf16 v[152:155], v[16:19], a[128:131], v[152:155]
  v_mfma_f32_16x16x32_bf16 v[156:159], v[16:19], a[132:135], v[156:159]
  s_add_u32 m0, s40, 36864
  s_add_u32 s44, s41, 184320
  buffer_load_dwordx4 v3, s[28:31], s44 offen offset:0 sc1 lds
  v_mfma_f32_16x16x32_bf16 v[160:163], v[20:23], a[128:131], v[160:163]
  v_mfma_f32_16x16x32_bf16 v[164:167], v[20:23], a[132:135], v[164:167]
  s_waitcnt lgkmcnt(8)
  v_mfma_f32_16x16x32_bf16 v[168:171], v[24:27], a[128:131], v[168:171]
  v_mfma_f32_16x16x32_bf16 v[172:175], v[24:27], a[132:135], v[172:175]
  v_mfma_f32_16x16x32_bf16 v[176:179], v[28:31], a[128:131], v[176:179]
  v_mfma_f32_16x16x32_bf16 v[180:183], v[28:31], a[132:135], v[180:183]
  buffer_load_dwordx4 v3, s[28:31], s44 offen offset:1024 sc1 lds
  s_waitcnt lgkmcnt(6)
  v_mfma_f32_16x16x32_bf16 v[184:187], v[32:35], a[128:131], v[184:187]
  v_mfma_f32_16x16x32_bf16 v[188:191], v[32:35], a[132:135], v[188:191]
  v_mfma_f32_16x16x32_bf16 v[192:195], v[36:39], a[128:131], v[192:195]
  v_mfma_f32_16x16x32_bf16 v[196:199], v[36:39], a[132:135], v[196:199]
  buffer_load_dwordx2 v[12:13], v9, s[28:31], s100 offen offset:0 sc1
  s_waitcnt lgkmcnt(0)
  s_waitcnt vmcnt(19)
  s_barrier
  s_waitcnt vmcnt(15)
  v_mfma_f32_16x16x32_bf16 v[152:155], v[40:43], a[136:139], v[152:155]
  ds_read_b128 v[64:67], v7 offset:0
  v_mfma_f32_16x16x32_bf16 v[156:159], v[40:43], a[140:143], v[156:159]
  ds_read_b128 v[68:71], v7 offset:1024
  v_mfma_f32_16x16x32_bf16 v[160:163], v[44:47], a[136:139], v[160:163]
  ds_read_b128 v[72:75], v7 offset:2048
  v_mfma_f32_16x16x32_bf16 v[164:167], v[44:47], a[140:143], v[164:167]
  buffer_load_dwordx4 v3, s[28:31], s44 offen offset:2048 sc1 lds
  v_mfma_f32_16x16x32_bf16 v[168:171], v[48:51], a[136:139], v[168:171]
  ds_read_b128 v[76:79], v7 offset:3072
  v_mfma_f32_16x16x32_bf16 v[172:175], v[48:51], a[140:143], v[172:175]
  ds_read_b128 v[16:19], v7 offset:4096
  v_mfma_f32_16x16x32_bf16 v[176:179], v[52:55], a[136:139], v[176:179]
  ds_read_b128 v[20:23], v7 offset:5120
  v_mfma_f32_16x16x32_bf16 v[180:183], v[52:55], a[140:143], v[180:183]
  buffer_load_dwordx4 v3, s[28:31], s44 offen offset:3072 sc1 lds
  v_mfma_f32_16x16x32_bf16 v[184:187], v[56:59], a[136:139], v[184:187]
  ds_read_b128 v[24:27], v7 offset:6144
  v_mfma_f32_16x16x32_bf16 v[188:191], v[56:59], a[140:143], v[188:191]
  ds_read_b128 v[28:31], v7 offset:7168
  v_mfma_f32_16x16x32_bf16 v[192:195], v[60:63], a[136:139], v[192:195]
  ds_read_b128 v[32:35], v7 offset:8192
  v_mfma_f32_16x16x32_bf16 v[196:199], v[60:63], a[140:143], v[196:199]
  ds_read_b128 v[36:39], v7 offset:9216
  s_waitcnt lgkmcnt(8)
  v_mfma_f32_16x16x32_bf16 v[216:219], v[64:67], a[0:3], 0
  ds_read_b128 v[40:43], v7 offset:10240
  v_mfma_f32_16x16x32_bf16 v[220:223], v[64:67], a[4:7], 0
  s_add_u32 m0, s40, 40960
  s_add_u32 s44, s41, 188416
  buffer_load_dwordx4 v3, s[28:31], s44 offen offset:0 sc1 lds
  v_mfma_f32_16x16x32_bf16 v[224:227], v[68:71], a[0:3], 0
  ds_read_b128 v[44:47], v7 offset:11264
  v_cvt_pk_bf16_f32 v80, v152, v153
  v_mfma_f32_16x16x32_bf16 v[228:231], v[68:71], a[4:7], 0
  v_cvt_pk_bf16_f32 v81, v154, v155
  s_waitcnt lgkmcnt(8)
  v_mfma_f32_16x16x32_bf16 v[216:219], v[72:75], a[8:11], v[216:219]
  ds_read_b128 v[48:51], v7 offset:12288
  v_cvt_pk_bf16_f32 v82, v160, v161
  v_mfma_f32_16x16x32_bf16 v[220:223], v[72:75], a[12:15], v[220:223]
  v_cvt_pk_bf16_f32 v83, v162, v163
  buffer_load_dwordx4 v3, s[28:31], s44 offen offset:1024 sc1 lds
  v_mfma_f32_16x16x32_bf16 v[224:227], v[76:79], a[8:11], v[224:227]
  ds_read_b128 v[52:55], v7 offset:13312
  v_pk_max_i16 v80, v80, v10
  v_mfma_f32_16x16x32_bf16 v[228:231], v[76:79], a[12:15], v[228:231]
  v_pk_max_i16 v81, v81, v10
  s_waitcnt lgkmcnt(8)
  v_mfma_f32_16x16x32_bf16 v[216:219], v[16:19], a[16:19], v[216:219]
  ds_read_b128 v[56:59], v7 offset:14336
  v_pk_max_i16 v82, v82, v10
  v_mfma_f32_16x16x32_bf16 v[220:223], v[16:19], a[20:23], v[220:223]
  v_pk_max_i16 v83, v83, v10
  buffer_load_dwordx4 v3, s[28:31], s44 offen offset:2048 sc1 lds
  v_mfma_f32_16x16x32_bf16 v[224:227], v[20:23], a[16:19], v[224:227]
  ds_read_b128 v[60:63], v7 offset:15360
  v_cvt_pk_bf16_f32 v84, v156, v157
  v_mfma_f32_16x16x32_bf16 v[228:231], v[20:23], a[20:23], v[228:231]
  v_cvt_pk_bf16_f32 v85, v158, v159
  s_waitcnt lgkmcnt(8)
  v_mfma_f32_16x16x32_bf16 v[216:219], v[24:27], a[24:27], v[216:219]
  ds_read_b128 v[64:67], v7 offset:16384
  v_mfma_f32_16x16x32_bf16 v[220:223], v[24:27], a[28:31], v[220:223]
  s_add_u32 s45, s47, 0
  buffer_store_dwordx4 v[80:83], v3, s[28:31], s45 offen sc1
  v_cvt_pk_bf16_f32 v86, v164, v165
  v_cvt_pk_bf16_f32 v87, v166, v167
  v_mfma_f32_16x16x32_bf16 v[224:227], v[28:31], a[24:27], v[224:227]
  ds_read_b128 v[68:71], v7 offset:17408
  v_pk_max_i16 v84, v84, v10
  v_mfma_f32_16x16x32_bf16 v[228:231], v[28:31], a[28:31], v[228:231]
  v_pk_max_i16 v85, v85, v10
  s_waitcnt lgkmcnt(8)
  v_mfma_f32_16x16x32_bf16 v[216:219], v[32:35], a[32:35], v[216:219]
  ds_read_b128 v[72:75], v7 offset:18432
  v_pk_max_i16 v86, v86, v10
  v_mfma_f32_16x16x32_bf16 v[220:223], v[32:35], a[36:39], v[220:223]
  v_pk_max_i16 v87, v87, v10
  v_mfma_f32_16x16x32_bf16 v[224:227], v[36:39], a[32:35], v[224:227]
  ds_read_b128 v[76:79], v7 offset:19456
  v_cvt_pk_bf16_f32 v88, v168, v169
  v_mfma_f32_16x16x32_bf16 v[228:231], v[36:39], a[36:39], v[228:231]
  v_cvt_pk_bf16_f32 v89, v170, v171
  buffer_load_dwordx4 v3, s[28:31], s44 offen offset:3072 sc1 lds
  s_waitcnt lgkmcnt(8)
  v_mfma_f32_16x16x32_bf16 v[216:219], v[40:43], a[40:43], v[216:219]
  ds_read_b128 v[16:19], v7 offset:20480
  v_cvt_pk_bf16_f32 v90, v176, v177
  v_mfma_f32_16x16x32_bf16 v[220:223], v[40:43], a[44:47], v[220:223]
  v_cvt_pk_bf16_f32 v91, v178, v179
  v_mfma_f32_16x16x32_bf16 v[224:227], v[44:47], a[40:43], v[224:227]
  ds_read_b128 v[20:23], v7 offset:21504
  v_pk_max_i16 v88, v88, v10
  v_mfma_f32_16x16x32_bf16 v[228:231], v[44:47], a[44:47], v[228:231]
  v_pk_max_i16 v89, v89, v10
  s_add_u32 m0, s40, 45056
  s_add_u32 s44, s41, 192512
  buffer_load_dwordx4 v3, s[28:31], s44 offen offset:0 sc1 lds
  s_waitcnt lgkmcnt(8)
  v_mfma_f32_16x16x32_bf16 v[216:219], v[48:51], a[48:51], v[216:219]
  ds_read_b128 v[24:27], v7 offset:22528
  v_pk_max_i16 v90, v90, v10
  v_mfma_f32_16x16x32_bf16 v[220:223], v[48:51], a[52:55], v[220:223]
  v_pk_max_i16 v91, v91, v10
  v_mfma_f32_16x16x32_bf16 v[224:227], v[52:55], a[48:51], v[224:227]
  ds_read_b128 v[28:31], v7 offset:23552
  v_mfma_f32_16x16x32_bf16 v[228:231], v[52:55], a[52:55], v[228:231]
  s_add_u32 s45, s47, 148736
  buffer_store_dwordx4 v[84:87], v3, s[28:31], s45 offen sc1
  v_cvt_pk_bf16_f32 v92, v172, v173
  v_cvt_pk_bf16_f32 v93, v174, v175
  s_waitcnt lgkmcnt(8)
  v_mfma_f32_16x16x32_bf16 v[216:219], v[56:59], a[56:59], v[216:219]
  ds_read_b128 v[32:35], v7 offset:24576
  v_cvt_pk_bf16_f32 v94, v180, v181
  v_mfma_f32_16x16x32_bf16 v[220:223], v[56:59], a[60:63], v[220:223]
  v_cvt_pk_bf16_f32 v95, v182, v183
  v_mfma_f32_16x16x32_bf16 v[224:227], v[60:63], a[56:59], v[224:227]
  ds_read_b128 v[36:39], v7 offset:25600
  v_pk_max_i16 v92, v92, v10
  v_mfma_f32_16x16x32_bf16 v[228:231], v[60:63], a[60:63], v[228:231]
  v_pk_max_i16 v93, v93, v10
  s_add_u32 m0, s40, 73728
  s_add_u32 s44, s41, 221184
  buffer_load_dwordx4 v3, s[28:31], s44 offen offset:0 sc1 lds
  s_waitcnt lgkmcnt(8)
  v_mfma_f32_16x16x32_bf16 v[216:219], v[64:67], a[64:67], v[216:219]
  ds_read_b128 v[40:43], v7 offset:26624
  v_pk_max_i16 v94, v94, v10
  v_mfma_f32_16x16x32_bf16 v[220:223], v[64:67], a[68:71], v[220:223]
  v_pk_max_i16 v95, v95, v10
  v_mfma_f32_16x16x32_bf16 v[224:227], v[68:71], a[64:67], v[224:227]
  ds_read_b128 v[44:47], v7 offset:27648
  v_cvt_pk_bf16_f32 v96, v184, v185
  v_mfma_f32_16x16x32_bf16 v[228:231], v[68:71], a[68:71], v[228:231]
  v_cvt_pk_bf16_f32 v97, v186, v187
  s_waitcnt lgkmcnt(8)
  v_mfma_f32_16x16x32_bf16 v[216:219], v[72:75], a[72:75], v[216:219]
  ds_read_b128 v[48:51], v7 offset:28672
  v_cvt_pk_bf16_f32 v98, v192, v193
  v_mfma_f32_16x16x32_bf16 v[220:223], v[72:75], a[76:79], v[220:223]
  v_cvt_pk_bf16_f32 v99, v194, v195
  buffer_load_dwordx4 v3, s[28:31], s44 offen offset:1024 sc1 lds
  v_mfma_f32_16x16x32_bf16 v[224:227], v[76:79], a[72:75], v[224:227]
  ds_read_b128 v[52:55], v7 offset:29696
  v_pk_max_i16 v96, v96, v10
  v_mfma_f32_16x16x32_bf16 v[228:231], v[76:79], a[76:79], v[228:231]
  v_pk_max_i16 v97, v97, v10
  s_waitcnt lgkmcnt(8)
  v_mfma_f32_16x16x32_bf16 v[216:219], v[16:19], a[80:83], v[216:219]
  ds_read_b128 v[56:59], v7 offset:30720
  v_mfma_f32_16x16x32_bf16 v[220:223], v[16:19], a[84:87], v[220:223]
  s_add_u32 s45, s47, 1024
  buffer_store_dwordx4 v[88:91], v3, s[28:31], s45 offen sc1
  v_pk_max_i16 v98, v98, v10
  v_pk_max_i16 v99, v99, v10
  v_mfma_f32_16x16x32_bf16 v[224:227], v[20:23], a[80:83], v[224:227]
  ds_read_b128 v[60:63], v7 offset:31744
  v_cvt_pk_bf16_f32 v100, v188, v189
  v_mfma_f32_16x16x32_bf16 v[228:231], v[20:23], a[84:87], v[228:231]
  v_cvt_pk_bf16_f32 v101, v190, v191
  s_waitcnt lgkmcnt(8)
  v_mfma_f32_16x16x32_bf16 v[216:219], v[24:27], a[88:91], v[216:219]
  ds_read_b128 v[64:67], v7 offset:32768
  v_cvt_pk_bf16_f32 v102, v196, v197
  v_mfma_f32_16x16x32_bf16 v[220:223], v[24:27], a[92:95], v[220:223]
  v_cvt_pk_bf16_f32 v103, v198, v199
  buffer_load_dwordx4 v3, s[28:31], s44 offen offset:2048 sc1 lds
  v_mfma_f32_16x16x32_bf16 v[224:227], v[28:31], a[88:91], v[224:227]
  ds_read_b128 v[68:71], v7 offset:33792
  v_mfma_f32_16x16x32_bf16 v[228:231], v[28:31], a[92:95], v[228:231]
  s_waitcnt vmcnt(13)
  s_mov_b32 s58, 0
  s_add_u32 s59, s88, 1
L_pw2_chk:
  s_mov_b64 s[60:61], -1
  v_subrev_u32 v14, s59, v12
  v_cmp_gt_u32 vcc, 15, v14
  v_cmp_eq_u32 s[62:63], s89, v13
  s_nop 1
  s_and_b64 vcc, vcc, s[62:63]
  s_mov_b32 s62, 0x0
  s_mov_b32 s63, 0xfffffff0
  s_or_b64 vcc, vcc, s[62:63]
  s_and_b64 s[60:61], s[60:61], vcc
  s_cmp_eq_u64 s[60:61], -1
  s_cbranch_scc1 L_pw2_ok
  s_add_u32 s58, s58, 1
  s_cmp_gt_u32 s58, 20000
  s_cbranch_scc1 L_pw2_ok
  buffer_load_dwordx2 v[12:13], v9, s[28:31], s100 offen offset:0 sc1
  s_waitcnt vmcnt(0)
  s_branch L_pw2_chk
L_pw2_ok:
  v_pk_max_i16 v100, v100, v10
  v_pk_max_i16 v101, v101, v10
  s_waitcnt lgkmcnt(8)
  v_mfma_f32_16x16x32_bf16 v[216:219], v[32:35], a[96:99], v[216:219]
  ds_read_b128 v[72:75], v7 offset:34816
  v_pk_max_i16 v102, v102, v10
  v_mfma_f32_16x16x32_bf16 v[220:223], v[32:35], a[100:103], v[220:223]
  v_pk_max_i16 v103, v103, v10
  buffer_load_dwordx4 v3, s[28:31], s44 offen offset:3072 sc1 lds
  v_mfma_f32_16x16x32_bf16 v[224:227], v[36:39], a[96:99], v[224:227]
  ds_read_b128 v[76:79], v7 offset:35840
  v_mfma_f32_16x16x32_bf16 v[228:231], v[36:39], a[100:103], v[228:231]
  s_waitcnt lgkmcnt(8)
  v_mfma_f32_16x16x32_bf16 v[216:219], v[40:43], a[104:107], v[216:219]
  v_mfma_f32_16x16x32_bf16 v[220:223], v[40:43], a[108:111], v[220:223]
  v_mfma_f32_16x16x32_bf16 v[224:227], v[44:47], a[104:107], v[224:227]
  v_mfma_f32_16x16x32_bf16 v[228:231], v[44:47], a[108:111], v[228:231]
  s_add_u32 s45, s47, 149760
  buffer_store_dwordx4 v[92:95], v3, s[28:31], s45 offen sc1
  s_waitcnt lgkmcnt(6)
  v_mfma_f32_16x16x32_bf16 v[216:219], v[48:51], a[112:115], v[216:219]
  v_mfma_f32_16x16x32_bf16 v[220:223], v[48:51], a[116:119], v[220:223]
  v_mfma_f32_16x16x32_bf16 v[224:227], v[52:55], a[112:115], v[224:227]
  v_mfma_f32_16x16x32_bf16 v[228:231], v[52:55], a[116:119], v[228:231]
  s_add_u32 m0, s40, 77824
  s_add_u32 s44, s41, 225280
  buffer_load_dwordx4 v3, s[28:31], s44 offen offset:0 sc1 lds
  s_waitcnt lgkmcnt(0)
  s_waitcnt vmcnt(19)
  s_barrier
  v_mfma_f32_16x16x32_bf16 v[216:219], v[56:59], a[120:123], v[216:219]
  ds_read_b128 v[16:19], v4 offset:0
  v_mfma_f32_16x16x32_bf16 v[220:223], v[56:59], a[124:127], v[220:223]
  ds_read_b128 v[20:23], v4 offset:1024
  v_mfma_f32_16x16x32_bf16 v[224:227], v[60:63], a[120:123], v[224:227]
  ds_read_b128 v[24:27], v4 offset:2048
  v_mfma_f32_16x16x32_bf16 v[228:231], v[60:63], a[124:127], v[228:231]
  buffer_load_dwordx4 v3, s[28:31], s44 offen offset:1024 sc1 lds
  v_mfma_f32_16x16x32_bf16 v[216:219], v[64:67], a[128:131], v[216:219]
  ds_read_b128 v[28:31], v4 offset:3072
  v_mfma_f32_16x16x32_bf16 v[220:223], v[64:67], a[132:135], v[220:223]
  ds_read_b128 v[32:35], v4 offset:4096
  v_mfma_f32_16x16x32_bf16 v[224:227], v[68:71], a[128:131], v[224:227]
  ds_read_b128 v[36:39], v4 offset:5120
  v_mfma_f32_16x16x32_bf16 v[228:231], v[68:71], a[132:135], v[228:231]
  s_add_u32 s45, s47, 2048
  buffer_store_dwordx4 v[96:99], v3, s[28:31], s45 offen sc1
  v_mfma_f32_16x16x32_bf16 v[216:219], v[72:75], a[136:139], v[216:219]
  ds_read_b128 v[40:43], v4 offset:6144
  v_mfma_f32_16x16x32_bf16 v[220:223], v[72:75], a[140:143], v[220:223]
  ds_read_b128 v[44:47], v4 offset:7168
  v_mfma_f32_16x16x32_bf16 v[224:227], v[76:79], a[136:139], v[224:227]
  ds_read_b128 v[48:51], v4 offset:8192
  v_mfma_f32_16x16x32_bf16 v[228:231], v[76:79], a[140:143], v[228:231]
  ds_read_b128 v[52:55], v4 offset:9216
  s_waitcnt lgkmcnt(8)
  v_mfma_f32_16x16x32_bf16 v[200:203], v[16:19], a[0:3], 0
  ds_read_b128 v[56:59], v4 offset:10240
  v_mfma_f32_16x16x32_bf16 v[204:207], v[16:19], a[4:7], 0
  buffer_load_dwordx4 v3, s[28:31], s44 offen offset:2048 sc1 lds
  v_mfma_f32_16x16x32_bf16 v[208:211], v[20:23], a[0:3], 0
  ds_read_b128 v[60:63], v4 offset:11264
  v_cvt_pk_bf16_f32 v104, v216, v217
  v_mfma_f32_16x16x32_bf16 v[212:215], v[20:23], a[4:7], 0
  v_cvt_pk_bf16_f32 v105, v218, v219
  s_waitcnt lgkmcnt(8)
  v_mfma_f32_16x16x32_bf16 v[200:203], v[24:27], a[8:11], v[200:203]
  ds_read_b128 v[64:67], v4 offset:12288
  v_cvt_pk_bf16_f32 v106, v224, v225
  v_mfma_f32_16x16x32_bf16 v[204:207], v[24:27], a[12:15], v[204:207]
  v_cvt_pk_bf16_f32 v107, v226, v227
  buffer_load_dwordx4 v3, s[28:31], s44 offen offset:3072 sc1 lds
  v_mfma_f32_16x16x32_bf16 v[208:211], v[28:31], a[8:11], v[208:211]
  ds_read_b128 v[68:71], v4 offset:13312
  v_pk_max_i16 v104, v104, v10
  v_mfma_f32_16x16x32_bf16 v[212:215], v[28:31], a[12:15], v[212:215]
  v_pk_max_i16 v105, v105, v10
  s_waitcnt lgkmcnt(8)
  v_mfma_f32_16x16x32_bf16 v[200:203], v[32:35], a[16:19], v[200:203]
  ds_read_b128 v[72:75], v4 offset:14336
  v_mfma_f32_16x16x32_bf16 v[204:207], v[32:35], a[20:23], v[204:207]
  s_add_u32 s45, s47, 150784
  buffer_store_dwordx4 v[100:103], v3, s[28:31], s45 offen sc1
  v_pk_max_i16 v106, v106, v10
  v_pk_max_i16 v107, v107, v10
  v_mfma_f32_16x16x32_bf16 v[208:211], v[36:39], a[16:19], v[208:211]
  ds_read_b128 v[76:79], v4 offset:15360
  v_cvt_pk_bf16_f32 v108, v220, v221
  v_mfma_f32_16x16x32_bf16 v[212:215], v[36:39], a[20:23], v[212:215]
  v_cvt_pk_bf16_f32 v109, v222, v223
  s_waitcnt lgkmcnt(8)
  v_mfma_f32_16x16x32_bf16 v[200:203], v[40:43], a[24:27], v[200:203]
  ds_read_b128 v[16:19], v4 offset:16384
  v_cvt_pk_bf16_f32 v110, v228, v229
  v_mfma_f32_16x16x32_bf16 v[204:207], v[40:43], a[28:31], v[204:207]
  v_cvt_pk_bf16_f32 v111, v230, v231
  s_add_u32 m0, s40, 81920
  s_add_u32 s44, s41, 229376
  buffer_load_dwordx4 v3, s[28:31], s44 offen offset:0 sc1 lds
  v_mfma_f32_16x16x32_bf16 v[208:211], v[44:47], a[24:27], v[208:211]
  ds_read_b128 v[20:23], v4 offset:17408
  v_pk_max_i16 v108, v108, v10
  v_mfma_f32_16x16x32_bf16 v[212:215], v[44:47], a[28:31], v[212:215]
  v_pk_max_i16 v109, v109, v10
  s_waitcnt lgkmcnt(8)
  v_mfma_f32_16x16x32_bf16 v[200:203], v[48:51], a[32:35], v[200:203]
  ds_read_b128 v[24:27], v4 offset:18432
  v_pk_max_i16 v110, v110, v10
  v_mfma_f32_16x16x32_bf16 v[204:207], v[48:51], a[36:39], v[204:207]
  v_pk_max_i16 v111, v111, v10
  v_mfma_f32_16x16x32_bf16 v[208:211], v[52:55], a[32:35], v[208:211]
  ds_read_b128 v[28:31], v4 offset:19456
  v_mfma_f32_16x16x32_bf16 v[212:215], v[52:55], a[36:39], v[212:215]
  s_add_u32 m0, s40, 110592
  s_add_u32 s44, s41, 258048
  buffer_load_dwordx4 v3, s[28:31], s44 offen offset:0 sc1 lds
  s_waitcnt lgkmcnt(8)
  v_mfma_f32_16x16x32_bf16 v[200:203], v[56:59], a[40:43], v[200:203]
  ds_read_b128 v[32:35], v4 offset:20480
  v_mfma_f32_16x16x32_bf16 v[204:207], v[56:59], a[44:47], v[204:207]
  ds_read_b128 v[36:39], v4 offset:21504
  v_mfma_f32_16x16x32_bf16 v[208:211], v[60:63], a[40:43], v[208:211]
  ds_read_b128 v[40:43], v4 offset:22528
  v_mfma_f32_16x16x32_bf16 v[212:215], v[60:63], a[44:47], v[212:215]
  buffer_load_dwordx4 v3, s[28:31], s44 offen offset:1024 sc1 lds
  s_waitcnt lgkmcnt(9)
  v_mfma_f32_16x16x32_bf16 v[200:203], v[64:67], a[48:51], v[200:203]
  ds_read_b128 v[44:47], v4 offset:23552
  v_mfma_f32_16x16x32_bf16 v[204:207], v[64:67], a[52:55], v[204:207]
  ds_read_b128 v[48:51], v4 offset:24576
  v_mfma_f32_16x16x32_bf16 v[208:211], v[68:71], a[48:51], v[208:211]
  ds_read_b128 v[52:55], v4 offset:25600
  v_mfma_f32_16x16x32_bf16 v[212:215], v[68:71], a[52:55], v[212:215]
  buffer_load_dwordx4 v3, s[28:31], s44 offen offset:2048 sc1 lds
  s_waitcnt lgkmcnt(10)
  v_mfma_f32_16x16x32_bf16 v[200:203], v[72:75], a[56:59], v[200:203]
  ds_read_b128 v[56:59], v4 offset:26624
  v_mfma_f32_16x16x32_bf16 v[204:207], v[72:75], a[60:63], v[204:207]
  v_mfma_f32_16x16x32_bf16 v[208:211], v[76:79], a[56:59], v[208:211]
  ds_read_b128 v[60:63], v4 offset:27648
  v_mfma_f32_16x16x32_bf16 v[212:215], v[76:79], a[60:63], v[212:215]
  s_add_u32 s45, s47, 3072
  buffer_store_dwordx4 v[104:107], v3, s[28:31], s45 offen sc1
  s_waitcnt lgkmcnt(10)
  v_mfma_f32_16x16x32_bf16 v[200:203], v[16:19], a[64:67], v[200:203]
  ds_read_b128 v[64:67], v4 offset:28672
  v_mfma_f32_16x16x32_bf16 v[204:207], v[16:19], a[68:71], v[204:207]
  v_mfma_f32_16x16x32_bf16 v[208:211], v[20:23], a[64:67], v[208:211]
  ds_read_b128 v[68:71], v4 offset:29696
  v_mfma_f32_16x16x32_bf16 v[212:215], v[20:23], a[68:71], v[212:215]
  s_waitcnt lgkmcnt(10)
  v_mfma_f32_16x16x32_bf16 v[200:203], v[24:27], a[72:75], v[200:203]
  ds_read_b128 v[72:75], v4 offset:30720
  v_mfma_f32_16x16x32_bf16 v[204:207], v[24:27], a[76:79], v[204:207]
  buffer_load_dwordx4 v3, s[28:31], s44 offen offset:3072 sc1 lds
  v_mfma_f32_16x16x32_bf16 v[208:211], v[28:31], a[72:75], v[208:211]
  ds_read_b128 v[76:79], v4 offset:31744
  v_mfma_f32_16x16x32_bf16 v[212:215], v[28:31], a[76:79], v[212:215]
  s_waitcnt lgkmcnt(10)
  v_mfma_f32_16x16x32_bf16 v[200:203], v[32:35], a[80:83], v[200:203]
  ds_read_b128 v[16:19], v4 offset:32768
  v_mfma_f32_16x16x32_bf16 v[204:207], v[32:35], a[84:87], v[204:207]
  s_add_u32 m0, s40, 114688
  s_add_u32 s44, s41, 262144
  buffer_load_dwordx4 v3, s[28:31], s44 offen offset:0 sc1 lds
  v_mfma_f32_16x16x32_bf16 v[208:211], v[36:39], a[80:83], v[208:211]
  ds_read_b128 v[20:23], v4 offset:33792
  v_mfma_f32_16x16x32_bf16 v[212:215], v[36:39], a[84:87], v[212:215]
  s_waitcnt lgkmcnt(10)
  v_mfma_f32_16x16x32_bf16 v[200:203], v[40:43], a[88:91], v[200:203]
  ds_read_b128 v[24:27], v4 offset:34816
  v_mfma_f32_16x16x32_bf16 v[204:207], v[40:43], a[92:95], v[204:207]
  buffer_load_dwordx4 v3, s[28:31], s44 offen offset:1024 sc1 lds
  v_mfma_f32_16x16x32_bf16 v[208:211], v[44:47], a[88:91], v[208:211]
  ds_read_b128 v[28:31], v4 offset:35840
  v_mfma_f32_16x16x32_bf16 v[212:215], v[44:47], a[92:95], v[212:215]
  s_waitcnt lgkmcnt(10)
  v_mfma_f32_16x16x32_bf16 v[200:203], v[48:51], a[96:99], v[200:203]
  v_mfma_f32_16x16x32_bf16 v[204:207], v[48:51], a[100:103], v[204:207]
  buffer_load_dwordx4 v3, s[28:31], s44 offen offset:2048 sc1 lds
  v_mfma_f32_16x16x32_bf16 v[208:211], v[52:55], a[96:99], v[208:211]
  v_mfma_f32_16x16x32_bf16 v[212:215], v[52:55], a[100:103], v[212:215]
  s_waitcnt lgkmcnt(8)
  v_mfma_f32_16x16x32_bf16 v[200:203], v[56:59], a[104:107], v[200:203]
  v_mfma_f32_16x16x32_bf16 v[204:207], v[56:59], a[108:111], v[204:207]
  v_mfma_f32_16x16x32_bf16 v[208:211], v[60:63], a[104:107], v[208:211]
  v_mfma_f32_16x16x32_bf16 v[212:215], v[60:63], a[108:111], v[212:215]
  s_add_u32 s45, s47, 151808
  buffer_store_dwordx4 v[108:111], v3, s[28:31], s45 offen sc1
  s_waitcnt lgkmcnt(6)
  v_mfma_f32_16x16x32_bf16 v[200:203], v[64:67], a[112:115], v[200:203]
  v_mfma_f32_16x16x32_bf16 v[204:207], v[64:67], a[116:119], v[204:207]
  v_mfma_f32_16x16x32_bf16 v[208:211], v[68:71], a[112:115], v[208:211]
  v_mfma_f32_16x16x32_bf16 v[212:215], v[68:71], a[116:119], v[212:215]
  buffer_load_dwordx4 v3, s[28:31], s44 offen offset:3072 sc1 lds
  s_waitcnt lgkmcnt(0)
  s_waitcnt vmcnt(24)
  s_barrier
  v_mfma_f32_16x16x32_bf16 v[200:203], v[72:75], a[120:123], v[200:203]
  ds_read_b128 v[32:35], v5 offset:0
  v_mfma_f32_16x16x32_bf16 v[204:207], v[72:75], a[124:127], v[204:207]
  ds_read_b128 v[36:39], v5 offset:1024
  v_mfma_f32_16x16x32_bf16 v[208:211], v[76:79], a[120:123], v[208:211]
  ds_read_b128 v[40:43], v5 offset:2048
  v_mfma_f32_16x16x32_bf16 v[212:215], v[76:79], a[124:127], v[212:215]
  s_add_u32 m0, s40, 118784
  s_add_u32 s44, s41, 266240
  buffer_load_dwordx4 v3, s[28:31], s44 offen offset:0 sc1 lds
  v_mfma_f32_16x16x32_bf16 v[200:203], v[16:19], a[128:131], v[200:203]
  ds_read_b128 v[44:47], v5 offset:3072
  v_mfma_f32_16x16x32_bf16 v[204:207], v[16:19], a[132:135], v[204:207]
  ds_read_b128 v[48:51], v5 offset:4096
  v_mfma_f32_16x16x32_bf16 v[208:211], v[20:23], a[128:131], v[208:211]
  ds_read_b128 v[52:55], v5 offset:5120
  v_mfma_f32_16x16x32_bf16 v[212:215], v[20:23], a[132:135], v[212:215]
  s_add_u32 m0, s40, 0
  s_add_u32 s44, s41, 294912
  buffer_load_dwordx4 v3, s[28:31], s44 offen offset:0 sc1 lds
  v_mfma_f32_16x16x32_bf16 v[200:203], v[24:27], a[136:139], v[200:203]
  ds_read_b128 v[56:59], v5 offset:6144
  v_mfma_f32_16x16x32_bf16 v[204:207], v[24:27], a[140:143], v[204:207]
  ds_read_b128 v[60:63], v5 offset:7168
  v_mfma_f32_16x16x32_bf16 v[208:211], v[28:31], a[136:139], v[208:211]
  ds_read_b128 v[64:67], v5 offset:8192
  v_mfma_f32_16x16x32_bf16 v[212:215], v[28:31], a[140:143], v[212:215]
  ds_read_b128 v[68:71], v5 offset:9216
  s_waitcnt lgkmcnt(8)
  v_mfma_f32_16x16x32_bf16 v[216:219], v[32:35], a[0:3], 0
  ds_read_b128 v[72:75], v5 offset:10240
  v_mfma_f32_16x16x32_bf16 v[220:223], v[32:35], a[4:7], 0
  buffer_load_dwordx4 v3, s[28:31], s44 offen offset:1024 sc1 lds
  v_mfma_f32_16x16x32_bf16 v[224:227], v[36:39], a[0:3], 0
  ds_read_b128 v[76:79], v5 offset:11264
  v_cvt_pk_bf16_f32 v112, v200, v201
  v_mfma_f32_16x16x32_bf16 v[228:231], v[36:39], a[4:7], 0
  v_cvt_pk_bf16_f32 v113, v202, v203
  s_waitcnt lgkmcnt(8)
  v_mfma_f32_16x16x32_bf16 v[216:219], v[40:43], a[8:11], v[216:219]
  ds_read_b128 v[16:19], v5 offset:12288
  v_cvt_pk_bf16_f32 v114, v208, v209
  v_mfma_f32_16x16x32_bf16 v[220:223], v[40:43], a[12:15], v[220:223]
  v_cvt_pk_bf16_f32 v115, v210, v211
  buffer_load_dwordx4 v3, s[28:31], s44 offen offset:2048 sc1 lds
  v_mfma_f32_16x16x32_bf16 v[224:227], v[44:47], a[8:11], v[224:227]
  ds_read_b128 v[20:23], v5 offset:13312
  v_pk_max_i16 v112, v112, v10
  v_mfma_f32_16x16x32_bf16 v[228:231], v[44:47], a[12:15], v[228:231]
  v_pk_max_i16 v113, v113, v10
  s_waitcnt lgkmcnt(8)
  v_mfma_f32_16x16x32_bf16 v[216:219], v[48:51], a[16:19], v[216:219]
  ds_read_b128 v[24:27], v5 offset:14336
  v_mfma_f32_16x16x32_bf16 v[220:223], v[48:51], a[20:23], v[220:223]
  s_waitcnt vmcnt(15)
  s_add_u32 s61, s88, 3
  v_mov_b32 v14, s61
  v_mov_b32 v15, s89
  s_mov_b64 exec, 1
  buffer_store_dwordx2 v[14:15], v10, s[28:31], s51 offen sc1
  s_mov_b64 exec, -1
  v_pk_max_i16 v114, v114, v10
  v_pk_max_i16 v115, v115, v10
  v_mfma_f32_16x16x32_bf16 v[224:227], v[52:55], a[16:19], v[224:227]
  ds_read_b128 v[28:31], v5 offset:15360
  v_cvt_pk_bf16_f32 v116, v204, v205
  v_mfma_f32_16x16x32_bf16 v[228:231], v[52:55], a[20:23], v[228:231]
  v_cvt_pk_bf16_f32 v117, v206, v207
  s_waitcnt lgkmcnt(8)
  v_mfma_f32_16x16x32_bf16 v[216:219], v[56:59], a[24:27], v[216:219]
  ds_read_b128 v[32:35], v5 offset:16384
  v_mfma_f32_16x16x32_bf16 v[220:223], v[56:59], a[28:31], v[220:223]
  s_add_u32 s45, s47, 4096
  buffer_store_dwordx4 v[112:115], v3, s[28:31], s45 offen sc1
  v_cvt_pk_bf16_f32 v118, v212, v213
  v_cvt_pk_bf16_f32 v119, v214, v215
  v_mfma_f32_16x16x32_bf16 v[224:227], v[60:63], a[24:27], v[224:227]
  ds_read_b128 v[36:39], v5 offset:17408
  v_pk_max_i16 v116, v116, v10
  v_mfma_f32_16x16x32_bf16 v[228:231], v[60:63], a[28:31], v[228:231]
  v_pk_max_i16 v117, v117, v10
  s_waitcnt lgkmcnt(8)
  v_mfma_f32_16x16x32_bf16 v[216:219], v[64:67], a[32:35], v[216:219]
  ds_read_b128 v[40:43], v5 offset:18432
  v_pk_max_i16 v118, v118, v10
  v_mfma_f32_16x16x32_bf16 v[220:223], v[64:67], a[36:39], v[220:223]
  v_pk_max_i16 v119, v119, v10
  v_mfma_f32_16x16x32_bf16 v[224:227], v[68:71], a[32:35], v[224:227]
  ds_read_b128 v[44:47], v5 offset:19456
  v_mfma_f32_16x16x32_bf16 v[228:231], v[68:71], a[36:39], v[228:231]
  buffer_load_dwordx4 v3, s[28:31], s44 offen offset:3072 sc1 lds
  s_waitcnt lgkmcnt(8)
  v_mfma_f32_16x16x32_bf16 v[216:219], v[72:75], a[40:43], v[216:219]
  ds_read_b128 v[48:51], v5 offset:20480
  v_mfma_f32_16x16x32_bf16 v[220:223], v[72:75], a[44:47], v[220:223]
  ds_read_b128 v[52:55], v5 offset:21504
  v_mfma_f32_16x16x32_bf16 v[224:227], v[76:79], a[40:43], v[224:227]
  ds_read_b128 v[56:59], v5 offset:22528
  v_mfma_f32_16x16x32_bf16 v[228:231], v[76:79], a[44:47], v[228:231]
  s_add_u32 m0, s40, 4096
  s_add_u32 s44, s41, 299008
  buffer_load_dwordx4 v3, s[28:31], s44 offen offset:0 sc1 lds
  s_waitcnt lgkmcnt(9)
  v_mfma_f32_16x16x32_bf16 v[216:219], v[16:19], a[48:51], v[216:219]
  ds_read_b128 v[60:63], v5 offset:23552
  v_mfma_f32_16x16x32_bf16 v[220:223], v[16:19], a[52:55], v[220:223]
  ds_read_b128 v[64:67], v5 offset:24576
  v_mfma_f32_16x16x32_bf16 v[224:227], v[20:23], a[48:51], v[224:227]
  ds_read_b128 v[68:71], v5 offset:25600
  v_mfma_f32_16x16x32_bf16 v[228:231], v[20:23], a[52:55], v[228:231]
  buffer_load_dwordx4 v3, s[28:31], s44 offen offset:1024 sc1 lds
  s_waitcnt lgkmcnt(10)
  v_mfma_f32_16x16x32_bf16 v[216:219], v[24:27], a[56:59], v[216:219]
  ds_read_b128 v[72:75], v5 offset:26624
  v_mfma_f32_16x16x32_bf16 v[220:223], v[24:27], a[60:63], v[220:223]
  v_mfma_f32_16x16x32_bf16 v[224:227], v[28:31], a[56:59], v[224:227]
  ds_read_b128 v[76:79], v5 offset:27648
  v_mfma_f32_16x16x32_bf16 v[228:231], v[28:31], a[60:63], v[228:231]
  buffer_load_dwordx4 v3, s[28:31], s44 offen offset:2048 sc1 lds
  s_waitcnt lgkmcnt(10)
  v_mfma_f32_16x16x32_bf16 v[216:219], v[32:35], a[64:67], v[216:219]
  ds_read_b128 v[16:19], v5 offset:28672
  v_mfma_f32_16x16x32_bf16 v[220:223], v[32:35], a[68:71], v[220:223]
  v_mfma_f32_16x16x32_bf16 v[224:227], v[36:39], a[64:67], v[224:227]
  ds_read_b128 v[20:23], v5 offset:29696
  v_mfma_f32_16x16x32_bf16 v[228:231], v[36:39], a[68:71], v[228:231]
  s_waitcnt lgkmcnt(10)
  v_mfma_f32_16x16x32_bf16 v[216:219], v[40:43], a[72:75], v[216:219]
  ds_read_b128 v[24:27], v5 offset:30720
  v_mfma_f32_16x16x32_bf16 v[220:223], v[40:43], a[76:79], v[220:223]
  s_add_u32 s45, s47, 152832
  buffer_store_dwordx4 v[116:119], v3, s[28:31], s45 offen sc1
  v_mfma_f32_16x16x32_bf16 v[224:227], v[44:47], a[72:75], v[224:227]
  ds_read_b128 v[28:31], v5 offset:31744
  v_mfma_f32_16x16x32_bf16 v[228:231], v[44:47], a[76:79], v[228:231]
  s_waitcnt lgkmcnt(10)
  v_mfma_f32_16x16x32_bf16 v[216:219], v[48:51], a[80:83], v[216:219]
  ds_read_b128 v[32:35], v5 offset:32768
  v_mfma_f32_16x16x32_bf16 v[220:223], v[48:51], a[84:87], v[220:223]
  buffer_load_dwordx4 v3, s[28:31], s44 offen offset:3072 sc1 lds
  v_mfma_f32_16x16x32_bf16 v[224:227], v[52:55], a[80:83], v[224:227]
  ds_read_b128 v[36:39], v5 offset:33792
  v_mfma_f32_16x16x32_bf16 v[228:231], v[52:55], a[84:87], v[228:231]
  s_waitcnt lgkmcnt(10)
  v_mfma_f32_16x16x32_bf16 v[216:219], v[56:59], a[88:91], v[216:219]
  ds_read_b128 v[40:43], v5 offset:34816
  v_mfma_f32_16x16x32_bf16 v[220:223], v[56:59], a[92:95], v[220:223]
  s_add_u32 m0, s40, 8192
  s_add_u32 s44, s41, 303104
  buffer_load_dwordx4 v3, s[28:31], s44 offen offset:0 sc1 lds
  v_mfma_f32_16x16x32_bf16 v[224:227], v[60:63], a[88:91], v[224:227]
  ds_read_b128 v[44:47], v5 offset:35840
  v_mfma_f32_16x16x32_bf16 v[228:231], v[60:63], a[92:95], v[228:231]
  s_waitcnt lgkmcnt(10)
  v_mfma_f32_16x16x32_bf16 v[216:219], v[64:67], a[96:99], v[216:219]
  v_mfma_f32_16x16x32_bf16 v[220:223], v[64:67], a[100:103], v[220:223]
  v_mfma_f32_16x16x32_bf16 v[224:227], v[68:71], a[96:99], v[224:227]
  v_mfma_f32_16x16x32_bf16 v[228:231], v[68:71], a[100:103], v[228:231]
  s_waitcnt lgkmcnt(8)
  v_mfma_f32_16x16x32_bf16 v[216:219], v[72:75], a[104:107], v[216:219]
  v_mfma_f32_16x16x32_bf16 v[220:223], v[72:75], a[108:111], v[220:223]
  v_mfma_f32_16x16x32_bf16 v[224:227], v[76:79], a[104:107], v[224:227]
  v_mfma_f32_16x16x32_bf16 v[228:231], v[76:79], a[108:111], v[228:231]
  s_waitcnt lgkmcnt(6)
  v_mfma_f32_16x16x32_bf16 v[216:219], v[16:19], a[112:115], v[216:219]
  v_mfma_f32_16x16x32_bf16 v[220:223], v[16:19], a[116:119], v[220:223]
  v_mfma_f32_16x16x32_bf16 v[224:227], v[20:23], a[112:115], v[224:227]
  v_mfma_f32_16x16x32_bf16 v[228:231], v[20:23], a[116:119], v[228:231]
  s_waitcnt lgkmcnt(0)
  s_waitcnt vmcnt(23)
  s_barrier
  v_mfma_f32_16x16x32_bf16 v[216:219], v[24:27], a[120:123], v[216:219]
  ds_read_b128 v[48:51], v6 offset:0
  v_mfma_f32_16x16x32_bf16 v[220:223], v[24:27], a[124:127], v[220:223]
  ds_read_b128 v[52:55], v6 offset:1024
  v_mfma_f32_16x16x32_bf16 v[224:227], v[28:31], a[120:123], v[224:227]
  ds_read_b128 v[56:59], v6 offset:2048
  v_mfma_f32_16x16x32_bf16 v[228:231], v[28:31], a[124:127], v[228:231]
  s_add_u32 m0, s40, 36864
  s_add_u32 s44, s42, 0
  buffer_load_dwordx4 v3, s[28:31], s44 offen offset:0 sc1 lds
  v_mfma_f32_16x16x32_bf16 v[216:219], v[32:35], a[128:131], v[216:219]
  ds_read_b128 v[60:63], v6 offset:3072
  v_mfma_f32_16x16x32_bf16 v[220:223], v[32:35], a[132:135], v[220:223]
  ds_read_b128 v[64:67], v6 offset:4096
  v_mfma_f32_16x16x32_bf16 v[224:227], v[36:39], a[128:131], v[224:227]
  ds_read_b128 v[68:71], v6 offset:5120
  v_mfma_f32_16x16x32_bf16 v[228:231], v[36:39], a[132:135], v[228:231]
  buffer_load_dwordx4 v3, s[28:31], s44 offen offset:1024 sc1 lds
  v_mfma_f32_16x16x32_bf16 v[216:219], v[40:43], a[136:139], v[216:219]
  ds_read_b128 v[72:75], v6 offset:6144
  v_mfma_f32_16x16x32_bf16 v[220:223], v[40:43], a[140:143], v[220:223]
  ds_read_b128 v[76:79], v6 offset:7168
  v_mfma_f32_16x16x32_bf16 v[224:227], v[44:47], a[136:139], v[224:227]
  ds_read_b128 v[16:19], v6 offset:8192
  v_mfma_f32_16x16x32_bf16 v[228:231], v[44:47], a[140:143], v[228:231]
  ds_read_b128 v[20:23], v6 offset:9216
  s_waitcnt lgkmcnt(8)
  v_mfma_f32_16x16x32_bf16 v[200:203], v[48:51], a[0:3], 0
  ds_read_b128 v[24:27], v6 offset:10240
  v_mfma_f32_16x16x32_bf16 v[204:207], v[48:51], a[4:7], 0
  buffer_load_dwordx2 v[12:13], v8, s[28:31], s48 offen offset:0 sc1
  v_mfma_f32_16x16x32_bf16 v[208:211], v[52:55], a[0:3], 0
  ds_read_b128 v[28:31], v6 offset:11264
  v_cvt_pk_bf16_f32 v120, v216, v217
  v_mfma_f32_16x16x32_bf16 v[212:215], v[52:55], a[4:7], 0
  v_cvt_pk_bf16_f32 v121, v218, v219
  s_waitcnt lgkmcnt(8)
  v_mfma_f32_16x16x32_bf16 v[200:203], v[56:59], a[8:11], v[200:203]
  ds_read_b128 v[32:35], v6 offset:12288
  v_cvt_pk_bf16_f32 v122, v224, v225
  v_mfma_f32_16x16x32_bf16 v[204:207], v[56:59], a[12:15], v[204:207]
  v_cvt_pk_bf16_f32 v123, v226, v227
  buffer_load_dwordx4 v3, s[28:31], s44 offen offset:2048 sc1 lds
  v_mfma_f32_16x16x32_bf16 v[208:211], v[60:63], a[8:11], v[208:211]
  ds_read_b128 v[36:39], v6 offset:13312
  v_pk_max_i16 v120, v120, v10
  v_mfma_f32_16x16x32_bf16 v[212:215], v[60:63], a[12:15], v[212:215]
  v_pk_max_i16 v121, v121, v10
  s_waitcnt lgkmcnt(8)
  v_mfma_f32_16x16x32_bf16 v[200:203], v[64:67], a[16:19], v[200:203]
  ds_read_b128 v[40:43], v6 offset:14336
  v_pk_max_i16 v122, v122, v10
  v_mfma_f32_16x16x32_bf16 v[204:207], v[64:67], a[20:23], v[204:207]
  v_pk_max_i16 v123, v123, v10
  buffer_load_dwordx4 v3, s[28:31], s44 offen offset:3072 sc1 lds
  v_mfma_f32_16x16x32_bf16 v[208:211], v[68:71], a[16:19], v[208:211]
  ds_read_b128 v[44:47], v6 offset:15360
  v_cvt_pk_bf16_f32 v124, v220, v221
  v_mfma_f32_16x16x32_bf16 v[212:215], v[68:71], a[20:23], v[212:215]
  v_cvt_pk_bf16_f32 v125, v222, v223
  s_waitcnt lgkmcnt(8)
  v_mfma_f32_16x16x32_bf16 v[200:203], v[72:75], a[24:27], v[200:203]
  ds_read_b128 v[48:51], v6 offset:16384
  v_mfma_f32_16x16x32_bf16 v[204:207], v[72:75], a[28:31], v[204:207]
  s_add_u32 s45, s47, 5120
  buffer_store_dwordx4 v[120:123], v3, s[28:31], s45 offen sc1
  v_cvt_pk_bf16_f32 v126, v228, v229
  v_cvt_pk_bf16_f32 v127, v230, v231
  v_mfma_f32_16x16x32_bf16 v[208:211], v[76:79], a[24:27], v[208:211]
  ds_read_b128 v[52:55], v6 offset:17408
  v_pk_max_i16 v124, v124, v10
  v_mfma_f32_16x16x32_bf16 v[212:215], v[76:79], a[28:31], v[212:215]
  v_pk_max_i16 v125, v125, v10
  s_waitcnt lgkmcnt(8)
  v_mfma_f32_16x16x32_bf16 v[200:203], v[16:19], a[32:35], v[200:203]
  ds_read_b128 v[56:59], v6 offset:18432
  v_pk_max_i16 v126, v126, v10
  v_mfma_f32_16x16x32_bf16 v[204:207], v[16:19], a[36:39], v[204:207]
  v_pk_max_i16 v127, v127, v10
  v_mfma_f32_16x16x32_bf16 v[208:211], v[20:23], a[32:35], v[208:211]
  ds_read_b128 v[60:63], v6 offset:19456
  v_mfma_f32_16x16x32_bf16 v[212:215], v[20:23], a[36:39], v[212:215]
  s_add_u32 m0, s40, 40960
  s_add_u32 s44, s42, 4096
  buffer_load_dwordx4 v3, s[28:31], s44 offen offset:0 sc1 lds
  s_waitcnt lgkmcnt(8)
  v_mfma_f32_16x16x32_bf16 v[200:203], v[24:27], a[40:43], v[200:203]
  ds_read_b128 v[64:67], v6 offset:20480
  v_mfma_f32_16x16x32_bf16 v[204:207], v[24:27], a[44:47], v[204:207]
  ds_read_b128 v[68:71], v6 offset:21504
  v_mfma_f32_16x16x32_bf16 v[208:211], v[28:31], a[40:43], v[208:211]
  ds_read_b128 v[72:75], v6 offset:22528
  v_mfma_f32_16x16x32_bf16 v[212:215], v[28:31], a[44:47], v[212:215]
  buffer_load_dwordx4 v3, s[28:31], s44 offen offset:1024 sc1 lds
  s_waitcnt lgkmcnt(9)
  v_mfma_f32_16x16x32_bf16 v[200:203], v[32:35], a[48:51], v[200:203]
  ds_read_b128 v[76:79], v6 offset:23552
  v_mfma_f32_16x16x32_bf16 v[204:207], v[32:35], a[52:55], v[204:207]
  ds_read_b128 v[16:19], v6 offset:24576
  v_mfma_f32_16x16x32_bf16 v[208:211], v[36:39], a[48:51], v[208:211]
  ds_read_b128 v[20:23], v6 offset:25600
  v_mfma_f32_16x16x32_bf16 v[212:215], v[36:39], a[52:55], v[212:215]
  buffer_load_dwordx4 v3, s[28:31], s44 offen offset:2048 sc1 lds
  s_waitcnt lgkmcnt(10)
  v_mfma_f32_16x16x32_bf16 v[200:203], v[40:43], a[56:59], v[200:203]
  ds_read_b128 v[24:27], v6 offset:26624
  v_mfma_f32_16x16x32_bf16 v[204:207], v[40:43], a[60:63], v[204:207]
  v_mfma_f32_16x16x32_bf16 v[208:211], v[44:47], a[56:59], v[208:211]
  ds_read_b128 v[28:31], v6 offset:27648
  v_mfma_f32_16x16x32_bf16 v[212:215], v[44:47], a[60:63], v[212:215]
  buffer_load_dwordx4 v3, s[28:31], s44 offen offset:3072 sc1 lds
  s_waitcnt lgkmcnt(10)
  v_mfma_f32_16x16x32_bf16 v[200:203], v[48:51], a[64:67], v[200:203]
  ds_read_b128 v[32:35], v6 offset:28672
  v_mfma_f32_16x16x32_bf16 v[204:207], v[48:51], a[68:71], v[204:207]
  v_mfma_f32_16x16x32_bf16 v[208:211], v[52:55], a[64:67], v[208:211]
  ds_read_b128 v[36:39], v6 offset:29696
  v_mfma_f32_16x16x32_bf16 v[212:215], v[52:55], a[68:71], v[212:215]
  s_waitcnt lgkmcnt(10)
  v_mfma_f32_16x16x32_bf16 v[200:203], v[56:59], a[72:75], v[200:203]
  ds_read_b128 v[40:43], v6 offset:30720
  v_mfma_f32_16x16x32_bf16 v[204:207], v[56:59], a[76:79], v[204:207]
  s_waitcnt vmcnt(12)
  s_add_u32 s61, s88, 5
  v_mov_b32 v14, s61
  v_mov_b32 v15, s89
  s_mov_b64 exec, 1
  buffer_store_dwordx2 v[14:15], v10, s[28:31], s51 offen sc1
  s_mov_b64 exec, -1
  v_mfma_f32_16x16x32_bf16 v[208:211], v[60:63], a[72:75], v[208:211]
  ds_read_b128 v[44:47], v6 offset:31744
  v_mfma_f32_16x16x32_bf16 v[212:215], v[60:63], a[76:79], v[212:215]
  s_waitcnt lgkmcnt(10)
  v_mfma_f32_16x16x32_bf16 v[200:203], v[64:67], a[80:83], v[200:203]
  ds_read_b128 v[48:51], v6 offset:32768
  v_mfma_f32_16x16x32_bf16 v[204:207], v[64:67], a[84:87], v[204:207]
  s_add_u32 s45, s47, 153856
  buffer_store_dwordx4 v[124:127], v3, s[28:31], s45 offen sc1
  v_mfma_f32_16x16x32_bf16 v[208:211], v[68:71], a[80:83], v[208:211]
  ds_read_b128 v[52:55], v6 offset:33792
  v_mfma_f32_16x16x32_bf16 v[212:215], v[68:71], a[84:87], v[212:215]
  s_waitcnt lgkmcnt(10)
  v_mfma_f32_16x16x32_bf16 v[200:203], v[72:75], a[88:91], v[200:203]
  ds_read_b128 v[56:59], v6 offset:34816
  v_mfma_f32_16x16x32_bf16 v[204:207], v[72:75], a[92:95], v[204:207]
  s_add_u32 m0, s40, 45056
  s_add_u32 s44, s42, 8192
  buffer_load_dwordx4 v3, s[28:31], s44 offen offset:0 sc1 lds
  v_mfma_f32_16x16x32_bf16 v[208:211], v[76:79], a[88:91], v[208:211]
  ds_read_b128 v[60:63], v6 offset:35840
  v_mfma_f32_16x16x32_bf16 v[212:215], v[76:79], a[92:95], v[212:215]
  s_waitcnt lgkmcnt(10)
  v_mfma_f32_16x16x32_bf16 v[200:203], v[16:19], a[96:99], v[200:203]
  v_mfma_f32_16x16x32_bf16 v[204:207], v[16:19], a[100:103], v[204:207]
  v_mfma_f32_16x16x32_bf16 v[208:211], v[20:23], a[96:99], v[208:211]
  v_mfma_f32_16x16x32_bf16 v[212:215], v[20:23], a[100:103], v[212:215]
  s_waitcnt vmcnt(10)
  s_mov_b32 s58, 0
  s_add_u32 s59, s88, 3
L_p2_0_chk:
  s_mov_b64 s[60:61], -1
  v_subrev_u32 v14, s59, v12
  v_cmp_gt_u32 vcc, 13, v14
  v_cmp_eq_u32 s[62:63], s89, v13
  s_nop 1
  s_and_b64 vcc, vcc, s[62:63]
  s_and_b64 s[60:61], s[60:61], vcc
  s_cmp_eq_u64 s[60:61], -1
  s_cbranch_scc1 L_p2_0_ok
  s_add_u32 s58, s58, 1
  s_cmp_gt_u32 s58, 20000
  s_cbranch_scc1 L_p2_0_ok
  buffer_load_dwordx2 v[12:13], v8, s[28:31], s48 offen offset:0 sc1
  s_waitcnt vmcnt(0)
  s_branch L_p2_0_chk
L_p2_0_ok:
  s_waitcnt lgkmcnt(8)
  v_mfma_f32_16x16x32_bf16 v[200:203], v[24:27], a[104:107], v[200:203]
  v_mfma_f32_16x16x32_bf16 v[204:207], v[24:27], a[108:111], v[204:207]
  v_mfma_f32_16x16x32_bf16 v[208:211], v[28:31], a[104:107], v[208:211]
  v_mfma_f32_16x16x32_bf16 v[212:215], v[28:31], a[108:111], v[212:215]
  s_add_u32 s45, s53, 0
  buffer_load_dwordx4 a[144:147], v3, s[28:31], s45 offen sc1
  s_waitcnt lgkmcnt(6)
  v_mfma_f32_16x16x32_bf16 v[200:203], v[32:35], a[112:115], v[200:203]
  v_mfma_f32_16x16x32_bf16 v[204:207], v[32:35], a[116:119], v[204:207]
  v_mfma_f32_16x16x32_bf16 v[208:211], v[36:39], a[112:115], v[208:211]
  v_mfma_f32_16x16x32_bf16 v[212:215], v[36:39], a[116:119], v[212:215]
  s_add_u32 s45, s53, 148736
  buffer_load_dwordx4 a[148:151], v3, s[28:31], s45 offen sc1
  s_waitcnt lgkmcnt(0)
  s_waitcnt vmcnt(27)
  s_barrier
  v_mfma_f32_16x16x32_bf16 v[200:203], v[40:43], a[120:123], v[200:203]
  ds_read_b128 v[64:67], v7 offset:0
  v_mfma_f32_16x16x32_bf16 v[204:207], v[40:43], a[124:127], v[204:207]
  ds_read_b128 v[68:71], v7 offset:1024
  v_mfma_f32_16x16x32_bf16 v[208:211], v[44:47], a[120:123], v[208:211]
  ds_read_b128 v[72:75], v7 offset:2048
  v_mfma_f32_16x16x32_bf16 v[212:215], v[44:47], a[124:127], v[212:215]
  s_add_u32 m0, s40, 73728
  s_add_u32 s44, s42, 36864
  buffer_load_dwordx4 v3, s[28:31], s44 offen offset:0 sc1 lds
  v_mfma_f32_16x16x32_bf16 v[200:203], v[48:51], a[128:131], v[200:203]
  ds_read_b128 v[76:79], v7 offset:3072
  v_mfma_f32_16x16x32_bf16 v[204:207], v[48:51], a[132:135], v[204:207]
  ds_read_b128 v[16:19], v7 offset:4096
  v_mfma_f32_16x16x32_bf16 v[208:211], v[52:55], a[128:131], v[208:211]
  ds_read_b128 v[20:23], v7 offset:5120
  v_mfma_f32_16x16x32_bf16 v[212:215], v[52:55], a[132:135], v[212:215]
  buffer_load_dwordx4 v3, s[28:31], s44 offen offset:1024 sc1 lds
  v_mfma_f32_16x16x32_bf16 v[200:203], v[56:59], a[136:139], v[200:203]
  ds_read_b128 v[24:27], v7 offset:6144
  v_mfma_f32_16x16x32_bf16 v[204:207], v[56:59], a[140:143], v[204:207]
  ds_read_b128 v[28:31], v7 offset:7168
  v_mfma_f32_16x16x32_bf16 v[208:211], v[60:63], a[136:139], v[208:211]
  ds_read_b128 v[32:35], v7 offset:8192
  v_mfma_f32_16x16x32_bf16 v[212:215], v[60:63], a[140:143], v[212:215]
  ds_read_b128 v[36:39], v7 offset:9216
  s_waitcnt lgkmcnt(8)
  v_mfma_f32_16x16x32_bf16 v[216:219], v[64:67], a[0:3], 0
  ds_read_b128 v[40:43], v7 offset:10240
  v_mfma_f32_16x16x32_bf16 v[220:223], v[64:67], a[4:7], 0
  buffer_load_dwordx4 v3, s[28:31], s44 offen offset:2048 sc1 lds
  v_mfma_f32_16x16x32_bf16 v[224:227], v[68:71], a[0:3], 0
  ds_read_b128 v[44:47], v7 offset:11264
  v_cvt_pk_bf16_f32 v128, v200, v201
  v_mfma_f32_16x16x32_bf16 v[228:231], v[68:71], a[4:7], 0
  v_cvt_pk_bf16_f32 v129, v202, v203
  s_waitcnt lgkmcnt(8)
  v_mfma_f32_16x16x32_bf16 v[216:219], v[72:75], a[8:11], v[216:219]
  ds_read_b128 v[48:51], v7 offset:12288
  v_cvt_pk_bf16_f32 v130, v208, v209
  v_mfma_f32_16x16x32_bf16 v[220:223], v[72:75], a[12:15], v[220:223]
  v_cvt_pk_bf16_f32 v131, v210, v211
  buffer_load_dwordx4 v3, s[28:31], s44 offen offset:3072 sc1 lds
  v_mfma_f32_16x16x32_bf16 v[224:227], v[76:79], a[8:11], v[224:227]
  ds_read_b128 v[52:55], v7 offset:13312
  v_pk_max_i16 v128, v128, v10
  v_mfma_f32_16x16x32_bf16 v[228:231], v[76:79], a[12:15], v[228:231]
  v_pk_max_i16 v129, v129, v10
  s_waitcnt lgkmcnt(8)
  v_mfma_f32_16x16x32_bf16 v[216:219], v[16:19], a[16:19], v[216:219]
  ds_read_b128 v[56:59], v7 offset:14336
  v_pk_max_i16 v130, v130, v10
  v_mfma_f32_16x16x32_bf16 v[220:223], v[16:19], a[20:23], v[220:223]
  v_pk_max_i16 v131, v131, v10
  s_add_u32 m0, s40, 77824
  s_add_u32 s44, s42, 40960
  buffer_load_dwordx4 v3, s[28:31], s44 offen offset:0 sc1 lds
  v_mfma_f32_16x16x32_bf16 v[224:227], v[20:23], a[16:19], v[224:227]
  ds_read_b128 v[60:63], v7 offset:15360
  v_cvt_pk_bf16_f32 v132, v204, v205
  v_mfma_f32_16x16x32_bf16 v[228:231], v[20:23], a[20:23], v[228:231]
  v_cvt_pk_bf16_f32 v133, v206, v207
  s_waitcnt lgkmcnt(8)
  v_mfma_f32_16x16x32_bf16 v[216:219], v[24:27], a[24:27], v[216:219]
  ds_read_b128 v[64:67], v7 offset:16384
  v_mfma_f32_16x16x32_bf16 v[220:223], v[24:27], a[28:31], v[220:223]
  s_add_u32 s45, s47, 6144
  buffer_store_dwordx4 v[128:131], v3, s[28:31], s45 offen sc1
  v_cvt_pk_bf16_f32 v134, v212, v213
  v_cvt_pk_bf16_f32 v135, v214, v215
  v_mfma_f32_16x16x32_bf16 v[224:227], v[28:31], a[24:27], v[224:227]
  ds_read_b128 v[68:71], v7 offset:17408
  v_pk_max_i16 v132, v132, v10
  v_mfma_f32_16x16x32_bf16 v[228:231], v[28:31], a[28:31], v[228:231]
  v_pk_max_i16 v133, v133, v10
  s_waitcnt lgkmcnt(8)
  v_mfma_f32_16x16x32_bf16 v[216:219], v[32:35], a[32:35], v[216:219]
  ds_read_b128 v[72:75], v7 offset:18432
  v_pk_max_i16 v134, v134, v10
  v_mfma_f32_16x16x32_bf16 v[220:223], v[32:35], a[36:39], v[220:223]
  v_pk_max_i16 v135, v135, v10
  v_mfma_f32_16x16x32_bf16 v[224:227], v[36:39], a[32:35], v[224:227]
  ds_read_b128 v[76:79], v7 offset:19456
  v_mfma_f32_16x16x32_bf16 v[228:231], v[36:39], a[36:39], v[228:231]
  buffer_load_dwordx4 v3, s[28:31], s44 offen offset:1024 sc1 lds
  s_waitcnt lgkmcnt(8)
  v_mfma_f32_16x16x32_bf16 v[216:219], v[40:43], a[40:43], v[216:219]
  ds_read_b128 v[16:19], v7 offset:20480
  v_mfma_f32_16x16x32_bf16 v[220:223], v[40:43], a[44:47], v[220:223]
  ds_read_b128 v[20:23], v7 offset:21504
  v_mfma_f32_16x16x32_bf16 v[224:227], v[44:47], a[40:43], v[224:227]
  ds_read_b128 v[24:27], v7 offset:22528
  v_mfma_f32_16x16x32_bf16 v[228:231], v[44:47], a[44:47], v[228:231]
  buffer_load_dwordx4 v3, s[28:31], s44 offen offset:2048 sc1 lds
  s_waitcnt lgkmcnt(9)
  v_mfma_f32_16x16x32_bf16 v[216:219], v[48:51], a[48:51], v[216:219]
  ds_read_b128 v[28:31], v7 offset:23552
  v_mfma_f32_16x16x32_bf16 v[220:223], v[48:51], a[52:55], v[220:223]
  ds_read_b128 v[32:35], v7 offset:24576
  v_mfma_f32_16x16x32_bf16 v[224:227], v[52:55], a[48:51], v[224:227]
  ds_read_b128 v[36:39], v7 offset:25600
  v_mfma_f32_16x16x32_bf16 v[228:231], v[52:55], a[52:55], v[228:231]
  buffer_load_dwordx4 v3, s[28:31], s44 offen offset:3072 sc1 lds
  s_waitcnt lgkmcnt(10)
  v_mfma_f32_16x16x32_bf16 v[216:219], v[56:59], a[56:59], v[216:219]
  ds_read_b128 v[40:43], v7 offset:26624
  v_mfma_f32_16x16x32_bf16 v[220:223], v[56:59], a[60:63], v[220:223]
  v_mfma_f32_16x16x32_bf16 v[224:227], v[60:63], a[56:59], v[224:227]
  ds_read_b128 v[44:47], v7 offset:27648
  v_mfma_f32_16x16x32_bf16 v[228:231], v[60:63], a[60:63], v[228:231]
  s_add_u32 m0, s40, 81920
  s_add_u32 s44, s42, 45056
  buffer_load_dwordx4 v3, s[28:31], s44 offen offset:0 sc1 lds
  s_waitcnt lgkmcnt(10)
  v_mfma_f32_16x16x32_bf16 v[216:219], v[64:67], a[64:67], v[216:219]
  ds_read_b128 v[48:51], v7 offset:28672
  v_mfma_f32_16x16x32_bf16 v[220:223], v[64:67], a[68:71], v[220:223]
  v_mfma_f32_16x16x32_bf16 v[224:227], v[68:71], a[64:67], v[224:227]
  ds_read_b128 v[52:55], v7 offset:29696
  v_mfma_f32_16x16x32_bf16 v[228:231], v[68:71], a[68:71], v[228:231]
  s_waitcnt lgkmcnt(10)
  v_mfma_f32_16x16x32_bf16 v[216:219], v[72:75], a[72:75], v[216:219]
  ds_read_b128 v[56:59], v7 offset:30720
  v_mfma_f32_16x16x32_bf16 v[220:223], v[72:75], a[76:79], v[220:223]
  s_add_u32 s45, s47, 154880
  buffer_store_dwordx4 v[132:135], v3, s[28:31], s45 offen sc1
  v_mfma_f32_16x16x32_bf16 v[224:227], v[76:79], a[72:75], v[224:227]
  ds_read_b128 v[60:63], v7 offset:31744
  v_mfma_f32_16x16x32_bf16 v[228:231], v[76:79], a[76:79], v[228:231]
  s_waitcnt lgkmcnt(10)
  v_mfma_f32_16x16x32_bf16 v[216:219], v[16:19], a[80:83], v[216:219]
  ds_read_b128 v[64:67], v7 offset:32768
  v_mfma_f32_16x16x32_bf16 v[220:223], v[16:19], a[84:87], v[220:223]
  s_add_u32 s45, s54, 0
  buffer_load_dwordx4 a[152:155], v3, s[28:31], s45 offen sc1
  v_mfma_f32_16x16x32_bf16 v[224:227], v[20:23], a[80:83], v[224:227]
  ds_read_b128 v[68:71], v7 offset:33792
  v_mfma_f32_16x16x32_bf16 v[228:231], v[20:23], a[84:87], v[228:231]
  s_waitcnt lgkmcnt(10)
  v_mfma_f32_16x16x32_bf16 v[216:219], v[24:27], a[88:91], v[216:219]
  ds_read_b128 v[72:75], v7 offset:34816
  v_mfma_f32_16x16x32_bf16 v[220:223], v[24:27], a[92:95], v[220:223]
  s_add_u32 s45, s54, 148736
  buffer_load_dwordx4 a[156:159], v3, s[28:31], s45 offen sc1
  v_mfma_f32_16x16x32_bf16 v[224:227], v[28:31], a[88:91], v[224:227]
  ds_read_b128 v[76:79], v7 offset:35840
  v_mfma_f32_16x16x32_bf16 v[228:231], v[28:31], a[92:95], v[228:231]
  s_waitcnt lgkmcnt(10)
  v_mfma_f32_16x16x32_bf16 v[216:219], v[32:35], a[96:99], v[216:219]
  v_mfma_f32_16x16x32_bf16 v[220:223], v[32:35], a[100:103], v[220:223]
  s_add_u32 s45, s55, 0
  buffer_load_dwordx4 a[160:163], v3, s[28:31], s45 offen sc1
  v_mfma_f32_16x16x32_bf16 v[224:227], v[36:39], a[96:99], v[224:227]
  v_mfma_f32_16x16x32_bf16 v[228:231], v[36:39], a[100:103], v[228:231]
  s_waitcnt lgkmcnt(8)
  v_mfma_f32_16x16x32_bf16 v[216:219], v[40:43], a[104:107], v[216:219]
  v_mfma_f32_16x16x32_bf16 v[220:223], v[40:43], a[108:111], v[220:223]
  v_mfma_f32_16x16x32_bf16 v[224:227], v[44:47], a[104:107], v[224:227]
  v_mfma_f32_16x16x32_bf16 v[228:231], v[44:47], a[108:111], v[228:231]
  s_add_u32 s45, s55, 148736
  buffer_load_dwordx4 a[164:167], v3, s[28:31], s45 offen sc1
  s_waitcnt lgkmcnt(6)
  v_mfma_f32_16x16x32_bf16 v[216:219], v[48:51], a[112:115], v[216:219]
  v_mfma_f32_16x16x32_bf16 v[220:223], v[48:51], a[116:119], v[220:223]
  v_mfma_f32_16x16x32_bf16 v[224:227], v[52:55], a[112:115], v[224:227]
  v_mfma_f32_16x16x32_bf16 v[228:231], v[52:55], a[116:119], v[228:231]
  buffer_load_dwordx2 v[12:13], v8, s[28:31], s48 offen offset:0 sc1
  s_waitcnt lgkmcnt(0)
  s_waitcnt vmcnt(31)
  s_barrier
  v_mfma_f32_16x16x32_bf16 v[216:219], v[56:59], a[120:123], v[216:219]
  ds_read_b128 v[16:19], v4 offset:0
  v_mfma_f32_16x16x32_bf16 v[220:223], v[56:59], a[124:127], v[220:223]
  ds_read_b128 v[20:23], v4 offset:1024
  v_mfma_f32_16x16x32_bf16 v[224:227], v[60:63], a[120:123], v[224:227]
  ds_read_b128 v[24:27], v4 offset:2048
  v_mfma_f32_16x16x32_bf16 v[228:231], v[60:63], a[124:127], v[228:231]
  s_add_u32 m0, s40, 110592
  s_add_u32 s44, s42, 73728
  buffer_load_dwordx4 v3, s[28:31], s44 offen offset:0 sc1 lds
  v_mfma_f32_16x16x32_bf16 v[216:219], v[64:67], a[128:131], v[216:219]
  ds_read_b128 v[28:31], v4 offset:3072
  v_mfma_f32_16x16x32_bf16 v[220:223], v[64:67], a[132:135], v[220:223]
  ds_read_b128 v[32:35], v4 offset:4096
  v_mfma_f32_16x16x32_bf16 v[224:227], v[68:71], a[128:131], v[224:227]
  ds_read_b128 v[36:39], v4 offset:5120
  v_mfma_f32_16x16x32_bf16 v[228:231], v[68:71], a[132:135], v[228:231]
  buffer_load_dwordx4 v3, s[28:31], s44 offen offset:1024 sc1 lds
  v_mfma_f32_16x16x32_bf16 v[216:219], v[72:75], a[136:139], v[216:219]
  ds_read_b128 v[40:43], v4 offset:6144
  v_mfma_f32_16x16x32_bf16 v[220:223], v[72:75], a[140:143], v[220:223]
  ds_read_b128 v[44:47], v4 offset:7168
  v_mfma_f32_16x16x32_bf16 v[224:227], v[76:79], a[136:139], v[224:227]
  ds_read_b128 v[48:51], v4 offset:8192
  v_mfma_f32_16x16x32_bf16 v[228:231], v[76:79], a[140:143], v[228:231]
  ds_read_b128 v[52:55], v4 offset:9216
  s_waitcnt lgkmcnt(8)
  v_mfma_f32_16x16x32_bf16 v[200:203], v[16:19], a[0:3], 0
  ds_read_b128 v[56:59], v4 offset:10240
  v_mfma_f32_16x16x32_bf16 v[204:207], v[16:19], a[4:7], 0
  buffer_load_dwordx4 v3, s[28:31], s44 offen offset:2048 sc1 lds
  v_mfma_f32_16x16x32_bf16 v[208:211], v[20:23], a[0:3], 0
  ds_read_b128 v[60:63], v4 offset:11264
  v_cvt_pk_bf16_f32 v136, v216, v217
  v_mfma_f32_16x16x32_bf16 v[212:215], v[20:23], a[4:7], 0
  v_cvt_pk_bf16_f32 v137, v218, v219
  s_waitcnt lgkmcnt(8)
  v_mfma_f32_16x16x32_bf16 v[200:203], v[24:27], a[8:11], v[200:203]
  ds_read_b128 v[64:67], v4 offset:12288
  v_cvt_pk_bf16_f32 v138, v224, v225
  v_mfma_f32_16x16x32_bf16 v[204:207], v[24:27], a[12:15], v[204:207]
  v_cvt_pk_bf16_f32 v139, v226, v227
  buffer_load_dwordx4 v3, s[28:31], s44 offen offset:3072 sc1 lds
  v_mfma_f32_16x16x32_bf16 v[208:211], v[28:31], a[8:11], v[208:211]
  ds_read_b128 v[68:71], v4 offset:13312
  v_pk_max_i16 v136, v136, v10
  v_mfma_f32_16x16x32_bf16 v[212:215], v[28:31], a[12:15], v[212:215]
  v_pk_max_i16 v137, v137, v10
  s_waitcnt lgkmcnt(8)
  v_mfma_f32_16x16x32_bf16 v[200:203], v[32:35], a[16:19], v[200:203]
  ds_read_b128 v[72:75], v4 offset:14336
  v_pk_max_i16 v138, v138, v10
  v_mfma_f32_16x16x32_bf16 v[204:207], v[32:35], a[20:23], v[204:207]
  v_pk_max_i16 v139, v139, v10
  s_add_u32 m0, s40, 114688
  s_add_u32 s44, s42, 77824
  buffer_load_dwordx4 v3, s[28:31], s44 offen offset:0 sc1 lds
  v_mfma_f32_16x16x32_bf16 v[208:211], v[36:39], a[16:19], v[208:211]
  ds_read_b128 v[76:79], v4 offset:15360
  v_cvt_pk_bf16_f32 v140, v220, v221
  v_mfma_f32_16x16x32_bf16 v[212:215], v[36:39], a[20:23], v[212:215]
  v_cvt_pk_bf16_f32 v141, v222, v223
  s_waitcnt lgkmcnt(8)
  v_mfma_f32_16x16x32_bf16 v[200:203], v[40:43], a[24:27], v[200:203]
  ds_read_b128 v[16:19], v4 offset:16384
  v_mfma_f32_16x16x32_bf16 v[204:207], v[40:43], a[28:31], v[204:207]
  s_add_u32 s45, s47, 7168
  buffer_store_dwordx4 v[136:139], v3, s[28:31], s45 offen sc1
  v_cvt_pk_bf16_f32 v142, v228, v229
  v_cvt_pk_bf16_f32 v143, v230, v231
  v_mfma_f32_16x16x32_bf16 v[208:211], v[44:47], a[24:27], v[208:211]
  ds_read_b128 v[20:23], v4 offset:17408
  v_pk_max_i16 v140, v140, v10
  v_mfma_f32_16x16x32_bf16 v[212:215], v[44:47], a[28:31], v[212:215]
  v_pk_max_i16 v141, v141, v10
  s_waitcnt lgkmcnt(8)
  v_mfma_f32_16x16x32_bf16 v[200:203], v[48:51], a[32:35], v[200:203]
  ds_read_b128 v[24:27], v4 offset:18432
  v_pk_max_i16 v142, v142, v10
  v_mfma_f32_16x16x32_bf16 v[204:207], v[48:51], a[36:39], v[204:207]
  v_pk_max_i16 v143, v143, v10
  v_mfma_f32_16x16x32_bf16 v[208:211], v[52:55], a[32:35], v[208:211]
  ds_read_b128 v[28:31], v4 offset:19456
  v_mfma_f32_16x16x32_bf16 v[212:215], v[52:55], a[36:39], v[212:215]
  buffer_load_dwordx4 v3, s[28:31], s44 offen offset:1024 sc1 lds
  s_waitcnt lgkmcnt(8)
  v_mfma_f32_16x16x32_bf16 v[200:203], v[56:59], a[40:43], v[200:203]
  ds_read_b128 v[32:35], v4 offset:20480
  v_mfma_f32_16x16x32_bf16 v[204:207], v[56:59], a[44:47], v[204:207]
  ds_read_b128 v[36:39], v4 offset:21504
  v_mfma_f32_16x16x32_bf16 v[208:211], v[60:63], a[40:43], v[208:211]
  ds_read_b128 v[40:43], v4 offset:22528
  v_mfma_f32_16x16x32_bf16 v[212:215], v[60:63], a[44:47], v[212:215]
  buffer_load_dwordx4 v3, s[28:31], s44 offen offset:2048 sc1 lds
  s_waitcnt lgkmcnt(9)
  v_mfma_f32_16x16x32_bf16 v[200:203], v[64:67], a[48:51], v[200:203]
  ds_read_b128 v[44:47], v4 offset:23552
  v_mfma_f32_16x16x32_bf16 v[204:207], v[64:67], a[52:55], v[204:207]
  ds_read_b128 v[48:51], v4 offset:24576
  v_mfma_f32_16x16x32_bf16 v[208:211], v[68:71], a[48:51], v[208:211]
  ds_read_b128 v[52:55], v4 offset:25600
  v_mfma_f32_16x16x32_bf16 v[212:215], v[68:71], a[52:55], v[212:215]
  buffer_load_dwordx4 v3, s[28:31], s44 offen offset:3072 sc1 lds
  s_waitcnt lgkmcnt(10)
  v_mfma_f32_16x16x32_bf16 v[200:203], v[72:75], a[56:59], v[200:203]
  ds_read_b128 v[56:59], v4 offset:26624
  v_mfma_f32_16x16x32_bf16 v[204:207], v[72:75], a[60:63], v[204:207]
  v_mfma_f32_16x16x32_bf16 v[208:211], v[76:79], a[56:59], v[208:211]
  ds_read_b128 v[60:63], v4 offset:27648
  v_mfma_f32_16x16x32_bf16 v[212:215], v[76:79], a[60:63], v[212:215]
  s_add_u32 m0, s40, 118784
  s_add_u32 s44, s42, 81920
  buffer_load_dwordx4 v3, s[28:31], s44 offen offset:0 sc1 lds
  s_waitcnt lgkmcnt(10)
  v_mfma_f32_16x16x32_bf16 v[200:203], v[16:19], a[64:67], v[200:203]
  ds_read_b128 v[64:67], v4 offset:28672
  v_mfma_f32_16x16x32_bf16 v[204:207], v[16:19], a[68:71], v[204:207]
  v_mfma_f32_16x16x32_bf16 v[208:211], v[20:23], a[64:67], v[208:211]
  ds_read_b128 v[68:71], v4 offset:29696
  v_mfma_f32_16x16x32_bf16 v[212:215], v[20:23], a[68:71], v[212:215]
  s_waitcnt lgkmcnt(10)
  v_mfma_f32_16x16x32_bf16 v[200:203], v[24:27], a[72:75], v[200:203]
  ds_read_b128 v[72:75], v4 offset:30720
  v_mfma_f32_16x16x32_bf16 v[204:207], v[24:27], a[76:79], v[204:207]
  s_waitcnt vmcnt(15)
  s_add_u32 s61, s88, 7
  v_mov_b32 v14, s61
  v_mov_b32 v15, s89
  s_mov_b64 exec, 1
  buffer_store_dwordx2 v[14:15], v10, s[28:31], s51 offen sc1
  s_mov_b64 exec, -1
  s_waitcnt vmcnt(11)
  s_mov_b32 s58, 0
  s_add_u32 s59, s88, 5
L_p2_1_chk:
  s_mov_b64 s[60:61], -1
  v_subrev_u32 v14, s59, v12
  v_cmp_gt_u32 vcc, 11, v14
  v_cmp_eq_u32 s[62:63], s89, v13
  s_nop 1
  s_and_b64 vcc, vcc, s[62:63]
  s_and_b64 s[60:61], s[60:61], vcc
  s_cmp_eq_u64 s[60:61], -1
  s_cbranch_scc1 L_p2_1_ok
  s_add_u32 s58, s58, 1
  s_cmp_gt_u32 s58, 20000
  s_cbranch_scc1 L_p2_1_ok
  buffer_load_dwordx2 v[12:13], v8, s[28:31], s48 offen offset:0 sc1
  s_waitcnt vmcnt(0)
  s_branch L_p2_1_chk
L_p2_1_ok:
  v_mfma_f32_16x16x32_bf16 v[208:211], v[28:31], a[72:75], v[208:211]
  ds_read_b128 v[76:79], v4 offset:31744
  v_mfma_f32_16x16x32_bf16 v[212:215], v[28:31], a[76:79], v[212:215]
  s_waitcnt lgkmcnt(10)
  v_mfma_f32_16x16x32_bf16 v[200:203], v[32:35], a[80:83], v[200:203]
  ds_read_b128 v[16:19], v4 offset:32768
  v_mfma_f32_16x16x32_bf16 v[204:207], v[32:35], a[84:87], v[204:207]
  s_add_u32 s45, s47, 155904
  buffer_store_dwordx4 v[140:143], v3, s[28:31], s45 offen sc1
  v_mfma_f32_16x16x32_bf16 v[208:211], v[36:39], a[80:83], v[208:211]
  ds_read_b128 v[20:23], v4 offset:33792
  v_mfma_f32_16x16x32_bf16 v[212:215], v[36:39], a[84:87], v[212:215]
  s_waitcnt lgkmcnt(10)
  v_mfma_f32_16x16x32_bf16 v[200:203], v[40:43], a[88:91], v[200:203]
  ds_read_b128 v[24:27], v4 offset:34816
  v_mfma_f32_16x16x32_bf16 v[204:207], v[40:43], a[92:95], v[204:207]
  s_add_u32 s45, s53, 1024
  buffer_load_dwordx4 a[168:171], v3, s[28:31], s45 offen sc1
  v_mfma_f32_16x16x32_bf16 v[208:211], v[44:47], a[88:91], v[208:211]
  ds_read_b128 v[28:31], v4 offset:35840
  v_mfma_f32_16x16x32_bf16 v[212:215], v[44:47], a[92:95], v[212:215]
  s_waitcnt lgkmcnt(10)
  v_mfma_f32_16x16x32_bf16 v[200:203], v[48:51], a[96:99], v[200:203]
  v_mfma_f32_16x16x32_bf16 v[204:207], v[48:51], a[100:103], v[204:207]
  s_add_u32 s45, s53, 149760
  buffer_load_dwordx4 a[172:175], v3, s[28:31], s45 offen sc1
  v_mfma_f32_16x16x32_bf16 v[208:211], v[52:55], a[96:99], v[208:211]
  v_mfma_f32_16x16x32_bf16 v[212:215], v[52:55], a[100:103], v[212:215]
  s_waitcnt lgkmcnt(8)
  v_mfma_f32_16x16x32_bf16 v[200:203], v[56:59], a[104:107], v[200:203]
  v_mfma_f32_16x16x32_bf16 v[204:207], v[56:59], a[108:111], v[204:207]
  v_mfma_f32_16x16x32_bf16 v[208:211], v[60:63], a[104:107], v[208:211]
  v_mfma_f32_16x16x32_bf16 v[212:215], v[60:63], a[108:111], v[212:215]
  s_add_u32 s45, s54, 1024
  buffer_load_dwordx4 a[176:179], v3, s[28:31], s45 offen sc1
  s_waitcnt lgkmcnt(6)
  v_mfma_f32_16x16x32_bf16 v[200:203], v[64:67], a[112:115], v[200:203]
  v_mfma_f32_16x16x32_bf16 v[204:207], v[64:67], a[116:119], v[204:207]
  v_mfma_f32_16x16x32_bf16 v[208:211], v[68:71], a[112:115], v[208:211]
  v_mfma_f32_16x16x32_bf16 v[212:215], v[68:71], a[116:119], v[212:215]
  s_add_u32 s45, s54, 149760
  buffer_load_dwordx4 a[180:183], v3, s[28:31], s45 offen sc1
  s_waitcnt lgkmcnt(0)
  s_waitcnt vmcnt(34)
  s_barrier
  v_mfma_f32_16x16x32_bf16 v[200:203], v[72:75], a[120:123], v[200:203]
  ds_read_b128 v[32:35], v5 offset:0
  v_mfma_f32_16x16x32_bf16 v[204:207], v[72:75], a[124:127], v[204:207]
  ds_read_b128 v[36:39], v5 offset:1024
  v_mfma_f32_16x16x32_bf16 v[208:211], v[76:79], a[120:123], v[208:211]
  ds_read_b128 v[40:43], v5 offset:2048
  v_mfma_f32_16x16x32_bf16 v[212:215], v[76:79], a[124:127], v[212:215]
  s_add_u32 s45, s55, 1024
  buffer_load_dwordx4 a[184:187], v3, s[28:31], s45 offen sc1
  v_mfma_f32_16x16x32_bf16 v[200:203], v[16:19], a[128:131], v[200:203]
  ds_read_b128 v[44:47], v5 offset:3072
  v_mfma_f32_16x16x32_bf16 v[204:207], v[16:19], a[132:135], v[204:207]
  ds_read_b128 v[48:51], v5 offset:4096
  v_mfma_f32_16x16x32_bf16 v[208:211], v[20:23], a[128:131], v[208:211]
  ds_read_b128 v[52:55], v5 offset:5120
  v_mfma_f32_16x16x32_bf16 v[212:215], v[20:23], a[132:135], v[212:215]
  s_add_u32 s45, s55, 149760
  buffer_load_dwordx4 a[188:191], v3, s[28:31], s45 offen sc1
  v_mfma_f32_16x16x32_bf16 v[200:203], v[24:27], a[136:139], v[200:203]
  ds_read_b128 v[56:59], v5 offset:6144
  v_mfma_f32_16x16x32_bf16 v[204:207], v[24:27], a[140:143], v[204:207]
  ds_read_b128 v[60:63], v5 offset:7168
  v_mfma_f32_16x16x32_bf16 v[208:211], v[28:31], a[136:139], v[208:211]
  ds_read_b128 v[64:67], v5 offset:8192
  v_mfma_f32_16x16x32_bf16 v[212:215], v[28:31], a[140:143], v[212:215]
  ds_read_b128 v[68:71], v5 offset:9216
  s_waitcnt lgkmcnt(8)
  v_mfma_f32_16x16x32_bf16 v[152:155], v[32:35], v[80:83], 0
  ds_read_b128 v[72:75], v5 offset:10240
  v_mfma_f32_16x16x32_bf16 v[156:159], v[32:35], v[84:87], 0
  s_add_u32 s45, s53, 2048
  buffer_load_dwordx4 a[192:195], v3, s[28:31], s45 offen sc1
  v_mfma_f32_16x16x32_bf16 v[160:163], v[36:39], v[80:83], 0
  ds_read_b128 v[76:79], v5 offset:11264
  v_cvt_pk_bf16_f32 v144, v200, v201
  v_mfma_f32_16x16x32_bf16 v[164:167], v[36:39], v[84:87], 0
  v_cvt_pk_bf16_f32 v145, v202, v203
  s_waitcnt lgkmcnt(8)
  v_mfma_f32_16x16x32_bf16 v[168:171], v[40:43], v[80:83], 0
  ds_read_b128 v[16:19], v5 offset:12288
  v_cvt_pk_bf16_f32 v146, v208, v209
  v_mfma_f32_16x16x32_bf16 v[172:175], v[40:43], v[84:87], 0
  v_cvt_pk_bf16_f32 v147, v210, v211
  s_add_u32 s45, s53, 150784
  buffer_load_dwordx4 a[196:199], v3, s[28:31], s45 offen sc1
  v_mfma_f32_16x16x32_bf16 v[152:155], v[44:47], v[88:91], v[152:155]
  ds_read_b128 v[20:23], v5 offset:13312
  v_pk_max_i16 v144, v144, v10
  v_mfma_f32_16x16x32_bf16 v[156:159], v[44:47], v[92:95], v[156:159]
  v_pk_max_i16 v145, v145, v10
  s_waitcnt lgkmcnt(8)
  v_mfma_f32_16x16x32_bf16 v[160:163], v[48:51], v[88:91], v[160:163]
  ds_read_b128 v[24:27], v5 offset:14336
  v_pk_max_i16 v146, v146, v10
  v_mfma_f32_16x16x32_bf16 v[164:167], v[48:51], v[92:95], v[164:167]
  v_pk_max_i16 v147, v147, v10
  s_add_u32 m0, s40, 0
  s_add_u32 s44, s42, 110592
  buffer_load_dwordx4 v3, s[28:31], s44 offen offset:0 sc1 lds
  v_mfma_f32_16x16x32_bf16 v[168:171], v[52:55], v[88:91], v[168:171]
  ds_read_b128 v[28:31], v5 offset:15360
  v_cvt_pk_bf16_f32 v148, v204, v205
  v_mfma_f32_16x16x32_bf16 v[172:175], v[52:55], v[92:95], v[172:175]
  v_cvt_pk_bf16_f32 v149, v206, v207
  s_waitcnt lgkmcnt(8)
  v_mfma_f32_16x16x32_bf16 v[152:155], v[56:59], v[96:99], v[152:155]
  ds_read_b128 v[32:35], v5 offset:16384
  v_mfma_f32_16x16x32_bf16 v[156:159], v[56:59], v[100:103], v[156:159]
  s_add_u32 s45, s47, 8192
  buffer_store_dwordx4 v[144:147], v3, s[28:31], s45 offen sc1
  v_cvt_pk_bf16_f32 v150, v212, v213
  v_cvt_pk_bf16_f32 v151, v214, v215
  v_mfma_f32_16x16x32_bf16 v[160:163], v[60:63], v[96:99], v[160:163]
  ds_read_b128 v[36:39], v5 offset:17408
  v_pk_max_i16 v148, v148, v10
  v_mfma_f32_16x16x32_bf16 v[164:167], v[60:63], v[100:103], v[164:167]
  v_pk_max_i16 v149, v149, v10
  s_waitcnt lgkmcnt(8)
  v_mfma_f32_16x16x32_bf16 v[168:171], v[64:67], v[96:99], v[168:171]
  ds_read_b128 v[40:43], v5 offset:18432
  v_pk_max_i16 v150, v150, v10
  v_mfma_f32_16x16x32_bf16 v[172:175], v[64:67], v[100:103], v[172:175]
  v_pk_max_i16 v151, v151, v10
  v_mfma_f32_16x16x32_bf16 v[152:155], v[68:71], v[104:107], v[152:155]
  ds_read_b128 v[44:47], v5 offset:19456
  v_mfma_f32_16x16x32_bf16 v[156:159], v[68:71], v[108:111], v[156:159]
  buffer_load_dwordx4 v3, s[28:31], s44 offen offset:1024 sc1 lds
  s_waitcnt lgkmcnt(8)
  v_mfma_f32_16x16x32_bf16 v[160:163], v[72:75], v[104:107], v[160:163]
  ds_read_b128 v[48:51], v5 offset:20480
  v_mfma_f32_16x16x32_bf16 v[164:167], v[72:75], v[108:111], v[164:167]
  ds_read_b128 v[52:55], v5 offset:21504
  v_mfma_f32_16x16x32_bf16 v[168:171], v[76:79], v[104:107], v[168:171]
  ds_read_b128 v[56:59], v5 offset:22528
  v_mfma_f32_16x16x32_bf16 v[172:175], v[76:79], v[108:111], v[172:175]
  buffer_load_dwordx4 v3, s[28:31], s44 offen offset:2048 sc1 lds
  s_waitcnt lgkmcnt(9)
  v_mfma_f32_16x16x32_bf16 v[152:155], v[16:19], v[112:115], v[152:155]
  ds_read_b128 v[60:63], v5 offset:23552
  v_mfma_f32_16x16x32_bf16 v[156:159], v[16:19], v[116:119], v[156:159]
  ds_read_b128 v[64:67], v5 offset:24576
  v_mfma_f32_16x16x32_bf16 v[160:163], v[20:23], v[112:115], v[160:163]
  ds_read_b128 v[68:71], v5 offset:25600
  v_mfma_f32_16x16x32_bf16 v[164:167], v[20:23], v[116:119], v[164:167]
  buffer_load_dwordx4 v3, s[28:31], s44 offen offset:3072 sc1 lds
  s_waitcnt lgkmcnt(10)
  v_mfma_f32_16x16x32_bf16 v[168:171], v[24:27], v[112:115], v[168:171]
  ds_read_b128 v[72:75], v5 offset:26624
  v_mfma_f32_16x16x32_bf16 v[172:175], v[24:27], v[116:119], v[172:175]
  v_mfma_f32_16x16x32_bf16 v[152:155], v[28:31], v[120:123], v[152:155]
  ds_read_b128 v[76:79], v5 offset:27648
  v_mfma_f32_16x16x32_bf16 v[156:159], v[28:31], v[124:127], v[156:159]
  s_add_u32 m0, s40, 4096
  s_add_u32 s44, s42, 114688
  buffer_load_dwordx4 v3, s[28:31], s44 offen offset:0 sc1 lds
  s_waitcnt lgkmcnt(10)
  v_mfma_f32_16x16x32_bf16 v[160:163], v[32:35], v[120:123], v[160:163]
  ds_read_b128 v[16:19], v5 offset:28672
  v_mfma_f32_16x16x32_bf16 v[164:167], v[32:35], v[124:127], v[164:167]
  v_mfma_f32_16x16x32_bf16 v[168:171], v[36:39], v[120:123], v[168:171]
  ds_read_b128 v[20:23], v5 offset:29696
  v_mfma_f32_16x16x32_bf16 v[172:175], v[36:39], v[124:127], v[172:175]
  s_waitcnt lgkmcnt(10)
  v_mfma_f32_16x16x32_bf16 v[152:155], v[40:43], v[128:131], v[152:155]
  ds_read_b128 v[24:27], v5 offset:30720
  v_mfma_f32_16x16x32_bf16 v[156:159], v[40:43], v[132:135], v[156:159]
  s_add_u32 s45, s47, 156928
  buffer_store_dwordx4 v[148:151], v3, s[28:31], s45 offen sc1
  v_mfma_f32_16x16x32_bf16 v[160:163], v[44:47], v[128:131], v[160:163]
  ds_read_b128 v[28:31], v5 offset:31744
  v_mfma_f32_16x16x32_bf16 v[164:167], v[44:47], v[132:135], v[164:167]
  s_waitcnt lgkmcnt(10)
  v_mfma_f32_16x16x32_bf16 v[168:171], v[48:51], v[128:131], v[168:171]
  ds_read_b128 v[32:35], v5 offset:32768
  v_mfma_f32_16x16x32_bf16 v[172:175], v[48:51], v[132:135], v[172:175]
  buffer_load_dwordx4 v3, s[28:31], s44 offen offset:1024 sc1 lds
  v_mfma_f32_16x16x32_bf16 v[152:155], v[52:55], v[136:139], v[152:155]
  ds_read_b128 v[36:39], v5 offset:33792
  v_mfma_f32_16x16x32_bf16 v[156:159], v[52:55], v[140:143], v[156:159]
  s_waitcnt lgkmcnt(10)
  v_mfma_f32_16x16x32_bf16 v[160:163], v[56:59], v[136:139], v[160:163]
  ds_read_b128 v[40:43], v5 offset:34816
  v_mfma_f32_16x16x32_bf16 v[164:167], v[56:59], v[140:143], v[164:167]
  buffer_load_dwordx2 v[12:13], v8, s[28:31], s48 offen offset:0 sc1
  v_mfma_f32_16x16x32_bf16 v[168:171], v[60:63], v[136:139], v[168:171]
  ds_read_b128 v[44:47], v5 offset:35840
  v_mfma_f32_16x16x32_bf16 v[172:175], v[60:63], v[140:143], v[172:175]
  s_waitcnt lgkmcnt(10)
  v_mfma_f32_16x16x32_bf16 v[152:155], v[64:67], v[144:147], v[152:155]
  v_mfma_f32_16x16x32_bf16 v[156:159], v[64:67], v[148:151], v[156:159]
  buffer_load_dwordx4 v3, s[28:31], s44 offen offset:2048 sc1 lds
  v_mfma_f32_16x16x32_bf16 v[160:163], v[68:71], v[144:147], v[160:163]
  v_mfma_f32_16x16x32_bf16 v[164:167], v[68:71], v[148:151], v[164:167]
  s_waitcnt lgkmcnt(8)
  v_mfma_f32_16x16x32_bf16 v[168:171], v[72:75], v[144:147], v[168:171]
  v_mfma_f32_16x16x32_bf16 v[172:175], v[72:75], v[148:151], v[172:175]
  v_mfma_f32_16x16x32_bf16 v[176:179], v[76:79], v[80:83], 0
  v_mfma_f32_16x16x32_bf16 v[180:183], v[76:79], v[84:87], 0
  buffer_load_dwordx4 v3, s[28:31], s44 offen offset:3072 sc1 lds
  s_waitcnt lgkmcnt(6)
  v_mfma_f32_16x16x32_bf16 v[184:187], v[16:19], v[80:83], 0
  v_mfma_f32_16x16x32_bf16 v[188:191], v[16:19], v[84:87], 0
  v_mfma_f32_16x16x32_bf16 v[192:195], v[20:23], v[80:83], 0
  v_mfma_f32_16x16x32_bf16 v[196:199], v[20:23], v[84:87], 0
  s_add_u32 m0, s40, 8192
  s_add_u32 s44, s42, 118784
  buffer_load_dwordx4 v3, s[28:31], s44 offen offset:0 sc1 lds
  s_waitcnt lgkmcnt(0)
  s_waitcnt vmcnt(38)
  s_barrier
  v_mfma_f32_16x16x32_bf16 v[176:179], v[24:27], v[88:91], v[176:179]
  ds_read_b128 v[48:51], v6 offset:0
  v_mfma_f32_16x16x32_bf16 v[180:183], v[24:27], v[92:95], v[180:183]
  ds_read_b128 v[52:55], v6 offset:1024
  v_mfma_f32_16x16x32_bf16 v[184:187], v[28:31], v[88:91], v[184:187]
  ds_read_b128 v[56:59], v6 offset:2048
  v_mfma_f32_16x16x32_bf16 v[188:191], v[28:31], v[92:95], v[188:191]
  s_add_u32 s45, s54, 2048
  buffer_load_dwordx4 a[200:203], v3, s[28:31], s45 offen sc1
  v_mfma_f32_16x16x32_bf16 v[192:195], v[32:35], v[88:91], v[192:195]
  ds_read_b128 v[60:63], v6 offset:3072
  v_mfma_f32_16x16x32_bf16 v[196:199], v[32:35], v[92:95], v[196:199]
  ds_read_b128 v[64:67], v6 offset:4096
  v_mfma_f32_16x16x32_bf16 v[176:179], v[36:39], v[96:99], v[176:179]
  ds_read_b128 v[68:71], v6 offset:5120
  v_mfma_f32_16x16x32_bf16 v[180:183], v[36:39], v[100:103], v[180:183]
  s_add_u32 s45, s54, 150784
  buffer_load_dwordx4 a[204:207], v3, s[28:31], s45 offen sc1
  v_mfma_f32_16x16x32_bf16 v[184:187], v[40:43], v[96:99], v[184:187]
  ds_read_b128 v[72:75], v6 offset:6144
  v_mfma_f32_16x16x32_bf16 v[188:191], v[40:43], v[100:103], v[188:191]
  ds_read_b128 v[76:79], v6 offset:7168
  v_mfma_f32_16x16x32_bf16 v[192:195], v[44:47], v[96:99], v[192:195]
  ds_read_b128 v[16:19], v6 offset:8192
  v_mfma_f32_16x16x32_bf16 v[196:199], v[44:47], v[100:103], v[196:199]
  ds_read_b128 v[20:23], v6 offset:9216
  s_waitcnt lgkmcnt(8)
  v_mfma_f32_16x16x32_bf16 v[176:179], v[48:51], v[104:107], v[176:179]
  ds_read_b128 v[24:27], v6 offset:10240
  v_mfma_f32_16x16x32_bf16 v[180:183], v[48:51], v[108:111], v[180:183]
  s_add_u32 s45, s55, 2048
  buffer_load_dwordx4 a[208:211], v3, s[28:31], s45 offen sc1
  v_mfma_f32_16x16x32_bf16 v[184:187], v[52:55], v[104:107], v[184:187]
  ds_read_b128 v[28:31], v6 offset:11264
  v_mfma_f32_16x16x32_bf16 v[188:191], v[52:55], v[108:111], v[188:191]
  ds_read_b128 v[32:35], v6 offset:12288
  s_waitcnt lgkmcnt(9)
  v_mfma_f32_16x16x32_bf16 v[192:195], v[56:59], v[104:107], v[192:195]
  ds_read_b128 v[36:39], v6 offset:13312
  v_mfma_f32_16x16x32_bf16 v[196:199], v[56:59], v[108:111], v[196:199]
  s_add_u32 s45, s55, 150784
  buffer_load_dwordx4 a[212:215], v3, s[28:31], s45 offen sc1
  v_mfma_f32_16x16x32_bf16 v[176:179], v[60:63], v[112:115], v[176:179]
  ds_read_b128 v[40:43], v6 offset:14336
  v_mfma_f32_16x16x32_bf16 v[180:183], v[60:63], v[116:119], v[180:183]
  ds_read_b128 v[44:47], v6 offset:15360
  s_waitcnt lgkmcnt(10)
  v_mfma_f32_16x16x32_bf16 v[184:187], v[64:67], v[112:115], v[184:187]
  ds_read_b128 v[48:51], v6 offset:16384
  v_mfma_f32_16x16x32_bf16 v[188:191], v[64:67], v[116:119], v[188:191]
  s_add_u32 s45, s53, 3072
  buffer_load_dwordx4 a[216:219], v3, s[28:31], s45 offen sc1
  v_mfma_f32_16x16x32_bf16 v[192:195], v[68:71], v[112:115], v[192:195]
  ds_read_b128 v[52:55], v6 offset:17408
  v_mfma_f32_16x16x32_bf16 v[196:199], v[68:71], v[116:119], v[196:199]
  s_waitcnt lgkmcnt(10)
  v_mfma_f32_16x16x32_bf16 v[176:179], v[72:75], v[120:123], v[176:179]
  ds_read_b128 v[56:59], v6 offset:18432
  v_mfma_f32_16x16x32_bf16 v[180:183], v[72:75], v[124:127], v[180:183]
  s_add_u32 s45, s53, 151808
  buffer_load_dwordx4 a[220:223], v3, s[28:31], s45 offen sc1
  v_mfma_f32_16x16x32_bf16 v[184:187], v[76:79], v[120:123], v[184:187]
  ds_read_b128 v[60:63], v6 offset:19456
  v_mfma_f32_16x16x32_bf16 v[188:191], v[76:79], v[124:127], v[188:191]
  s_waitcnt lgkmcnt(10)
  v_mfma_f32_16x16x32_bf16 v[192:195], v[16:19], v[120:123], v[192:195]
  ds_read_b128 v[64:67], v6 offset:20480
  v_mfma_f32_16x16x32_bf16 v[196:199], v[16:19], v[124:127], v[196:199]
  v_mfma_f32_16x16x32_bf16 v[176:179], v[20:23], v[128:131], v[176:179]
  ds_read_b128 v[68:71], v6 offset:21504
  v_mfma_f32_16x16x32_bf16 v[180:183], v[20:23], v[132:135], v[180:183]
  s_add_u32 s45, s54, 3072
  buffer_load_dwordx4 a[224:227], v3, s[28:31], s45 offen sc1
  s_waitcnt lgkmcnt(10)
  v_mfma_f32_16x16x32_bf16 v[184:187], v[24:27], v[128:131], v[184:187]
  ds_read_b128 v[72:75], v6 offset:22528
  v_mfma_f32_16x16x32_bf16 v[188:191], v[24:27], v[132:135], v[188:191]
  v_mfma_f32_16x16x32_bf16 v[192:195], v[28:31], v[128:131], v[192:195]
  ds_read_b128 v[76:79], v6 offset:23552
  v_mfma_f32_16x16x32_bf16 v[196:199], v[28:31], v[132:135], v[196:199]
  s_waitcnt vmcnt(10)
  s_mov_b32 s58, 0
  s_add_u32 s59, s88, 7
L_p2_2_chk:
  s_mov_b64 s[60:61], -1
  v_subrev_u32 v14, s59, v12
  v_cmp_gt_u32 vcc, 9, v14
  v_cmp_eq_u32 s[62:63], s89, v13
  s_nop 1
  s_and_b64 vcc, vcc, s[62:63]
  s_and_b64 s[60:61], s[60:61], vcc
  s_cmp_eq_u64 s[60:61], -1
  s_cbranch_scc1 L_p2_2_ok
  s_add_u32 s58, s58, 1
  s_cmp_gt_u32 s58, 20000
  s_cbranch_scc1 L_p2_2_ok
  buffer_load_dwordx2 v[12:13], v8, s[28:31], s48 offen offset:0 sc1
  s_waitcnt vmcnt(0)
  s_branch L_p2_2_chk
L_p2_2_ok:
  s_add_u32 s45, s54, 151808
  buffer_load_dwordx4 a[228:231], v3, s[28:31], s45 offen sc1
  s_waitcnt lgkmcnt(10)
  v_mfma_f32_16x16x32_bf16 v[176:179], v[32:35], v[136:139], v[176:179]
  ds_read_b128 v[16:19], v6 offset:24576
  v_mfma_f32_16x16x32_bf16 v[180:183], v[32:35], v[140:143], v[180:183]
  v_mfma_f32_16x16x32_bf16 v[184:187], v[36:39], v[136:139], v[184:187]
  ds_read_b128 v[20:23], v6 offset:25600
  v_mfma_f32_16x16x32_bf16 v[188:191], v[36:39], v[140:143], v[188:191]
  s_add_u32 s45, s55, 3072
  buffer_load_dwordx4 a[232:235], v3, s[28:31], s45 offen sc1
  s_waitcnt lgkmcnt(10)
  v_mfma_f32_16x16x32_bf16 v[192:195], v[40:43], v[136:139], v[192:195]
  ds_read_b128 v[24:27], v6 offset:26624
  v_mfma_f32_16x16x32_bf16 v[196:199], v[40:43], v[140:143], v[196:199]
  v_mfma_f32_16x16x32_bf16 v[176:179], v[44:47], v[144:147], v[176:179]
  ds_read_b128 v[28:31], v6 offset:27648
  v_mfma_f32_16x16x32_bf16 v[180:183], v[44:47], v[148:151], v[180:183]
  s_add_u32 s45, s55, 151808
  buffer_load_dwordx4 a[236:239], v3, s[28:31], s45 offen sc1
  s_waitcnt lgkmcnt(10)
  v_mfma_f32_16x16x32_bf16 v[184:187], v[48:51], v[144:147], v[184:187]
  ds_read_b128 v[32:35], v6 offset:28672
  v_mfma_f32_16x16x32_bf16 v[188:191], v[48:51], v[148:151], v[188:191]
  v_mfma_f32_16x16x32_bf16 v[192:195], v[52:55], v[144:147], v[192:195]
  ds_read_b128 v[36:39], v6 offset:29696
  v_mfma_f32_16x16x32_bf16 v[196:199], v[52:55], v[148:151], v[196:199]
  s_waitcnt lgkmcnt(10)
  v_mfma_f32_16x16x32_bf16 v[224:227], v[56:59], v[80:83], 0
  ds_read_b128 v[40:43], v6 offset:30720
  v_mfma_f32_16x16x32_bf16 v[228:231], v[56:59], v[84:87], 0
  s_waitcnt vmcnt(15)
  s_add_u32 s61, s88, 9
  v_mov_b32 v14, s61
  v_mov_b32 v15, s89
  s_mov_b64 exec, 1
  buffer_store_dwordx2 v[14:15], v10, s[28:31], s51 offen sc1
  s_mov_b64 exec, -1
  v_mfma_f32_16x16x32_bf16 v[232:235], v[60:63], v[80:83], 0
  ds_read_b128 v[44:47], v6 offset:31744
  v_mfma_f32_16x16x32_bf16 v[236:239], v[60:63], v[84:87], 0
  s_waitcnt lgkmcnt(10)
  v_mfma_f32_16x16x32_bf16 v[240:243], v[64:67], v[80:83], 0
  ds_read_b128 v[48:51], v6 offset:32768
  v_mfma_f32_16x16x32_bf16 v[244:247], v[64:67], v[84:87], 0
  s_add_u32 s45, s53, 4096
  buffer_load_dwordx4 a[240:243], v3, s[28:31], s45 offen sc1
  v_mfma_f32_16x16x32_bf16 v[224:227], v[68:71], v[88:91], v[224:227]
  ds_read_b128 v[52:55], v6 offset:33792
  v_mfma_f32_16x16x32_bf16 v[228:231], v[68:71], v[92:95], v[228:231]
  s_waitcnt lgkmcnt(10)
  v_mfma_f32_16x16x32_bf16 v[232:235], v[72:75], v[88:91], v[232:235]
  ds_read_b128 v[56:59], v6 offset:34816
  v_mfma_f32_16x16x32_bf16 v[236:239], v[72:75], v[92:95], v[236:239]
  s_add_u32 s45, s53, 152832
  buffer_load_dwordx4 a[244:247], v3, s[28:31], s45 offen sc1
  v_mfma_f32_16x16x32_bf16 v[240:243], v[76:79], v[88:91], v[240:243]
  ds_read_b128 v[60:63], v6 offset:35840
  v_mfma_f32_16x16x32_bf16 v[244:247], v[76:79], v[92:95], v[244:247]
  s_waitcnt lgkmcnt(10)
  v_mfma_f32_16x16x32_bf16 v[224:227], v[16:19], v[96:99], v[224:227]
  v_mfma_f32_16x16x32_bf16 v[228:231], v[16:19], v[100:103], v[228:231]
  s_add_u32 s45, s54, 4096
  buffer_load_dwordx4 a[248:251], v3, s[28:31], s45 offen sc1
  v_mfma_f32_16x16x32_bf16 v[232:235], v[20:23], v[96:99], v[232:235]
  v_mfma_f32_16x16x32_bf16 v[236:239], v[20:23], v[100:103], v[236:239]
  s_waitcnt lgkmcnt(8)
  v_mfma_f32_16x16x32_bf16 v[240:243], v[24:27], v[96:99], v[240:243]
  v_mfma_f32_16x16x32_bf16 v[244:247], v[24:27], v[100:103], v[244:247]
  v_mfma_f32_16x16x32_bf16 v[224:227], v[28:31], v[104:107], v[224:227]
  v_mfma_f32_16x16x32_bf16 v[228:231], v[28:31], v[108:111], v[228:231]
  s_add_u32 s45, s54, 152832
  buffer_load_dwordx4 a[252:255], v3, s[28:31], s45 offen sc1
  s_waitcnt lgkmcnt(6)
  v_mfma_f32_16x16x32_bf16 v[232:235], v[32:35], v[104:107], v[232:235]
  v_mfma_f32_16x16x32_bf16 v[236:239], v[32:35], v[108:111], v[236:239]
  v_mfma_f32_16x16x32_bf16 v[240:243], v[36:39], v[104:107], v[240:243]
  v_mfma_f32_16x16x32_bf16 v[244:247], v[36:39], v[108:111], v[244:247]
  s_add_u32 s45, s55, 4096
  buffer_load_dwordx4 a[0:3], v3, s[28:31], s45 offen sc1
  s_waitcnt lgkmcnt(0)
  s_waitcnt vmcnt(38)
  s_barrier
  v_mfma_f32_16x16x32_bf16 v[224:227], v[40:43], v[112:115], v[224:227]
  ds_read_b128 v[64:67], v7 offset:0
  v_mfma_f32_16x16x32_bf16 v[228:231], v[40:43], v[116:119], v[228:231]
  ds_read_b128 v[68:71], v7 offset:1024
  v_mfma_f32_16x16x32_bf16 v[232:235], v[44:47], v[112:115], v[232:235]
  ds_read_b128 v[72:75], v7 offset:2048
  v_mfma_f32_16x16x32_bf16 v[236:239], v[44:47], v[116:119], v[236:239]
  s_add_u32 s45, s55, 152832
  buffer_load_dwordx4 a[4:7], v3, s[28:31], s45 offen sc1
  v_mfma_f32_16x16x32_bf16 v[240:243], v[48:51], v[112:115], v[240:243]
  ds_read_b128 v[76:79], v7 offset:3072
  v_mfma_f32_16x16x32_bf16 v[244:247], v[48:51], v[116:119], v[244:247]
  ds_read_b128 v[16:19], v7 offset:4096
  v_mfma_f32_16x16x32_bf16 v[224:227], v[52:55], v[120:123], v[224:227]
  ds_read_b128 v[20:23], v7 offset:5120
  v_mfma_f32_16x16x32_bf16 v[228:231], v[52:55], v[124:127], v[228:231]
  s_add_u32 s45, s53, 5120
  buffer_load_dwordx4 a[8:11], v3, s[28:31], s45 offen sc1
  v_mfma_f32_16x16x32_bf16 v[232:235], v[56:59], v[120:123], v[232:235]
  ds_read_b128 v[24:27], v7 offset:6144
  v_mfma_f32_16x16x32_bf16 v[236:239], v[56:59], v[124:127], v[236:239]
  ds_read_b128 v[28:31], v7 offset:7168
  v_mfma_f32_16x16x32_bf16 v[240:243], v[60:63], v[120:123], v[240:243]
  ds_read_b128 v[32:35], v7 offset:8192
  v_mfma_f32_16x16x32_bf16 v[244:247], v[60:63], v[124:127], v[244:247]
  ds_read_b128 v[36:39], v7 offset:9216
  s_waitcnt lgkmcnt(8)
  v_mfma_f32_16x16x32_bf16 v[224:227], v[64:67], v[128:131], v[224:227]
  ds_read_b128 v[40:43], v7 offset:10240
  v_mfma_f32_16x16x32_bf16 v[228:231], v[64:67], v[132:135], v[228:231]
  s_add_u32 s45, s53, 153856
  buffer_load_dwordx4 a[12:15], v3, s[28:31], s45 offen sc1
  v_mfma_f32_16x16x32_bf16 v[232:235], v[68:71], v[128:131], v[232:235]
  ds_read_b128 v[44:47], v7 offset:11264
  v_mfma_f32_16x16x32_bf16 v[236:239], v[68:71], v[132:135], v[236:239]
  ds_read_b128 v[48:51], v7 offset:12288
  s_waitcnt lgkmcnt(9)
  v_mfma_f32_16x16x32_bf16 v[240:243], v[72:75], v[128:131], v[240:243]
  ds_read_b128 v[52:55], v7 offset:13312
  v_mfma_f32_16x16x32_bf16 v[244:247], v[72:75], v[132:135], v[244:247]
  s_add_u32 s45, s54, 5120
  buffer_load_dwordx4 a[16:19], v3, s[28:31], s45 offen sc1
  v_mfma_f32_16x16x32_bf16 v[224:227], v[76:79], v[136:139], v[224:227]
  ds_read_b128 v[56:59], v7 offset:14336
  v_mfma_f32_16x16x32_bf16 v[228:231], v[76:79], v[140:143], v[228:231]
  ds_read_b128 v[60:63], v7 offset:15360
  s_waitcnt lgkmcnt(10)
  v_mfma_f32_16x16x32_bf16 v[232:235], v[16:19], v[136:139], v[232:235]
  ds_read_b128 v[64:67], v7 offset:16384
  v_mfma_f32_16x16x32_bf16 v[236:239], v[16:19], v[140:143], v[236:239]
  s_add_u32 s45, s54, 153856
  buffer_load_dwordx4 a[20:23], v3, s[28:31], s45 offen sc1
  v_mfma_f32_16x16x32_bf16 v[240:243], v[20:23], v[136:139], v[240:243]
  ds_read_b128 v[68:71], v7 offset:17408
  v_mfma_f32_16x16x32_bf16 v[244:247], v[20:23], v[140:143], v[244:247]
  s_waitcnt lgkmcnt(10)
  v_mfma_f32_16x16x32_bf16 v[224:227], v[24:27], v[144:147], v[224:227]
  ds_read_b128 v[72:75], v7 offset:18432
  v_mfma_f32_16x16x32_bf16 v[228:231], v[24:27], v[148:151], v[228:231]
  s_add_u32 s45, s55, 5120
  buffer_load_dwordx4 a[24:27], v3, s[28:31], s45 offen sc1
  v_mfma_f32_16x16x32_bf16 v[232:235], v[28:31], v[144:147], v[232:235]
  ds_read_b128 v[76:79], v7 offset:19456
  v_mfma_f32_16x16x32_bf16 v[236:239], v[28:31], v[148:151], v[236:239]
  s_waitcnt lgkmcnt(10)
  v_mfma_f32_16x16x32_bf16 v[240:243], v[32:35], v[144:147], v[240:243]
  ds_read_b128 v[16:19], v7 offset:20480
  v_mfma_f32_16x16x32_bf16 v[244:247], v[32:35], v[148:151], v[244:247]
  s_waitcnt vmcnt(63)
  v_mfma_f32_16x16x32_bf16 v[152:155], v[36:39], a[144:147], v[152:155]
  ds_read_b128 v[20:23], v7 offset:21504
  v_mfma_f32_16x16x32_bf16 v[156:159], v[36:39], a[148:151], v[156:159]
  s_add_u32 s45, s55, 153856
  buffer_load_dwordx4 a[28:31], v3, s[28:31], s45 offen sc1
  s_waitcnt lgkmcnt(10)
  v_mfma_f32_16x16x32_bf16 v[160:163], v[40:43], a[144:147], v[160:163]
  ds_read_b128 v[24:27], v7 offset:22528
  v_mfma_f32_16x16x32_bf16 v[164:167], v[40:43], a[148:151], v[164:167]
  v_mfma_f32_16x16x32_bf16 v[168:171], v[44:47], a[144:147], v[168:171]
  ds_read_b128 v[28:31], v7 offset:23552
  v_mfma_f32_16x16x32_bf16 v[172:175], v[44:47], a[148:151], v[172:175]
  s_add_u32 m0, s40, 36864
  s_add_u32 s44, s42, 147456
  buffer_load_dwordx4 v3, s[28:31], s44 offen offset:0 sc1 lds
  s_waitcnt lgkmcnt(10)
  s_waitcnt vmcnt(59)
  v_mfma_f32_16x16x32_bf16 v[152:155], v[48:51], a[152:155], v[152:155]
  ds_read_b128 v[32:35], v7 offset:24576
  v_mfma_f32_16x16x32_bf16 v[156:159], v[48:51], a[156:159], v[156:159]
  v_mfma_f32_16x16x32_bf16 v[160:163], v[52:55], a[152:155], v[160:163]
  ds_read_b128 v[36:39], v7 offset:25600
  v_mfma_f32_16x16x32_bf16 v[164:167], v[52:55], a[156:159], v[164:167]
  buffer_load_dwordx4 v3, s[28:31], s44 offen offset:1024 sc1 lds
  s_waitcnt lgkmcnt(10)
  v_mfma_f32_16x16x32_bf16 v[168:171], v[56:59], a[152:155], v[168:171]
  ds_read_b128 v[40:43], v7 offset:26624
  v_mfma_f32_16x16x32_bf16 v[172:175], v[56:59], a[156:159], v[172:175]
  s_waitcnt vmcnt(58)
  v_mfma_f32_16x16x32_bf16 v[152:155], v[60:63], a[160:163], v[152:155]
  ds_read_b128 v[44:47], v7 offset:27648
  v_mfma_f32_16x16x32_bf16 v[156:159], v[60:63], a[164:167], v[156:159]
  buffer_load_dwordx4 v3, s[28:31], s44 offen offset:2048 sc1 lds
  s_waitcnt lgkmcnt(10)
  v_mfma_f32_16x16x32_bf16 v[160:163], v[64:67], a[160:163], v[160:163]
  ds_read_b128 v[48:51], v7 offset:28672
  v_mfma_f32_16x16x32_bf16 v[164:167], v[64:67], a[164:167], v[164:167]
  v_mfma_f32_16x16x32_bf16 v[168:171], v[68:71], a[160:163], v[168:171]
  ds_read_b128 v[52:55], v7 offset:29696
  v_mfma_f32_16x16x32_bf16 v[172:175], v[68:71], a[164:167], v[172:175]
  s_waitcnt lgkmcnt(10)
  s_waitcnt vmcnt(44)
  v_mfma_f32_16x16x32_bf16 v[152:155], v[72:75], a[168:171], v[152:155]
  ds_read_b128 v[56:59], v7 offset:30720
  v_mfma_f32_16x16x32_bf16 v[156:159], v[72:75], a[172:175], v[156:159]
  buffer_load_dwordx4 v3, s[28:31], s44 offen offset:3072 sc1 lds
  v_mfma_f32_16x16x32_bf16 v[160:163], v[76:79], a[168:171], v[160:163]
  ds_read_b128 v[60:63], v7 offset:31744
  v_mfma_f32_16x16x32_bf16 v[164:167], v[76:79], a[172:175], v[164:167]
  s_waitcnt lgkmcnt(10)
  v_mfma_f32_16x16x32_bf16 v[168:171], v[16:19], a[168:171], v[168:171]
  ds_read_b128 v[64:67], v7 offset:32768
  v_mfma_f32_16x16x32_bf16 v[172:175], v[16:19], a[172:175], v[172:175]
  buffer_load_dwordx2 v[12:13], v8, s[28:31], s48 offen offset:0 sc1
  s_waitcnt vmcnt(44)
  v_mfma_f32_16x16x32_bf16 v[152:155], v[20:23], a[176:179], v[152:155]
  ds_read_b128 v[68:71], v7 offset:33792
  v_mfma_f32_16x16x32_bf16 v[156:159], v[20:23], a[180:183], v[156:159]
  s_waitcnt lgkmcnt(10)
  v_mfma_f32_16x16x32_bf16 v[160:163], v[24:27], a[176:179], v[160:163]
  ds_read_b128 v[72:75], v7 offset:34816
  v_mfma_f32_16x16x32_bf16 v[164:167], v[24:27], a[180:183], v[164:167]
  s_add_u32 m0, s40, 40960
  s_add_u32 s44, s42, 151552
  buffer_load_dwordx4 v3, s[28:31], s44 offen offset:0 sc1 lds
  v_mfma_f32_16x16x32_bf16 v[168:171], v[28:31], a[176:179], v[168:171]
  ds_read_b128 v[76:79], v7 offset:35840
  v_mfma_f32_16x16x32_bf16 v[172:175], v[28:31], a[180:183], v[172:175]
  s_waitcnt lgkmcnt(10)
  s_waitcnt vmcnt(43)
  v_mfma_f32_16x16x32_bf16 v[152:155], v[32:35], a[184:187], v[152:155]
  v_mfma_f32_16x16x32_bf16 v[156:159], v[32:35], a[188:191], v[156:159]
  buffer_load_dwordx4 v3, s[28:31], s44 offen offset:1024 sc1 lds
  v_mfma_f32_16x16x32_bf16 v[160:163], v[36:39], a[184:187], v[160:163]
  v_mfma_f32_16x16x32_bf16 v[164:167], v[36:39], a[188:191], v[164:167]
  s_waitcnt lgkmcnt(8)
  v_mfma_f32_16x16x32_bf16 v[168:171], v[40:43], a[184:187], v[168:171]
  v_mfma_f32_16x16x32_bf16 v[172:175], v[40:43], a[188:191], v[172:175]
  s_waitcnt vmcnt(42)
  v_mfma_f32_16x16x32_bf16 v[152:155], v[44:47], a[192:195], v[152:155]
  v_mfma_f32_16x16x32_bf16 v[156:159], v[44:47], a[196:199], v[156:159]
  buffer_load_dwordx4 v3, s[28:31], s44 offen offset:2048 sc1 lds
  s_waitcnt lgkmcnt(6)
  v_mfma_f32_16x16x32_bf16 v[160:163], v[48:51], a[192:195], v[160:163]
  v_mfma_f32_16x16x32_bf16 v[164:167], v[48:51], a[196:199], v[164:167]
  v_mfma_f32_16x16x32_bf16 v[168:171], v[52:55], a[192:195], v[168:171]
  v_mfma_f32_16x16x32_bf16 v[172:175], v[52:55], a[196:199], v[172:175]
  buffer_load_dwordx4 v3, s[28:31], s44 offen offset:3072 sc1 lds
  s_waitcnt lgkmcnt(0)
  s_waitcnt vmcnt(32)
  s_barrier
  s_waitcnt vmcnt(30)
  v_mfma_f32_16x16x32_bf16 v[152:155], v[56:59], a[200:203], v[152:155]
  ds_read_b128 v[16:19], v4 offset:0
  v_mfma_f32_16x16x32_bf16 v[156:159], v[56:59], a[204:207], v[156:159]
  ds_read_b128 v[20:23], v4 offset:1024
  v_mfma_f32_16x16x32_bf16 v[160:163], v[60:63], a[200:203], v[160:163]
  ds_read_b128 v[24:27], v4 offset:2048
  v_mfma_f32_16x16x32_bf16 v[164:167], v[60:63], a[204:207], v[164:167]
  s_add_u32 m0, s40, 45056
  s_add_u32 s44, s42, 155648
  buffer_load_dwordx4 v3, s[28:31], s44 offen offset:0 sc1 lds
  v_mfma_f32_16x16x32_bf16 v[168:171], v[64:67], a[200:203], v[168:171]
  ds_read_b128 v[28:31], v4 offset:3072
  v_mfma_f32_16x16x32_bf16 v[172:175], v[64:67], a[204:207], v[172:175]
  ds_read_b128 v[32:35], v4 offset:4096
  s_waitcnt vmcnt(29)
  v_mfma_f32_16x16x32_bf16 v[152:155], v[68:71], a[208:211], v[152:155]
  ds_read_b128 v[36:39], v4 offset:5120
  v_mfma_f32_16x16x32_bf16 v[156:159], v[68:71], a[212:215], v[156:159]
  s_add_u32 m0, s40, 73728
  s_add_u32 s44, s42, 184320
  buffer_load_dwordx4 v3, s[28:31], s44 offen offset:0 sc1 lds
  v_mfma_f32_16x16x32_bf16 v[160:163], v[72:75], a[208:211], v[160:163]
  ds_read_b128 v[40:43], v4 offset:6144
  v_mfma_f32_16x16x32_bf16 v[164:167], v[72:75], a[212:215], v[164:167]
  ds_read_b128 v[44:47], v4 offset:7168
  v_mfma_f32_16x16x32_bf16 v[168:171], v[76:79], a[208:211], v[168:171]
  ds_read_b128 v[48:51], v4 offset:8192
  v_mfma_f32_16x16x32_bf16 v[172:175], v[76:79], a[212:215], v[172:175]
  ds_read_b128 v[52:55], v4 offset:9216
  s_waitcnt lgkmcnt(8)
  s_waitcnt vmcnt(28)
  v_mfma_f32_16x16x32_bf16 v[152:155], v[16:19], a[216:219], v[152:155]
  ds_read_b128 v[56:59], v4 offset:10240
  v_mfma_f32_16x16x32_bf16 v[156:159], v[16:19], a[220:223], v[156:159]
  buffer_load_dwordx4 v3, s[28:31], s44 offen offset:1024 sc1 lds
  v_mfma_f32_16x16x32_bf16 v[160:163], v[20:23], a[216:219], v[160:163]
  ds_read_b128 v[60:63], v4 offset:11264
  v_mfma_f32_16x16x32_bf16 v[164:167], v[20:23], a[220:223], v[164:167]
  ds_read_b128 v[64:67], v4 offset:12288
  s_waitcnt lgkmcnt(9)
  v_mfma_f32_16x16x32_bf16 v[168:171], v[24:27], a[216:219], v[168:171]
  ds_read_b128 v[68:71], v4 offset:13312
  v_mfma_f32_16x16x32_bf16 v[172:175], v[24:27], a[220:223], v[172:175]
  buffer_load_dwordx4 v3, s[28:31], s44 offen offset:2048 sc1 lds
  s_waitcnt vmcnt(28)
  v_mfma_f32_16x16x32_bf16 v[152:155], v[28:31], a[224:227], v[152:155]
  ds_read_b128 v[72:75], v4 offset:14336
  v_mfma_f32_16x16x32_bf16 v[156:159], v[28:31], a[228:231], v[156:159]
  ds_read_b128 v[76:79], v4 offset:15360
  s_waitcnt lgkmcnt(10)
  v_mfma_f32_16x16x32_bf16 v[160:163], v[32:35], a[224:227], v[160:163]
  ds_read_b128 v[16:19], v4 offset:16384
  v_mfma_f32_16x16x32_bf16 v[164:167], v[32:35], a[228:231], v[164:167]
  buffer_load_dwordx4 v3, s[28:31], s44 offen offset:3072 sc1 lds
  v_mfma_f32_16x16x32_bf16 v[168:171], v[36:39], a[224:227], v[168:171]
  ds_read_b128 v[20:23], v4 offset:17408
  v_mfma_f32_16x16x32_bf16 v[172:175], v[36:39], a[228:231], v[172:175]
  s_waitcnt lgkmcnt(10)
  s_waitcnt vmcnt(27)
  v_mfma_f32_16x16x32_bf16 v[152:155], v[40:43], a[232:235], v[152:155]
  ds_read_b128 v[24:27], v4 offset:18432
  v_mfma_f32_16x16x32_bf16 v[156:159], v[40:43], a[236:239], v[156:159]
  s_add_u32 m0, s40, 77824
  s_add_u32 s44, s42, 188416
  buffer_load_dwordx4 v3, s[28:31], s44 offen offset:0 sc1 lds
  v_mfma_f32_16x16x32_bf16 v[160:163], v[44:47], a[232:235], v[160:163]
  ds_read_b128 v[28:31], v4 offset:19456
  v_mfma_f32_16x16x32_bf16 v[164:167], v[44:47], a[236:239], v[164:167]
  s_waitcnt lgkmcnt(10)
  v_mfma_f32_16x16x32_bf16 v[168:171], v[48:51], a[232:235], v[168:171]
  ds_read_b128 v[32:35], v4 offset:20480
  v_mfma_f32_16x16x32_bf16 v[172:175], v[48:51], a[236:239], v[172:175]
  s_waitcnt vmcnt(25)
  v_mfma_f32_16x16x32_bf16 v[152:155], v[52:55], a[240:243], v[152:155]
  ds_read_b128 v[36:39], v4 offset:21504
  v_mfma_f32_16x16x32_bf16 v[156:159], v[52:55], a[244:247], v[156:159]
  s_waitcnt vmcnt(10)
  s_mov_b32 s58, 0
  s_add_u32 s59, s88, 9
L_p2_3_chk:
  s_mov_b64 s[60:61], -1
  v_subrev_u32 v14, s59, v12
  v_cmp_gt_u32 vcc, 7, v14
  v_cmp_eq_u32 s[62:63], s89, v13
  s_nop 1
  s_and_b64 vcc, vcc, s[62:63]
  s_and_b64 s[60:61], s[60:61], vcc
  s_cmp_eq_u64 s[60:61], -1
  s_cbranch_scc1 L_p2_3_ok
  s_add_u32 s58, s58, 1
  s_cmp_gt_u32 s58, 20000
  s_cbranch_scc1 L_p2_3_ok
  buffer_load_dwordx2 v[12:13], v8, s[28:31], s48 offen offset:0 sc1
  s_waitcnt vmcnt(0)
  s_branch L_p2_3_chk
L_p2_3_ok:
  buffer_load_dwordx4 v3, s[28:31], s44 offen offset:1024 sc1 lds
  s_waitcnt lgkmcnt(10)
  v_mfma_f32_16x16x32_bf16 v[160:163], v[56:59], a[240:243], v[160:163]
  ds_read_b128 v[40:43], v4 offset:22528
  v_mfma_f32_16x16x32_bf16 v[164:167], v[56:59], a[244:247], v[164:167]
  v_mfma_f32_16x16x32_bf16 v[168:171], v[60:63], a[240:243], v[168:171]
  ds_read_b128 v[44:47], v4 offset:23552
  v_mfma_f32_16x16x32_bf16 v[172:175], v[60:63], a[244:247], v[172:175]
  buffer_load_dwordx4 v3, s[28:31], s44 offen offset:2048 sc1 lds
  s_waitcnt lgkmcnt(10)
  s_waitcnt vmcnt(25)
  v_mfma_f32_16x16x32_bf16 v[152:155], v[64:67], a[248:251], v[152:155]
  ds_read_b128 v[48:51], v4 offset:24576
  v_mfma_f32_16x16x32_bf16 v[156:159], v[64:67], a[252:255], v[156:159]
  v_mfma_f32_16x16x32_bf16 v[160:163], v[68:71], a[248:251], v[160:163]
  ds_read_b128 v[52:55], v4 offset:25600
  v_mfma_f32_16x16x32_bf16 v[164:167], v[68:71], a[252:255], v[164:167]
  buffer_load_dwordx4 v3, s[28:31], s44 offen offset:3072 sc1 lds
  s_waitcnt lgkmcnt(10)
  v_mfma_f32_16x16x32_bf16 v[168:171], v[72:75], a[248:251], v[168:171]
  ds_read_b128 v[56:59], v4 offset:26624
  v_mfma_f32_16x16x32_bf16 v[172:175], v[72:75], a[252:255], v[172:175]
  s_waitcnt vmcnt(24)
  v_mfma_f32_16x16x32_bf16 v[152:155], v[76:79], a[0:3], v[152:155]
  ds_read_b128 v[60:63], v4 offset:27648
  v_mfma_f32_16x16x32_bf16 v[156:159], v[76:79], a[4:7], v[156:159]
  s_add_u32 m0, s40, 81920
  s_add_u32 s44, s42, 192512
  buffer_load_dwordx4 v3, s[28:31], s44 offen offset:0 sc1 lds
  s_waitcnt lgkmcnt(10)
  v_mfma_f32_16x16x32_bf16 v[160:163], v[16:19], a[0:3], v[160:163]
  ds_read_b128 v[64:67], v4 offset:28672
  v_mfma_f32_16x16x32_bf16 v[164:167], v[16:19], a[4:7], v[164:167]
  v_mfma_f32_16x16x32_bf16 v[168:171], v[20:23], a[0:3], v[168:171]
  ds_read_b128 v[68:71], v4 offset:29696
  v_mfma_f32_16x16x32_bf16 v[172:175], v[20:23], a[4:7], v[172:175]
  s_waitcnt lgkmcnt(10)
  s_waitcnt vmcnt(23)
  v_mfma_f32_16x16x32_bf16 v[152:155], v[24:27], a[8:11], v[152:155]
  ds_read_b128 v[72:75], v4 offset:30720
  v_mfma_f32_16x16x32_bf16 v[156:159], v[24:27], a[12:15], v[156:159]
  s_add_u32 s45, s53, 6144
  buffer_load_dwordx4 a[32:35], v3, s[28:31], s45 offen sc1
  v_mfma_f32_16x16x32_bf16 v[160:163], v[28:31], a[8:11], v[160:163]
  ds_read_b128 v[76:79], v4 offset:31744
  v_mfma_f32_16x16x32_bf16 v[164:167], v[28:31], a[12:15], v[164:167]
  s_waitcnt lgkmcnt(10)
  v_mfma_f32_16x16x32_bf16 v[168:171], v[32:35], a[8:11], v[168:171]
  ds_read_b128 v[16:19], v4 offset:32768
  v_mfma_f32_16x16x32_bf16 v[172:175], v[32:35], a[12:15], v[172:175]
  s_add_u32 s45, s53, 154880
  buffer_load_dwordx4 a[36:39], v3, s[28:31], s45 offen sc1
  s_waitcnt vmcnt(23)
  v_mfma_f32_16x16x32_bf16 v[152:155], v[36:39], a[16:19], v[152:155]
  ds_read_b128 v[20:23], v4 offset:33792
  v_mfma_f32_16x16x32_bf16 v[156:159], v[36:39], a[20:23], v[156:159]
  s_waitcnt lgkmcnt(10)
  v_mfma_f32_16x16x32_bf16 v[160:163], v[40:43], a[16:19], v[160:163]
  ds_read_b128 v[24:27], v4 offset:34816
  v_mfma_f32_16x16x32_bf16 v[164:167], v[40:43], a[20:23], v[164:167]
  s_add_u32 s45, s54, 6144
  buffer_load_dwordx4 a[40:43], v3, s[28:31], s45 offen sc1
  v_mfma_f32_16x16x32_bf16 v[168:171], v[44:47], a[16:19], v[168:171]
  ds_read_b128 v[28:31], v4 offset:35840
  v_mfma_f32_16x16x32_bf16 v[172:175], v[44:47], a[20:23], v[172:175]
  s_waitcnt lgkmcnt(10)
  s_waitcnt vmcnt(22)
  v_mfma_f32_16x16x32_bf16 v[152:155], v[48:51], a[24:27], v[152:155]
  v_mfma_f32_16x16x32_bf16 v[156:159], v[48:51], a[28:31], v[156:159]
  s_add_u32 s45, s54, 154880
  buffer_load_dwordx4 a[44:47], v3, s[28:31], s45 offen sc1
  v_mfma_f32_16x16x32_bf16 v[160:163], v[52:55], a[24:27], v[160:163]
  v_mfma_f32_16x16x32_bf16 v[164:167], v[52:55], a[28:31], v[164:167]
  s_waitcnt lgkmcnt(8)
  v_mfma_f32_16x16x32_bf16 v[168:171], v[56:59], a[24:27], v[168:171]
  v_mfma_f32_16x16x32_bf16 v[172:175], v[56:59], a[28:31], v[172:175]
  v_mfma_f32_16x16x32_bf16 v[176:179], v[60:63], a[144:147], v[176:179]
  v_mfma_f32_16x16x32_bf16 v[180:183], v[60:63], a[148:151], v[180:183]
  s_add_u32 s45, s55, 6144
  buffer_load_dwordx4 a[48:51], v3, s[28:31], s45 offen sc1
  s_waitcnt lgkmcnt(6)
  v_mfma_f32_16x16x32_bf16 v[184:187], v[64:67], a[144:147], v[184:187]
  v_mfma_f32_16x16x32_bf16 v[188:191], v[64:67], a[148:151], v[188:191]
  v_mfma_f32_16x16x32_bf16 v[192:195], v[68:71], a[144:147], v[192:195]
  v_mfma_f32_16x16x32_bf16 v[196:199], v[68:71], a[148:151], v[196:199]
  s_add_u32 s45, s55, 154880
  buffer_load_dwordx4 a[52:55], v3, s[28:31], s45 offen sc1
  s_waitcnt lgkmcnt(0)
  s_waitcnt vmcnt(15)
  s_barrier
  v_mfma_f32_16x16x32_bf16 v[176:179], v[72:75], a[152:155], v[176:179]
  ds_read_b128 v[32:35], v5 offset:0
  v_mfma_f32_16x16x32_bf16 v[180:183], v[72:75], a[156:159], v[180:183]
  ds_read_b128 v[36:39], v5 offset:1024
  v_mfma_f32_16x16x32_bf16 v[184:187], v[76:79], a[152:155], v[184:187]
  ds_read_b128 v[40:43], v5 offset:2048
  v_mfma_f32_16x16x32_bf16 v[188:191], v[76:79], a[156:159], v[188:191]
  s_add_u32 s45, s53, 7168
  buffer_load_dwordx4 a[56:59], v3, s[28:31], s45 offen sc1
  v_mfma_f32_16x16x32_bf16 v[192:195], v[16:19], a[152:155], v[192:195]
  ds_read_b128 v[44:47], v5 offset:3072
  v_mfma_f32_16x16x32_bf16 v[196:199], v[16:19], a[156:159], v[196:199]
  ds_read_b128 v[48:51], v5 offset:4096
  v_mfma_f32_16x16x32_bf16 v[176:179], v[20:23], a[160:163], v[176:179]
  ds_read_b128 v[52:55], v5 offset:5120
  v_mfma_f32_16x16x32_bf16 v[180:183], v[20:23], a[164:167], v[180:183]
  s_add_u32 s45, s53, 155904
  buffer_load_dwordx4 a[60:63], v3, s[28:31], s45 offen sc1
  v_mfma_f32_16x16x32_bf16 v[184:187], v[24:27], a[160:163], v[184:187]
  ds_read_b128 v[56:59], v5 offset:6144
  v_mfma_f32_16x16x32_bf16 v[188:191], v[24:27], a[164:167], v[188:191]
  ds_read_b128 v[60:63], v5 offset:7168
  v_mfma_f32_16x16x32_bf16 v[192:195], v[28:31], a[160:163], v[192:195]
  ds_read_b128 v[64:67], v5 offset:8192
  v_mfma_f32_16x16x32_bf16 v[196:199], v[28:31], a[164:167], v[196:199]
  ds_read_b128 v[68:71], v5 offset:9216
  s_waitcnt lgkmcnt(8)
  v_mfma_f32_16x16x32_bf16 v[176:179], v[32:35], a[168:171], v[176:179]
  ds_read_b128 v[72:75], v5 offset:10240
  v_mfma_f32_16x16x32_bf16 v[180:183], v[32:35], a[172:175], v[180:183]
  s_add_u32 s45, s54, 7168
  buffer_load_dwordx4 a[64:67], v3, s[28:31], s45 offen sc1
  v_mfma_f32_16x16x32_bf16 v[184:187], v[36:39], a[168:171], v[184:187]
  ds_read_b128 v[76:79], v5 offset:11264
  v_mfma_f32_16x16x32_bf16 v[188:191], v[36:39], a[172:175], v[188:191]
  ds_read_b128 v[16:19], v5 offset:12288
  s_waitcnt lgkmcnt(9)
  v_mfma_f32_16x16x32_bf16 v[192:195], v[40:43], a[168:171], v[192:195]
  ds_read_b128 v[20:23], v5 offset:13312
  v_mfma_f32_16x16x32_bf16 v[196:199], v[40:43], a[172:175], v[196:199]
  s_add_u32 s45, s54, 155904
  buffer_load_dwordx4 a[68:71], v3, s[28:31], s45 offen sc1
  v_mfma_f32_16x16x32_bf16 v[176:179], v[44:47], a[176:179], v[176:179]
  ds_read_b128 v[24:27], v5 offset:14336
  v_mfma_f32_16x16x32_bf16 v[180:183], v[44:47], a[180:183], v[180:183]
  ds_read_b128 v[28:31], v5 offset:15360
  s_waitcnt lgkmcnt(10)
  v_mfma_f32_16x16x32_bf16 v[184:187], v[48:51], a[176:179], v[184:187]
  ds_read_b128 v[32:35], v5 offset:16384
  v_mfma_f32_16x16x32_bf16 v[188:191], v[48:51], a[180:183], v[188:191]
  s_add_u32 s45, s55, 7168
  buffer_load_dwordx4 a[72:75], v3, s[28:31], s45 offen sc1
  v_mfma_f32_16x16x32_bf16 v[192:195], v[52:55], a[176:179], v[192:195]
  ds_read_b128 v[36:39], v5 offset:17408
  v_mfma_f32_16x16x32_bf16 v[196:199], v[52:55], a[180:183], v[196:199]
  s_waitcnt lgkmcnt(10)
  v_mfma_f32_16x16x32_bf16 v[176:179], v[56:59], a[184:187], v[176:179]
  ds_read_b128 v[40:43], v5 offset:18432
  v_mfma_f32_16x16x32_bf16 v[180:183], v[56:59], a[188:191], v[180:183]
  s_add_u32 s45, s55, 155904
  buffer_load_dwordx4 a[76:79], v3, s[28:31], s45 offen sc1
  v_mfma_f32_16x16x32_bf16 v[184:187], v[60:63], a[184:187], v[184:187]
  ds_read_b128 v[44:47], v5 offset:19456
  v_mfma_f32_16x16x32_bf16 v[188:191], v[60:63], a[188:191], v[188:191]
  s_waitcnt lgkmcnt(10)
  v_mfma_f32_16x16x32_bf16 v[192:195], v[64:67], a[184:187], v[192:195]
  ds_read_b128 v[48:51], v5 offset:20480
  v_mfma_f32_16x16x32_bf16 v[196:199], v[64:67], a[188:191], v[196:199]
  v_mfma_f32_16x16x32_bf16 v[176:179], v[68:71], a[192:195], v[176:179]
  ds_read_b128 v[52:55], v5 offset:21504
  v_mfma_f32_16x16x32_bf16 v[180:183], v[68:71], a[196:199], v[180:183]
  s_add_u32 s45, s53, 8192
  buffer_load_dwordx4 a[80:83], v3, s[28:31], s45 offen sc1
  s_waitcnt lgkmcnt(10)
  v_mfma_f32_16x16x32_bf16 v[184:187], v[72:75], a[192:195], v[184:187]
  ds_read_b128 v[56:59], v5 offset:22528
  v_mfma_f32_16x16x32_bf16 v[188:191], v[72:75], a[196:199], v[188:191]
  v_mfma_f32_16x16x32_bf16 v[192:195], v[76:79], a[192:195], v[192:195]
  ds_read_b128 v[60:63], v5 offset:23552
  v_mfma_f32_16x16x32_bf16 v[196:199], v[76:79], a[196:199], v[196:199]
  s_add_u32 s45, s53, 156928
  buffer_load_dwordx4 a[84:87], v3, s[28:31], s45 offen sc1
  s_waitcnt lgkmcnt(10)
  v_mfma_f32_16x16x32_bf16 v[176:179], v[16:19], a[200:203], v[176:179]
  ds_read_b128 v[64:67], v5 offset:24576
  v_mfma_f32_16x16x32_bf16 v[180:183], v[16:19], a[204:207], v[180:183]
  v_mfma_f32_16x16x32_bf16 v[184:187], v[20:23], a[200:203], v[184:187]
  ds_read_b128 v[68:71], v5 offset:25600
  v_mfma_f32_16x16x32_bf16 v[188:191], v[20:23], a[204:207], v[188:191]
  s_add_u32 m0, s40, 110592
  s_add_u32 s44, s42, 221184
  buffer_load_dwordx4 v3, s[28:31], s44 offen offset:0 sc1 lds
  s_waitcnt lgkmcnt(10)
  v_mfma_f32_16x16x32_bf16 v[192:195], v[24:27], a[200:203], v[192:195]
  ds_read_b128 v[72:75], v5 offset:26624
  v_mfma_f32_16x16x32_bf16 v[196:199], v[24:27], a[204:207], v[196:199]
  v_mfma_f32_16x16x32_bf16 v[176:179], v[28:31], a[208:211], v[176:179]
  ds_read_b128 v[76:79], v5 offset:27648
  v_mfma_f32_16x16x32_bf16 v[180:183], v[28:31], a[212:215], v[180:183]
  buffer_load_dwordx4 v3, s[28:31], s44 offen offset:1024 sc1 lds
  s_waitcnt lgkmcnt(10)
  v_mfma_f32_16x16x32_bf16 v[184:187], v[32:35], a[208:211], v[184:187]
  ds_read_b128 v[16:19], v5 offset:28672
  v_mfma_f32_16x16x32_bf16 v[188:191], v[32:35], a[212:215], v[188:191]
  v_mfma_f32_16x16x32_bf16 v[192:195], v[36:39], a[208:211], v[192:195]
  ds_read_b128 v[20:23], v5 offset:29696
  v_mfma_f32_16x16x32_bf16 v[196:199], v[36:39], a[212:215], v[196:199]
  s_waitcnt lgkmcnt(10)
  v_mfma_f32_16x16x32_bf16 v[176:179], v[40:43], a[216:219], v[176:179]
  ds_read_b128 v[24:27], v5 offset:30720
  v_mfma_f32_16x16x32_bf16 v[180:183], v[40:43], a[220:223], v[180:183]
  buffer_load_dwordx4 v3, s[28:31], s44 offen offset:2048 sc1 lds
  v_mfma_f32_16x16x32_bf16 v[184:187], v[44:47], a[216:219], v[184:187]
  ds_read_b128 v[28:31], v5 offset:31744
  v_mfma_f32_16x16x32_bf16 v[188:191], v[44:47], a[220:223], v[188:191]
  s_waitcnt lgkmcnt(10)
  v_mfma_f32_16x16x32_bf16 v[192:195], v[48:51], a[216:219], v[192:195]
  ds_read_b128 v[32:35], v5 offset:32768
  v_mfma_f32_16x16x32_bf16 v[196:199], v[48:51], a[220:223], v[196:199]
  buffer_load_dwordx4 v3, s[28:31], s44 offen offset:3072 sc1 lds
  v_mfma_f32_16x16x32_bf16 v[176:179], v[52:55], a[224:227], v[176:179]
  ds_read_b128 v[36:39], v5 offset:33792
  v_mfma_f32_16x16x32_bf16 v[180:183], v[52:55], a[228:231], v[180:183]
  s_waitcnt lgkmcnt(10)
  v_mfma_f32_16x16x32_bf16 v[184:187], v[56:59], a[224:227], v[184:187]
  ds_read_b128 v[40:43], v5 offset:34816
  v_mfma_f32_16x16x32_bf16 v[188:191], v[56:59], a[228:231], v[188:191]
  s_add_u32 m0, s40, 114688
  s_add_u32 s44, s42, 225280
  buffer_load_dwordx4 v3, s[28:31], s44 offen offset:0 sc1 lds
  v_mfma_f32_16x16x32_bf16 v[192:195], v[60:63], a[224:227], v[192:195]
  ds_read_b128 v[44:47], v5 offset:35840
  v_mfma_f32_16x16x32_bf16 v[196:199], v[60:63], a[228:231], v[196:199]
  s_waitcnt lgkmcnt(10)
  v_mfma_f32_16x16x32_bf16 v[176:179], v[64:67], a[232:235], v[176:179]
  v_mfma_f32_16x16x32_bf16 v[180:183], v[64:67], a[236:239], v[180:183]
  buffer_load_dwordx4 v3, s[28:31], s44 offen offset:1024 sc1 lds
  v_mfma_f32_16x16x32_bf16 v[184:187], v[68:71], a[232:235], v[184:187]
  v_mfma_f32_16x16x32_bf16 v[188:191], v[68:71], a[236:239], v[188:191]
  s_waitcnt lgkmcnt(8)
  v_mfma_f32_16x16x32_bf16 v[192:195], v[72:75], a[232:235], v[192:195]
  v_mfma_f32_16x16x32_bf16 v[196:199], v[72:75], a[236:239], v[196:199]
  v_mfma_f32_16x16x32_bf16 v[176:179], v[76:79], a[240:243], v[176:179]
  v_mfma_f32_16x16x32_bf16 v[180:183], v[76:79], a[244:247], v[180:183]
  buffer_load_dwordx4 v3, s[28:31], s44 offen offset:2048 sc1 lds
  s_waitcnt lgkmcnt(6)
  v_mfma_f32_16x16x32_bf16 v[184:187], v[16:19], a[240:243], v[184:187]
  v_mfma_f32_16x16x32_bf16 v[188:191], v[16:19], a[244:247], v[188:191]
  v_mfma_f32_16x16x32_bf16 v[192:195], v[20:23], a[240:243], v[192:195]
  v_mfma_f32_16x16x32_bf16 v[196:199], v[20:23], a[244:247], v[196:199]
  buffer_load_dwordx4 v3, s[28:31], s44 offen offset:3072 sc1 lds
  s_waitcnt lgkmcnt(0)
  s_waitcnt vmcnt(22)
  s_barrier
  v_mfma_f32_16x16x32_bf16 v[176:179], v[24:27], a[248:251], v[176:179]
  ds_read_b128 v[48:51], v6 offset:0
  v_mfma_f32_16x16x32_bf16 v[180:183], v[24:27], a[252:255], v[180:183]
  ds_read_b128 v[52:55], v6 offset:1024
  v_mfma_f32_16x16x32_bf16 v[184:187], v[28:31], a[248:251], v[184:187]
  ds_read_b128 v[56:59], v6 offset:2048
  v_mfma_f32_16x16x32_bf16 v[188:191], v[28:31], a[252:255], v[188:191]
  s_add_u32 m0, s40, 118784
  s_add_u32 s44, s42, 229376
  buffer_load_dwordx4 v3, s[28:31], s44 offen offset:0 sc1 lds
  v_mfma_f32_16x16x32_bf16 v[192:195], v[32:35], a[248:251], v[192:195]
  ds_read_b128 v[60:63], v6 offset:3072
  v_mfma_f32_16x16x32_bf16 v[196:199], v[32:35], a[252:255], v[196:199]
  ds_read_b128 v[64:67], v6 offset:4096
  v_mfma_f32_16x16x32_bf16 v[176:179], v[36:39], a[0:3], v[176:179]
  ds_read_b128 v[68:71], v6 offset:5120
  v_mfma_f32_16x16x32_bf16 v[180:183], v[36:39], a[4:7], v[180:183]
  s_add_u32 s45, s54, 8192
  buffer_load_dwordx4 a[88:91], v3, s[28:31], s45 offen sc1
  v_mfma_f32_16x16x32_bf16 v[184:187], v[40:43], a[0:3], v[184:187]
  ds_read_b128 v[72:75], v6 offset:6144
  v_mfma_f32_16x16x32_bf16 v[188:191], v[40:43], a[4:7], v[188:191]
  ds_read_b128 v[76:79], v6 offset:7168
  v_mfma_f32_16x16x32_bf16 v[192:195], v[44:47], a[0:3], v[192:195]
  ds_read_b128 v[16:19], v6 offset:8192
  v_mfma_f32_16x16x32_bf16 v[196:199], v[44:47], a[4:7], v[196:199]
  ds_read_b128 v[20:23], v6 offset:9216
  s_waitcnt lgkmcnt(8)
  v_mfma_f32_16x16x32_bf16 v[176:179], v[48:51], a[8:11], v[176:179]
  ds_read_b128 v[24:27], v6 offset:10240
  v_mfma_f32_16x16x32_bf16 v[180:183], v[48:51], a[12:15], v[180:183]
  s_add_u32 s45, s54, 156928
  buffer_load_dwordx4 a[92:95], v3, s[28:31], s45 offen sc1
  v_mfma_f32_16x16x32_bf16 v[184:187], v[52:55], a[8:11], v[184:187]
  ds_read_b128 v[28:31], v6 offset:11264
  v_mfma_f32_16x16x32_bf16 v[188:191], v[52:55], a[12:15], v[188:191]
  ds_read_b128 v[32:35], v6 offset:12288
  s_waitcnt lgkmcnt(9)
  v_mfma_f32_16x16x32_bf16 v[192:195], v[56:59], a[8:11], v[192:195]
  ds_read_b128 v[36:39], v6 offset:13312
  v_mfma_f32_16x16x32_bf16 v[196:199], v[56:59], a[12:15], v[196:199]
  s_add_u32 s45, s55, 8192
  buffer_load_dwordx4 a[96:99], v3, s[28:31], s45 offen sc1
  v_mfma_f32_16x16x32_bf16 v[176:179], v[60:63], a[16:19], v[176:179]
  ds_read_b128 v[40:43], v6 offset:14336
  v_mfma_f32_16x16x32_bf16 v[180:183], v[60:63], a[20:23], v[180:183]
  ds_read_b128 v[44:47], v6 offset:15360
  s_waitcnt lgkmcnt(10)
  v_mfma_f32_16x16x32_bf16 v[184:187], v[64:67], a[16:19], v[184:187]
  ds_read_b128 v[48:51], v6 offset:16384
  v_mfma_f32_16x16x32_bf16 v[188:191], v[64:67], a[20:23], v[188:191]
  s_add_u32 s45, s55, 156928
  buffer_load_dwordx4 a[100:103], v3, s[28:31], s45 offen sc1
  v_mfma_f32_16x16x32_bf16 v[192:195], v[68:71], a[16:19], v[192:195]
  ds_read_b128 v[52:55], v6 offset:17408
  v_mfma_f32_16x16x32_bf16 v[196:199], v[68:71], a[20:23], v[196:199]
  s_waitcnt lgkmcnt(10)
  v_mfma_f32_16x16x32_bf16 v[176:179], v[72:75], a[24:27], v[176:179]
  ds_read_b128 v[56:59], v6 offset:18432
  v_mfma_f32_16x16x32_bf16 v[180:183], v[72:75], a[28:31], v[180:183]
  s_add_u32 m0, s40, 0
  s_add_u32 s44, s42, 258048
  buffer_load_dwordx4 v3, s[28:31], s44 offen offset:0 sc1 lds
  v_mfma_f32_16x16x32_bf16 v[184:187], v[76:79], a[24:27], v[184:187]
  ds_read_b128 v[60:63], v6 offset:19456
  v_mfma_f32_16x16x32_bf16 v[188:191], v[76:79], a[28:31], v[188:191]
  s_waitcnt lgkmcnt(10)
  v_mfma_f32_16x16x32_bf16 v[192:195], v[16:19], a[24:27], v[192:195]
  ds_read_b128 v[64:67], v6 offset:20480
  v_mfma_f32_16x16x32_bf16 v[196:199], v[16:19], a[28:31], v[196:199]
  s_waitcnt vmcnt(26)
  v_mfma_f32_16x16x32_bf16 v[152:155], v[20:23], a[32:35], v[152:155]
  ds_read_b128 v[68:71], v6 offset:21504
  v_mfma_f32_16x16x32_bf16 v[156:159], v[20:23], a[36:39], v[156:159]
  buffer_load_dwordx4 v3, s[28:31], s44 offen offset:1024 sc1 lds
  s_waitcnt lgkmcnt(10)
  v_mfma_f32_16x16x32_bf16 v[160:163], v[24:27], a[32:35], v[160:163]
  ds_read_b128 v[72:75], v6 offset:22528
  v_mfma_f32_16x16x32_bf16 v[164:167], v[24:27], a[36:39], v[164:167]
  v_mfma_f32_16x16x32_bf16 v[168:171], v[28:31], a[32:35], v[168:171]
  ds_read_b128 v[76:79], v6 offset:23552
  v_mfma_f32_16x16x32_bf16 v[172:175], v[28:31], a[36:39], v[172:175]
  buffer_load_dwordx4 v3, s[28:31], s44 offen offset:2048 sc1 lds
  s_waitcnt lgkmcnt(10)
  s_waitcnt vmcnt(26)
  v_mfma_f32_16x16x32_bf16 v[152:155], v[32:35], a[40:43], v[152:155]
  ds_read_b128 v[16:19], v6 offset:24576
  v_mfma_f32_16x16x32_bf16 v[156:159], v[32:35], a[44:47], v[156:159]
  v_mfma_f32_16x16x32_bf16 v[160:163], v[36:39], a[40:43], v[160:163]
  ds_read_b128 v[20:23], v6 offset:25600
  v_mfma_f32_16x16x32_bf16 v[164:167], v[36:39], a[44:47], v[164:167]
  buffer_load_dwordx4 v3, s[28:31], s44 offen offset:3072 sc1 lds
  s_waitcnt lgkmcnt(10)
  v_mfma_f32_16x16x32_bf16 v[168:171], v[40:43], a[40:43], v[168:171]
  ds_read_b128 v[24:27], v6 offset:26624
  v_mfma_f32_16x16x32_bf16 v[172:175], v[40:43], a[44:47], v[172:175]
  s_waitcnt vmcnt(25)
  v_mfma_f32_16x16x32_bf16 v[152:155], v[44:47], a[48:51], v[152:155]
  ds_read_b128 v[28:31], v6 offset:27648
  v_mfma_f32_16x16x32_bf16 v[156:159], v[44:47], a[52:55], v[156:159]
  s_add_u32 m0, s40, 4096
  s_add_u32 s44, s42, 262144
  buffer_load_dwordx4 v3, s[28:31], s44 offen offset:0 sc1 lds
  s_waitcnt lgkmcnt(10)
  v_mfma_f32_16x16x32_bf16 v[160:163], v[48:51], a[48:51], v[160:163]
  ds_read_b128 v[32:35], v6 offset:28672
  v_mfma_f32_16x16x32_bf16 v[164:167], v[48:51], a[52:55], v[164:167]
  v_mfma_f32_16x16x32_bf16 v[168:171], v[52:55], a[48:51], v[168:171]
  ds_read_b128 v[36:39], v6 offset:29696
  v_mfma_f32_16x16x32_bf16 v[172:175], v[52:55], a[52:55], v[172:175]
  s_waitcnt lgkmcnt(10)
  s_waitcnt vmcnt(24)
  v_mfma_f32_16x16x32_bf16 v[152:155], v[56:59], a[56:59], v[152:155]
  ds_read_b128 v[40:43], v6 offset:30720
  v_mfma_f32_16x16x32_bf16 v[156:159], v[56:59], a[60:63], v[156:159]
  buffer_load_dwordx4 v3, s[28:31], s44 offen offset:1024 sc1 lds
  v_mfma_f32_16x16x32_bf16 v[160:163], v[60:63], a[56:59], v[160:163]
  ds_read_b128 v[44:47], v6 offset:31744
  v_mfma_f32_16x16x32_bf16 v[164:167], v[60:63], a[60:63], v[164:167]
  s_waitcnt lgkmcnt(10)
  v_mfma_f32_16x16x32_bf16 v[168:171], v[64:67], a[56:59], v[168:171]
  ds_read_b128 v[48:51], v6 offset:32768
  v_mfma_f32_16x16x32_bf16 v[172:175], v[64:67], a[60:63], v[172:175]
  buffer_load_dwordx4 v3, s[28:31], s44 offen offset:2048 sc1 lds
  s_waitcnt vmcnt(24)
  v_mfma_f32_16x16x32_bf16 v[152:155], v[68:71], a[64:67], v[152:155]
  ds_read_b128 v[52:55], v6 offset:33792
  v_mfma_f32_16x16x32_bf16 v[156:159], v[68:71], a[68:71], v[156:159]
  s_waitcnt lgkmcnt(10)
  v_mfma_f32_16x16x32_bf16 v[160:163], v[72:75], a[64:67], v[160:163]
  ds_read_b128 v[56:59], v6 offset:34816
  v_mfma_f32_16x16x32_bf16 v[164:167], v[72:75], a[68:71], v[164:167]
  buffer_load_dwordx4 v3, s[28:31], s44 offen offset:3072 sc1 lds
  v_mfma_f32_16x16x32_bf16 v[168:171], v[76:79], a[64:67], v[168:171]
  ds_read_b128 v[60:63], v6 offset:35840
  v_mfma_f32_16x16x32_bf16 v[172:175], v[76:79], a[68:71], v[172:175]
  s_waitcnt lgkmcnt(10)
  s_waitcnt vmcnt(23)
  v_mfma_f32_16x16x32_bf16 v[152:155], v[16:19], a[72:75], v[152:155]
  v_mfma_f32_16x16x32_bf16 v[156:159], v[16:19], a[76:79], v[156:159]
  s_add_u32 m0, s40, 8192
  s_add_u32 s44, s42, 266240
  buffer_load_dwordx4 v3, s[28:31], s44 offen offset:0 sc1 lds
  v_mfma_f32_16x16x32_bf16 v[160:163], v[20:23], a[72:75], v[160:163]
  v_mfma_f32_16x16x32_bf16 v[164:167], v[20:23], a[76:79], v[164:167]
  s_waitcnt lgkmcnt(8)
  v_mfma_f32_16x16x32_bf16 v[168:171], v[24:27], a[72:75], v[168:171]
  v_mfma_f32_16x16x32_bf16 v[172:175], v[24:27], a[76:79], v[172:175]
  s_waitcnt vmcnt(22)
  v_mfma_f32_16x16x32_bf16 v[152:155], v[28:31], a[80:83], v[152:155]
  v_mfma_f32_16x16x32_bf16 v[156:159], v[28:31], a[84:87], v[156:159]
  s_add_u32 m0, s40, 36864
  s_add_u32 s44, s42, 294912
  buffer_load_dwordx4 v3, s[28:31], s44 offen offset:0 sc1 lds
  s_waitcnt lgkmcnt(6)
  v_mfma_f32_16x16x32_bf16 v[160:163], v[32:35], a[80:83], v[160:163]
  v_mfma_f32_16x16x32_bf16 v[164:167], v[32:35], a[84:87], v[164:167]
  v_mfma_f32_16x16x32_bf16 v[168:171], v[36:39], a[80:83], v[168:171]
  v_mfma_f32_16x16x32_bf16 v[172:175], v[36:39], a[84:87], v[172:175]
  buffer_load_dwordx4 v3, s[28:31], s44 offen offset:1024 sc1 lds
  s_waitcnt lgkmcnt(0)
  s_waitcnt vmcnt(15)
  s_barrier
  s_waitcnt vmcnt(13)
  v_mfma_f32_16x16x32_bf16 v[152:155], v[40:43], a[88:91], v[152:155]
  ds_read_b128 v[64:67], v7 offset:0
  v_mfma_f32_16x16x32_bf16 v[156:159], v[40:43], a[92:95], v[156:159]
  ds_read_b128 v[68:71], v7 offset:1024
  v_mfma_f32_16x16x32_bf16 v[160:163], v[44:47], a[88:91], v[160:163]
  ds_read_b128 v[72:75], v7 offset:2048
  v_mfma_f32_16x16x32_bf16 v[164:167], v[44:47], a[92:95], v[164:167]
  buffer_load_dwordx4 v3, s[28:31], s44 offen offset:2048 sc1 lds
  s_cmp_lg_u32 s32, 0
  s_cbranch_scc1 L_v1
  v_mfma_f32_16x16x32_bf16 v[168:171], v[48:51], a[88:91], v[168:171]
  ds_read_b128 v[76:79], v7 offset:3072
  v_mfma_f32_16x16x32_bf16 v[172:175], v[48:51], a[92:95], v[172:175]
  ds_read_b128 v[16:19], v7 offset:4096
  s_waitcnt vmcnt(12)
  v_mfma_f32_16x16x32_bf16 v[152:155], v[52:55], a[96:99], v[152:155]
  ds_read_b128 v[20:23], v7 offset:5120
  v_mfma_f32_16x16x32_bf16 v[156:159], v[52:55], a[100:103], v[156:159]
  buffer_load_dwordx4 v3, s[28:31], s44 offen offset:3072 sc1 lds
  v_mfma_f32_16x16x32_bf16 v[160:163], v[56:59], a[96:99], v[160:163]
  ds_read_b128 v[24:27], v7 offset:6144
  v_mfma_f32_16x16x32_bf16 v[164:167], v[56:59], a[100:103], v[164:167]
  ds_read_b128 v[28:31], v7 offset:7168
  v_mfma_f32_16x16x32_bf16 v[168:171], v[60:63], a[96:99], v[168:171]
  ds_read_b128 v[32:35], v7 offset:8192
  v_mfma_f32_16x16x32_bf16 v[172:175], v[60:63], a[100:103], v[172:175]
  ds_read_b128 v[36:39], v7 offset:9216
  s_waitcnt lgkmcnt(8)
  v_mfma_f32_16x16x32_bf16 v[176:179], v[64:67], a[32:35], v[176:179]
  ds_read_b128 v[40:43], v7 offset:10240
  v_mfma_f32_16x16x32_bf16 v[180:183], v[64:67], a[36:39], v[180:183]
  s_add_u32 m0, s40, 40960
  s_add_u32 s44, s42, 299008
  buffer_load_dwordx4 v3, s[28:31], s44 offen offset:0 sc1 lds
  v_mfma_f32_16x16x32_bf16 v[184:187], v[68:71], a[32:35], v[184:187]
  ds_read_b128 v[44:47], v7 offset:11264
  v_mfma_f32_16x16x32_bf16 v[188:191], v[68:71], a[36:39], v[188:191]
  ds_read_b128 v[48:51], v7 offset:12288
  s_waitcnt lgkmcnt(9)
  v_mfma_f32_16x16x32_bf16 v[192:195], v[72:75], a[32:35], v[192:195]
  ds_read_b128 v[52:55], v7 offset:13312
  v_mfma_f32_16x16x32_bf16 v[196:199], v[72:75], a[36:39], v[196:199]
  s_add_u32 s45, s50, 4096
  buffer_store_dwordx4 v[156:159], v3, s[28:31], s45 offen sc1
  v_mfma_f32_16x16x32_bf16 v[176:179], v[76:79], a[40:43], v[176:179]
  ds_read_b128 v[56:59], v7 offset:14336
  v_mfma_f32_16x16x32_bf16 v[180:183], v[76:79], a[44:47], v[180:183]
  ds_read_b128 v[60:63], v7 offset:15360
  s_waitcnt lgkmcnt(10)
  v_mfma_f32_16x16x32_bf16 v[184:187], v[16:19], a[40:43], v[184:187]
  ds_read_b128 v[64:67], v7 offset:16384
  v_mfma_f32_16x16x32_bf16 v[188:191], v[16:19], a[44:47], v[188:191]
  buffer_load_dwordx4 v3, s[28:31], s44 offen offset:1024 sc1 lds
  v_mfma_f32_16x16x32_bf16 v[192:195], v[20:23], a[40:43], v[192:195]
  ds_read_b128 v[68:71], v7 offset:17408
  v_mfma_f32_16x16x32_bf16 v[196:199], v[20:23], a[44:47], v[196:199]
  s_waitcnt lgkmcnt(10)
  v_mfma_f32_16x16x32_bf16 v[176:179], v[24:27], a[48:51], v[176:179]
  ds_read_b128 v[72:75], v7 offset:18432
  v_mfma_f32_16x16x32_bf16 v[180:183], v[24:27], a[52:55], v[180:183]
  buffer_load_dwordx4 v3, s[28:31], s44 offen offset:2048 sc1 lds
  v_mfma_f32_16x16x32_bf16 v[184:187], v[28:31], a[48:51], v[184:187]
  ds_read_b128 v[76:79], v7 offset:19456
  v_mfma_f32_16x16x32_bf16 v[188:191], v[28:31], a[52:55], v[188:191]
  s_waitcnt lgkmcnt(10)
  v_mfma_f32_16x16x32_bf16 v[192:195], v[32:35], a[48:51], v[192:195]
  ds_read_b128 v[16:19], v7 offset:20480
  v_mfma_f32_16x16x32_bf16 v[196:199], v[32:35], a[52:55], v[196:199]
  v_mfma_f32_16x16x32_bf16 v[176:179], v[36:39], a[56:59], v[176:179]
  ds_read_b128 v[20:23], v7 offset:21504
  v_mfma_f32_16x16x32_bf16 v[180:183], v[36:39], a[60:63], v[180:183]
  s_add_u32 s45, s50, 8192
  buffer_store_dwordx4 v[160:163], v3, s[28:31], s45 offen sc1
  s_waitcnt lgkmcnt(10)
  v_mfma_f32_16x16x32_bf16 v[184:187], v[40:43], a[56:59], v[184:187]
  ds_read_b128 v[24:27], v7 offset:22528
  v_mfma_f32_16x16x32_bf16 v[188:191], v[40:43], a[60:63], v[188:191]
  v_mfma_f32_16x16x32_bf16 v[192:195], v[44:47], a[56:59], v[192:195]
  ds_read_b128 v[28:31], v7 offset:23552
  v_mfma_f32_16x16x32_bf16 v[196:199], v[44:47], a[60:63], v[196:199]
  buffer_load_dwordx4 v3, s[28:31], s44 offen offset:3072 sc1 lds
  s_waitcnt lgkmcnt(10)
  v_mfma_f32_16x16x32_bf16 v[176:179], v[48:51], a[64:67], v[176:179]
  ds_read_b128 v[32:35], v7 offset:24576
  v_mfma_f32_16x16x32_bf16 v[180:183], v[48:51], a[68:71], v[180:183]
  v_mfma_f32_16x16x32_bf16 v[184:187], v[52:55], a[64:67], v[184:187]
  ds_read_b128 v[36:39], v7 offset:25600
  v_mfma_f32_16x16x32_bf16 v[188:191], v[52:55], a[68:71], v[188:191]
  s_add_u32 m0, s40, 45056
  s_add_u32 s44, s42, 303104
  buffer_load_dwordx4 v3, s[28:31], s44 offen offset:0 sc1 lds
  s_waitcnt lgkmcnt(10)
  v_mfma_f32_16x16x32_bf16 v[192:195], v[56:59], a[64:67], v[192:195]
  ds_read_b128 v[40:43], v7 offset:26624
  v_mfma_f32_16x16x32_bf16 v[196:199], v[56:59], a[68:71], v[196:199]
  v_mfma_f32_16x16x32_bf16 v[176:179], v[60:63], a[72:75], v[176:179]
  ds_read_b128 v[44:47], v7 offset:27648
  v_mfma_f32_16x16x32_bf16 v[180:183], v[60:63], a[76:79], v[180:183]
  s_add_u32 s45, s50, 12288
  buffer_store_dwordx4 v[164:167], v3, s[28:31], s45 offen sc1
  s_waitcnt lgkmcnt(10)
  v_mfma_f32_16x16x32_bf16 v[184:187], v[64:67], a[72:75], v[184:187]
  ds_read_b128 v[48:51], v7 offset:28672
  v_mfma_f32_16x16x32_bf16 v[188:191], v[64:67], a[76:79], v[188:191]
  v_mfma_f32_16x16x32_bf16 v[192:195], v[68:71], a[72:75], v[192:195]
  ds_read_b128 v[52:55], v7 offset:29696
  v_mfma_f32_16x16x32_bf16 v[196:199], v[68:71], a[76:79], v[196:199]
  s_waitcnt lgkmcnt(10)
  v_mfma_f32_16x16x32_bf16 v[176:179], v[72:75], a[80:83], v[176:179]
  ds_read_b128 v[56:59], v7 offset:30720
  v_mfma_f32_16x16x32_bf16 v[180:183], v[72:75], a[84:87], v[180:183]
  v_mfma_f32_16x16x32_bf16 v[184:187], v[76:79], a[80:83], v[184:187]
  ds_read_b128 v[60:63], v7 offset:31744
  v_mfma_f32_16x16x32_bf16 v[188:191], v[76:79], a[84:87], v[188:191]
  s_waitcnt lgkmcnt(10)
  v_mfma_f32_16x16x32_bf16 v[192:195], v[16:19], a[80:83], v[192:195]
  ds_read_b128 v[64:67], v7 offset:32768
  v_mfma_f32_16x16x32_bf16 v[196:199], v[16:19], a[84:87], v[196:199]
  s_add_u32 s45, s50, 20480
  buffer_store_dwordx4 v[172:175], v3, s[28:31], s45 offen sc1
  v_mfma_f32_16x16x32_bf16 v[176:179], v[20:23], a[88:91], v[176:179]
  ds_read_b128 v[68:71], v7 offset:33792
  v_mfma_f32_16x16x32_bf16 v[180:183], v[20:23], a[92:95], v[180:183]
  s_waitcnt lgkmcnt(10)
  v_mfma_f32_16x16x32_bf16 v[184:187], v[24:27], a[88:91], v[184:187]
  ds_read_b128 v[72:75], v7 offset:34816
  v_mfma_f32_16x16x32_bf16 v[188:191], v[24:27], a[92:95], v[188:191]
  v_mfma_f32_16x16x32_bf16 v[192:195], v[28:31], a[88:91], v[192:195]
  ds_read_b128 v[76:79], v7 offset:35840
  v_mfma_f32_16x16x32_bf16 v[196:199], v[28:31], a[92:95], v[196:199]
  s_waitcnt lgkmcnt(10)
  v_mfma_f32_16x16x32_bf16 v[176:179], v[32:35], a[96:99], v[176:179]
  v_mfma_f32_16x16x32_bf16 v[180:183], v[32:35], a[100:103], v[180:183]
  v_mfma_f32_16x16x32_bf16 v[184:187], v[36:39], a[96:99], v[184:187]
  v_mfma_f32_16x16x32_bf16 v[188:191], v[36:39], a[100:103], v[188:191]
  s_waitcnt lgkmcnt(8)
  v_mfma_f32_16x16x32_bf16 v[192:195], v[40:43], a[96:99], v[192:195]
  v_mfma_f32_16x16x32_bf16 v[196:199], v[40:43], a[100:103], v[196:199]
  v_mfma_f32_16x16x32_bf16 v[224:227], v[44:47], a[144:147], v[224:227]
  v_mfma_f32_16x16x32_bf16 v[228:231], v[44:47], a[148:151], v[228:231]
  s_waitcnt lgkmcnt(6)
  v_mfma_f32_16x16x32_bf16 v[232:235], v[48:51], a[144:147], v[232:235]
  v_mfma_f32_16x16x32_bf16 v[236:239], v[48:51], a[148:151], v[236:239]
  v_mfma_f32_16x16x32_bf16 v[240:243], v[52:55], a[144:147], v[240:243]
  v_mfma_f32_16x16x32_bf16 v[244:247], v[52:55], a[148:151], v[244:247]
  s_add_u32 s45, s50, 24576
  buffer_store_dwordx4 v[176:179], v3, s[28:31], s45 offen sc1
  s_waitcnt lgkmcnt(0)
  s_waitcnt vmcnt(14)
  s_barrier
  v_mfma_f32_16x16x32_bf16 v[224:227], v[56:59], a[152:155], v[224:227]
  ds_read_b128 v[16:19], v4 offset:0
  v_mfma_f32_16x16x32_bf16 v[228:231], v[56:59], a[156:159], v[228:231]
  ds_read_b128 v[20:23], v4 offset:1024
  v_mfma_f32_16x16x32_bf16 v[232:235], v[60:63], a[152:155], v[232:235]
  ds_read_b128 v[24:27], v4 offset:2048
  v_mfma_f32_16x16x32_bf16 v[236:239], v[60:63], a[156:159], v[236:239]
  ds_read_b128 v[28:31], v4 offset:3072
  v_mfma_f32_16x16x32_bf16 v[240:243], v[64:67], a[152:155], v[240:243]
  ds_read_b128 v[32:35], v4 offset:4096
  v_mfma_f32_16x16x32_bf16 v[244:247], v[64:67], a[156:159], v[244:247]
  ds_read_b128 v[36:39], v4 offset:5120
  v_mfma_f32_16x16x32_bf16 v[224:227], v[68:71], a[160:163], v[224:227]
  ds_read_b128 v[40:43], v4 offset:6144
  v_mfma_f32_16x16x32_bf16 v[228:231], v[68:71], a[164:167], v[228:231]
  ds_read_b128 v[44:47], v4 offset:7168
  v_mfma_f32_16x16x32_bf16 v[232:235], v[72:75], a[160:163], v[232:235]
  ds_read_b128 v[48:51], v4 offset:8192
  v_mfma_f32_16x16x32_bf16 v[236:239], v[72:75], a[164:167], v[236:239]
  ds_read_b128 v[52:55], v4 offset:9216
  v_mfma_f32_16x16x32_bf16 v[240:243], v[76:79], a[160:163], v[240:243]
  ds_read_b128 v[56:59], v4 offset:10240
  v_mfma_f32_16x16x32_bf16 v[244:247], v[76:79], a[164:167], v[244:247]
  ds_read_b128 v[60:63], v4 offset:11264
  s_waitcnt lgkmcnt(10)
  v_mfma_f32_16x16x32_bf16 v[224:227], v[16:19], a[168:171], v[224:227]
  ds_read_b128 v[64:67], v4 offset:12288
  v_mfma_f32_16x16x32_bf16 v[228:231], v[16:19], a[172:175], v[228:231]
  s_add_u32 s45, s50, 28672
  buffer_store_dwordx4 v[180:183], v3, s[28:31], s45 offen sc1
  v_mfma_f32_16x16x32_bf16 v[232:235], v[20:23], a[168:171], v[232:235]
  ds_read_b128 v[68:71], v4 offset:13312
  v_mfma_f32_16x16x32_bf16 v[236:239], v[20:23], a[172:175], v[236:239]
  s_waitcnt lgkmcnt(10)
  v_mfma_f32_16x16x32_bf16 v[240:243], v[24:27], a[168:171], v[240:243]
  ds_read_b128 v[72:75], v4 offset:14336
  v_mfma_f32_16x16x32_bf16 v[244:247], v[24:27], a[172:175], v[244:247]
  v_mfma_f32_16x16x32_bf16 v[224:227], v[28:31], a[176:179], v[224:227]
  ds_read_b128 v[76:79], v4 offset:15360
  v_mfma_f32_16x16x32_bf16 v[228:231], v[28:31], a[180:183], v[228:231]
  s_waitcnt lgkmcnt(10)
  v_mfma_f32_16x16x32_bf16 v[232:235], v[32:35], a[176:179], v[232:235]
  ds_read_b128 v[16:19], v4 offset:16384
  v_mfma_f32_16x16x32_bf16 v[236:239], v[32:35], a[180:183], v[236:239]
  v_mfma_f32_16x16x32_bf16 v[240:243], v[36:39], a[176:179], v[240:243]
  ds_read_b128 v[20:23], v4 offset:17408
  v_mfma_f32_16x16x32_bf16 v[244:247], v[36:39], a[180:183], v[244:247]
  s_waitcnt lgkmcnt(10)
  v_mfma_f32_16x16x32_bf16 v[224:227], v[40:43], a[184:187], v[224:227]
  ds_read_b128 v[24:27], v4 offset:18432
  v_mfma_f32_16x16x32_bf16 v[228:231], v[40:43], a[188:191], v[228:231]
  s_add_u32 s45, s50, 36864
  buffer_store_dwordx4 v[188:191], v3, s[28:31], s45 offen sc1
  v_mfma_f32_16x16x32_bf16 v[232:235], v[44:47], a[184:187], v[232:235]
  ds_read_b128 v[28:31], v4 offset:19456
  v_mfma_f32_16x16x32_bf16 v[236:239], v[44:47], a[188:191], v[236:239]
  s_waitcnt lgkmcnt(10)
  v_mfma_f32_16x16x32_bf16 v[240:243], v[48:51], a[184:187], v[240:243]
  ds_read_b128 v[32:35], v4 offset:20480
  v_mfma_f32_16x16x32_bf16 v[244:247], v[48:51], a[188:191], v[244:247]
  v_mfma_f32_16x16x32_bf16 v[224:227], v[52:55], a[192:195], v[224:227]
  ds_read_b128 v[36:39], v4 offset:21504
  v_mfma_f32_16x16x32_bf16 v[228:231], v[52:55], a[196:199], v[228:231]
  s_waitcnt lgkmcnt(10)
  v_mfma_f32_16x16x32_bf16 v[232:235], v[56:59], a[192:195], v[232:235]
  ds_read_b128 v[40:43], v4 offset:22528
  v_mfma_f32_16x16x32_bf16 v[236:239], v[56:59], a[196:199], v[236:239]
  v_mfma_f32_16x16x32_bf16 v[240:243], v[60:63], a[192:195], v[240:243]
  ds_read_b128 v[44:47], v4 offset:23552
  v_mfma_f32_16x16x32_bf16 v[244:247], v[60:63], a[196:199], v[244:247]
  s_waitcnt vmcnt(3)
  s_add_u32 s61, s88, 2
  v_mov_b32 v14, s61
  v_mov_b32 v15, s89
  s_mov_b64 exec, 1
  buffer_store_dwordx2 v[14:15], v10, s[28:31], s52 offen sc1
  s_mov_b64 exec, -1
  s_waitcnt lgkmcnt(10)
  v_mfma_f32_16x16x32_bf16 v[224:227], v[64:67], a[200:203], v[224:227]
  ds_read_b128 v[48:51], v4 offset:24576
  v_mfma_f32_16x16x32_bf16 v[228:231], v[64:67], a[204:207], v[228:231]
  v_mfma_f32_16x16x32_bf16 v[232:235], v[68:71], a[200:203], v[232:235]
  ds_read_b128 v[52:55], v4 offset:25600
  v_mfma_f32_16x16x32_bf16 v[236:239], v[68:71], a[204:207], v[236:239]
  s_add_u32 s45, s50, 40960
  buffer_store_dwordx4 v[192:195], v3, s[28:31], s45 offen sc1
  s_waitcnt lgkmcnt(10)
  v_mfma_f32_16x16x32_bf16 v[240:243], v[72:75], a[200:203], v[240:243]
  ds_read_b128 v[56:59], v4 offset:26624
  v_mfma_f32_16x16x32_bf16 v[244:247], v[72:75], a[204:207], v[244:247]
  v_mfma_f32_16x16x32_bf16 v[224:227], v[76:79], a[208:211], v[224:227]
  ds_read_b128 v[60:63], v4 offset:27648
  v_mfma_f32_16x16x32_bf16 v[228:231], v[76:79], a[212:215], v[228:231]
  s_waitcnt lgkmcnt(10)
  v_mfma_f32_16x16x32_bf16 v[232:235], v[16:19], a[208:211], v[232:235]
  ds_read_b128 v[64:67], v4 offset:28672
  v_mfma_f32_16x16x32_bf16 v[236:239], v[16:19], a[212:215], v[236:239]
  v_mfma_f32_16x16x32_bf16 v[240:243], v[20:23], a[208:211], v[240:243]
  ds_read_b128 v[68:71], v4 offset:29696
  v_mfma_f32_16x16x32_bf16 v[244:247], v[20:23], a[212:215], v[244:247]
  s_waitcnt lgkmcnt(10)
  v_mfma_f32_16x16x32_bf16 v[224:227], v[24:27], a[216:219], v[224:227]
  ds_read_b128 v[72:75], v4 offset:30720
  v_mfma_f32_16x16x32_bf16 v[228:231], v[24:27], a[220:223], v[228:231]
  s_add_u32 s45, s50, 45056
  buffer_store_dwordx4 v[196:199], v3, s[28:31], s45 offen sc1
  v_mfma_f32_16x16x32_bf16 v[232:235], v[28:31], a[216:219], v[232:235]
  ds_read_b128 v[76:79], v4 offset:31744
  v_mfma_f32_16x16x32_bf16 v[236:239], v[28:31], a[220:223], v[236:239]
  s_waitcnt lgkmcnt(10)
  v_mfma_f32_16x16x32_bf16 v[240:243], v[32:35], a[216:219], v[240:243]
  ds_read_b128 v[16:19], v4 offset:32768
  v_mfma_f32_16x16x32_bf16 v[244:247], v[32:35], a[220:223], v[244:247]
  v_mfma_f32_16x16x32_bf16 v[224:227], v[36:39], a[224:227], v[224:227]
  ds_read_b128 v[20:23], v4 offset:33792
  v_mfma_f32_16x16x32_bf16 v[228:231], v[36:39], a[228:231], v[228:231]
  s_waitcnt lgkmcnt(10)
  v_mfma_f32_16x16x32_bf16 v[232:235], v[40:43], a[224:227], v[232:235]
  ds_read_b128 v[24:27], v4 offset:34816
  v_mfma_f32_16x16x32_bf16 v[236:239], v[40:43], a[228:231], v[236:239]
  v_mfma_f32_16x16x32_bf16 v[240:243], v[44:47], a[224:227], v[240:243]
  ds_read_b128 v[28:31], v4 offset:35840
  v_mfma_f32_16x16x32_bf16 v[244:247], v[44:47], a[228:231], v[244:247]
  s_waitcnt lgkmcnt(10)
  v_mfma_f32_16x16x32_bf16 v[224:227], v[48:51], a[232:235], v[224:227]
  v_mfma_f32_16x16x32_bf16 v[228:231], v[48:51], a[236:239], v[228:231]
  v_mfma_f32_16x16x32_bf16 v[232:235], v[52:55], a[232:235], v[232:235]
  v_mfma_f32_16x16x32_bf16 v[236:239], v[52:55], a[236:239], v[236:239]
  s_waitcnt lgkmcnt(8)
  v_mfma_f32_16x16x32_bf16 v[240:243], v[56:59], a[232:235], v[240:243]
  v_mfma_f32_16x16x32_bf16 v[244:247], v[56:59], a[236:239], v[244:247]
  v_mfma_f32_16x16x32_bf16 v[224:227], v[60:63], a[240:243], v[224:227]
  v_mfma_f32_16x16x32_bf16 v[228:231], v[60:63], a[244:247], v[228:231]
  s_waitcnt lgkmcnt(6)
  v_mfma_f32_16x16x32_bf16 v[232:235], v[64:67], a[240:243], v[232:235]
  v_mfma_f32_16x16x32_bf16 v[236:239], v[64:67], a[244:247], v[236:239]
  v_mfma_f32_16x16x32_bf16 v[240:243], v[68:71], a[240:243], v[240:243]
  v_mfma_f32_16x16x32_bf16 v[244:247], v[68:71], a[244:247], v[244:247]
  s_waitcnt lgkmcnt(0)
  s_waitcnt vmcnt(8)
  s_barrier
  v_mfma_f32_16x16x32_bf16 v[224:227], v[72:75], a[248:251], v[224:227]
  ds_read_b128 v[32:35], v5 offset:0
  v_mfma_f32_16x16x32_bf16 v[228:231], v[72:75], a[252:255], v[228:231]
  ds_read_b128 v[36:39], v5 offset:1024
  v_mfma_f32_16x16x32_bf16 v[232:235], v[76:79], a[248:251], v[232:235]
  ds_read_b128 v[40:43], v5 offset:2048
  v_mfma_f32_16x16x32_bf16 v[236:239], v[76:79], a[252:255], v[236:239]
  ds_read_b128 v[44:47], v5 offset:3072
  v_mfma_f32_16x16x32_bf16 v[240:243], v[16:19], a[248:251], v[240:243]
  ds_read_b128 v[48:51], v5 offset:4096
  v_mfma_f32_16x16x32_bf16 v[244:247], v[16:19], a[252:255], v[244:247]
  ds_read_b128 v[52:55], v5 offset:5120
  v_mfma_f32_16x16x32_bf16 v[224:227], v[20:23], a[0:3], v[224:227]
  ds_read_b128 v[56:59], v5 offset:6144
  v_mfma_f32_16x16x32_bf16 v[228:231], v[20:23], a[4:7], v[228:231]
  ds_read_b128 v[60:63], v5 offset:7168
  v_mfma_f32_16x16x32_bf16 v[232:235], v[24:27], a[0:3], v[232:235]
  ds_read_b128 v[64:67], v5 offset:8192
  v_mfma_f32_16x16x32_bf16 v[236:239], v[24:27], a[4:7], v[236:239]
  ds_read_b128 v[68:71], v5 offset:9216
  v_mfma_f32_16x16x32_bf16 v[240:243], v[28:31], a[0:3], v[240:243]
  ds_read_b128 v[72:75], v5 offset:10240
  v_mfma_f32_16x16x32_bf16 v[244:247], v[28:31], a[4:7], v[244:247]
  ds_read_b128 v[76:79], v5 offset:11264
  s_waitcnt lgkmcnt(10)
  v_mfma_f32_16x16x32_bf16 v[224:227], v[32:35], a[8:11], v[224:227]
  ds_read_b128 v[16:19], v5 offset:12288
  v_mfma_f32_16x16x32_bf16 v[228:231], v[32:35], a[12:15], v[228:231]
  v_mfma_f32_16x16x32_bf16 v[232:235], v[36:39], a[8:11], v[232:235]
  ds_read_b128 v[20:23], v5 offset:13312
  v_mfma_f32_16x16x32_bf16 v[236:239], v[36:39], a[12:15], v[236:239]
  s_waitcnt lgkmcnt(10)
  v_mfma_f32_16x16x32_bf16 v[240:243], v[40:43], a[8:11], v[240:243]
  ds_read_b128 v[24:27], v5 offset:14336
  v_mfma_f32_16x16x32_bf16 v[244:247], v[40:43], a[12:15], v[244:247]
  v_mfma_f32_16x16x32_bf16 v[224:227], v[44:47], a[16:19], v[224:227]
  ds_read_b128 v[28:31], v5 offset:15360
  v_mfma_f32_16x16x32_bf16 v[228:231], v[44:47], a[20:23], v[228:231]
  s_waitcnt lgkmcnt(10)
  v_mfma_f32_16x16x32_bf16 v[232:235], v[48:51], a[16:19], v[232:235]
  ds_read_b128 v[32:35], v5 offset:16384
  v_mfma_f32_16x16x32_bf16 v[236:239], v[48:51], a[20:23], v[236:239]
  v_mfma_f32_16x16x32_bf16 v[240:243], v[52:55], a[16:19], v[240:243]
  ds_read_b128 v[36:39], v5 offset:17408
  v_mfma_f32_16x16x32_bf16 v[244:247], v[52:55], a[20:23], v[244:247]
  s_waitcnt lgkmcnt(10)
  v_mfma_f32_16x16x32_bf16 v[224:227], v[56:59], a[24:27], v[224:227]
  ds_read_b128 v[40:43], v5 offset:18432
  v_mfma_f32_16x16x32_bf16 v[228:231], v[56:59], a[28:31], v[228:231]
  v_mfma_f32_16x16x32_bf16 v[232:235], v[60:63], a[24:27], v[232:235]
  ds_read_b128 v[44:47], v5 offset:19456
  v_mfma_f32_16x16x32_bf16 v[236:239], v[60:63], a[28:31], v[236:239]
  s_waitcnt lgkmcnt(10)
  v_mfma_f32_16x16x32_bf16 v[240:243], v[64:67], a[24:27], v[240:243]
  ds_read_b128 v[48:51], v5 offset:20480
  v_mfma_f32_16x16x32_bf16 v[244:247], v[64:67], a[28:31], v[244:247]
  v_mfma_f32_16x16x32_bf16 v[224:227], v[68:71], a[32:35], v[224:227]
  ds_read_b128 v[52:55], v5 offset:21504
  v_mfma_f32_16x16x32_bf16 v[228:231], v[68:71], a[36:39], v[228:231]
  s_waitcnt vmcnt(0)
  s_add_u32 s61, s88, 3
  v_mov_b32 v14, s61
  v_mov_b32 v15, s89
  s_mov_b64 exec, 1
  buffer_store_dwordx2 v[14:15], v10, s[28:31], s52 offen sc1
  s_mov_b64 exec, -1
  s_waitcnt lgkmcnt(10)
  v_mfma_f32_16x16x32_bf16 v[232:235], v[72:75], a[32:35], v[232:235]
  ds_read_b128 v[56:59], v5 offset:22528
  v_mfma_f32_16x16x32_bf16 v[236:239], v[72:75], a[36:39], v[236:239]
  v_mfma_f32_16x16x32_bf16 v[240:243], v[76:79], a[32:35], v[240:243]
  ds_read_b128 v[60:63], v5 offset:23552
  v_mfma_f32_16x16x32_bf16 v[244:247], v[76:79], a[36:39], v[244:247]
  s_waitcnt lgkmcnt(10)
  v_mfma_f32_16x16x32_bf16 v[224:227], v[16:19], a[40:43], v[224:227]
  ds_read_b128 v[64:67], v5 offset:24576
  v_mfma_f32_16x16x32_bf16 v[228:231], v[16:19], a[44:47], v[228:231]
  v_mfma_f32_16x16x32_bf16 v[232:235], v[20:23], a[40:43], v[232:235]
  ds_read_b128 v[68:71], v5 offset:25600
  v_mfma_f32_16x16x32_bf16 v[236:239], v[20:23], a[44:47], v[236:239]
  s_waitcnt lgkmcnt(10)
  v_mfma_f32_16x16x32_bf16 v[240:243], v[24:27], a[40:43], v[240:243]
  ds_read_b128 v[72:75], v5 offset:26624
  v_mfma_f32_16x16x32_bf16 v[244:247], v[24:27], a[44:47], v[244:247]
  v_mfma_f32_16x16x32_bf16 v[224:227], v[28:31], a[48:51], v[224:227]
  ds_read_b128 v[76:79], v5 offset:27648
  v_mfma_f32_16x16x32_bf16 v[228:231], v[28:31], a[52:55], v[228:231]
  s_waitcnt lgkmcnt(10)
  v_mfma_f32_16x16x32_bf16 v[232:235], v[32:35], a[48:51], v[232:235]
  ds_read_b128 v[16:19], v5 offset:28672
  v_mfma_f32_16x16x32_bf16 v[236:239], v[32:35], a[52:55], v[236:239]
  v_mfma_f32_16x16x32_bf16 v[240:243], v[36:39], a[48:51], v[240:243]
  ds_read_b128 v[20:23], v5 offset:29696
  v_mfma_f32_16x16x32_bf16 v[244:247], v[36:39], a[52:55], v[244:247]
  s_waitcnt lgkmcnt(10)
  v_mfma_f32_16x16x32_bf16 v[224:227], v[40:43], a[56:59], v[224:227]
  ds_read_b128 v[24:27], v5 offset:30720
  v_mfma_f32_16x16x32_bf16 v[228:231], v[40:43], a[60:63], v[228:231]
  v_mfma_f32_16x16x32_bf16 v[232:235], v[44:47], a[56:59], v[232:235]
  ds_read_b128 v[28:31], v5 offset:31744
  v_mfma_f32_16x16x32_bf16 v[236:239], v[44:47], a[60:63], v[236:239]
  s_waitcnt lgkmcnt(10)
  v_mfma_f32_16x16x32_bf16 v[240:243], v[48:51], a[56:59], v[240:243]
  ds_read_b128 v[32:35], v5 offset:32768
  v_mfma_f32_16x16x32_bf16 v[244:247], v[48:51], a[60:63], v[244:247]
  v_mfma_f32_16x16x32_bf16 v[224:227], v[52:55], a[64:67], v[224:227]
  ds_read_b128 v[36:39], v5 offset:33792
  v_mfma_f32_16x16x32_bf16 v[228:231], v[52:55], a[68:71], v[228:231]
  s_waitcnt lgkmcnt(10)
  v_mfma_f32_16x16x32_bf16 v[232:235], v[56:59], a[64:67], v[232:235]
  ds_read_b128 v[40:43], v5 offset:34816
  v_mfma_f32_16x16x32_bf16 v[236:239], v[56:59], a[68:71], v[236:239]
  v_mfma_f32_16x16x32_bf16 v[240:243], v[60:63], a[64:67], v[240:243]
  ds_read_b128 v[44:47], v5 offset:35840
  v_mfma_f32_16x16x32_bf16 v[244:247], v[60:63], a[68:71], v[244:247]
  s_waitcnt lgkmcnt(10)
  v_mfma_f32_16x16x32_bf16 v[224:227], v[64:67], a[72:75], v[224:227]
  v_mfma_f32_16x16x32_bf16 v[228:231], v[64:67], a[76:79], v[228:231]
  v_mfma_f32_16x16x32_bf16 v[232:235], v[68:71], a[72:75], v[232:235]
  v_mfma_f32_16x16x32_bf16 v[236:239], v[68:71], a[76:79], v[236:239]
  s_waitcnt lgkmcnt(8)
  v_mfma_f32_16x16x32_bf16 v[240:243], v[72:75], a[72:75], v[240:243]
  v_mfma_f32_16x16x32_bf16 v[244:247], v[72:75], a[76:79], v[244:247]
  v_mfma_f32_16x16x32_bf16 v[224:227], v[76:79], a[80:83], v[224:227]
  v_mfma_f32_16x16x32_bf16 v[228:231], v[76:79], a[84:87], v[228:231]
  s_waitcnt lgkmcnt(6)
  v_mfma_f32_16x16x32_bf16 v[232:235], v[16:19], a[80:83], v[232:235]
  v_mfma_f32_16x16x32_bf16 v[236:239], v[16:19], a[84:87], v[236:239]
  v_mfma_f32_16x16x32_bf16 v[240:243], v[20:23], a[80:83], v[240:243]
  v_mfma_f32_16x16x32_bf16 v[244:247], v[20:23], a[84:87], v[244:247]
  s_waitcnt lgkmcnt(4)
  v_mfma_f32_16x16x32_bf16 v[224:227], v[24:27], a[88:91], v[224:227]
  v_mfma_f32_16x16x32_bf16 v[228:231], v[24:27], a[92:95], v[228:231]
  v_mfma_f32_16x16x32_bf16 v[232:235], v[28:31], a[88:91], v[232:235]
  v_mfma_f32_16x16x32_bf16 v[236:239], v[28:31], a[92:95], v[236:239]
  s_waitcnt lgkmcnt(2)
  v_mfma_f32_16x16x32_bf16 v[240:243], v[32:35], a[88:91], v[240:243]
  v_mfma_f32_16x16x32_bf16 v[244:247], v[32:35], a[92:95], v[244:247]
  v_mfma_f32_16x16x32_bf16 v[224:227], v[36:39], a[96:99], v[224:227]
  v_mfma_f32_16x16x32_bf16 v[228:231], v[36:39], a[100:103], v[228:231]
  s_waitcnt lgkmcnt(0)
  v_mfma_f32_16x16x32_bf16 v[232:235], v[40:43], a[96:99], v[232:235]
  v_mfma_f32_16x16x32_bf16 v[236:239], v[40:43], a[100:103], v[236:239]
  v_mfma_f32_16x16x32_bf16 v[240:243], v[44:47], a[96:99], v[240:243]
  v_mfma_f32_16x16x32_bf16 v[244:247], v[44:47], a[100:103], v[244:247]
  s_nop 7
  s_add_u32 s45, s50, 53248
  buffer_store_dwordx4 v[228:231], v3, s[28:31], s45 offen sc1
  s_add_u32 s45, s50, 57344
  buffer_store_dwordx4 v[232:235], v3, s[28:31], s45 offen sc1
  s_add_u32 s45, s50, 61440
  buffer_store_dwordx4 v[236:239], v3, s[28:31], s45 offen sc1
  s_add_u32 s45, s50, 69632
  buffer_store_dwordx4 v[244:247], v3, s[28:31], s45 offen sc1
  buffer_load_dwordx2 v[12:13], v8, s[28:31], s49 offen offset:0 sc1
  s_waitcnt vmcnt(0)
  s_add_u32 s61, s88, 4
  v_mov_b32 v14, s61
  v_mov_b32 v15, s89
  s_mov_b64 exec, 1
  buffer_store_dwordx2 v[14:15], v10, s[28:31], s52 offen sc1
  s_mov_b64 exec, -1
  s_waitcnt vmcnt(1)
  s_mov_b32 s58, 0
  s_add_u32 s59, s88, 3
  s_mov_b64 s[60:61], -1
  v_subrev_u32 v14, s59, v12
  v_cmp_gt_u32 vcc, 13, v14
  v_cmp_eq_u32 s[62:63], s89, v13
  s_nop 1
  s_and_b64 vcc, vcc, s[62:63]
  s_and_b64 s[60:61], s[60:61], vcc
  s_cmp_eq_u64 s[60:61], -1
  s_cbranch_scc1 L_p3a_0_ok
  buffer_load_dwordx2 v[12:13], v8, s[28:31], s49 offen offset:0 sc1
  s_sleep 4
  buffer_load_dwordx2 v[250:251], v8, s[28:31], s49 offen offset:0 sc1
L_p3a_0_chk:
  s_waitcnt vmcnt(1)
  s_mov_b64 s[60:61], -1
  v_subrev_u32 v14, s59, v12
  v_cmp_gt_u32 vcc, 13, v14
  v_cmp_eq_u32 s[62:63], s89, v13
  s_nop 1
  s_and_b64 vcc, vcc, s[62:63]
  s_and_b64 s[60:61], s[60:61], vcc
  s_cmp_eq_u64 s[60:61], -1
  s_cbranch_scc1 L_p3a_0_ok
  buffer_load_dwordx2 v[12:13], v8, s[28:31], s49 offen offset:0 sc1
  s_waitcnt vmcnt(1)
  s_mov_b64 s[60:61], -1
  v_subrev_u32 v14, s59, v250
  v_cmp_gt_u32 vcc, 13, v14
  v_cmp_eq_u32 s[62:63], s89, v251
  s_nop 1
  s_and_b64 vcc, vcc, s[62:63]
  s_and_b64 s[60:61], s[60:61], vcc
  s_cmp_eq_u64 s[60:61], -1
  s_cbranch_scc1 L_p3a_0_ok
  buffer_load_dwordx2 v[250:251], v8, s[28:31], s49 offen offset:0 sc1
  s_add_u32 s58, s58, 1
  s_cmp_gt_u32 s58, 20000
  s_cbranch_scc0 L_p3a_0_chk
L_p3a_0_ok:
  s_add_u32 s45, s50, 1024
  buffer_load_dwordx4 v[80:83], v3, s[28:31], s45 offen sc1
  s_add_u32 s45, s50, 2048
  buffer_load_dwordx4 v[84:87], v3, s[28:31], s45 offen sc1
  s_add_u32 s45, s50, 3072
  buffer_load_dwordx4 v[88:91], v3, s[28:31], s45 offen sc1
  s_add_u32 s45, s57, 0
  buffer_load_dwordx2 v[92:93], v11, s[28:31], s45 offen sc1
  s_add_u32 s45, s50, 17408
  buffer_load_dwordx4 v[96:99], v3, s[28:31], s45 offen sc1
  s_add_u32 s45, s50, 18432
  buffer_load_dwordx4 v[100:103], v3, s[28:31], s45 offen sc1
  s_add_u32 s45, s50, 19456
  buffer_load_dwordx4 v[104:107], v3, s[28:31], s45 offen sc1
  s_add_u32 s45, s57, 64
  buffer_load_dwordx2 v[108:109], v11, s[28:31], s45 offen sc1
  s_add_u32 s45, s50, 33792
  buffer_load_dwordx4 v[112:115], v3, s[28:31], s45 offen sc1
  s_add_u32 s45, s50, 34816
  buffer_load_dwordx4 v[116:119], v3, s[28:31], s45 offen sc1
  s_add_u32 s45, s50, 35840
  buffer_load_dwordx4 v[120:123], v3, s[28:31], s45 offen sc1
  s_add_u32 s45, s57, 128
  buffer_load_dwordx2 v[124:125], v11, s[28:31], s45 offen sc1
  buffer_load_dwordx2 v[12:13], v8, s[28:31], s49 offen offset:0 sc1
  s_waitcnt vmcnt(0)
  s_mov_b32 s58, 0
  s_add_u32 s59, s88, 4
  s_mov_b64 s[60:61], -1
  v_subrev_u32 v14, s59, v12
  v_cmp_gt_u32 vcc, 12, v14
  v_cmp_eq_u32 s[62:63], s89, v13
  s_nop 1
  s_and_b64 vcc, vcc, s[62:63]
  s_and_b64 s[60:61], s[60:61], vcc
  s_cmp_eq_u64 s[60:61], -1
  s_cbranch_scc1 L_p3b_0_ok
  buffer_load_dwordx2 v[12:13], v8, s[28:31], s49 offen offset:0 sc1
  s_sleep 4
  buffer_load_dwordx2 v[250:251], v8, s[28:31], s49 offen offset:0 sc1
L_p3b_0_chk:
  s_waitcnt vmcnt(1)
  s_mov_b64 s[60:61], -1
  v_subrev_u32 v14, s59, v12
  v_cmp_gt_u32 vcc, 12, v14
  v_cmp_eq_u32 s[62:63], s89, v13
  s_nop 1
  s_and_b64 vcc, vcc, s[62:63]
  s_and_b64 s[60:61], s[60:61], vcc
  s_cmp_eq_u64 s[60:61], -1
  s_cbranch_scc1 L_p3b_0_ok
  buffer_load_dwordx2 v[12:13], v8, s[28:31], s49 offen offset:0 sc1
  s_waitcnt vmcnt(1)
  s_mov_b64 s[60:61], -1
  v_subrev_u32 v14, s59, v250
  v_cmp_gt_u32 vcc, 12, v14
  v_cmp_eq_u32 s[62:63], s89, v251
  s_nop 1
  s_and_b64 vcc, vcc, s[62:63]
  s_and_b64 s[60:61], s[60:61], vcc
  s_cmp_eq_u64 s[60:61], -1
  s_cbranch_scc1 L_p3b_0_ok
  buffer_load_dwordx2 v[250:251], v8, s[28:31], s49 offen offset:0 sc1
  s_add_u32 s58, s58, 1
  s_cmp_gt_u32 s58, 20000
  s_cbranch_scc0 L_p3b_0_chk
L_p3b_0_ok:
  s_add_u32 s45, s50, 50176
  buffer_load_dwordx4 v[16:19], v3, s[28:31], s45 offen sc1
  s_add_u32 s45, s50, 51200
  buffer_load_dwordx4 v[20:23], v3, s[28:31], s45 offen sc1
  s_add_u32 s45, s50, 52224
  buffer_load_dwordx4 v[24:27], v3, s[28:31], s45 offen sc1
  s_add_u32 s45, s57, 192
  buffer_load_dwordx2 v[28:29], v11, s[28:31], s45 offen sc1
  s_add_u32 s45, s50, 66560
  buffer_load_dwordx4 v[32:35], v3, s[28:31], s45 offen sc1
  s_add_u32 s45, s50, 67584
  buffer_load_dwordx4 v[36:39], v3, s[28:31], s45 offen sc1
  s_add_u32 s45, s50, 68608
  buffer_load_dwordx4 v[40:43], v3, s[28:31], s45 offen sc1
  s_add_u32 s45, s57, 256
  buffer_load_dwordx2 v[44:45], v11, s[28:31], s45 offen sc1
  s_waitcnt vmcnt(17)
  v_pk_add_f32 v[152:153], v[152:153], v[80:81]
  v_pk_add_f32 v[154:155], v[154:155], v[82:83]
  v_pk_add_f32 v[152:153], v[152:153], v[84:85]
  v_pk_add_f32 v[154:155], v[154:155], v[86:87]
  v_pk_add_f32 v[152:153], v[152:153], v[88:89]
  v_pk_add_f32 v[154:155], v[154:155], v[90:91]
  v_cvt_pk_bf16_f32 v94, v152, v153
  v_lshlrev_b32 v152, 16, v94
  v_and_b32 v153, s43, v94
  v_lshlrev_b32 v84, 16, v92
  v_and_b32 v85, s43, v92
  v_pk_add_f32 v[152:153], v[152:153], v[84:85]
  v_cvt_pk_bf16_f32 v94, v154, v155
  v_lshlrev_b32 v154, 16, v94
  v_and_b32 v155, s43, v94
  v_lshlrev_b32 v86, 16, v93
  v_and_b32 v87, s43, v93
  v_pk_add_f32 v[154:155], v[154:155], v[86:87]
  v_cvt_pk_bf16_f32 v88, v152, v153
  v_cvt_pk_bf16_f32 v89, v154, v155
  s_add_u32 s45, s56, 0
  buffer_store_dwordx2 v[88:89], v11, s[20:23], s45 offen
  s_waitcnt vmcnt(14)
  v_pk_add_f32 v[168:169], v[168:169], v[96:97]
  v_pk_add_f32 v[170:171], v[170:171], v[98:99]
  v_pk_add_f32 v[168:169], v[168:169], v[100:101]
  v_pk_add_f32 v[170:171], v[170:171], v[102:103]
  v_pk_add_f32 v[168:169], v[168:169], v[104:105]
  v_pk_add_f32 v[170:171], v[170:171], v[106:107]
  v_cvt_pk_bf16_f32 v110, v168, v169
  v_lshlrev_b32 v168, 16, v110
  v_and_b32 v169, s43, v110
  v_lshlrev_b32 v100, 16, v108
  v_and_b32 v101, s43, v108
  v_pk_add_f32 v[168:169], v[168:169], v[100:101]
  v_cvt_pk_bf16_f32 v110, v170, v171
  v_lshlrev_b32 v170, 16, v110
  v_and_b32 v171, s43, v110
  v_lshlrev_b32 v102, 16, v109
  v_and_b32 v103, s43, v109
  v_pk_add_f32 v[170:171], v[170:171], v[102:103]
  v_cvt_pk_bf16_f32 v104, v168, v169
  v_cvt_pk_bf16_f32 v105, v170, v171
  s_add_u32 s45, s56, 64
  buffer_store_dwordx2 v[104:105], v11, s[20:23], s45 offen
  s_waitcnt vmcnt(11)
  v_pk_add_f32 v[184:185], v[184:185], v[112:113]
  v_pk_add_f32 v[186:187], v[186:187], v[114:115]
  v_pk_add_f32 v[184:185], v[184:185], v[116:117]
  v_pk_add_f32 v[186:187], v[186:187], v[118:119]
  v_pk_add_f32 v[184:185], v[184:185], v[120:121]
  v_pk_add_f32 v[186:187], v[186:187], v[122:123]
  v_cvt_pk_bf16_f32 v126, v184, v185
  v_lshlrev_b32 v184, 16, v126
  v_and_b32 v185, s43, v126
  v_lshlrev_b32 v116, 16, v124
  v_and_b32 v117, s43, v124
  v_pk_add_f32 v[184:185], v[184:185], v[116:117]
  v_cvt_pk_bf16_f32 v126, v186, v187
  v_lshlrev_b32 v186, 16, v126
  v_and_b32 v187, s43, v126
  v_lshlrev_b32 v118, 16, v125
  v_and_b32 v119, s43, v125
  v_pk_add_f32 v[186:187], v[186:187], v[118:119]
  v_cvt_pk_bf16_f32 v120, v184, v185
  v_cvt_pk_bf16_f32 v121, v186, v187
  s_add_u32 s45, s56, 128
  buffer_store_dwordx2 v[120:121], v11, s[20:23], s45 offen
  s_waitcnt vmcnt(7)
  v_pk_add_f32 v[224:225], v[224:225], v[16:17]
  v_pk_add_f32 v[226:227], v[226:227], v[18:19]
  v_pk_add_f32 v[224:225], v[224:225], v[20:21]
  v_pk_add_f32 v[226:227], v[226:227], v[22:23]
  v_pk_add_f32 v[224:225], v[224:225], v[24:25]
  v_pk_add_f32 v[226:227], v[226:227], v[26:27]
  v_cvt_pk_bf16_f32 v30, v224, v225
  v_lshlrev_b32 v224, 16, v30
  v_and_b32 v225, s43, v30
  v_lshlrev_b32 v20, 16, v28
  v_and_b32 v21, s43, v28
  v_pk_add_f32 v[224:225], v[224:225], v[20:21]
  v_cvt_pk_bf16_f32 v30, v226, v227
  v_lshlrev_b32 v226, 16, v30
  v_and_b32 v227, s43, v30
  v_lshlrev_b32 v22, 16, v29
  v_and_b32 v23, s43, v29
  v_pk_add_f32 v[226:227], v[226:227], v[22:23]
  v_cvt_pk_bf16_f32 v24, v224, v225
  v_cvt_pk_bf16_f32 v25, v226, v227
  s_add_u32 s45, s56, 192
  buffer_store_dwordx2 v[24:25], v11, s[20:23], s45 offen
  s_waitcnt vmcnt(4)
  v_pk_add_f32 v[240:241], v[240:241], v[32:33]
  v_pk_add_f32 v[242:243], v[242:243], v[34:35]
  v_pk_add_f32 v[240:241], v[240:241], v[36:37]
  v_pk_add_f32 v[242:243], v[242:243], v[38:39]
  v_pk_add_f32 v[240:241], v[240:241], v[40:41]
  v_pk_add_f32 v[242:243], v[242:243], v[42:43]
  v_cvt_pk_bf16_f32 v46, v240, v241
  v_lshlrev_b32 v240, 16, v46
  v_and_b32 v241, s43, v46
  v_lshlrev_b32 v36, 16, v44
  v_and_b32 v37, s43, v44
  v_pk_add_f32 v[240:241], v[240:241], v[36:37]
  v_cvt_pk_bf16_f32 v46, v242, v243
  v_lshlrev_b32 v242, 16, v46
  v_and_b32 v243, s43, v46
  v_lshlrev_b32 v38, 16, v45
  v_and_b32 v39, s43, v45
  v_pk_add_f32 v[242:243], v[242:243], v[38:39]
  v_cvt_pk_bf16_f32 v40, v240, v241
  v_cvt_pk_bf16_f32 v41, v242, v243
  s_add_u32 s45, s56, 256
  buffer_store_dwordx2 v[40:41], v11, s[20:23], s45 offen
  s_or_b32 s62, s2, s39
  s_cmp_lg_u32 s62, 0
  s_cbranch_scc1 L_nores
  s_load_dwordx2 s[60:61], s[0:1], 80
  s_waitcnt lgkmcnt(0)
  s_mov_b32 s4, s60
  s_mov_b32 s5, s61
  s_mov_b32 s6, 0x100
  s_mov_b32 s7, 0x20000
  s_mov_b64 exec, 1
  buffer_store_dword v10, v10, s[4:7], 0 offen sc1
  s_mov_b64 exec, -1
L_nores:
  s_endpgm
L_v1:
  s_cmp_lg_u32 s32, 1
  s_cbranch_scc1 L_v2
  v_mfma_f32_16x16x32_bf16 v[168:171], v[48:51], a[88:91], v[168:171]
  ds_read_b128 v[76:79], v7 offset:3072
  v_mfma_f32_16x16x32_bf16 v[172:175], v[48:51], a[92:95], v[172:175]
  ds_read_b128 v[16:19], v7 offset:4096
  s_waitcnt vmcnt(12)
  v_mfma_f32_16x16x32_bf16 v[152:155], v[52:55], a[96:99], v[152:155]
  ds_read_b128 v[20:23], v7 offset:5120
  v_mfma_f32_16x16x32_bf16 v[156:159], v[52:55], a[100:103], v[156:159]
  buffer_load_dwordx4 v3, s[28:31], s44 offen offset:3072 sc1 lds
  v_mfma_f32_16x16x32_bf16 v[160:163], v[56:59], a[96:99], v[160:163]
  ds_read_b128 v[24:27], v7 offset:6144
  v_mfma_f32_16x16x32_bf16 v[164:167], v[56:59], a[100:103], v[164:167]
  ds_read_b128 v[28:31], v7 offset:7168
  v_mfma_f32_16x16x32_bf16 v[168:171], v[60:63], a[96:99], v[168:171]
  ds_read_b128 v[32:35], v7 offset:8192
  v_mfma_f32_16x16x32_bf16 v[172:175], v[60:63], a[100:103], v[172:175]
  ds_read_b128 v[36:39], v7 offset:9216
  s_waitcnt lgkmcnt(8)
  v_mfma_f32_16x16x32_bf16 v[176:179], v[64:67], a[32:35], v[176:179]
  ds_read_b128 v[40:43], v7 offset:10240
  v_mfma_f32_16x16x32_bf16 v[180:183], v[64:67], a[36:39], v[180:183]
  s_add_u32 m0, s40, 40960
  s_add_u32 s44, s42, 299008
  buffer_load_dwordx4 v3, s[28:31], s44 offen offset:0 sc1 lds
  v_mfma_f32_16x16x32_bf16 v[184:187], v[68:71], a[32:35], v[184:187]
  ds_read_b128 v[44:47], v7 offset:11264
  v_mfma_f32_16x16x32_bf16 v[188:191], v[68:71], a[36:39], v[188:191]
  ds_read_b128 v[48:51], v7 offset:12288
  s_waitcnt lgkmcnt(9)
  v_mfma_f32_16x16x32_bf16 v[192:195], v[72:75], a[32:35], v[192:195]
  ds_read_b128 v[52:55], v7 offset:13312
  v_mfma_f32_16x16x32_bf16 v[196:199], v[72:75], a[36:39], v[196:199]
  s_add_u32 s45, s50, 1024
  buffer_store_dwordx4 v[152:155], v3, s[28:31], s45 offen sc1
  v_mfma_f32_16x16x32_bf16 v[176:179], v[76:79], a[40:43], v[176:179]
  ds_read_b128 v[56:59], v7 offset:14336
  v_mfma_f32_16x16x32_bf16 v[180:183], v[76:79], a[44:47], v[180:183]
  ds_read_b128 v[60:63], v7 offset:15360
  s_waitcnt lgkmcnt(10)
  v_mfma_f32_16x16x32_bf16 v[184:187], v[16:19], a[40:43], v[184:187]
  ds_read_b128 v[64:67], v7 offset:16384
  v_mfma_f32_16x16x32_bf16 v[188:191], v[16:19], a[44:47], v[188:191]
  buffer_load_dwordx4 v3, s[28:31], s44 offen offset:1024 sc1 lds
  v_mfma_f32_16x16x32_bf16 v[192:195], v[20:23], a[40:43], v[192:195]
  ds_read_b128 v[68:71], v7 offset:17408
  v_mfma_f32_16x16x32_bf16 v[196:199], v[20:23], a[44:47], v[196:199]
  s_waitcnt lgkmcnt(10)
  v_mfma_f32_16x16x32_bf16 v[176:179], v[24:27], a[48:51], v[176:179]
  ds_read_b128 v[72:75], v7 offset:18432
  v_mfma_f32_16x16x32_bf16 v[180:183], v[24:27], a[52:55], v[180:183]
  buffer_load_dwordx4 v3, s[28:31], s44 offen offset:2048 sc1 lds
  v_mfma_f32_16x16x32_bf16 v[184:187], v[28:31], a[48:51], v[184:187]
  ds_read_b128 v[76:79], v7 offset:19456
  v_mfma_f32_16x16x32_bf16 v[188:191], v[28:31], a[52:55], v[188:191]
  s_waitcnt lgkmcnt(10)
  v_mfma_f32_16x16x32_bf16 v[192:195], v[32:35], a[48:51], v[192:195]
  ds_read_b128 v[16:19], v7 offset:20480
  v_mfma_f32_16x16x32_bf16 v[196:199], v[32:35], a[52:55], v[196:199]
  v_mfma_f32_16x16x32_bf16 v[176:179], v[36:39], a[56:59], v[176:179]
  ds_read_b128 v[20:23], v7 offset:21504
  v_mfma_f32_16x16x32_bf16 v[180:183], v[36:39], a[60:63], v[180:183]
  s_add_u32 s45, s50, 9216
  buffer_store_dwordx4 v[160:163], v3, s[28:31], s45 offen sc1
  s_waitcnt lgkmcnt(10)
  v_mfma_f32_16x16x32_bf16 v[184:187], v[40:43], a[56:59], v[184:187]
  ds_read_b128 v[24:27], v7 offset:22528
  v_mfma_f32_16x16x32_bf16 v[188:191], v[40:43], a[60:63], v[188:191]
  v_mfma_f32_16x16x32_bf16 v[192:195], v[44:47], a[56:59], v[192:195]
  ds_read_b128 v[28:31], v7 offset:23552
  v_mfma_f32_16x16x32_bf16 v[196:199], v[44:47], a[60:63], v[196:199]
  buffer_load_dwordx4 v3, s[28:31], s44 offen offset:3072 sc1 lds
  s_waitcnt lgkmcnt(10)
  v_mfma_f32_16x16x32_bf16 v[176:179], v[48:51], a[64:67], v[176:179]
  ds_read_b128 v[32:35], v7 offset:24576
  v_mfma_f32_16x16x32_bf16 v[180:183], v[48:51], a[68:71], v[180:183]
  v_mfma_f32_16x16x32_bf16 v[184:187], v[52:55], a[64:67], v[184:187]
  ds_read_b128 v[36:39], v7 offset:25600
  v_mfma_f32_16x16x32_bf16 v[188:191], v[52:55], a[68:71], v[188:191]
  s_add_u32 m0, s40, 45056
  s_add_u32 s44, s42, 303104
  buffer_load_dwordx4 v3, s[28:31], s44 offen offset:0 sc1 lds
  s_waitcnt lgkmcnt(10)
  v_mfma_f32_16x16x32_bf16 v[192:195], v[56:59], a[64:67], v[192:195]
  ds_read_b128 v[40:43], v7 offset:26624
  v_mfma_f32_16x16x32_bf16 v[196:199], v[56:59], a[68:71], v[196:199]
  v_mfma_f32_16x16x32_bf16 v[176:179], v[60:63], a[72:75], v[176:179]
  ds_read_b128 v[44:47], v7 offset:27648
  v_mfma_f32_16x16x32_bf16 v[180:183], v[60:63], a[76:79], v[180:183]
  s_add_u32 s45, s50, 13312
  buffer_store_dwordx4 v[164:167], v3, s[28:31], s45 offen sc1
  s_waitcnt lgkmcnt(10)
  v_mfma_f32_16x16x32_bf16 v[184:187], v[64:67], a[72:75], v[184:187]
  ds_read_b128 v[48:51], v7 offset:28672
  v_mfma_f32_16x16x32_bf16 v[188:191], v[64:67], a[76:79], v[188:191]
  v_mfma_f32_16x16x32_bf16 v[192:195], v[68:71], a[72:75], v[192:195]
  ds_read_b128 v[52:55], v7 offset:29696
  v_mfma_f32_16x16x32_bf16 v[196:199], v[68:71], a[76:79], v[196:199]
  s_waitcnt lgkmcnt(10)
  v_mfma_f32_16x16x32_bf16 v[176:179], v[72:75], a[80:83], v[176:179]
  ds_read_b128 v[56:59], v7 offset:30720
  v_mfma_f32_16x16x32_bf16 v[180:183], v[72:75], a[84:87], v[180:183]
  v_mfma_f32_16x16x32_bf16 v[184:187], v[76:79], a[80:83], v[184:187]
  ds_read_b128 v[60:63], v7 offset:31744
  v_mfma_f32_16x16x32_bf16 v[188:191], v[76:79], a[84:87], v[188:191]
  s_waitcnt lgkmcnt(10)
  v_mfma_f32_16x16x32_bf16 v[192:195], v[16:19], a[80:83], v[192:195]
  ds_read_b128 v[64:67], v7 offset:32768
  v_mfma_f32_16x16x32_bf16 v[196:199], v[16:19], a[84:87], v[196:199]
  s_add_u32 s45, s50, 17408
  buffer_store_dwordx4 v[168:171], v3, s[28:31], s45 offen sc1
  v_mfma_f32_16x16x32_bf16 v[176:179], v[20:23], a[88:91], v[176:179]
  ds_read_b128 v[68:71], v7 offset:33792
  v_mfma_f32_16x16x32_bf16 v[180:183], v[20:23], a[92:95], v[180:183]
  s_waitcnt lgkmcnt(10)
  v_mfma_f32_16x16x32_bf16 v[184:187], v[24:27], a[88:91], v[184:187]
  ds_read_b128 v[72:75], v7 offset:34816
  v_mfma_f32_16x16x32_bf16 v[188:191], v[24:27], a[92:95], v[188:191]
  v_mfma_f32_16x16x32_bf16 v[192:195], v[28:31], a[88:91], v[192:195]
  ds_read_b128 v[76:79], v7 offset:35840
  v_mfma_f32_16x16x32_bf16 v[196:199], v[28:31], a[92:95], v[196:199]
  s_waitcnt lgkmcnt(10)
  v_mfma_f32_16x16x32_bf16 v[176:179], v[32:35], a[96:99], v[176:179]
  v_mfma_f32_16x16x32_bf16 v[180:183], v[32:35], a[100:103], v[180:183]
  v_mfma_f32_16x16x32_bf16 v[184:187], v[36:39], a[96:99], v[184:187]
  v_mfma_f32_16x16x32_bf16 v[188:191], v[36:39], a[100:103], v[188:191]
  s_waitcnt lgkmcnt(8)
  v_mfma_f32_16x16x32_bf16 v[192:195], v[40:43], a[96:99], v[192:195]
  v_mfma_f32_16x16x32_bf16 v[196:199], v[40:43], a[100:103], v[196:199]
  v_mfma_f32_16x16x32_bf16 v[224:227], v[44:47], a[144:147], v[224:227]
  v_mfma_f32_16x16x32_bf16 v[228:231], v[44:47], a[148:151], v[228:231]
  s_waitcnt lgkmcnt(6)
  v_mfma_f32_16x16x32_bf16 v[232:235], v[48:51], a[144:147], v[232:235]
  v_mfma_f32_16x16x32_bf16 v[236:239], v[48:51], a[148:151], v[236:239]
  v_mfma_f32_16x16x32_bf16 v[240:243], v[52:55], a[144:147], v[240:243]
  v_mfma_f32_16x16x32_bf16 v[244:247], v[52:55], a[148:151], v[244:247]
  s_add_u32 s45, s50, 25600
  buffer_store_dwordx4 v[176:179], v3, s[28:31], s45 offen sc1
  s_waitcnt lgkmcnt(0)
  s_waitcnt vmcnt(14)
  s_barrier
  v_mfma_f32_16x16x32_bf16 v[224:227], v[56:59], a[152:155], v[224:227]
  ds_read_b128 v[16:19], v4 offset:0
  v_mfma_f32_16x16x32_bf16 v[228:231], v[56:59], a[156:159], v[228:231]
  ds_read_b128 v[20:23], v4 offset:1024
  v_mfma_f32_16x16x32_bf16 v[232:235], v[60:63], a[152:155], v[232:235]
  ds_read_b128 v[24:27], v4 offset:2048
  v_mfma_f32_16x16x32_bf16 v[236:239], v[60:63], a[156:159], v[236:239]
  ds_read_b128 v[28:31], v4 offset:3072
  v_mfma_f32_16x16x32_bf16 v[240:243], v[64:67], a[152:155], v[240:243]
  ds_read_b128 v[32:35], v4 offset:4096
  v_mfma_f32_16x16x32_bf16 v[244:247], v[64:67], a[156:159], v[244:247]
  ds_read_b128 v[36:39], v4 offset:5120
  v_mfma_f32_16x16x32_bf16 v[224:227], v[68:71], a[160:163], v[224:227]
  ds_read_b128 v[40:43], v4 offset:6144
  v_mfma_f32_16x16x32_bf16 v[228:231], v[68:71], a[164:167], v[228:231]
  ds_read_b128 v[44:47], v4 offset:7168
  v_mfma_f32_16x16x32_bf16 v[232:235], v[72:75], a[160:163], v[232:235]
  ds_read_b128 v[48:51], v4 offset:8192
  v_mfma_f32_16x16x32_bf16 v[236:239], v[72:75], a[164:167], v[236:239]
  ds_read_b128 v[52:55], v4 offset:9216
  v_mfma_f32_16x16x32_bf16 v[240:243], v[76:79], a[160:163], v[240:243]
  ds_read_b128 v[56:59], v4 offset:10240
  v_mfma_f32_16x16x32_bf16 v[244:247], v[76:79], a[164:167], v[244:247]
  ds_read_b128 v[60:63], v4 offset:11264
  s_waitcnt lgkmcnt(10)
  v_mfma_f32_16x16x32_bf16 v[224:227], v[16:19], a[168:171], v[224:227]
  ds_read_b128 v[64:67], v4 offset:12288
  v_mfma_f32_16x16x32_bf16 v[228:231], v[16:19], a[172:175], v[228:231]
  s_add_u32 s45, s50, 29696
  buffer_store_dwordx4 v[180:183], v3, s[28:31], s45 offen sc1
  v_mfma_f32_16x16x32_bf16 v[232:235], v[20:23], a[168:171], v[232:235]
  ds_read_b128 v[68:71], v4 offset:13312
  v_mfma_f32_16x16x32_bf16 v[236:239], v[20:23], a[172:175], v[236:239]
  s_waitcnt lgkmcnt(10)
  v_mfma_f32_16x16x32_bf16 v[240:243], v[24:27], a[168:171], v[240:243]
  ds_read_b128 v[72:75], v4 offset:14336
  v_mfma_f32_16x16x32_bf16 v[244:247], v[24:27], a[172:175], v[244:247]
  v_mfma_f32_16x16x32_bf16 v[224:227], v[28:31], a[176:179], v[224:227]
  ds_read_b128 v[76:79], v4 offset:15360
  v_mfma_f32_16x16x32_bf16 v[228:231], v[28:31], a[180:183], v[228:231]
  s_waitcnt lgkmcnt(10)
  v_mfma_f32_16x16x32_bf16 v[232:235], v[32:35], a[176:179], v[232:235]
  ds_read_b128 v[16:19], v4 offset:16384
  v_mfma_f32_16x16x32_bf16 v[236:239], v[32:35], a[180:183], v[236:239]
  v_mfma_f32_16x16x32_bf16 v[240:243], v[36:39], a[176:179], v[240:243]
  ds_read_b128 v[20:23], v4 offset:17408
  v_mfma_f32_16x16x32_bf16 v[244:247], v[36:39], a[180:183], v[244:247]
  s_waitcnt lgkmcnt(10)
  v_mfma_f32_16x16x32_bf16 v[224:227], v[40:43], a[184:187], v[224:227]
  ds_read_b128 v[24:27], v4 offset:18432
  v_mfma_f32_16x16x32_bf16 v[228:231], v[40:43], a[188:191], v[228:231]
  s_add_u32 s45, s50, 33792
  buffer_store_dwordx4 v[184:187], v3, s[28:31], s45 offen sc1
  v_mfma_f32_16x16x32_bf16 v[232:235], v[44:47], a[184:187], v[232:235]
  ds_read_b128 v[28:31], v4 offset:19456
  v_mfma_f32_16x16x32_bf16 v[236:239], v[44:47], a[188:191], v[236:239]
  s_waitcnt lgkmcnt(10)
  v_mfma_f32_16x16x32_bf16 v[240:243], v[48:51], a[184:187], v[240:243]
  ds_read_b128 v[32:35], v4 offset:20480
  v_mfma_f32_16x16x32_bf16 v[244:247], v[48:51], a[188:191], v[244:247]
  v_mfma_f32_16x16x32_bf16 v[224:227], v[52:55], a[192:195], v[224:227]
  ds_read_b128 v[36:39], v4 offset:21504
  v_mfma_f32_16x16x32_bf16 v[228:231], v[52:55], a[196:199], v[228:231]
  s_waitcnt lgkmcnt(10)
  v_mfma_f32_16x16x32_bf16 v[232:235], v[56:59], a[192:195], v[232:235]
  ds_read_b128 v[40:43], v4 offset:22528
  v_mfma_f32_16x16x32_bf16 v[236:239], v[56:59], a[196:199], v[236:239]
  v_mfma_f32_16x16x32_bf16 v[240:243], v[60:63], a[192:195], v[240:243]
  ds_read_b128 v[44:47], v4 offset:23552
  v_mfma_f32_16x16x32_bf16 v[244:247], v[60:63], a[196:199], v[244:247]
  s_waitcnt vmcnt(3)
  s_add_u32 s61, s88, 2
  v_mov_b32 v14, s61
  v_mov_b32 v15, s89
  s_mov_b64 exec, 1
  buffer_store_dwordx2 v[14:15], v10, s[28:31], s52 offen sc1
  s_mov_b64 exec, -1
  s_waitcnt lgkmcnt(10)
  v_mfma_f32_16x16x32_bf16 v[224:227], v[64:67], a[200:203], v[224:227]
  ds_read_b128 v[48:51], v4 offset:24576
  v_mfma_f32_16x16x32_bf16 v[228:231], v[64:67], a[204:207], v[228:231]
  v_mfma_f32_16x16x32_bf16 v[232:235], v[68:71], a[200:203], v[232:235]
  ds_read_b128 v[52:55], v4 offset:25600
  v_mfma_f32_16x16x32_bf16 v[236:239], v[68:71], a[204:207], v[236:239]
  s_add_u32 s45, s50, 41984
  buffer_store_dwordx4 v[192:195], v3, s[28:31], s45 offen sc1
  s_waitcnt lgkmcnt(10)
  v_mfma_f32_16x16x32_bf16 v[240:243], v[72:75], a[200:203], v[240:243]
  ds_read_b128 v[56:59], v4 offset:26624
  v_mfma_f32_16x16x32_bf16 v[244:247], v[72:75], a[204:207], v[244:247]
  v_mfma_f32_16x16x32_bf16 v[224:227], v[76:79], a[208:211], v[224:227]
  ds_read_b128 v[60:63], v4 offset:27648
  v_mfma_f32_16x16x32_bf16 v[228:231], v[76:79], a[212:215], v[228:231]
  s_waitcnt lgkmcnt(10)
  v_mfma_f32_16x16x32_bf16 v[232:235], v[16:19], a[208:211], v[232:235]
  ds_read_b128 v[64:67], v4 offset:28672
  v_mfma_f32_16x16x32_bf16 v[236:239], v[16:19], a[212:215], v[236:239]
  v_mfma_f32_16x16x32_bf16 v[240:243], v[20:23], a[208:211], v[240:243]
  ds_read_b128 v[68:71], v4 offset:29696
  v_mfma_f32_16x16x32_bf16 v[244:247], v[20:23], a[212:215], v[244:247]
  s_waitcnt lgkmcnt(10)
  v_mfma_f32_16x16x32_bf16 v[224:227], v[24:27], a[216:219], v[224:227]
  ds_read_b128 v[72:75], v4 offset:30720
  v_mfma_f32_16x16x32_bf16 v[228:231], v[24:27], a[220:223], v[228:231]
  s_add_u32 s45, s50, 46080
  buffer_store_dwordx4 v[196:199], v3, s[28:31], s45 offen sc1
  v_mfma_f32_16x16x32_bf16 v[232:235], v[28:31], a[216:219], v[232:235]
  ds_read_b128 v[76:79], v4 offset:31744
  v_mfma_f32_16x16x32_bf16 v[236:239], v[28:31], a[220:223], v[236:239]
  s_waitcnt lgkmcnt(10)
  v_mfma_f32_16x16x32_bf16 v[240:243], v[32:35], a[216:219], v[240:243]
  ds_read_b128 v[16:19], v4 offset:32768
  v_mfma_f32_16x16x32_bf16 v[244:247], v[32:35], a[220:223], v[244:247]
  v_mfma_f32_16x16x32_bf16 v[224:227], v[36:39], a[224:227], v[224:227]
  ds_read_b128 v[20:23], v4 offset:33792
  v_mfma_f32_16x16x32_bf16 v[228:231], v[36:39], a[228:231], v[228:231]
  s_waitcnt lgkmcnt(10)
  v_mfma_f32_16x16x32_bf16 v[232:235], v[40:43], a[224:227], v[232:235]
  ds_read_b128 v[24:27], v4 offset:34816
  v_mfma_f32_16x16x32_bf16 v[236:239], v[40:43], a[228:231], v[236:239]
  v_mfma_f32_16x16x32_bf16 v[240:243], v[44:47], a[224:227], v[240:243]
  ds_read_b128 v[28:31], v4 offset:35840
  v_mfma_f32_16x16x32_bf16 v[244:247], v[44:47], a[228:231], v[244:247]
  s_waitcnt lgkmcnt(10)
  v_mfma_f32_16x16x32_bf16 v[224:227], v[48:51], a[232:235], v[224:227]
  v_mfma_f32_16x16x32_bf16 v[228:231], v[48:51], a[236:239], v[228:231]
  v_mfma_f32_16x16x32_bf16 v[232:235], v[52:55], a[232:235], v[232:235]
  v_mfma_f32_16x16x32_bf16 v[236:239], v[52:55], a[236:239], v[236:239]
  s_waitcnt lgkmcnt(8)
  v_mfma_f32_16x16x32_bf16 v[240:243], v[56:59], a[232:235], v[240:243]
  v_mfma_f32_16x16x32_bf16 v[244:247], v[56:59], a[236:239], v[244:247]
  v_mfma_f32_16x16x32_bf16 v[224:227], v[60:63], a[240:243], v[224:227]
  v_mfma_f32_16x16x32_bf16 v[228:231], v[60:63], a[244:247], v[228:231]
  s_waitcnt lgkmcnt(6)
  v_mfma_f32_16x16x32_bf16 v[232:235], v[64:67], a[240:243], v[232:235]
  v_mfma_f32_16x16x32_bf16 v[236:239], v[64:67], a[244:247], v[236:239]
  v_mfma_f32_16x16x32_bf16 v[240:243], v[68:71], a[240:243], v[240:243]
  v_mfma_f32_16x16x32_bf16 v[244:247], v[68:71], a[244:247], v[244:247]
  s_waitcnt lgkmcnt(0)
  s_waitcnt vmcnt(8)
  s_barrier
  v_mfma_f32_16x16x32_bf16 v[224:227], v[72:75], a[248:251], v[224:227]
  ds_read_b128 v[32:35], v5 offset:0
  v_mfma_f32_16x16x32_bf16 v[228:231], v[72:75], a[252:255], v[228:231]
  ds_read_b128 v[36:39], v5 offset:1024
  v_mfma_f32_16x16x32_bf16 v[232:235], v[76:79], a[248:251], v[232:235]
  ds_read_b128 v[40:43], v5 offset:2048
  v_mfma_f32_16x16x32_bf16 v[236:239], v[76:79], a[252:255], v[236:239]
  ds_read_b128 v[44:47], v5 offset:3072
  v_mfma_f32_16x16x32_bf16 v[240:243], v[16:19], a[248:251], v[240:243]
  ds_read_b128 v[48:51], v5 offset:4096
  v_mfma_f32_16x16x32_bf16 v[244:247], v[16:19], a[252:255], v[244:247]
  ds_read_b128 v[52:55], v5 offset:5120
  v_mfma_f32_16x16x32_bf16 v[224:227], v[20:23], a[0:3], v[224:227]
  ds_read_b128 v[56:59], v5 offset:6144
  v_mfma_f32_16x16x32_bf16 v[228:231], v[20:23], a[4:7], v[228:231]
  ds_read_b128 v[60:63], v5 offset:7168
  v_mfma_f32_16x16x32_bf16 v[232:235], v[24:27], a[0:3], v[232:235]
  ds_read_b128 v[64:67], v5 offset:8192
  v_mfma_f32_16x16x32_bf16 v[236:239], v[24:27], a[4:7], v[236:239]
  ds_read_b128 v[68:71], v5 offset:9216
  v_mfma_f32_16x16x32_bf16 v[240:243], v[28:31], a[0:3], v[240:243]
  ds_read_b128 v[72:75], v5 offset:10240
  v_mfma_f32_16x16x32_bf16 v[244:247], v[28:31], a[4:7], v[244:247]
  ds_read_b128 v[76:79], v5 offset:11264
  s_waitcnt lgkmcnt(10)
  v_mfma_f32_16x16x32_bf16 v[224:227], v[32:35], a[8:11], v[224:227]
  ds_read_b128 v[16:19], v5 offset:12288
  v_mfma_f32_16x16x32_bf16 v[228:231], v[32:35], a[12:15], v[228:231]
  v_mfma_f32_16x16x32_bf16 v[232:235], v[36:39], a[8:11], v[232:235]
  ds_read_b128 v[20:23], v5 offset:13312
  v_mfma_f32_16x16x32_bf16 v[236:239], v[36:39], a[12:15], v[236:239]
  s_waitcnt lgkmcnt(10)
  v_mfma_f32_16x16x32_bf16 v[240:243], v[40:43], a[8:11], v[240:243]
  ds_read_b128 v[24:27], v5 offset:14336
  v_mfma_f32_16x16x32_bf16 v[244:247], v[40:43], a[12:15], v[244:247]
  v_mfma_f32_16x16x32_bf16 v[224:227], v[44:47], a[16:19], v[224:227]
  ds_read_b128 v[28:31], v5 offset:15360
  v_mfma_f32_16x16x32_bf16 v[228:231], v[44:47], a[20:23], v[228:231]
  s_waitcnt lgkmcnt(10)
  v_mfma_f32_16x16x32_bf16 v[232:235], v[48:51], a[16:19], v[232:235]
  ds_read_b128 v[32:35], v5 offset:16384
  v_mfma_f32_16x16x32_bf16 v[236:239], v[48:51], a[20:23], v[236:239]
  v_mfma_f32_16x16x32_bf16 v[240:243], v[52:55], a[16:19], v[240:243]
  ds_read_b128 v[36:39], v5 offset:17408
  v_mfma_f32_16x16x32_bf16 v[244:247], v[52:55], a[20:23], v[244:247]
  s_waitcnt lgkmcnt(10)
  v_mfma_f32_16x16x32_bf16 v[224:227], v[56:59], a[24:27], v[224:227]
  ds_read_b128 v[40:43], v5 offset:18432
  v_mfma_f32_16x16x32_bf16 v[228:231], v[56:59], a[28:31], v[228:231]
  v_mfma_f32_16x16x32_bf16 v[232:235], v[60:63], a[24:27], v[232:235]
  ds_read_b128 v[44:47], v5 offset:19456
  v_mfma_f32_16x16x32_bf16 v[236:239], v[60:63], a[28:31], v[236:239]
  s_waitcnt lgkmcnt(10)
  v_mfma_f32_16x16x32_bf16 v[240:243], v[64:67], a[24:27], v[240:243]
  ds_read_b128 v[48:51], v5 offset:20480
  v_mfma_f32_16x16x32_bf16 v[244:247], v[64:67], a[28:31], v[244:247]
  v_mfma_f32_16x16x32_bf16 v[224:227], v[68:71], a[32:35], v[224:227]
  ds_read_b128 v[52:55], v5 offset:21504
  v_mfma_f32_16x16x32_bf16 v[228:231], v[68:71], a[36:39], v[228:231]
  s_waitcnt vmcnt(0)
  s_add_u32 s61, s88, 3
  v_mov_b32 v14, s61
  v_mov_b32 v15, s89
  s_mov_b64 exec, 1
  buffer_store_dwordx2 v[14:15], v10, s[28:31], s52 offen sc1
  s_mov_b64 exec, -1
  s_waitcnt lgkmcnt(10)
  v_mfma_f32_16x16x32_bf16 v[232:235], v[72:75], a[32:35], v[232:235]
  ds_read_b128 v[56:59], v5 offset:22528
  v_mfma_f32_16x16x32_bf16 v[236:239], v[72:75], a[36:39], v[236:239]
  v_mfma_f32_16x16x32_bf16 v[240:243], v[76:79], a[32:35], v[240:243]
  ds_read_b128 v[60:63], v5 offset:23552
  v_mfma_f32_16x16x32_bf16 v[244:247], v[76:79], a[36:39], v[244:247]
  s_waitcnt lgkmcnt(10)
  v_mfma_f32_16x16x32_bf16 v[224:227], v[16:19], a[40:43], v[224:227]
  ds_read_b128 v[64:67], v5 offset:24576
  v_mfma_f32_16x16x32_bf16 v[228:231], v[16:19], a[44:47], v[228:231]
  v_mfma_f32_16x16x32_bf16 v[232:235], v[20:23], a[40:43], v[232:235]
  ds_read_b128 v[68:71], v5 offset:25600
  v_mfma_f32_16x16x32_bf16 v[236:239], v[20:23], a[44:47], v[236:239]
  s_waitcnt lgkmcnt(10)
  v_mfma_f32_16x16x32_bf16 v[240:243], v[24:27], a[40:43], v[240:243]
  ds_read_b128 v[72:75], v5 offset:26624
  v_mfma_f32_16x16x32_bf16 v[244:247], v[24:27], a[44:47], v[244:247]
  v_mfma_f32_16x16x32_bf16 v[224:227], v[28:31], a[48:51], v[224:227]
  ds_read_b128 v[76:79], v5 offset:27648
  v_mfma_f32_16x16x32_bf16 v[228:231], v[28:31], a[52:55], v[228:231]
  s_waitcnt lgkmcnt(10)
  v_mfma_f32_16x16x32_bf16 v[232:235], v[32:35], a[48:51], v[232:235]
  ds_read_b128 v[16:19], v5 offset:28672
  v_mfma_f32_16x16x32_bf16 v[236:239], v[32:35], a[52:55], v[236:239]
  v_mfma_f32_16x16x32_bf16 v[240:243], v[36:39], a[48:51], v[240:243]
  ds_read_b128 v[20:23], v5 offset:29696
  v_mfma_f32_16x16x32_bf16 v[244:247], v[36:39], a[52:55], v[244:247]
  s_waitcnt lgkmcnt(10)
  v_mfma_f32_16x16x32_bf16 v[224:227], v[40:43], a[56:59], v[224:227]
  ds_read_b128 v[24:27], v5 offset:30720
  v_mfma_f32_16x16x32_bf16 v[228:231], v[40:43], a[60:63], v[228:231]
  v_mfma_f32_16x16x32_bf16 v[232:235], v[44:47], a[56:59], v[232:235]
  ds_read_b128 v[28:31], v5 offset:31744
  v_mfma_f32_16x16x32_bf16 v[236:239], v[44:47], a[60:63], v[236:239]
  s_waitcnt lgkmcnt(10)
  v_mfma_f32_16x16x32_bf16 v[240:243], v[48:51], a[56:59], v[240:243]
  ds_read_b128 v[32:35], v5 offset:32768
  v_mfma_f32_16x16x32_bf16 v[244:247], v[48:51], a[60:63], v[244:247]
  v_mfma_f32_16x16x32_bf16 v[224:227], v[52:55], a[64:67], v[224:227]
  ds_read_b128 v[36:39], v5 offset:33792
  v_mfma_f32_16x16x32_bf16 v[228:231], v[52:55], a[68:71], v[228:231]
  s_waitcnt lgkmcnt(10)
  v_mfma_f32_16x16x32_bf16 v[232:235], v[56:59], a[64:67], v[232:235]
  ds_read_b128 v[40:43], v5 offset:34816
  v_mfma_f32_16x16x32_bf16 v[236:239], v[56:59], a[68:71], v[236:239]
  v_mfma_f32_16x16x32_bf16 v[240:243], v[60:63], a[64:67], v[240:243]
  ds_read_b128 v[44:47], v5 offset:35840
  v_mfma_f32_16x16x32_bf16 v[244:247], v[60:63], a[68:71], v[244:247]
  s_waitcnt lgkmcnt(10)
  v_mfma_f32_16x16x32_bf16 v[224:227], v[64:67], a[72:75], v[224:227]
  v_mfma_f32_16x16x32_bf16 v[228:231], v[64:67], a[76:79], v[228:231]
  v_mfma_f32_16x16x32_bf16 v[232:235], v[68:71], a[72:75], v[232:235]
  v_mfma_f32_16x16x32_bf16 v[236:239], v[68:71], a[76:79], v[236:239]
  s_waitcnt lgkmcnt(8)
  v_mfma_f32_16x16x32_bf16 v[240:243], v[72:75], a[72:75], v[240:243]
  v_mfma_f32_16x16x32_bf16 v[244:247], v[72:75], a[76:79], v[244:247]
  v_mfma_f32_16x16x32_bf16 v[224:227], v[76:79], a[80:83], v[224:227]
  v_mfma_f32_16x16x32_bf16 v[228:231], v[76:79], a[84:87], v[228:231]
  s_waitcnt lgkmcnt(6)
  v_mfma_f32_16x16x32_bf16 v[232:235], v[16:19], a[80:83], v[232:235]
  v_mfma_f32_16x16x32_bf16 v[236:239], v[16:19], a[84:87], v[236:239]
  v_mfma_f32_16x16x32_bf16 v[240:243], v[20:23], a[80:83], v[240:243]
  v_mfma_f32_16x16x32_bf16 v[244:247], v[20:23], a[84:87], v[244:247]
  s_waitcnt lgkmcnt(4)
  v_mfma_f32_16x16x32_bf16 v[224:227], v[24:27], a[88:91], v[224:227]
  v_mfma_f32_16x16x32_bf16 v[228:231], v[24:27], a[92:95], v[228:231]
  v_mfma_f32_16x16x32_bf16 v[232:235], v[28:31], a[88:91], v[232:235]
  v_mfma_f32_16x16x32_bf16 v[236:239], v[28:31], a[92:95], v[236:239]
  s_waitcnt lgkmcnt(2)
  v_mfma_f32_16x16x32_bf16 v[240:243], v[32:35], a[88:91], v[240:243]
  v_mfma_f32_16x16x32_bf16 v[244:247], v[32:35], a[92:95], v[244:247]
  v_mfma_f32_16x16x32_bf16 v[224:227], v[36:39], a[96:99], v[224:227]
  v_mfma_f32_16x16x32_bf16 v[228:231], v[36:39], a[100:103], v[228:231]
  s_waitcnt lgkmcnt(0)
  v_mfma_f32_16x16x32_bf16 v[232:235], v[40:43], a[96:99], v[232:235]
  v_mfma_f32_16x16x32_bf16 v[236:239], v[40:43], a[100:103], v[236:239]
  v_mfma_f32_16x16x32_bf16 v[240:243], v[44:47], a[96:99], v[240:243]
  v_mfma_f32_16x16x32_bf16 v[244:247], v[44:47], a[100:103], v[244:247]
  s_nop 7
  s_add_u32 s45, s50, 50176
  buffer_store_dwordx4 v[224:227], v3, s[28:31], s45 offen sc1
  s_add_u32 s45, s50, 58368
  buffer_store_dwordx4 v[232:235], v3, s[28:31], s45 offen sc1
  s_add_u32 s45, s50, 62464
  buffer_store_dwordx4 v[236:239], v3, s[28:31], s45 offen sc1
  s_add_u32 s45, s50, 66560
  buffer_store_dwordx4 v[240:243], v3, s[28:31], s45 offen sc1
  buffer_load_dwordx2 v[12:13], v8, s[28:31], s49 offen offset:0 sc1
  s_waitcnt vmcnt(0)
  s_add_u32 s61, s88, 4
  v_mov_b32 v14, s61
  v_mov_b32 v15, s89
  s_mov_b64 exec, 1
  buffer_store_dwordx2 v[14:15], v10, s[28:31], s52 offen sc1
  s_mov_b64 exec, -1
  s_waitcnt vmcnt(1)
  s_mov_b32 s58, 0
  s_add_u32 s59, s88, 3
  s_mov_b64 s[60:61], -1
  v_subrev_u32 v14, s59, v12
  v_cmp_gt_u32 vcc, 13, v14
  v_cmp_eq_u32 s[62:63], s89, v13
  s_nop 1
  s_and_b64 vcc, vcc, s[62:63]
  s_and_b64 s[60:61], s[60:61], vcc
  s_cmp_eq_u64 s[60:61], -1
  s_cbranch_scc1 L_p3a_1_ok
  buffer_load_dwordx2 v[12:13], v8, s[28:31], s49 offen offset:0 sc1
  s_sleep 4
  buffer_load_dwordx2 v[250:251], v8, s[28:31], s49 offen offset:0 sc1
L_p3a_1_chk:
  s_waitcnt vmcnt(1)
  s_mov_b64 s[60:61], -1
  v_subrev_u32 v14, s59, v12
  v_cmp_gt_u32 vcc, 13, v14
  v_cmp_eq_u32 s[62:63], s89, v13
  s_nop 1
  s_and_b64 vcc, vcc, s[62:63]
  s_and_b64 s[60:61], s[60:61], vcc
  s_cmp_eq_u64 s[60:61], -1
  s_cbranch_scc1 L_p3a_1_ok
  buffer_load_dwordx2 v[12:13], v8, s[28:31], s49 offen offset:0 sc1
  s_waitcnt vmcnt(1)
  s_mov_b64 s[60:61], -1
  v_subrev_u32 v14, s59, v250
  v_cmp_gt_u32 vcc, 13, v14
  v_cmp_eq_u32 s[62:63], s89, v251
  s_nop 1
  s_and_b64 vcc, vcc, s[62:63]
  s_and_b64 s[60:61], s[60:61], vcc
  s_cmp_eq_u64 s[60:61], -1
  s_cbranch_scc1 L_p3a_1_ok
  buffer_load_dwordx2 v[250:251], v8, s[28:31], s49 offen offset:0 sc1
  s_add_u32 s58, s58, 1
  s_cmp_gt_u32 s58, 20000
  s_cbranch_scc0 L_p3a_1_chk
L_p3a_1_ok:
  s_add_u32 s45, s50, 4096
  buffer_load_dwordx4 v[80:83], v3, s[28:31], s45 offen sc1
  s_add_u32 s45, s50, 6144
  buffer_load_dwordx4 v[84:87], v3, s[28:31], s45 offen sc1
  s_add_u32 s45, s50, 7168
  buffer_load_dwordx4 v[88:91], v3, s[28:31], s45 offen sc1
  s_add_u32 s45, s57, 18432
  buffer_load_dwordx2 v[92:93], v11, s[28:31], s45 offen sc1
  s_add_u32 s45, s50, 20480
  buffer_load_dwordx4 v[96:99], v3, s[28:31], s45 offen sc1
  s_add_u32 s45, s50, 22528
  buffer_load_dwordx4 v[100:103], v3, s[28:31], s45 offen sc1
  s_add_u32 s45, s50, 23552
  buffer_load_dwordx4 v[104:107], v3, s[28:31], s45 offen sc1
  s_add_u32 s45, s57, 18496
  buffer_load_dwordx2 v[108:109], v11, s[28:31], s45 offen sc1
  s_add_u32 s45, s50, 36864
  buffer_load_dwordx4 v[112:115], v3, s[28:31], s45 offen sc1
  s_add_u32 s45, s50, 38912
  buffer_load_dwordx4 v[116:119], v3, s[28:31], s45 offen sc1
  s_add_u32 s45, s50, 39936
  buffer_load_dwordx4 v[120:123], v3, s[28:31], s45 offen sc1
  s_add_u32 s45, s57, 18560
  buffer_load_dwordx2 v[124:125], v11, s[28:31], s45 offen sc1
  buffer_load_dwordx2 v[12:13], v8, s[28:31], s49 offen offset:0 sc1
  s_waitcnt vmcnt(0)
  s_mov_b32 s58, 0
  s_add_u32 s59, s88, 4
  s_mov_b64 s[60:61], -1
  v_subrev_u32 v14, s59, v12
  v_cmp_gt_u32 vcc, 12, v14
  v_cmp_eq_u32 s[62:63], s89, v13
  s_nop 1
  s_and_b64 vcc, vcc, s[62:63]
  s_and_b64 s[60:61], s[60:61], vcc
  s_cmp_eq_u64 s[60:61], -1
  s_cbranch_scc1 L_p3b_1_ok
  buffer_load_dwordx2 v[12:13], v8, s[28:31], s49 offen offset:0 sc1
  s_sleep 4
  buffer_load_dwordx2 v[250:251], v8, s[28:31], s49 offen offset:0 sc1
L_p3b_1_chk:
  s_waitcnt vmcnt(1)
  s_mov_b64 s[60:61], -1
  v_subrev_u32 v14, s59, v12
  v_cmp_gt_u32 vcc, 12, v14
  v_cmp_eq_u32 s[62:63], s89, v13
  s_nop 1
  s_and_b64 vcc, vcc, s[62:63]
  s_and_b64 s[60:61], s[60:61], vcc
  s_cmp_eq_u64 s[60:61], -1
  s_cbranch_scc1 L_p3b_1_ok
  buffer_load_dwordx2 v[12:13], v8, s[28:31], s49 offen offset:0 sc1
  s_waitcnt vmcnt(1)
  s_mov_b64 s[60:61], -1
  v_subrev_u32 v14, s59, v250
  v_cmp_gt_u32 vcc, 12, v14
  v_cmp_eq_u32 s[62:63], s89, v251
  s_nop 1
  s_and_b64 vcc, vcc, s[62:63]
  s_and_b64 s[60:61], s[60:61], vcc
  s_cmp_eq_u64 s[60:61], -1
  s_cbranch_scc1 L_p3b_1_ok
  buffer_load_dwordx2 v[250:251], v8, s[28:31], s49 offen offset:0 sc1
  s_add_u32 s58, s58, 1
  s_cmp_gt_u32 s58, 20000
  s_cbranch_scc0 L_p3b_1_chk
L_p3b_1_ok:
  s_add_u32 s45, s50, 53248
  buffer_load_dwordx4 v[16:19], v3, s[28:31], s45 offen sc1
  s_add_u32 s45, s50, 55296
  buffer_load_dwordx4 v[20:23], v3, s[28:31], s45 offen sc1
  s_add_u32 s45, s50, 56320
  buffer_load_dwordx4 v[24:27], v3, s[28:31], s45 offen sc1
  s_add_u32 s45, s57, 18624
  buffer_load_dwordx2 v[28:29], v11, s[28:31], s45 offen sc1
  s_add_u32 s45, s50, 69632
  buffer_load_dwordx4 v[32:35], v3, s[28:31], s45 offen sc1
  s_add_u32 s45, s50, 71680
  buffer_load_dwordx4 v[36:39], v3, s[28:31], s45 offen sc1
  s_add_u32 s45, s50, 72704
  buffer_load_dwordx4 v[40:43], v3, s[28:31], s45 offen sc1
  s_add_u32 s45, s57, 18688
  buffer_load_dwordx2 v[44:45], v11, s[28:31], s45 offen sc1
  s_waitcnt vmcnt(17)
  v_pk_add_f32 v[156:157], v[80:81], v[156:157]
  v_pk_add_f32 v[158:159], v[82:83], v[158:159]
  v_pk_add_f32 v[156:157], v[156:157], v[84:85]
  v_pk_add_f32 v[158:159], v[158:159], v[86:87]
  v_pk_add_f32 v[156:157], v[156:157], v[88:89]
  v_pk_add_f32 v[158:159], v[158:159], v[90:91]
  v_cvt_pk_bf16_f32 v94, v156, v157
  v_lshlrev_b32 v156, 16, v94
  v_and_b32 v157, s43, v94
  v_lshlrev_b32 v84, 16, v92
  v_and_b32 v85, s43, v92
  v_pk_add_f32 v[156:157], v[156:157], v[84:85]
  v_cvt_pk_bf16_f32 v94, v158, v159
  v_lshlrev_b32 v158, 16, v94
  v_and_b32 v159, s43, v94
  v_lshlrev_b32 v86, 16, v93
  v_and_b32 v87, s43, v93
  v_pk_add_f32 v[158:159], v[158:159], v[86:87]
  v_cvt_pk_bf16_f32 v88, v156, v157
  v_cvt_pk_bf16_f32 v89, v158, v159
  s_add_u32 s45, s56, 18432
  buffer_store_dwordx2 v[88:89], v11, s[20:23], s45 offen
  s_waitcnt vmcnt(14)
  v_pk_add_f32 v[172:173], v[96:97], v[172:173]
  v_pk_add_f32 v[174:175], v[98:99], v[174:175]
  v_pk_add_f32 v[172:173], v[172:173], v[100:101]
  v_pk_add_f32 v[174:175], v[174:175], v[102:103]
  v_pk_add_f32 v[172:173], v[172:173], v[104:105]
  v_pk_add_f32 v[174:175], v[174:175], v[106:107]
  v_cvt_pk_bf16_f32 v110, v172, v173
  v_lshlrev_b32 v172, 16, v110
  v_and_b32 v173, s43, v110
  v_lshlrev_b32 v100, 16, v108
  v_and_b32 v101, s43, v108
  v_pk_add_f32 v[172:173], v[172:173], v[100:101]
  v_cvt_pk_bf16_f32 v110, v174, v175
  v_lshlrev_b32 v174, 16, v110
  v_and_b32 v175, s43, v110
  v_lshlrev_b32 v102, 16, v109
  v_and_b32 v103, s43, v109
  v_pk_add_f32 v[174:175], v[174:175], v[102:103]
  v_cvt_pk_bf16_f32 v104, v172, v173
  v_cvt_pk_bf16_f32 v105, v174, v175
  s_add_u32 s45, s56, 18496
  buffer_store_dwordx2 v[104:105], v11, s[20:23], s45 offen
  s_waitcnt vmcnt(11)
  v_pk_add_f32 v[188:189], v[112:113], v[188:189]
  v_pk_add_f32 v[190:191], v[114:115], v[190:191]
  v_pk_add_f32 v[188:189], v[188:189], v[116:117]
  v_pk_add_f32 v[190:191], v[190:191], v[118:119]
  v_pk_add_f32 v[188:189], v[188:189], v[120:121]
  v_pk_add_f32 v[190:191], v[190:191], v[122:123]
  v_cvt_pk_bf16_f32 v126, v188, v189
  v_lshlrev_b32 v188, 16, v126
  v_and_b32 v189, s43, v126
  v_lshlrev_b32 v116, 16, v124
  v_and_b32 v117, s43, v124
  v_pk_add_f32 v[188:189], v[188:189], v[116:117]
  v_cvt_pk_bf16_f32 v126, v190, v191
  v_lshlrev_b32 v190, 16, v126
  v_and_b32 v191, s43, v126
  v_lshlrev_b32 v118, 16, v125
  v_and_b32 v119, s43, v125
  v_pk_add_f32 v[190:191], v[190:191], v[118:119]
  v_cvt_pk_bf16_f32 v120, v188, v189
  v_cvt_pk_bf16_f32 v121, v190, v191
  s_add_u32 s45, s56, 18560
  buffer_store_dwordx2 v[120:121], v11, s[20:23], s45 offen
  s_waitcnt vmcnt(7)
  v_pk_add_f32 v[228:229], v[16:17], v[228:229]
  v_pk_add_f32 v[230:231], v[18:19], v[230:231]
  v_pk_add_f32 v[228:229], v[228:229], v[20:21]
  v_pk_add_f32 v[230:231], v[230:231], v[22:23]
  v_pk_add_f32 v[228:229], v[228:229], v[24:25]
  v_pk_add_f32 v[230:231], v[230:231], v[26:27]
  v_cvt_pk_bf16_f32 v30, v228, v229
  v_lshlrev_b32 v228, 16, v30
  v_and_b32 v229, s43, v30
  v_lshlrev_b32 v20, 16, v28
  v_and_b32 v21, s43, v28
  v_pk_add_f32 v[228:229], v[228:229], v[20:21]
  v_cvt_pk_bf16_f32 v30, v230, v231
  v_lshlrev_b32 v230, 16, v30
  v_and_b32 v231, s43, v30
  v_lshlrev_b32 v22, 16, v29
  v_and_b32 v23, s43, v29
  v_pk_add_f32 v[230:231], v[230:231], v[22:23]
  v_cvt_pk_bf16_f32 v24, v228, v229
  v_cvt_pk_bf16_f32 v25, v230, v231
  s_add_u32 s45, s56, 18624
  buffer_store_dwordx2 v[24:25], v11, s[20:23], s45 offen
  s_waitcnt vmcnt(4)
  v_pk_add_f32 v[244:245], v[32:33], v[244:245]
  v_pk_add_f32 v[246:247], v[34:35], v[246:247]
  v_pk_add_f32 v[244:245], v[244:245], v[36:37]
  v_pk_add_f32 v[246:247], v[246:247], v[38:39]
  v_pk_add_f32 v[244:245], v[244:245], v[40:41]
  v_pk_add_f32 v[246:247], v[246:247], v[42:43]
  v_cvt_pk_bf16_f32 v46, v244, v245
  v_lshlrev_b32 v244, 16, v46
  v_and_b32 v245, s43, v46
  v_lshlrev_b32 v36, 16, v44
  v_and_b32 v37, s43, v44
  v_pk_add_f32 v[244:245], v[244:245], v[36:37]
  v_cvt_pk_bf16_f32 v46, v246, v247
  v_lshlrev_b32 v246, 16, v46
  v_and_b32 v247, s43, v46
  v_lshlrev_b32 v38, 16, v45
  v_and_b32 v39, s43, v45
  v_pk_add_f32 v[246:247], v[246:247], v[38:39]
  v_cvt_pk_bf16_f32 v40, v244, v245
  v_cvt_pk_bf16_f32 v41, v246, v247
  s_add_u32 s45, s56, 18688
  buffer_store_dwordx2 v[40:41], v11, s[20:23], s45 offen
  s_endpgm
L_v2:
  s_cmp_lg_u32 s32, 2
  s_cbranch_scc1 L_v3
  v_mfma_f32_16x16x32_bf16 v[168:171], v[48:51], a[88:91], v[168:171]
  ds_read_b128 v[76:79], v7 offset:3072
  v_mfma_f32_16x16x32_bf16 v[172:175], v[48:51], a[92:95], v[172:175]
  ds_read_b128 v[16:19], v7 offset:4096
  s_waitcnt vmcnt(12)
  v_mfma_f32_16x16x32_bf16 v[152:155], v[52:55], a[96:99], v[152:155]
  ds_read_b128 v[20:23], v7 offset:5120
  v_mfma_f32_16x16x32_bf16 v[156:159], v[52:55], a[100:103], v[156:159]
  buffer_load_dwordx4 v3, s[28:31], s44 offen offset:3072 sc1 lds
  v_mfma_f32_16x16x32_bf16 v[160:163], v[56:59], a[96:99], v[160:163]
  ds_read_b128 v[24:27], v7 offset:6144
  v_mfma_f32_16x16x32_bf16 v[164:167], v[56:59], a[100:103], v[164:167]
  ds_read_b128 v[28:31], v7 offset:7168
  v_mfma_f32_16x16x32_bf16 v[168:171], v[60:63], a[96:99], v[168:171]
  ds_read_b128 v[32:35], v7 offset:8192
  v_mfma_f32_16x16x32_bf16 v[172:175], v[60:63], a[100:103], v[172:175]
  ds_read_b128 v[36:39], v7 offset:9216
  s_waitcnt lgkmcnt(8)
  v_mfma_f32_16x16x32_bf16 v[176:179], v[64:67], a[32:35], v[176:179]
  ds_read_b128 v[40:43], v7 offset:10240
  v_mfma_f32_16x16x32_bf16 v[180:183], v[64:67], a[36:39], v[180:183]
  s_add_u32 m0, s40, 40960
  s_add_u32 s44, s42, 299008
  buffer_load_dwordx4 v3, s[28:31], s44 offen offset:0 sc1 lds
  v_mfma_f32_16x16x32_bf16 v[184:187], v[68:71], a[32:35], v[184:187]
  ds_read_b128 v[44:47], v7 offset:11264
  v_mfma_f32_16x16x32_bf16 v[188:191], v[68:71], a[36:39], v[188:191]
  ds_read_b128 v[48:51], v7 offset:12288
  s_waitcnt lgkmcnt(9)
  v_mfma_f32_16x16x32_bf16 v[192:195], v[72:75], a[32:35], v[192:195]
  ds_read_b128 v[52:55], v7 offset:13312
  v_mfma_f32_16x16x32_bf16 v[196:199], v[72:75], a[36:39], v[196:199]
  s_add_u32 s45, s50, 2048
  buffer_store_dwordx4 v[152:155], v3, s[28:31], s45 offen sc1
  v_mfma_f32_16x16x32_bf16 v[176:179], v[76:79], a[40:43], v[176:179]
  ds_read_b128 v[56:59], v7 offset:14336
  v_mfma_f32_16x16x32_bf16 v[180:183], v[76:79], a[44:47], v[180:183]
  ds_read_b128 v[60:63], v7 offset:15360
  s_waitcnt lgkmcnt(10)
  v_mfma_f32_16x16x32_bf16 v[184:187], v[16:19], a[40:43], v[184:187]
  ds_read_b128 v[64:67], v7 offset:16384
  v_mfma_f32_16x16x32_bf16 v[188:191], v[16:19], a[44:47], v[188:191]
  buffer_load_dwordx4 v3, s[28:31], s44 offen offset:1024 sc1 lds
  v_mfma_f32_16x16x32_bf16 v[192:195], v[20:23], a[40:43], v[192:195]
  ds_read_b128 v[68:71], v7 offset:17408
  v_mfma_f32_16x16x32_bf16 v[196:199], v[20:23], a[44:47], v[196:199]
  s_waitcnt lgkmcnt(10)
  v_mfma_f32_16x16x32_bf16 v[176:179], v[24:27], a[48:51], v[176:179]
  ds_read_b128 v[72:75], v7 offset:18432
  v_mfma_f32_16x16x32_bf16 v[180:183], v[24:27], a[52:55], v[180:183]
  buffer_load_dwordx4 v3, s[28:31], s44 offen offset:2048 sc1 lds
  v_mfma_f32_16x16x32_bf16 v[184:187], v[28:31], a[48:51], v[184:187]
  ds_read_b128 v[76:79], v7 offset:19456
  v_mfma_f32_16x16x32_bf16 v[188:191], v[28:31], a[52:55], v[188:191]
  s_waitcnt lgkmcnt(10)
  v_mfma_f32_16x16x32_bf16 v[192:195], v[32:35], a[48:51], v[192:195]
  ds_read_b128 v[16:19], v7 offset:20480
  v_mfma_f32_16x16x32_bf16 v[196:199], v[32:35], a[52:55], v[196:199]
  v_mfma_f32_16x16x32_bf16 v[176:179], v[36:39], a[56:59], v[176:179]
  ds_read_b128 v[20:23], v7 offset:21504
  v_mfma_f32_16x16x32_bf16 v[180:183], v[36:39], a[60:63], v[180:183]
  s_add_u32 s45, s50, 6144
  buffer_store_dwordx4 v[156:159], v3, s[28:31], s45 offen sc1
  s_waitcnt lgkmcnt(10)
  v_mfma_f32_16x16x32_bf16 v[184:187], v[40:43], a[56:59], v[184:187]
  ds_read_b128 v[24:27], v7 offset:22528
  v_mfma_f32_16x16x32_bf16 v[188:191], v[40:43], a[60:63], v[188:191]
  v_mfma_f32_16x16x32_bf16 v[192:195], v[44:47], a[56:59], v[192:195]
  ds_read_b128 v[28:31], v7 offset:23552
  v_mfma_f32_16x16x32_bf16 v[196:199], v[44:47], a[60:63], v[196:199]
  buffer_load_dwordx4 v3, s[28:31], s44 offen offset:3072 sc1 lds
  s_waitcnt lgkmcnt(10)
  v_mfma_f32_16x16x32_bf16 v[176:179], v[48:51], a[64:67], v[176:179]
  ds_read_b128 v[32:35], v7 offset:24576
  v_mfma_f32_16x16x32_bf16 v[180:183], v[48:51], a[68:71], v[180:183]
  v_mfma_f32_16x16x32_bf16 v[184:187], v[52:55], a[64:67], v[184:187]
  ds_read_b128 v[36:39], v7 offset:25600
  v_mfma_f32_16x16x32_bf16 v[188:191], v[52:55], a[68:71], v[188:191]
  s_add_u32 m0, s40, 45056
  s_add_u32 s44, s42, 303104
  buffer_load_dwordx4 v3, s[28:31], s44 offen offset:0 sc1 lds
  s_waitcnt lgkmcnt(10)
  v_mfma_f32_16x16x32_bf16 v[192:195], v[56:59], a[64:67], v[192:195]
  ds_read_b128 v[40:43], v7 offset:26624
  v_mfma_f32_16x16x32_bf16 v[196:199], v[56:59], a[68:71], v[196:199]
  v_mfma_f32_16x16x32_bf16 v[176:179], v[60:63], a[72:75], v[176:179]
  ds_read_b128 v[44:47], v7 offset:27648
  v_mfma_f32_16x16x32_bf16 v[180:183], v[60:63], a[76:79], v[180:183]
  s_add_u32 s45, s50, 14336
  buffer_store_dwordx4 v[164:167], v3, s[28:31], s45 offen sc1
  s_waitcnt lgkmcnt(10)
  v_mfma_f32_16x16x32_bf16 v[184:187], v[64:67], a[72:75], v[184:187]
  ds_read_b128 v[48:51], v7 offset:28672
  v_mfma_f32_16x16x32_bf16 v[188:191], v[64:67], a[76:79], v[188:191]
  v_mfma_f32_16x16x32_bf16 v[192:195], v[68:71], a[72:75], v[192:195]
  ds_read_b128 v[52:55], v7 offset:29696
  v_mfma_f32_16x16x32_bf16 v[196:199], v[68:71], a[76:79], v[196:199]
  s_waitcnt lgkmcnt(10)
  v_mfma_f32_16x16x32_bf16 v[176:179], v[72:75], a[80:83], v[176:179]
  ds_read_b128 v[56:59], v7 offset:30720
  v_mfma_f32_16x16x32_bf16 v[180:183], v[72:75], a[84:87], v[180:183]
  v_mfma_f32_16x16x32_bf16 v[184:187], v[76:79], a[80:83], v[184:187]
  ds_read_b128 v[60:63], v7 offset:31744
  v_mfma_f32_16x16x32_bf16 v[188:191], v[76:79], a[84:87], v[188:191]
  s_waitcnt lgkmcnt(10)
  v_mfma_f32_16x16x32_bf16 v[192:195], v[16:19], a[80:83], v[192:195]
  ds_read_b128 v[64:67], v7 offset:32768
  v_mfma_f32_16x16x32_bf16 v[196:199], v[16:19], a[84:87], v[196:199]
  s_add_u32 s45, s50, 18432
  buffer_store_dwordx4 v[168:171], v3, s[28:31], s45 offen sc1
  v_mfma_f32_16x16x32_bf16 v[176:179], v[20:23], a[88:91], v[176:179]
  ds_read_b128 v[68:71], v7 offset:33792
  v_mfma_f32_16x16x32_bf16 v[180:183], v[20:23], a[92:95], v[180:183]
  s_waitcnt lgkmcnt(10)
  v_mfma_f32_16x16x32_bf16 v[184:187], v[24:27], a[88:91], v[184:187]
  ds_read_b128 v[72:75], v7 offset:34816
  v_mfma_f32_16x16x32_bf16 v[188:191], v[24:27], a[92:95], v[188:191]
  v_mfma_f32_16x16x32_bf16 v[192:195], v[28:31], a[88:91], v[192:195]
  ds_read_b128 v[76:79], v7 offset:35840
  v_mfma_f32_16x16x32_bf16 v[196:199], v[28:31], a[92:95], v[196:199]
  s_waitcnt lgkmcnt(10)
  v_mfma_f32_16x16x32_bf16 v[176:179], v[32:35], a[96:99], v[176:179]
  v_mfma_f32_16x16x32_bf16 v[180:183], v[32:35], a[100:103], v[180:183]
  v_mfma_f32_16x16x32_bf16 v[184:187], v[36:39], a[96:99], v[184:187]
  v_mfma_f32_16x16x32_bf16 v[188:191], v[36:39], a[100:103], v[188:191]
  s_waitcnt lgkmcnt(8)
  v_mfma_f32_16x16x32_bf16 v[192:195], v[40:43], a[96:99], v[192:195]
  v_mfma_f32_16x16x32_bf16 v[196:199], v[40:43], a[100:103], v[196:199]
  v_mfma_f32_16x16x32_bf16 v[224:227], v[44:47], a[144:147], v[224:227]
  v_mfma_f32_16x16x32_bf16 v[228:231], v[44:47], a[148:151], v[228:231]
  s_add_u32 s45, s50, 22528
  buffer_store_dwordx4 v[172:175], v3, s[28:31], s45 offen sc1
  s_waitcnt lgkmcnt(6)
  v_mfma_f32_16x16x32_bf16 v[232:235], v[48:51], a[144:147], v[232:235]
  v_mfma_f32_16x16x32_bf16 v[236:239], v[48:51], a[148:151], v[236:239]
  v_mfma_f32_16x16x32_bf16 v[240:243], v[52:55], a[144:147], v[240:243]
  v_mfma_f32_16x16x32_bf16 v[244:247], v[52:55], a[148:151], v[244:247]
  s_waitcnt lgkmcnt(0)
  s_waitcnt vmcnt(14)
  s_barrier
  v_mfma_f32_16x16x32_bf16 v[224:227], v[56:59], a[152:155], v[224:227]
  ds_read_b128 v[16:19], v4 offset:0
  v_mfma_f32_16x16x32_bf16 v[228:231], v[56:59], a[156:159], v[228:231]
  ds_read_b128 v[20:23], v4 offset:1024
  v_mfma_f32_16x16x32_bf16 v[232:235], v[60:63], a[152:155], v[232:235]
  ds_read_b128 v[24:27], v4 offset:2048
  v_mfma_f32_16x16x32_bf16 v[236:239], v[60:63], a[156:159], v[236:239]
  ds_read_b128 v[28:31], v4 offset:3072
  v_mfma_f32_16x16x32_bf16 v[240:243], v[64:67], a[152:155], v[240:243]
  ds_read_b128 v[32:35], v4 offset:4096
  v_mfma_f32_16x16x32_bf16 v[244:247], v[64:67], a[156:159], v[244:247]
  ds_read_b128 v[36:39], v4 offset:5120
  v_mfma_f32_16x16x32_bf16 v[224:227], v[68:71], a[160:163], v[224:227]
  ds_read_b128 v[40:43], v4 offset:6144
  v_mfma_f32_16x16x32_bf16 v[228:231], v[68:71], a[164:167], v[228:231]
  s_add_u32 s45, s50, 30720
  buffer_store_dwordx4 v[180:183], v3, s[28:31], s45 offen sc1
  v_mfma_f32_16x16x32_bf16 v[232:235], v[72:75], a[160:163], v[232:235]
  ds_read_b128 v[44:47], v4 offset:7168
  v_mfma_f32_16x16x32_bf16 v[236:239], v[72:75], a[164:167], v[236:239]
  ds_read_b128 v[48:51], v4 offset:8192
  v_mfma_f32_16x16x32_bf16 v[240:243], v[76:79], a[160:163], v[240:243]
  ds_read_b128 v[52:55], v4 offset:9216
  v_mfma_f32_16x16x32_bf16 v[244:247], v[76:79], a[164:167], v[244:247]
  ds_read_b128 v[56:59], v4 offset:10240
  s_waitcnt lgkmcnt(9)
  v_mfma_f32_16x16x32_bf16 v[224:227], v[16:19], a[168:171], v[224:227]
  ds_read_b128 v[60:63], v4 offset:11264
  v_mfma_f32_16x16x32_bf16 v[228:231], v[16:19], a[172:175], v[228:231]
  ds_read_b128 v[64:67], v4 offset:12288
  v_mfma_f32_16x16x32_bf16 v[232:235], v[20:23], a[168:171], v[232:235]
  ds_read_b128 v[68:71], v4 offset:13312
  v_mfma_f32_16x16x32_bf16 v[236:239], v[20:23], a[172:175], v[236:239]
  s_waitcnt lgkmcnt(10)
  v_mfma_f32_16x16x32_bf16 v[240:243], v[24:27], a[168:171], v[240:243]
  ds_read_b128 v[72:75], v4 offset:14336
  v_mfma_f32_16x16x32_bf16 v[244:247], v[24:27], a[172:175], v[244:247]
  s_add_u32 s45, s50, 34816
  buffer_store_dwordx4 v[184:187], v3, s[28:31], s45 offen sc1
  v_mfma_f32_16x16x32_bf16 v[224:227], v[28:31], a[176:179], v[224:227]
  ds_read_b128 v[76:79], v4 offset:15360
  v_mfma_f32_16x16x32_bf16 v[228:231], v[28:31], a[180:183], v[228:231]
  s_waitcnt lgkmcnt(10)
  v_mfma_f32_16x16x32_bf16 v[232:235], v[32:35], a[176:179], v[232:235]
  ds_read_b128 v[16:19], v4 offset:16384
  v_mfma_f32_16x16x32_bf16 v[236:239], v[32:35], a[180:183], v[236:239]
  v_mfma_f32_16x16x32_bf16 v[240:243], v[36:39], a[176:179], v[240:243]
  ds_read_b128 v[20:23], v4 offset:17408
  v_mfma_f32_16x16x32_bf16 v[244:247], v[36:39], a[180:183], v[244:247]
  s_waitcnt lgkmcnt(10)
  v_mfma_f32_16x16x32_bf16 v[224:227], v[40:43], a[184:187], v[224:227]
  ds_read_b128 v[24:27], v4 offset:18432
  v_mfma_f32_16x16x32_bf16 v[228:231], v[40:43], a[188:191], v[228:231]
  v_mfma_f32_16x16x32_bf16 v[232:235], v[44:47], a[184:187], v[232:235]
  ds_read_b128 v[28:31], v4 offset:19456
  v_mfma_f32_16x16x32_bf16 v[236:239], v[44:47], a[188:191], v[236:239]
  s_waitcnt lgkmcnt(10)
  v_mfma_f32_16x16x32_bf16 v[240:243], v[48:51], a[184:187], v[240:243]
  ds_read_b128 v[32:35], v4 offset:20480
  v_mfma_f32_16x16x32_bf16 v[244:247], v[48:51], a[188:191], v[244:247]
  v_mfma_f32_16x16x32_bf16 v[224:227], v[52:55], a[192:195], v[224:227]
  ds_read_b128 v[36:39], v4 offset:21504
  v_mfma_f32_16x16x32_bf16 v[228:231], v[52:55], a[196:199], v[228:231]
  s_add_u32 s45, s50, 38912
  buffer_store_dwordx4 v[188:191], v3, s[28:31], s45 offen sc1
  s_waitcnt lgkmcnt(10)
  v_mfma_f32_16x16x32_bf16 v[232:235], v[56:59], a[192:195], v[232:235]
  ds_read_b128 v[40:43], v4 offset:22528
  v_mfma_f32_16x16x32_bf16 v[236:239], v[56:59], a[196:199], v[236:239]
  v_mfma_f32_16x16x32_bf16 v[240:243], v[60:63], a[192:195], v[240:243]
  ds_read_b128 v[44:47], v4 offset:23552
  v_mfma_f32_16x16x32_bf16 v[244:247], v[60:63], a[196:199], v[244:247]
  s_waitcnt lgkmcnt(10)
  v_mfma_f32_16x16x32_bf16 v[224:227], v[64:67], a[200:203], v[224:227]
  ds_read_b128 v[48:51], v4 offset:24576
  v_mfma_f32_16x16x32_bf16 v[228:231], v[64:67], a[204:207], v[228:231]
  v_mfma_f32_16x16x32_bf16 v[232:235], v[68:71], a[200:203], v[232:235]
  ds_read_b128 v[52:55], v4 offset:25600
  v_mfma_f32_16x16x32_bf16 v[236:239], v[68:71], a[204:207], v[236:239]
  s_waitcnt lgkmcnt(10)
  v_mfma_f32_16x16x32_bf16 v[240:243], v[72:75], a[200:203], v[240:243]
  ds_read_b128 v[56:59], v4 offset:26624
  v_mfma_f32_16x16x32_bf16 v[244:247], v[72:75], a[204:207], v[244:247]
  v_mfma_f32_16x16x32_bf16 v[224:227], v[76:79], a[208:211], v[224:227]
  ds_read_b128 v[60:63], v4 offset:27648
  v_mfma_f32_16x16x32_bf16 v[228:231], v[76:79], a[212:215], v[228:231]
  s_add_u32 s45, s50, 47104
  buffer_store_dwordx4 v[196:199], v3, s[28:31], s45 offen sc1
  s_waitcnt lgkmcnt(10)
  v_mfma_f32_16x16x32_bf16 v[232:235], v[16:19], a[208:211], v[232:235]
  ds_read_b128 v[64:67], v4 offset:28672
  v_mfma_f32_16x16x32_bf16 v[236:239], v[16:19], a[212:215], v[236:239]
  v_mfma_f32_16x16x32_bf16 v[240:243], v[20:23], a[208:211], v[240:243]
  ds_read_b128 v[68:71], v4 offset:29696
  v_mfma_f32_16x16x32_bf16 v[244:247], v[20:23], a[212:215], v[244:247]
  s_waitcnt lgkmcnt(10)
  v_mfma_f32_16x16x32_bf16 v[224:227], v[24:27], a[216:219], v[224:227]
  ds_read_b128 v[72:75], v4 offset:30720
  v_mfma_f32_16x16x32_bf16 v[228:231], v[24:27], a[220:223], v[228:231]
  s_waitcnt vmcnt(4)
  s_add_u32 s61, s88, 2
  v_mov_b32 v14, s61
  v_mov_b32 v15, s89
  s_mov_b64 exec, 1
  buffer_store_dwordx2 v[14:15], v10, s[28:31], s52 offen sc1
  s_mov_b64 exec, -1
  v_mfma_f32_16x16x32_bf16 v[232:235], v[28:31], a[216:219], v[232:235]
  ds_read_b128 v[76:79], v4 offset:31744
  v_mfma_f32_16x16x32_bf16 v[236:239], v[28:31], a[220:223], v[236:239]
  s_waitcnt lgkmcnt(10)
  v_mfma_f32_16x16x32_bf16 v[240:243], v[32:35], a[216:219], v[240:243]
  ds_read_b128 v[16:19], v4 offset:32768
  v_mfma_f32_16x16x32_bf16 v[244:247], v[32:35], a[220:223], v[244:247]
  v_mfma_f32_16x16x32_bf16 v[224:227], v[36:39], a[224:227], v[224:227]
  ds_read_b128 v[20:23], v4 offset:33792
  v_mfma_f32_16x16x32_bf16 v[228:231], v[36:39], a[228:231], v[228:231]
  s_waitcnt lgkmcnt(10)
  v_mfma_f32_16x16x32_bf16 v[232:235], v[40:43], a[224:227], v[232:235]
  ds_read_b128 v[24:27], v4 offset:34816
  v_mfma_f32_16x16x32_bf16 v[236:239], v[40:43], a[228:231], v[236:239]
  v_mfma_f32_16x16x32_bf16 v[240:243], v[44:47], a[224:227], v[240:243]
  ds_read_b128 v[28:31], v4 offset:35840
  v_mfma_f32_16x16x32_bf16 v[244:247], v[44:47], a[228:231], v[244:247]
  s_waitcnt lgkmcnt(10)
  v_mfma_f32_16x16x32_bf16 v[224:227], v[48:51], a[232:235], v[224:227]
  v_mfma_f32_16x16x32_bf16 v[228:231], v[48:51], a[236:239], v[228:231]
  v_mfma_f32_16x16x32_bf16 v[232:235], v[52:55], a[232:235], v[232:235]
  v_mfma_f32_16x16x32_bf16 v[236:239], v[52:55], a[236:239], v[236:239]
  s_waitcnt lgkmcnt(8)
  v_mfma_f32_16x16x32_bf16 v[240:243], v[56:59], a[232:235], v[240:243]
  v_mfma_f32_16x16x32_bf16 v[244:247], v[56:59], a[236:239], v[244:247]
  v_mfma_f32_16x16x32_bf16 v[224:227], v[60:63], a[240:243], v[224:227]
  v_mfma_f32_16x16x32_bf16 v[228:231], v[60:63], a[244:247], v[228:231]
  s_waitcnt lgkmcnt(6)
  v_mfma_f32_16x16x32_bf16 v[232:235], v[64:67], a[240:243], v[232:235]
  v_mfma_f32_16x16x32_bf16 v[236:239], v[64:67], a[244:247], v[236:239]
  v_mfma_f32_16x16x32_bf16 v[240:243], v[68:71], a[240:243], v[240:243]
  v_mfma_f32_16x16x32_bf16 v[244:247], v[68:71], a[244:247], v[244:247]
  s_waitcnt lgkmcnt(0)
  s_waitcnt vmcnt(8)
  s_barrier
  v_mfma_f32_16x16x32_bf16 v[224:227], v[72:75], a[248:251], v[224:227]
  ds_read_b128 v[32:35], v5 offset:0
  v_mfma_f32_16x16x32_bf16 v[228:231], v[72:75], a[252:255], v[228:231]
  ds_read_b128 v[36:39], v5 offset:1024
  v_mfma_f32_16x16x32_bf16 v[232:235], v[76:79], a[248:251], v[232:235]
  ds_read_b128 v[40:43], v5 offset:2048
  v_mfma_f32_16x16x32_bf16 v[236:239], v[76:79], a[252:255], v[236:239]
  ds_read_b128 v[44:47], v5 offset:3072
  v_mfma_f32_16x16x32_bf16 v[240:243], v[16:19], a[248:251], v[240:243]
  ds_read_b128 v[48:51], v5 offset:4096
  v_mfma_f32_16x16x32_bf16 v[244:247], v[16:19], a[252:255], v[244:247]
  ds_read_b128 v[52:55], v5 offset:5120
  v_mfma_f32_16x16x32_bf16 v[224:227], v[20:23], a[0:3], v[224:227]
  ds_read_b128 v[56:59], v5 offset:6144
  v_mfma_f32_16x16x32_bf16 v[228:231], v[20:23], a[4:7], v[228:231]
  ds_read_b128 v[60:63], v5 offset:7168
  v_mfma_f32_16x16x32_bf16 v[232:235], v[24:27], a[0:3], v[232:235]
  ds_read_b128 v[64:67], v5 offset:8192
  v_mfma_f32_16x16x32_bf16 v[236:239], v[24:27], a[4:7], v[236:239]
  ds_read_b128 v[68:71], v5 offset:9216
  v_mfma_f32_16x16x32_bf16 v[240:243], v[28:31], a[0:3], v[240:243]
  ds_read_b128 v[72:75], v5 offset:10240
  v_mfma_f32_16x16x32_bf16 v[244:247], v[28:31], a[4:7], v[244:247]
  ds_read_b128 v[76:79], v5 offset:11264
  s_waitcnt lgkmcnt(10)
  v_mfma_f32_16x16x32_bf16 v[224:227], v[32:35], a[8:11], v[224:227]
  ds_read_b128 v[16:19], v5 offset:12288
  v_mfma_f32_16x16x32_bf16 v[228:231], v[32:35], a[12:15], v[228:231]
  v_mfma_f32_16x16x32_bf16 v[232:235], v[36:39], a[8:11], v[232:235]
  ds_read_b128 v[20:23], v5 offset:13312
  v_mfma_f32_16x16x32_bf16 v[236:239], v[36:39], a[12:15], v[236:239]
  s_waitcnt lgkmcnt(10)
  v_mfma_f32_16x16x32_bf16 v[240:243], v[40:43], a[8:11], v[240:243]
  ds_read_b128 v[24:27], v5 offset:14336
  v_mfma_f32_16x16x32_bf16 v[244:247], v[40:43], a[12:15], v[244:247]
  v_mfma_f32_16x16x32_bf16 v[224:227], v[44:47], a[16:19], v[224:227]
  ds_read_b128 v[28:31], v5 offset:15360
  v_mfma_f32_16x16x32_bf16 v[228:231], v[44:47], a[20:23], v[228:231]
  s_waitcnt lgkmcnt(10)
  v_mfma_f32_16x16x32_bf16 v[232:235], v[48:51], a[16:19], v[232:235]
  ds_read_b128 v[32:35], v5 offset:16384
  v_mfma_f32_16x16x32_bf16 v[236:239], v[48:51], a[20:23], v[236:239]
  v_mfma_f32_16x16x32_bf16 v[240:243], v[52:55], a[16:19], v[240:243]
  ds_read_b128 v[36:39], v5 offset:17408
  v_mfma_f32_16x16x32_bf16 v[244:247], v[52:55], a[20:23], v[244:247]
  s_waitcnt lgkmcnt(10)
  v_mfma_f32_16x16x32_bf16 v[224:227], v[56:59], a[24:27], v[224:227]
  ds_read_b128 v[40:43], v5 offset:18432
  v_mfma_f32_16x16x32_bf16 v[228:231], v[56:59], a[28:31], v[228:231]
  s_waitcnt vmcnt(1)
  s_add_u32 s61, s88, 3
  v_mov_b32 v14, s61
  v_mov_b32 v15, s89
  s_mov_b64 exec, 1
  buffer_store_dwordx2 v[14:15], v10, s[28:31], s52 offen sc1
  s_mov_b64 exec, -1
  v_mfma_f32_16x16x32_bf16 v[232:235], v[60:63], a[24:27], v[232:235]
  ds_read_b128 v[44:47], v5 offset:19456
  v_mfma_f32_16x16x32_bf16 v[236:239], v[60:63], a[28:31], v[236:239]
  s_waitcnt lgkmcnt(10)
  v_mfma_f32_16x16x32_bf16 v[240:243], v[64:67], a[24:27], v[240:243]
  ds_read_b128 v[48:51], v5 offset:20480
  v_mfma_f32_16x16x32_bf16 v[244:247], v[64:67], a[28:31], v[244:247]
  v_mfma_f32_16x16x32_bf16 v[224:227], v[68:71], a[32:35], v[224:227]
  ds_read_b128 v[52:55], v5 offset:21504
  v_mfma_f32_16x16x32_bf16 v[228:231], v[68:71], a[36:39], v[228:231]
  s_waitcnt lgkmcnt(10)
  v_mfma_f32_16x16x32_bf16 v[232:235], v[72:75], a[32:35], v[232:235]
  ds_read_b128 v[56:59], v5 offset:22528
  v_mfma_f32_16x16x32_bf16 v[236:239], v[72:75], a[36:39], v[236:239]
  v_mfma_f32_16x16x32_bf16 v[240:243], v[76:79], a[32:35], v[240:243]
  ds_read_b128 v[60:63], v5 offset:23552
  v_mfma_f32_16x16x32_bf16 v[244:247], v[76:79], a[36:39], v[244:247]
  s_waitcnt lgkmcnt(10)
  v_mfma_f32_16x16x32_bf16 v[224:227], v[16:19], a[40:43], v[224:227]
  ds_read_b128 v[64:67], v5 offset:24576
  v_mfma_f32_16x16x32_bf16 v[228:231], v[16:19], a[44:47], v[228:231]
  v_mfma_f32_16x16x32_bf16 v[232:235], v[20:23], a[40:43], v[232:235]
  ds_read_b128 v[68:71], v5 offset:25600
  v_mfma_f32_16x16x32_bf16 v[236:239], v[20:23], a[44:47], v[236:239]
  s_waitcnt lgkmcnt(10)
  v_mfma_f32_16x16x32_bf16 v[240:243], v[24:27], a[40:43], v[240:243]
  ds_read_b128 v[72:75], v5 offset:26624
  v_mfma_f32_16x16x32_bf16 v[244:247], v[24:27], a[44:47], v[244:247]
  v_mfma_f32_16x16x32_bf16 v[224:227], v[28:31], a[48:51], v[224:227]
  ds_read_b128 v[76:79], v5 offset:27648
  v_mfma_f32_16x16x32_bf16 v[228:231], v[28:31], a[52:55], v[228:231]
  s_waitcnt lgkmcnt(10)
  v_mfma_f32_16x16x32_bf16 v[232:235], v[32:35], a[48:51], v[232:235]
  ds_read_b128 v[16:19], v5 offset:28672
  v_mfma_f32_16x16x32_bf16 v[236:239], v[32:35], a[52:55], v[236:239]
  v_mfma_f32_16x16x32_bf16 v[240:243], v[36:39], a[48:51], v[240:243]
  ds_read_b128 v[20:23], v5 offset:29696
  v_mfma_f32_16x16x32_bf16 v[244:247], v[36:39], a[52:55], v[244:247]
  s_waitcnt lgkmcnt(10)
  v_mfma_f32_16x16x32_bf16 v[224:227], v[40:43], a[56:59], v[224:227]
  ds_read_b128 v[24:27], v5 offset:30720
  v_mfma_f32_16x16x32_bf16 v[228:231], v[40:43], a[60:63], v[228:231]
  v_mfma_f32_16x16x32_bf16 v[232:235], v[44:47], a[56:59], v[232:235]
  ds_read_b128 v[28:31], v5 offset:31744
  v_mfma_f32_16x16x32_bf16 v[236:239], v[44:47], a[60:63], v[236:239]
  s_waitcnt lgkmcnt(10)
  v_mfma_f32_16x16x32_bf16 v[240:243], v[48:51], a[56:59], v[240:243]
  ds_read_b128 v[32:35], v5 offset:32768
  v_mfma_f32_16x16x32_bf16 v[244:247], v[48:51], a[60:63], v[244:247]
  v_mfma_f32_16x16x32_bf16 v[224:227], v[52:55], a[64:67], v[224:227]
  ds_read_b128 v[36:39], v5 offset:33792
  v_mfma_f32_16x16x32_bf16 v[228:231], v[52:55], a[68:71], v[228:231]
  s_waitcnt lgkmcnt(10)
  v_mfma_f32_16x16x32_bf16 v[232:235], v[56:59], a[64:67], v[232:235]
  ds_read_b128 v[40:43], v5 offset:34816
  v_mfma_f32_16x16x32_bf16 v[236:239], v[56:59], a[68:71], v[236:239]
  v_mfma_f32_16x16x32_bf16 v[240:243], v[60:63], a[64:67], v[240:243]
  ds_read_b128 v[44:47], v5 offset:35840
  v_mfma_f32_16x16x32_bf16 v[244:247], v[60:63], a[68:71], v[244:247]
  s_waitcnt lgkmcnt(10)
  v_mfma_f32_16x16x32_bf16 v[224:227], v[64:67], a[72:75], v[224:227]
  v_mfma_f32_16x16x32_bf16 v[228:231], v[64:67], a[76:79], v[228:231]
  v_mfma_f32_16x16x32_bf16 v[232:235], v[68:71], a[72:75], v[232:235]
  v_mfma_f32_16x16x32_bf16 v[236:239], v[68:71], a[76:79], v[236:239]
  s_waitcnt lgkmcnt(8)
  v_mfma_f32_16x16x32_bf16 v[240:243], v[72:75], a[72:75], v[240:243]
  v_mfma_f32_16x16x32_bf16 v[244:247], v[72:75], a[76:79], v[244:247]
  v_mfma_f32_16x16x32_bf16 v[224:227], v[76:79], a[80:83], v[224:227]
  v_mfma_f32_16x16x32_bf16 v[228:231], v[76:79], a[84:87], v[228:231]
  s_waitcnt lgkmcnt(6)
  v_mfma_f32_16x16x32_bf16 v[232:235], v[16:19], a[80:83], v[232:235]
  v_mfma_f32_16x16x32_bf16 v[236:239], v[16:19], a[84:87], v[236:239]
  v_mfma_f32_16x16x32_bf16 v[240:243], v[20:23], a[80:83], v[240:243]
  v_mfma_f32_16x16x32_bf16 v[244:247], v[20:23], a[84:87], v[244:247]
  s_waitcnt lgkmcnt(4)
  v_mfma_f32_16x16x32_bf16 v[224:227], v[24:27], a[88:91], v[224:227]
  v_mfma_f32_16x16x32_bf16 v[228:231], v[24:27], a[92:95], v[228:231]
  v_mfma_f32_16x16x32_bf16 v[232:235], v[28:31], a[88:91], v[232:235]
  v_mfma_f32_16x16x32_bf16 v[236:239], v[28:31], a[92:95], v[236:239]
  s_waitcnt lgkmcnt(2)
  v_mfma_f32_16x16x32_bf16 v[240:243], v[32:35], a[88:91], v[240:243]
  v_mfma_f32_16x16x32_bf16 v[244:247], v[32:35], a[92:95], v[244:247]
  v_mfma_f32_16x16x32_bf16 v[224:227], v[36:39], a[96:99], v[224:227]
  v_mfma_f32_16x16x32_bf16 v[228:231], v[36:39], a[100:103], v[228:231]
  s_waitcnt lgkmcnt(0)
  v_mfma_f32_16x16x32_bf16 v[232:235], v[40:43], a[96:99], v[232:235]
  v_mfma_f32_16x16x32_bf16 v[236:239], v[40:43], a[100:103], v[236:239]
  v_mfma_f32_16x16x32_bf16 v[240:243], v[44:47], a[96:99], v[240:243]
  v_mfma_f32_16x16x32_bf16 v[244:247], v[44:47], a[100:103], v[244:247]
  s_nop 7
  s_add_u32 s45, s50, 51200
  buffer_store_dwordx4 v[224:227], v3, s[28:31], s45 offen sc1
  s_add_u32 s45, s50, 55296
  buffer_store_dwordx4 v[228:231], v3, s[28:31], s45 offen sc1
  s_add_u32 s45, s50, 63488
  buffer_store_dwordx4 v[236:239], v3, s[28:31], s45 offen sc1
  s_add_u32 s45, s50, 67584
  buffer_store_dwordx4 v[240:243], v3, s[28:31], s45 offen sc1
  s_add_u32 s45, s50, 71680
  buffer_store_dwordx4 v[244:247], v3, s[28:31], s45 offen sc1
  buffer_load_dwordx2 v[12:13], v8, s[28:31], s49 offen offset:0 sc1
  s_waitcnt vmcnt(0)
  s_add_u32 s61, s88, 4
  v_mov_b32 v14, s61
  v_mov_b32 v15, s89
  s_mov_b64 exec, 1
  buffer_store_dwordx2 v[14:15], v10, s[28:31], s52 offen sc1
  s_mov_b64 exec, -1
  s_waitcnt vmcnt(1)
  s_mov_b32 s58, 0
  s_add_u32 s59, s88, 3
  s_mov_b64 s[60:61], -1
  v_subrev_u32 v14, s59, v12
  v_cmp_gt_u32 vcc, 13, v14
  v_cmp_eq_u32 s[62:63], s89, v13
  s_nop 1
  s_and_b64 vcc, vcc, s[62:63]
  s_and_b64 s[60:61], s[60:61], vcc
  s_cmp_eq_u64 s[60:61], -1
  s_cbranch_scc1 L_p3a_2_ok
  buffer_load_dwordx2 v[12:13], v8, s[28:31], s49 offen offset:0 sc1
  s_sleep 4
  buffer_load_dwordx2 v[250:251], v8, s[28:31], s49 offen offset:0 sc1
L_p3a_2_chk:
  s_waitcnt vmcnt(1)
  s_mov_b64 s[60:61], -1
  v_subrev_u32 v14, s59, v12
  v_cmp_gt_u32 vcc, 13, v14
  v_cmp_eq_u32 s[62:63], s89, v13
  s_nop 1
  s_and_b64 vcc, vcc, s[62:63]
  s_and_b64 s[60:61], s[60:61], vcc
  s_cmp_eq_u64 s[60:61], -1
  s_cbranch_scc1 L_p3a_2_ok
  buffer_load_dwordx2 v[12:13], v8, s[28:31], s49 offen offset:0 sc1
  s_waitcnt vmcnt(1)
  s_mov_b64 s[60:61], -1
  v_subrev_u32 v14, s59, v250
  v_cmp_gt_u32 vcc, 13, v14
  v_cmp_eq_u32 s[62:63], s89, v251
  s_nop 1
  s_and_b64 vcc, vcc, s[62:63]
  s_and_b64 s[60:61], s[60:61], vcc
  s_cmp_eq_u64 s[60:61], -1
  s_cbranch_scc1 L_p3a_2_ok
  buffer_load_dwordx2 v[250:251], v8, s[28:31], s49 offen offset:0 sc1
  s_add_u32 s58, s58, 1
  s_cmp_gt_u32 s58, 20000
  s_cbranch_scc0 L_p3a_2_chk
L_p3a_2_ok:
  s_add_u32 s45, s50, 8192
  buffer_load_dwordx4 v[80:83], v3, s[28:31], s45 offen sc1
  s_add_u32 s45, s50, 9216
  buffer_load_dwordx4 v[84:87], v3, s[28:31], s45 offen sc1
  s_add_u32 s45, s50, 11264
  buffer_load_dwordx4 v[88:91], v3, s[28:31], s45 offen sc1
  s_add_u32 s45, s57, 32
  buffer_load_dwordx2 v[92:93], v11, s[28:31], s45 offen sc1
  s_add_u32 s45, s50, 24576
  buffer_load_dwordx4 v[96:99], v3, s[28:31], s45 offen sc1
  s_add_u32 s45, s50, 25600
  buffer_load_dwordx4 v[100:103], v3, s[28:31], s45 offen sc1
  s_add_u32 s45, s50, 27648
  buffer_load_dwordx4 v[104:107], v3, s[28:31], s45 offen sc1
  s_add_u32 s45, s57, 96
  buffer_load_dwordx2 v[108:109], v11, s[28:31], s45 offen sc1
  s_add_u32 s45, s50, 40960
  buffer_load_dwordx4 v[112:115], v3, s[28:31], s45 offen sc1
  s_add_u32 s45, s50, 41984
  buffer_load_dwordx4 v[116:119], v3, s[28:31], s45 offen sc1
  s_add_u32 s45, s50, 44032
  buffer_load_dwordx4 v[120:123], v3, s[28:31], s45 offen sc1
  s_add_u32 s45, s57, 160
  buffer_load_dwordx2 v[124:125], v11, s[28:31], s45 offen sc1
  buffer_load_dwordx2 v[12:13], v8, s[28:31], s49 offen offset:0 sc1
  s_waitcnt vmcnt(0)
  s_mov_b32 s58, 0
  s_add_u32 s59, s88, 4
  s_mov_b64 s[60:61], -1
  v_subrev_u32 v14, s59, v12
  v_cmp_gt_u32 vcc, 12, v14
  v_cmp_eq_u32 s[62:63], s89, v13
  s_nop 1
  s_and_b64 vcc, vcc, s[62:63]
  s_and_b64 s[60:61], s[60:61], vcc
  s_cmp_eq_u64 s[60:61], -1
  s_cbranch_scc1 L_p3b_2_ok
  buffer_load_dwordx2 v[12:13], v8, s[28:31], s49 offen offset:0 sc1
  s_sleep 4
  buffer_load_dwordx2 v[250:251], v8, s[28:31], s49 offen offset:0 sc1
L_p3b_2_chk:
  s_waitcnt vmcnt(1)
  s_mov_b64 s[60:61], -1
  v_subrev_u32 v14, s59, v12
  v_cmp_gt_u32 vcc, 12, v14
  v_cmp_eq_u32 s[62:63], s89, v13
  s_nop 1
  s_and_b64 vcc, vcc, s[62:63]
  s_and_b64 s[60:61], s[60:61], vcc
  s_cmp_eq_u64 s[60:61], -1
  s_cbranch_scc1 L_p3b_2_ok
  buffer_load_dwordx2 v[12:13], v8, s[28:31], s49 offen offset:0 sc1
  s_waitcnt vmcnt(1)
  s_mov_b64 s[60:61], -1
  v_subrev_u32 v14, s59, v250
  v_cmp_gt_u32 vcc, 12, v14
  v_cmp_eq_u32 s[62:63], s89, v251
  s_nop 1
  s_and_b64 vcc, vcc, s[62:63]
  s_and_b64 s[60:61], s[60:61], vcc
  s_cmp_eq_u64 s[60:61], -1
  s_cbranch_scc1 L_p3b_2_ok
  buffer_load_dwordx2 v[250:251], v8, s[28:31], s49 offen offset:0 sc1
  s_add_u32 s58, s58, 1
  s_cmp_gt_u32 s58, 20000
  s_cbranch_scc0 L_p3b_2_chk
L_p3b_2_ok:
  s_add_u32 s45, s50, 57344
  buffer_load_dwordx4 v[16:19], v3, s[28:31], s45 offen sc1
  s_add_u32 s45, s50, 58368
  buffer_load_dwordx4 v[20:23], v3, s[28:31], s45 offen sc1
  s_add_u32 s45, s50, 60416
  buffer_load_dwordx4 v[24:27], v3, s[28:31], s45 offen sc1
  s_add_u32 s45, s57, 224
  buffer_load_dwordx2 v[28:29], v11, s[28:31], s45 offen sc1
  s_waitcnt vmcnt(13)
  v_pk_add_f32 v[80:81], v[80:81], v[84:85]
  v_pk_add_f32 v[82:83], v[82:83], v[86:87]
  v_pk_add_f32 v[80:81], v[80:81], v[160:161]
  v_pk_add_f32 v[82:83], v[82:83], v[162:163]
  v_pk_add_f32 v[80:81], v[80:81], v[88:89]
  v_pk_add_f32 v[82:83], v[82:83], v[90:91]
  v_cvt_pk_bf16_f32 v94, v80, v81
  v_lshlrev_b32 v80, 16, v94
  v_and_b32 v81, s43, v94
  v_lshlrev_b32 v84, 16, v92
  v_and_b32 v85, s43, v92
  v_pk_add_f32 v[80:81], v[80:81], v[84:85]
  v_cvt_pk_bf16_f32 v94, v82, v83
  v_lshlrev_b32 v82, 16, v94
  v_and_b32 v83, s43, v94
  v_lshlrev_b32 v86, 16, v93
  v_and_b32 v87, s43, v93
  v_pk_add_f32 v[82:83], v[82:83], v[86:87]
  v_cvt_pk_bf16_f32 v88, v80, v81
  v_cvt_pk_bf16_f32 v89, v82, v83
  s_add_u32 s45, s56, 32
  buffer_store_dwordx2 v[88:89], v11, s[20:23], s45 offen
  s_waitcnt vmcnt(10)
  v_pk_add_f32 v[96:97], v[96:97], v[100:101]
  v_pk_add_f32 v[98:99], v[98:99], v[102:103]
  v_pk_add_f32 v[96:97], v[96:97], v[176:177]
  v_pk_add_f32 v[98:99], v[98:99], v[178:179]
  v_pk_add_f32 v[96:97], v[96:97], v[104:105]
  v_pk_add_f32 v[98:99], v[98:99], v[106:107]
  v_cvt_pk_bf16_f32 v110, v96, v97
  v_lshlrev_b32 v96, 16, v110
  v_and_b32 v97, s43, v110
  v_lshlrev_b32 v100, 16, v108
  v_and_b32 v101, s43, v108
  v_pk_add_f32 v[96:97], v[96:97], v[100:101]
  v_cvt_pk_bf16_f32 v110, v98, v99
  v_lshlrev_b32 v98, 16, v110
  v_and_b32 v99, s43, v110
  v_lshlrev_b32 v102, 16, v109
  v_and_b32 v103, s43, v109
  v_pk_add_f32 v[98:99], v[98:99], v[102:103]
  v_cvt_pk_bf16_f32 v104, v96, v97
  v_cvt_pk_bf16_f32 v105, v98, v99
  s_add_u32 s45, s56, 96
  buffer_store_dwordx2 v[104:105], v11, s[20:23], s45 offen
  s_waitcnt vmcnt(7)
  v_pk_add_f32 v[112:113], v[112:113], v[116:117]
  v_pk_add_f32 v[114:115], v[114:115], v[118:119]
  v_pk_add_f32 v[112:113], v[112:113], v[192:193]
  v_pk_add_f32 v[114:115], v[114:115], v[194:195]
  v_pk_add_f32 v[112:113], v[112:113], v[120:121]
  v_pk_add_f32 v[114:115], v[114:115], v[122:123]
  v_cvt_pk_bf16_f32 v126, v112, v113
  v_lshlrev_b32 v112, 16, v126
  v_and_b32 v113, s43, v126
  v_lshlrev_b32 v116, 16, v124
  v_and_b32 v117, s43, v124
  v_pk_add_f32 v[112:113], v[112:113], v[116:117]
  v_cvt_pk_bf16_f32 v126, v114, v115
  v_lshlrev_b32 v114, 16, v126
  v_and_b32 v115, s43, v126
  v_lshlrev_b32 v118, 16, v125
  v_and_b32 v119, s43, v125
  v_pk_add_f32 v[114:115], v[114:115], v[118:119]
  v_cvt_pk_bf16_f32 v120, v112, v113
  v_cvt_pk_bf16_f32 v121, v114, v115
  s_add_u32 s45, s56, 160
  buffer_store_dwordx2 v[120:121], v11, s[20:23], s45 offen
  s_waitcnt vmcnt(3)
  v_pk_add_f32 v[16:17], v[16:17], v[20:21]
  v_pk_add_f32 v[18:19], v[18:19], v[22:23]
  v_pk_add_f32 v[16:17], v[16:17], v[232:233]
  v_pk_add_f32 v[18:19], v[18:19], v[234:235]
  v_pk_add_f32 v[16:17], v[16:17], v[24:25]
  v_pk_add_f32 v[18:19], v[18:19], v[26:27]
  v_cvt_pk_bf16_f32 v30, v16, v17
  v_lshlrev_b32 v16, 16, v30
  v_and_b32 v17, s43, v30
  v_lshlrev_b32 v20, 16, v28
  v_and_b32 v21, s43, v28
  v_pk_add_f32 v[16:17], v[16:17], v[20:21]
  v_cvt_pk_bf16_f32 v30, v18, v19
  v_lshlrev_b32 v18, 16, v30
  v_and_b32 v19, s43, v30
  v_lshlrev_b32 v22, 16, v29
  v_and_b32 v23, s43, v29
  v_pk_add_f32 v[18:19], v[18:19], v[22:23]
  v_cvt_pk_bf16_f32 v24, v16, v17
  v_cvt_pk_bf16_f32 v25, v18, v19
  s_add_u32 s45, s56, 224
  buffer_store_dwordx2 v[24:25], v11, s[20:23], s45 offen
  s_endpgm
L_v3:
  v_mfma_f32_16x16x32_bf16 v[168:171], v[48:51], a[88:91], v[168:171]
  ds_read_b128 v[76:79], v7 offset:3072
  v_mfma_f32_16x16x32_bf16 v[172:175], v[48:51], a[92:95], v[172:175]
  ds_read_b128 v[16:19], v7 offset:4096
  s_waitcnt vmcnt(12)
  v_mfma_f32_16x16x32_bf16 v[152:155], v[52:55], a[96:99], v[152:155]
  ds_read_b128 v[20:23], v7 offset:5120
  v_mfma_f32_16x16x32_bf16 v[156:159], v[52:55], a[100:103], v[156:159]
  buffer_load_dwordx4 v3, s[28:31], s44 offen offset:3072 sc1 lds
  v_mfma_f32_16x16x32_bf16 v[160:163], v[56:59], a[96:99], v[160:163]
  ds_read_b128 v[24:27], v7 offset:6144
  v_mfma_f32_16x16x32_bf16 v[164:167], v[56:59], a[100:103], v[164:167]
  ds_read_b128 v[28:31], v7 offset:7168
  v_mfma_f32_16x16x32_bf16 v[168:171], v[60:63], a[96:99], v[168:171]
  ds_read_b128 v[32:35], v7 offset:8192
  v_mfma_f32_16x16x32_bf16 v[172:175], v[60:63], a[100:103], v[172:175]
  ds_read_b128 v[36:39], v7 offset:9216
  s_waitcnt lgkmcnt(8)
  v_mfma_f32_16x16x32_bf16 v[176:179], v[64:67], a[32:35], v[176:179]
  ds_read_b128 v[40:43], v7 offset:10240
  v_mfma_f32_16x16x32_bf16 v[180:183], v[64:67], a[36:39], v[180:183]
  s_add_u32 m0, s40, 40960
  s_add_u32 s44, s42, 299008
  buffer_load_dwordx4 v3, s[28:31], s44 offen offset:0 sc1 lds
  v_mfma_f32_16x16x32_bf16 v[184:187], v[68:71], a[32:35], v[184:187]
  ds_read_b128 v[44:47], v7 offset:11264
  v_mfma_f32_16x16x32_bf16 v[188:191], v[68:71], a[36:39], v[188:191]
  ds_read_b128 v[48:51], v7 offset:12288
  s_waitcnt lgkmcnt(9)
  v_mfma_f32_16x16x32_bf16 v[192:195], v[72:75], a[32:35], v[192:195]
  ds_read_b128 v[52:55], v7 offset:13312
  v_mfma_f32_16x16x32_bf16 v[196:199], v[72:75], a[36:39], v[196:199]
  s_add_u32 s45, s50, 3072
  buffer_store_dwordx4 v[152:155], v3, s[28:31], s45 offen sc1
  v_mfma_f32_16x16x32_bf16 v[176:179], v[76:79], a[40:43], v[176:179]
  ds_read_b128 v[56:59], v7 offset:14336
  v_mfma_f32_16x16x32_bf16 v[180:183], v[76:79], a[44:47], v[180:183]
  ds_read_b128 v[60:63], v7 offset:15360
  s_waitcnt lgkmcnt(10)
  v_mfma_f32_16x16x32_bf16 v[184:187], v[16:19], a[40:43], v[184:187]
  ds_read_b128 v[64:67], v7 offset:16384
  v_mfma_f32_16x16x32_bf16 v[188:191], v[16:19], a[44:47], v[188:191]
  buffer_load_dwordx4 v3, s[28:31], s44 offen offset:1024 sc1 lds
  v_mfma_f32_16x16x32_bf16 v[192:195], v[20:23], a[40:43], v[192:195]
  ds_read_b128 v[68:71], v7 offset:17408
  v_mfma_f32_16x16x32_bf16 v[196:199], v[20:23], a[44:47], v[196:199]
  s_waitcnt lgkmcnt(10)
  v_mfma_f32_16x16x32_bf16 v[176:179], v[24:27], a[48:51], v[176:179]
  ds_read_b128 v[72:75], v7 offset:18432
  v_mfma_f32_16x16x32_bf16 v[180:183], v[24:27], a[52:55], v[180:183]
  buffer_load_dwordx4 v3, s[28:31], s44 offen offset:2048 sc1 lds
  v_mfma_f32_16x16x32_bf16 v[184:187], v[28:31], a[48:51], v[184:187]
  ds_read_b128 v[76:79], v7 offset:19456
  v_mfma_f32_16x16x32_bf16 v[188:191], v[28:31], a[52:55], v[188:191]
  s_waitcnt lgkmcnt(10)
  v_mfma_f32_16x16x32_bf16 v[192:195], v[32:35], a[48:51], v[192:195]
  ds_read_b128 v[16:19], v7 offset:20480
  v_mfma_f32_16x16x32_bf16 v[196:199], v[32:35], a[52:55], v[196:199]
  v_mfma_f32_16x16x32_bf16 v[176:179], v[36:39], a[56:59], v[176:179]
  ds_read_b128 v[20:23], v7 offset:21504
  v_mfma_f32_16x16x32_bf16 v[180:183], v[36:39], a[60:63], v[180:183]
  s_add_u32 s45, s50, 7168
  buffer_store_dwordx4 v[156:159], v3, s[28:31], s45 offen sc1
  s_waitcnt lgkmcnt(10)
  v_mfma_f32_16x16x32_bf16 v[184:187], v[40:43], a[56:59], v[184:187]
  ds_read_b128 v[24:27], v7 offset:22528
  v_mfma_f32_16x16x32_bf16 v[188:191], v[40:43], a[60:63], v[188:191]
  v_mfma_f32_16x16x32_bf16 v[192:195], v[44:47], a[56:59], v[192:195]
  ds_read_b128 v[28:31], v7 offset:23552
  v_mfma_f32_16x16x32_bf16 v[196:199], v[44:47], a[60:63], v[196:199]
  buffer_load_dwordx4 v3, s[28:31], s44 offen offset:3072 sc1 lds
  s_waitcnt lgkmcnt(10)
  v_mfma_f32_16x16x32_bf16 v[176:179], v[48:51], a[64:67], v[176:179]
  ds_read_b128 v[32:35], v7 offset:24576
  v_mfma_f32_16x16x32_bf16 v[180:183], v[48:51], a[68:71], v[180:183]
  v_mfma_f32_16x16x32_bf16 v[184:187], v[52:55], a[64:67], v[184:187]
  ds_read_b128 v[36:39], v7 offset:25600
  v_mfma_f32_16x16x32_bf16 v[188:191], v[52:55], a[68:71], v[188:191]
  s_add_u32 m0, s40, 45056
  s_add_u32 s44, s42, 303104
  buffer_load_dwordx4 v3, s[28:31], s44 offen offset:0 sc1 lds
  s_waitcnt lgkmcnt(10)
  v_mfma_f32_16x16x32_bf16 v[192:195], v[56:59], a[64:67], v[192:195]
  ds_read_b128 v[40:43], v7 offset:26624
  v_mfma_f32_16x16x32_bf16 v[196:199], v[56:59], a[68:71], v[196:199]
  v_mfma_f32_16x16x32_bf16 v[176:179], v[60:63], a[72:75], v[176:179]
  ds_read_b128 v[44:47], v7 offset:27648
  v_mfma_f32_16x16x32_bf16 v[180:183], v[60:63], a[76:79], v[180:183]
  s_add_u32 s45, s50, 11264
  buffer_store_dwordx4 v[160:163], v3, s[28:31], s45 offen sc1
  s_waitcnt lgkmcnt(10)
  v_mfma_f32_16x16x32_bf16 v[184:187], v[64:67], a[72:75], v[184:187]
  ds_read_b128 v[48:51], v7 offset:28672
  v_mfma_f32_16x16x32_bf16 v[188:191], v[64:67], a[76:79], v[188:191]
  v_mfma_f32_16x16x32_bf16 v[192:195], v[68:71], a[72:75], v[192:195]
  ds_read_b128 v[52:55], v7 offset:29696
  v_mfma_f32_16x16x32_bf16 v[196:199], v[68:71], a[76:79], v[196:199]
  s_waitcnt lgkmcnt(10)
  v_mfma_f32_16x16x32_bf16 v[176:179], v[72:75], a[80:83], v[176:179]
  ds_read_b128 v[56:59], v7 offset:30720
  v_mfma_f32_16x16x32_bf16 v[180:183], v[72:75], a[84:87], v[180:183]
  v_mfma_f32_16x16x32_bf16 v[184:187], v[76:79], a[80:83], v[184:187]
  ds_read_b128 v[60:63], v7 offset:31744
  v_mfma_f32_16x16x32_bf16 v[188:191], v[76:79], a[84:87], v[188:191]
  s_waitcnt lgkmcnt(10)
  v_mfma_f32_16x16x32_bf16 v[192:195], v[16:19], a[80:83], v[192:195]
  ds_read_b128 v[64:67], v7 offset:32768
  v_mfma_f32_16x16x32_bf16 v[196:199], v[16:19], a[84:87], v[196:199]
  s_add_u32 s45, s50, 19456
  buffer_store_dwordx4 v[168:171], v3, s[28:31], s45 offen sc1
  v_mfma_f32_16x16x32_bf16 v[176:179], v[20:23], a[88:91], v[176:179]
  ds_read_b128 v[68:71], v7 offset:33792
  v_mfma_f32_16x16x32_bf16 v[180:183], v[20:23], a[92:95], v[180:183]
  s_waitcnt lgkmcnt(10)
  v_mfma_f32_16x16x32_bf16 v[184:187], v[24:27], a[88:91], v[184:187]
  ds_read_b128 v[72:75], v7 offset:34816
  v_mfma_f32_16x16x32_bf16 v[188:191], v[24:27], a[92:95], v[188:191]
  v_mfma_f32_16x16x32_bf16 v[192:195], v[28:31], a[88:91], v[192:195]
  ds_read_b128 v[76:79], v7 offset:35840
  v_mfma_f32_16x16x32_bf16 v[196:199], v[28:31], a[92:95], v[196:199]
  s_waitcnt lgkmcnt(10)
  v_mfma_f32_16x16x32_bf16 v[176:179], v[32:35], a[96:99], v[176:179]
  v_mfma_f32_16x16x32_bf16 v[180:183], v[32:35], a[100:103], v[180:183]
  v_mfma_f32_16x16x32_bf16 v[184:187], v[36:39], a[96:99], v[184:187]
  v_mfma_f32_16x16x32_bf16 v[188:191], v[36:39], a[100:103], v[188:191]
  s_waitcnt lgkmcnt(8)
  v_mfma_f32_16x16x32_bf16 v[192:195], v[40:43], a[96:99], v[192:195]
  v_mfma_f32_16x16x32_bf16 v[196:199], v[40:43], a[100:103], v[196:199]
  v_mfma_f32_16x16x32_bf16 v[224:227], v[44:47], a[144:147], v[224:227]
  v_mfma_f32_16x16x32_bf16 v[228:231], v[44:47], a[148:151], v[228:231]
  s_add_u32 s45, s50, 23552
  buffer_store_dwordx4 v[172:175], v3, s[28:31], s45 offen sc1
  s_waitcnt lgkmcnt(6)
  v_mfma_f32_16x16x32_bf16 v[232:235], v[48:51], a[144:147], v[232:235]
  v_mfma_f32_16x16x32_bf16 v[236:239], v[48:51], a[148:151], v[236:239]
  v_mfma_f32_16x16x32_bf16 v[240:243], v[52:55], a[144:147], v[240:243]
  v_mfma_f32_16x16x32_bf16 v[244:247], v[52:55], a[148:151], v[244:247]
  s_waitcnt lgkmcnt(0)
  s_waitcnt vmcnt(14)
  s_barrier
  v_mfma_f32_16x16x32_bf16 v[224:227], v[56:59], a[152:155], v[224:227]
  ds_read_b128 v[16:19], v4 offset:0
  v_mfma_f32_16x16x32_bf16 v[228:231], v[56:59], a[156:159], v[228:231]
  ds_read_b128 v[20:23], v4 offset:1024
  v_mfma_f32_16x16x32_bf16 v[232:235], v[60:63], a[152:155], v[232:235]
  ds_read_b128 v[24:27], v4 offset:2048
  v_mfma_f32_16x16x32_bf16 v[236:239], v[60:63], a[156:159], v[236:239]
  ds_read_b128 v[28:31], v4 offset:3072
  v_mfma_f32_16x16x32_bf16 v[240:243], v[64:67], a[152:155], v[240:243]
  ds_read_b128 v[32:35], v4 offset:4096
  v_mfma_f32_16x16x32_bf16 v[244:247], v[64:67], a[156:159], v[244:247]
  ds_read_b128 v[36:39], v4 offset:5120
  v_mfma_f32_16x16x32_bf16 v[224:227], v[68:71], a[160:163], v[224:227]
  ds_read_b128 v[40:43], v4 offset:6144
  v_mfma_f32_16x16x32_bf16 v[228:231], v[68:71], a[164:167], v[228:231]
  s_add_u32 s45, s50, 27648
  buffer_store_dwordx4 v[176:179], v3, s[28:31], s45 offen sc1
  v_mfma_f32_16x16x32_bf16 v[232:235], v[72:75], a[160:163], v[232:235]
  ds_read_b128 v[44:47], v4 offset:7168
  v_mfma_f32_16x16x32_bf16 v[236:239], v[72:75], a[164:167], v[236:239]
  ds_read_b128 v[48:51], v4 offset:8192
  v_mfma_f32_16x16x32_bf16 v[240:243], v[76:79], a[160:163], v[240:243]
  ds_read_b128 v[52:55], v4 offset:9216
  v_mfma_f32_16x16x32_bf16 v[244:247], v[76:79], a[164:167], v[244:247]
  ds_read_b128 v[56:59], v4 offset:10240
  s_waitcnt lgkmcnt(9)
  v_mfma_f32_16x16x32_bf16 v[224:227], v[16:19], a[168:171], v[224:227]
  ds_read_b128 v[60:63], v4 offset:11264
  v_mfma_f32_16x16x32_bf16 v[228:231], v[16:19], a[172:175], v[228:231]
  ds_read_b128 v[64:67], v4 offset:12288
  v_mfma_f32_16x16x32_bf16 v[232:235], v[20:23], a[168:171], v[232:235]
  ds_read_b128 v[68:71], v4 offset:13312
  v_mfma_f32_16x16x32_bf16 v[236:239], v[20:23], a[172:175], v[236:239]
  s_waitcnt lgkmcnt(10)
  v_mfma_f32_16x16x32_bf16 v[240:243], v[24:27], a[168:171], v[240:243]
  ds_read_b128 v[72:75], v4 offset:14336
  v_mfma_f32_16x16x32_bf16 v[244:247], v[24:27], a[172:175], v[244:247]
  s_add_u32 s45, s50, 35840
  buffer_store_dwordx4 v[184:187], v3, s[28:31], s45 offen sc1
  v_mfma_f32_16x16x32_bf16 v[224:227], v[28:31], a[176:179], v[224:227]
  ds_read_b128 v[76:79], v4 offset:15360
  v_mfma_f32_16x16x32_bf16 v[228:231], v[28:31], a[180:183], v[228:231]
  s_waitcnt lgkmcnt(10)
  v_mfma_f32_16x16x32_bf16 v[232:235], v[32:35], a[176:179], v[232:235]
  ds_read_b128 v[16:19], v4 offset:16384
  v_mfma_f32_16x16x32_bf16 v[236:239], v[32:35], a[180:183], v[236:239]
  v_mfma_f32_16x16x32_bf16 v[240:243], v[36:39], a[176:179], v[240:243]
  ds_read_b128 v[20:23], v4 offset:17408
  v_mfma_f32_16x16x32_bf16 v[244:247], v[36:39], a[180:183], v[244:247]
  s_waitcnt lgkmcnt(10)
  v_mfma_f32_16x16x32_bf16 v[224:227], v[40:43], a[184:187], v[224:227]
  ds_read_b128 v[24:27], v4 offset:18432
  v_mfma_f32_16x16x32_bf16 v[228:231], v[40:43], a[188:191], v[228:231]
  v_mfma_f32_16x16x32_bf16 v[232:235], v[44:47], a[184:187], v[232:235]
  ds_read_b128 v[28:31], v4 offset:19456
  v_mfma_f32_16x16x32_bf16 v[236:239], v[44:47], a[188:191], v[236:239]
  s_waitcnt lgkmcnt(10)
  v_mfma_f32_16x16x32_bf16 v[240:243], v[48:51], a[184:187], v[240:243]
  ds_read_b128 v[32:35], v4 offset:20480
  v_mfma_f32_16x16x32_bf16 v[244:247], v[48:51], a[188:191], v[244:247]
  v_mfma_f32_16x16x32_bf16 v[224:227], v[52:55], a[192:195], v[224:227]
  ds_read_b128 v[36:39], v4 offset:21504
  v_mfma_f32_16x16x32_bf16 v[228:231], v[52:55], a[196:199], v[228:231]
  s_add_u32 s45, s50, 39936
  buffer_store_dwordx4 v[188:191], v3, s[28:31], s45 offen sc1
  s_waitcnt lgkmcnt(10)
  v_mfma_f32_16x16x32_bf16 v[232:235], v[56:59], a[192:195], v[232:235]
  ds_read_b128 v[40:43], v4 offset:22528
  v_mfma_f32_16x16x32_bf16 v[236:239], v[56:59], a[196:199], v[236:239]
  v_mfma_f32_16x16x32_bf16 v[240:243], v[60:63], a[192:195], v[240:243]
  ds_read_b128 v[44:47], v4 offset:23552
  v_mfma_f32_16x16x32_bf16 v[244:247], v[60:63], a[196:199], v[244:247]
  s_waitcnt lgkmcnt(10)
  v_mfma_f32_16x16x32_bf16 v[224:227], v[64:67], a[200:203], v[224:227]
  ds_read_b128 v[48:51], v4 offset:24576
  v_mfma_f32_16x16x32_bf16 v[228:231], v[64:67], a[204:207], v[228:231]
  v_mfma_f32_16x16x32_bf16 v[232:235], v[68:71], a[200:203], v[232:235]
  ds_read_b128 v[52:55], v4 offset:25600
  v_mfma_f32_16x16x32_bf16 v[236:239], v[68:71], a[204:207], v[236:239]
  s_waitcnt lgkmcnt(10)
  v_mfma_f32_16x16x32_bf16 v[240:243], v[72:75], a[200:203], v[240:243]
  ds_read_b128 v[56:59], v4 offset:26624
  v_mfma_f32_16x16x32_bf16 v[244:247], v[72:75], a[204:207], v[244:247]
  v_mfma_f32_16x16x32_bf16 v[224:227], v[76:79], a[208:211], v[224:227]
  ds_read_b128 v[60:63], v4 offset:27648
  v_mfma_f32_16x16x32_bf16 v[228:231], v[76:79], a[212:215], v[228:231]
  s_add_u32 s45, s50, 44032
  buffer_store_dwordx4 v[192:195], v3, s[28:31], s45 offen sc1
  s_waitcnt lgkmcnt(10)
  v_mfma_f32_16x16x32_bf16 v[232:235], v[16:19], a[208:211], v[232:235]
  ds_read_b128 v[64:67], v4 offset:28672
  v_mfma_f32_16x16x32_bf16 v[236:239], v[16:19], a[212:215], v[236:239]
  v_mfma_f32_16x16x32_bf16 v[240:243], v[20:23], a[208:211], v[240:243]
  ds_read_b128 v[68:71], v4 offset:29696
  v_mfma_f32_16x16x32_bf16 v[244:247], v[20:23], a[212:215], v[244:247]
  s_waitcnt lgkmcnt(10)
  v_mfma_f32_16x16x32_bf16 v[224:227], v[24:27], a[216:219], v[224:227]
  ds_read_b128 v[72:75], v4 offset:30720
  v_mfma_f32_16x16x32_bf16 v[228:231], v[24:27], a[220:223], v[228:231]
  s_waitcnt vmcnt(4)
  s_add_u32 s61, s88, 2
  v_mov_b32 v14, s61
  v_mov_b32 v15, s89
  s_mov_b64 exec, 1
  buffer_store_dwordx2 v[14:15], v10, s[28:31], s52 offen sc1
  s_mov_b64 exec, -1
  v_mfma_f32_16x16x32_bf16 v[232:235], v[28:31], a[216:219], v[232:235]
  ds_read_b128 v[76:79], v4 offset:31744
  v_mfma_f32_16x16x32_bf16 v[236:239], v[28:31], a[220:223], v[236:239]
  s_waitcnt lgkmcnt(10)
  v_mfma_f32_16x16x32_bf16 v[240:243], v[32:35], a[216:219], v[240:243]
  ds_read_b128 v[16:19], v4 offset:32768
  v_mfma_f32_16x16x32_bf16 v[244:247], v[32:35], a[220:223], v[244:247]
  v_mfma_f32_16x16x32_bf16 v[224:227], v[36:39], a[224:227], v[224:227]
  ds_read_b128 v[20:23], v4 offset:33792
  v_mfma_f32_16x16x32_bf16 v[228:231], v[36:39], a[228:231], v[228:231]
  s_waitcnt lgkmcnt(10)
  v_mfma_f32_16x16x32_bf16 v[232:235], v[40:43], a[224:227], v[232:235]
  ds_read_b128 v[24:27], v4 offset:34816
  v_mfma_f32_16x16x32_bf16 v[236:239], v[40:43], a[228:231], v[236:239]
  v_mfma_f32_16x16x32_bf16 v[240:243], v[44:47], a[224:227], v[240:243]
  ds_read_b128 v[28:31], v4 offset:35840
  v_mfma_f32_16x16x32_bf16 v[244:247], v[44:47], a[228:231], v[244:247]
  s_waitcnt lgkmcnt(10)
  v_mfma_f32_16x16x32_bf16 v[224:227], v[48:51], a[232:235], v[224:227]
  v_mfma_f32_16x16x32_bf16 v[228:231], v[48:51], a[236:239], v[228:231]
  v_mfma_f32_16x16x32_bf16 v[232:235], v[52:55], a[232:235], v[232:235]
  v_mfma_f32_16x16x32_bf16 v[236:239], v[52:55], a[236:239], v[236:239]
  s_waitcnt lgkmcnt(8)
  v_mfma_f32_16x16x32_bf16 v[240:243], v[56:59], a[232:235], v[240:243]
  v_mfma_f32_16x16x32_bf16 v[244:247], v[56:59], a[236:239], v[244:247]
  v_mfma_f32_16x16x32_bf16 v[224:227], v[60:63], a[240:243], v[224:227]
  v_mfma_f32_16x16x32_bf16 v[228:231], v[60:63], a[244:247], v[228:231]
  s_waitcnt lgkmcnt(6)
  v_mfma_f32_16x16x32_bf16 v[232:235], v[64:67], a[240:243], v[232:235]
  v_mfma_f32_16x16x32_bf16 v[236:239], v[64:67], a[244:247], v[236:239]
  v_mfma_f32_16x16x32_bf16 v[240:243], v[68:71], a[240:243], v[240:243]
  v_mfma_f32_16x16x32_bf16 v[244:247], v[68:71], a[244:247], v[244:247]
  s_waitcnt lgkmcnt(0)
  s_waitcnt vmcnt(8)
  s_barrier
  v_mfma_f32_16x16x32_bf16 v[224:227], v[72:75], a[248:251], v[224:227]
  ds_read_b128 v[32:35], v5 offset:0
  v_mfma_f32_16x16x32_bf16 v[228:231], v[72:75], a[252:255], v[228:231]
  ds_read_b128 v[36:39], v5 offset:1024
  v_mfma_f32_16x16x32_bf16 v[232:235], v[76:79], a[248:251], v[232:235]
  ds_read_b128 v[40:43], v5 offset:2048
  v_mfma_f32_16x16x32_bf16 v[236:239], v[76:79], a[252:255], v[236:239]
  ds_read_b128 v[44:47], v5 offset:3072
  v_mfma_f32_16x16x32_bf16 v[240:243], v[16:19], a[248:251], v[240:243]
  ds_read_b128 v[48:51], v5 offset:4096
  v_mfma_f32_16x16x32_bf16 v[244:247], v[16:19], a[252:255], v[244:247]
  ds_read_b128 v[52:55], v5 offset:5120
  v_mfma_f32_16x16x32_bf16 v[224:227], v[20:23], a[0:3], v[224:227]
  ds_read_b128 v[56:59], v5 offset:6144
  v_mfma_f32_16x16x32_bf16 v[228:231], v[20:23], a[4:7], v[228:231]
  ds_read_b128 v[60:63], v5 offset:7168
  v_mfma_f32_16x16x32_bf16 v[232:235], v[24:27], a[0:3], v[232:235]
  ds_read_b128 v[64:67], v5 offset:8192
  v_mfma_f32_16x16x32_bf16 v[236:239], v[24:27], a[4:7], v[236:239]
  ds_read_b128 v[68:71], v5 offset:9216
  v_mfma_f32_16x16x32_bf16 v[240:243], v[28:31], a[0:3], v[240:243]
  ds_read_b128 v[72:75], v5 offset:10240
  v_mfma_f32_16x16x32_bf16 v[244:247], v[28:31], a[4:7], v[244:247]
  ds_read_b128 v[76:79], v5 offset:11264
  s_waitcnt lgkmcnt(10)
  v_mfma_f32_16x16x32_bf16 v[224:227], v[32:35], a[8:11], v[224:227]
  ds_read_b128 v[16:19], v5 offset:12288
  v_mfma_f32_16x16x32_bf16 v[228:231], v[32:35], a[12:15], v[228:231]
  v_mfma_f32_16x16x32_bf16 v[232:235], v[36:39], a[8:11], v[232:235]
  ds_read_b128 v[20:23], v5 offset:13312
  v_mfma_f32_16x16x32_bf16 v[236:239], v[36:39], a[12:15], v[236:239]
  s_waitcnt lgkmcnt(10)
  v_mfma_f32_16x16x32_bf16 v[240:243], v[40:43], a[8:11], v[240:243]
  ds_read_b128 v[24:27], v5 offset:14336
  v_mfma_f32_16x16x32_bf16 v[244:247], v[40:43], a[12:15], v[244:247]
  v_mfma_f32_16x16x32_bf16 v[224:227], v[44:47], a[16:19], v[224:227]
  ds_read_b128 v[28:31], v5 offset:15360
  v_mfma_f32_16x16x32_bf16 v[228:231], v[44:47], a[20:23], v[228:231]
  s_waitcnt lgkmcnt(10)
  v_mfma_f32_16x16x32_bf16 v[232:235], v[48:51], a[16:19], v[232:235]
  ds_read_b128 v[32:35], v5 offset:16384
  v_mfma_f32_16x16x32_bf16 v[236:239], v[48:51], a[20:23], v[236:239]
  v_mfma_f32_16x16x32_bf16 v[240:243], v[52:55], a[16:19], v[240:243]
  ds_read_b128 v[36:39], v5 offset:17408
  v_mfma_f32_16x16x32_bf16 v[244:247], v[52:55], a[20:23], v[244:247]
  s_waitcnt lgkmcnt(10)
  v_mfma_f32_16x16x32_bf16 v[224:227], v[56:59], a[24:27], v[224:227]
  ds_read_b128 v[40:43], v5 offset:18432
  v_mfma_f32_16x16x32_bf16 v[228:231], v[56:59], a[28:31], v[228:231]
  s_waitcnt vmcnt(1)
  s_add_u32 s61, s88, 3
  v_mov_b32 v14, s61
  v_mov_b32 v15, s89
  s_mov_b64 exec, 1
  buffer_store_dwordx2 v[14:15], v10, s[28:31], s52 offen sc1
  s_mov_b64 exec, -1
  v_mfma_f32_16x16x32_bf16 v[232:235], v[60:63], a[24:27], v[232:235]
  ds_read_b128 v[44:47], v5 offset:19456
  v_mfma_f32_16x16x32_bf16 v[236:239], v[60:63], a[28:31], v[236:239]
  s_waitcnt lgkmcnt(10)
  v_mfma_f32_16x16x32_bf16 v[240:243], v[64:67], a[24:27], v[240:243]
  ds_read_b128 v[48:51], v5 offset:20480
  v_mfma_f32_16x16x32_bf16 v[244:247], v[64:67], a[28:31], v[244:247]
  v_mfma_f32_16x16x32_bf16 v[224:227], v[68:71], a[32:35], v[224:227]
  ds_read_b128 v[52:55], v5 offset:21504
  v_mfma_f32_16x16x32_bf16 v[228:231], v[68:71], a[36:39], v[228:231]
  s_waitcnt lgkmcnt(10)
  v_mfma_f32_16x16x32_bf16 v[232:235], v[72:75], a[32:35], v[232:235]
  ds_read_b128 v[56:59], v5 offset:22528
  v_mfma_f32_16x16x32_bf16 v[236:239], v[72:75], a[36:39], v[236:239]
  v_mfma_f32_16x16x32_bf16 v[240:243], v[76:79], a[32:35], v[240:243]
  ds_read_b128 v[60:63], v5 offset:23552
  v_mfma_f32_16x16x32_bf16 v[244:247], v[76:79], a[36:39], v[244:247]
  s_waitcnt lgkmcnt(10)
  v_mfma_f32_16x16x32_bf16 v[224:227], v[16:19], a[40:43], v[224:227]
  ds_read_b128 v[64:67], v5 offset:24576
  v_mfma_f32_16x16x32_bf16 v[228:231], v[16:19], a[44:47], v[228:231]
  v_mfma_f32_16x16x32_bf16 v[232:235], v[20:23], a[40:43], v[232:235]
  ds_read_b128 v[68:71], v5 offset:25600
  v_mfma_f32_16x16x32_bf16 v[236:239], v[20:23], a[44:47], v[236:239]
  s_waitcnt lgkmcnt(10)
  v_mfma_f32_16x16x32_bf16 v[240:243], v[24:27], a[40:43], v[240:243]
  ds_read_b128 v[72:75], v5 offset:26624
  v_mfma_f32_16x16x32_bf16 v[244:247], v[24:27], a[44:47], v[244:247]
  v_mfma_f32_16x16x32_bf16 v[224:227], v[28:31], a[48:51], v[224:227]
  ds_read_b128 v[76:79], v5 offset:27648
  v_mfma_f32_16x16x32_bf16 v[228:231], v[28:31], a[52:55], v[228:231]
  s_waitcnt lgkmcnt(10)
  v_mfma_f32_16x16x32_bf16 v[232:235], v[32:35], a[48:51], v[232:235]
  ds_read_b128 v[16:19], v5 offset:28672
  v_mfma_f32_16x16x32_bf16 v[236:239], v[32:35], a[52:55], v[236:239]
  v_mfma_f32_16x16x32_bf16 v[240:243], v[36:39], a[48:51], v[240:243]
  ds_read_b128 v[20:23], v5 offset:29696
  v_mfma_f32_16x16x32_bf16 v[244:247], v[36:39], a[52:55], v[244:247]
  s_waitcnt lgkmcnt(10)
  v_mfma_f32_16x16x32_bf16 v[224:227], v[40:43], a[56:59], v[224:227]
  ds_read_b128 v[24:27], v5 offset:30720
  v_mfma_f32_16x16x32_bf16 v[228:231], v[40:43], a[60:63], v[228:231]
  v_mfma_f32_16x16x32_bf16 v[232:235], v[44:47], a[56:59], v[232:235]
  ds_read_b128 v[28:31], v5 offset:31744
  v_mfma_f32_16x16x32_bf16 v[236:239], v[44:47], a[60:63], v[236:239]
  s_waitcnt lgkmcnt(10)
  v_mfma_f32_16x16x32_bf16 v[240:243], v[48:51], a[56:59], v[240:243]
  ds_read_b128 v[32:35], v5 offset:32768
  v_mfma_f32_16x16x32_bf16 v[244:247], v[48:51], a[60:63], v[244:247]
  v_mfma_f32_16x16x32_bf16 v[224:227], v[52:55], a[64:67], v[224:227]
  ds_read_b128 v[36:39], v5 offset:33792
  v_mfma_f32_16x16x32_bf16 v[228:231], v[52:55], a[68:71], v[228:231]
  s_waitcnt lgkmcnt(10)
  v_mfma_f32_16x16x32_bf16 v[232:235], v[56:59], a[64:67], v[232:235]
  ds_read_b128 v[40:43], v5 offset:34816
  v_mfma_f32_16x16x32_bf16 v[236:239], v[56:59], a[68:71], v[236:239]
  v_mfma_f32_16x16x32_bf16 v[240:243], v[60:63], a[64:67], v[240:243]
  ds_read_b128 v[44:47], v5 offset:35840
  v_mfma_f32_16x16x32_bf16 v[244:247], v[60:63], a[68:71], v[244:247]
  s_waitcnt lgkmcnt(10)
  v_mfma_f32_16x16x32_bf16 v[224:227], v[64:67], a[72:75], v[224:227]
  v_mfma_f32_16x16x32_bf16 v[228:231], v[64:67], a[76:79], v[228:231]
  v_mfma_f32_16x16x32_bf16 v[232:235], v[68:71], a[72:75], v[232:235]
  v_mfma_f32_16x16x32_bf16 v[236:239], v[68:71], a[76:79], v[236:239]
  s_waitcnt lgkmcnt(8)
  v_mfma_f32_16x16x32_bf16 v[240:243], v[72:75], a[72:75], v[240:243]
  v_mfma_f32_16x16x32_bf16 v[244:247], v[72:75], a[76:79], v[244:247]
  v_mfma_f32_16x16x32_bf16 v[224:227], v[76:79], a[80:83], v[224:227]
  v_mfma_f32_16x16x32_bf16 v[228:231], v[76:79], a[84:87], v[228:231]
  s_waitcnt lgkmcnt(6)
  v_mfma_f32_16x16x32_bf16 v[232:235], v[16:19], a[80:83], v[232:235]
  v_mfma_f32_16x16x32_bf16 v[236:239], v[16:19], a[84:87], v[236:239]
  v_mfma_f32_16x16x32_bf16 v[240:243], v[20:23], a[80:83], v[240:243]
  v_mfma_f32_16x16x32_bf16 v[244:247], v[20:23], a[84:87], v[244:247]
  s_waitcnt lgkmcnt(4)
  v_mfma_f32_16x16x32_bf16 v[224:227], v[24:27], a[88:91], v[224:227]
  v_mfma_f32_16x16x32_bf16 v[228:231], v[24:27], a[92:95], v[228:231]
  v_mfma_f32_16x16x32_bf16 v[232:235], v[28:31], a[88:91], v[232:235]
  v_mfma_f32_16x16x32_bf16 v[236:239], v[28:31], a[92:95], v[236:239]
  s_waitcnt lgkmcnt(2)
  v_mfma_f32_16x16x32_bf16 v[240:243], v[32:35], a[88:91], v[240:243]
  v_mfma_f32_16x16x32_bf16 v[244:247], v[32:35], a[92:95], v[244:247]
  v_mfma_f32_16x16x32_bf16 v[224:227], v[36:39], a[96:99], v[224:227]
  v_mfma_f32_16x16x32_bf16 v[228:231], v[36:39], a[100:103], v[228:231]
  s_waitcnt lgkmcnt(0)
  v_mfma_f32_16x16x32_bf16 v[232:235], v[40:43], a[96:99], v[232:235]
  v_mfma_f32_16x16x32_bf16 v[236:239], v[40:43], a[100:103], v[236:239]
  v_mfma_f32_16x16x32_bf16 v[240:243], v[44:47], a[96:99], v[240:243]
  v_mfma_f32_16x16x32_bf16 v[244:247], v[44:47], a[100:103], v[244:247]
  s_nop 7
  s_add_u32 s45, s50, 52224
  buffer_store_dwordx4 v[224:227], v3, s[28:31], s45 offen sc1
  s_add_u32 s45, s50, 56320
  buffer_store_dwordx4 v[228:231], v3, s[28:31], s45 offen sc1
  s_add_u32 s45, s50, 60416
  buffer_store_dwordx4 v[232:235], v3, s[28:31], s45 offen sc1
  s_add_u32 s45, s50, 68608
  buffer_store_dwordx4 v[240:243], v3, s[28:31], s45 offen sc1
  s_add_u32 s45, s50, 72704
  buffer_store_dwordx4 v[244:247], v3, s[28:31], s45 offen sc1
  buffer_load_dwordx2 v[12:13], v8, s[28:31], s49 offen offset:0 sc1
  s_waitcnt vmcnt(0)
  s_add_u32 s61, s88, 4
  v_mov_b32 v14, s61
  v_mov_b32 v15, s89
  s_mov_b64 exec, 1
  buffer_store_dwordx2 v[14:15], v10, s[28:31], s52 offen sc1
  s_mov_b64 exec, -1
  s_waitcnt vmcnt(1)
  s_mov_b32 s58, 0
  s_add_u32 s59, s88, 3
  s_mov_b64 s[60:61], -1
  v_subrev_u32 v14, s59, v12
  v_cmp_gt_u32 vcc, 13, v14
  v_cmp_eq_u32 s[62:63], s89, v13
  s_nop 1
  s_and_b64 vcc, vcc, s[62:63]
  s_and_b64 s[60:61], s[60:61], vcc
  s_cmp_eq_u64 s[60:61], -1
  s_cbranch_scc1 L_p3a_3_ok
  buffer_load_dwordx2 v[12:13], v8, s[28:31], s49 offen offset:0 sc1
  s_sleep 4
  buffer_load_dwordx2 v[250:251], v8, s[28:31], s49 offen offset:0 sc1
L_p3a_3_chk:
  s_waitcnt vmcnt(1)
  s_mov_b64 s[60:61], -1
  v_subrev_u32 v14, s59, v12
  v_cmp_gt_u32 vcc, 13, v14
  v_cmp_eq_u32 s[62:63], s89, v13
  s_nop 1
  s_and_b64 vcc, vcc, s[62:63]
  s_and_b64 s[60:61], s[60:61], vcc
  s_cmp_eq_u64 s[60:61], -1
  s_cbranch_scc1 L_p3a_3_ok
  buffer_load_dwordx2 v[12:13], v8, s[28:31], s49 offen offset:0 sc1
  s_waitcnt vmcnt(1)
  s_mov_b64 s[60:61], -1
  v_subrev_u32 v14, s59, v250
  v_cmp_gt_u32 vcc, 13, v14
  v_cmp_eq_u32 s[62:63], s89, v251
  s_nop 1
  s_and_b64 vcc, vcc, s[62:63]
  s_and_b64 s[60:61], s[60:61], vcc
  s_cmp_eq_u64 s[60:61], -1
  s_cbranch_scc1 L_p3a_3_ok
  buffer_load_dwordx2 v[250:251], v8, s[28:31], s49 offen offset:0 sc1
  s_add_u32 s58, s58, 1
  s_cmp_gt_u32 s58, 20000
  s_cbranch_scc0 L_p3a_3_chk
L_p3a_3_ok:
  s_add_u32 s45, s50, 12288
  buffer_load_dwordx4 v[80:83], v3, s[28:31], s45 offen sc1
  s_add_u32 s45, s50, 13312
  buffer_load_dwordx4 v[84:87], v3, s[28:31], s45 offen sc1
  s_add_u32 s45, s50, 14336
  buffer_load_dwordx4 v[88:91], v3, s[28:31], s45 offen sc1
  s_add_u32 s45, s57, 18464
  buffer_load_dwordx2 v[92:93], v11, s[28:31], s45 offen sc1
  s_add_u32 s45, s50, 28672
  buffer_load_dwordx4 v[96:99], v3, s[28:31], s45 offen sc1
  s_add_u32 s45, s50, 29696
  buffer_load_dwordx4 v[100:103], v3, s[28:31], s45 offen sc1
  s_add_u32 s45, s50, 30720
  buffer_load_dwordx4 v[104:107], v3, s[28:31], s45 offen sc1
  s_add_u32 s45, s57, 18528
  buffer_load_dwordx2 v[108:109], v11, s[28:31], s45 offen sc1
  s_add_u32 s45, s50, 45056
  buffer_load_dwordx4 v[112:115], v3, s[28:31], s45 offen sc1
  s_add_u32 s45, s50, 46080
  buffer_load_dwordx4 v[116:119], v3, s[28:31], s45 offen sc1
  s_add_u32 s45, s50, 47104
  buffer_load_dwordx4 v[120:123], v3, s[28:31], s45 offen sc1
  s_add_u32 s45, s57, 18592
  buffer_load_dwordx2 v[124:125], v11, s[28:31], s45 offen sc1
  buffer_load_dwordx2 v[12:13], v8, s[28:31], s49 offen offset:0 sc1
  s_waitcnt vmcnt(0)
  s_mov_b32 s58, 0
  s_add_u32 s59, s88, 4
  s_mov_b64 s[60:61], -1
  v_subrev_u32 v14, s59, v12
  v_cmp_gt_u32 vcc, 12, v14
  v_cmp_eq_u32 s[62:63], s89, v13
  s_nop 1
  s_and_b64 vcc, vcc, s[62:63]
  s_and_b64 s[60:61], s[60:61], vcc
  s_cmp_eq_u64 s[60:61], -1
  s_cbranch_scc1 L_p3b_3_ok
  buffer_load_dwordx2 v[12:13], v8, s[28:31], s49 offen offset:0 sc1
  s_sleep 4
  buffer_load_dwordx2 v[250:251], v8, s[28:31], s49 offen offset:0 sc1
L_p3b_3_chk:
  s_waitcnt vmcnt(1)
  s_mov_b64 s[60:61], -1
  v_subrev_u32 v14, s59, v12
  v_cmp_gt_u32 vcc, 12, v14
  v_cmp_eq_u32 s[62:63], s89, v13
  s_nop 1
  s_and_b64 vcc, vcc, s[62:63]
  s_and_b64 s[60:61], s[60:61], vcc
  s_cmp_eq_u64 s[60:61], -1
  s_cbranch_scc1 L_p3b_3_ok
  buffer_load_dwordx2 v[12:13], v8, s[28:31], s49 offen offset:0 sc1
  s_waitcnt vmcnt(1)
  s_mov_b64 s[60:61], -1
  v_subrev_u32 v14, s59, v250
  v_cmp_gt_u32 vcc, 12, v14
  v_cmp_eq_u32 s[62:63], s89, v251
  s_nop 1
  s_and_b64 vcc, vcc, s[62:63]
  s_and_b64 s[60:61], s[60:61], vcc
  s_cmp_eq_u64 s[60:61], -1
  s_cbranch_scc1 L_p3b_3_ok
  buffer_load_dwordx2 v[250:251], v8, s[28:31], s49 offen offset:0 sc1
  s_add_u32 s58, s58, 1
  s_cmp_gt_u32 s58, 20000
  s_cbranch_scc0 L_p3b_3_chk
L_p3b_3_ok:
  s_add_u32 s45, s50, 61440
  buffer_load_dwordx4 v[16:19], v3, s[28:31], s45 offen sc1
  s_add_u32 s45, s50, 62464
  buffer_load_dwordx4 v[20:23], v3, s[28:31], s45 offen sc1
  s_add_u32 s45, s50, 63488
  buffer_load_dwordx4 v[24:27], v3, s[28:31], s45 offen sc1
  s_add_u32 s45, s57, 18656
  buffer_load_dwordx2 v[28:29], v11, s[28:31], s45 offen sc1
  s_waitcnt vmcnt(13)
  v_pk_add_f32 v[80:81], v[80:81], v[84:85]
  v_pk_add_f32 v[82:83], v[82:83], v[86:87]
  v_pk_add_f32 v[80:81], v[80:81], v[88:89]
  v_pk_add_f32 v[82:83], v[82:83], v[90:91]
  v_pk_add_f32 v[80:81], v[80:81], v[164:165]
  v_pk_add_f32 v[82:83], v[82:83], v[166:167]
  v_cvt_pk_bf16_f32 v94, v80, v81
  v_lshlrev_b32 v80, 16, v94
  v_and_b32 v81, s43, v94
  v_lshlrev_b32 v84, 16, v92
  v_and_b32 v85, s43, v92
  v_pk_add_f32 v[80:81], v[80:81], v[84:85]
  v_cvt_pk_bf16_f32 v94, v82, v83
  v_lshlrev_b32 v82, 16, v94
  v_and_b32 v83, s43, v94
  v_lshlrev_b32 v86, 16, v93
  v_and_b32 v87, s43, v93
  v_pk_add_f32 v[82:83], v[82:83], v[86:87]
  v_cvt_pk_bf16_f32 v88, v80, v81
  v_cvt_pk_bf16_f32 v89, v82, v83
  s_add_u32 s45, s56, 18464
  buffer_store_dwordx2 v[88:89], v11, s[20:23], s45 offen
  s_waitcnt vmcnt(10)
  v_pk_add_f32 v[96:97], v[96:97], v[100:101]
  v_pk_add_f32 v[98:99], v[98:99], v[102:103]
  v_pk_add_f32 v[96:97], v[96:97], v[104:105]
  v_pk_add_f32 v[98:99], v[98:99], v[106:107]
  v_pk_add_f32 v[96:97], v[96:97], v[180:181]
  v_pk_add_f32 v[98:99], v[98:99], v[182:183]
  v_cvt_pk_bf16_f32 v110, v96, v97
  v_lshlrev_b32 v96, 16, v110
  v_and_b32 v97, s43, v110
  v_lshlrev_b32 v100, 16, v108
  v_and_b32 v101, s43, v108
  v_pk_add_f32 v[96:97], v[96:97], v[100:101]
  v_cvt_pk_bf16_f32 v110, v98, v99
  v_lshlrev_b32 v98, 16, v110
  v_and_b32 v99, s43, v110
  v_lshlrev_b32 v102, 16, v109
  v_and_b32 v103, s43, v109
  v_pk_add_f32 v[98:99], v[98:99], v[102:103]
  v_cvt_pk_bf16_f32 v104, v96, v97
  v_cvt_pk_bf16_f32 v105, v98, v99
  s_add_u32 s45, s56, 18528
  buffer_store_dwordx2 v[104:105], v11, s[20:23], s45 offen
  s_waitcnt vmcnt(7)
  v_pk_add_f32 v[112:113], v[112:113], v[116:117]
  v_pk_add_f32 v[114:115], v[114:115], v[118:119]
  v_pk_add_f32 v[112:113], v[112:113], v[120:121]
  v_pk_add_f32 v[114:115], v[114:115], v[122:123]
  v_pk_add_f32 v[112:113], v[112:113], v[196:197]
  v_pk_add_f32 v[114:115], v[114:115], v[198:199]
  v_cvt_pk_bf16_f32 v126, v112, v113
  v_lshlrev_b32 v112, 16, v126
  v_and_b32 v113, s43, v126
  v_lshlrev_b32 v116, 16, v124
  v_and_b32 v117, s43, v124
  v_pk_add_f32 v[112:113], v[112:113], v[116:117]
  v_cvt_pk_bf16_f32 v126, v114, v115
  v_lshlrev_b32 v114, 16, v126
  v_and_b32 v115, s43, v126
  v_lshlrev_b32 v118, 16, v125
  v_and_b32 v119, s43, v125
  v_pk_add_f32 v[114:115], v[114:115], v[118:119]
  v_cvt_pk_bf16_f32 v120, v112, v113
  v_cvt_pk_bf16_f32 v121, v114, v115
  s_add_u32 s45, s56, 18592
  buffer_store_dwordx2 v[120:121], v11, s[20:23], s45 offen
  s_waitcnt vmcnt(3)
  v_pk_add_f32 v[16:17], v[16:17], v[20:21]
  v_pk_add_f32 v[18:19], v[18:19], v[22:23]
  v_pk_add_f32 v[16:17], v[16:17], v[24:25]
  v_pk_add_f32 v[18:19], v[18:19], v[26:27]
  v_pk_add_f32 v[16:17], v[16:17], v[236:237]
  v_pk_add_f32 v[18:19], v[18:19], v[238:239]
  v_cvt_pk_bf16_f32 v30, v16, v17
  v_lshlrev_b32 v16, 16, v30
  v_and_b32 v17, s43, v30
  v_lshlrev_b32 v20, 16, v28
  v_and_b32 v21, s43, v28
  v_pk_add_f32 v[16:17], v[16:17], v[20:21]
  v_cvt_pk_bf16_f32 v30, v18, v19
  v_lshlrev_b32 v18, 16, v30
  v_and_b32 v19, s43, v30
  v_lshlrev_b32 v22, 16, v29
  v_and_b32 v23, s43, v29
  v_pk_add_f32 v[18:19], v[18:19], v[22:23]
  v_cvt_pk_bf16_f32 v24, v16, v17
  v_cvt_pk_bf16_f32 v25, v18, v19
  s_add_u32 s45, s56, 18656
  buffer_store_dwordx2 v[24:25], v11, s[20:23], s45 offen
  s_endpgm
L_end:
  s_endpgm
.section .rodata,"a"
.p2align 6
.amdhsa_kernel sequential_preLN__ssm_conv_h3__dense_activation_relu__prompt_kernel
  .amdhsa_next_free_vgpr 512
  .amdhsa_next_free_sgpr 102
  .amdhsa_accum_offset 256
  .amdhsa_group_segment_fixed_size 0
  .amdhsa_kernarg_size 96
  .amdhsa_user_sgpr_count 2
  .amdhsa_user_sgpr_kernarg_segment_ptr 1
  .amdhsa_system_sgpr_workgroup_id_x 1
.end_amdhsa_kernel
```
